```python
import torch

def _softmax(x, axis=-1):
    return torch.softmax(x, dim=axis)

def _gelu(x):
    return torch.nn.functional.gelu(x, approximate='tanh')

def _silu(x):
    return torch.nn.functional.silu(x)

def _sigmoid(x):
    return torch.sigmoid(x)

def _layernorm(x, axis=-1, eps=1e-05):
    m = x.mean(dim=axis, keepdim=True)
    v = x.var(dim=axis, keepdim=True, unbiased=False)
    return (x - m) / torch.sqrt(v + eps)

def _scatter_add(tgt, idx, src, axis=0):
    return tgt.clone().index_add_(axis, idx, src)

def _segment_sum(src, seg, n):
    out = torch.zeros((n,) + src.shape[1:], dtype=src.dtype)
    return out.index_add_(0, seg, src)

def _pad(x, pw):
    flat = tuple((v for pair in reversed(pw) for v in pair))
    return torch.nn.functional.pad(x, flat)
kernel_name = 'gated_mix__memory_aug_recurrent_mem_tr__mixer_channel_mlp__prompt'

def setup_inputs():

    _w = lambda a: (lambda t: t.to(torch.bfloat16) if t.is_floating_point() else t)(torch.as_tensor(a))

    def _A_setup():
        B, S, Dm = (1, 2048, 448)
        H, Dh = (16, 256)
        M, seg = (8, 32)
        seg = min(seg, S)
        S = S // seg * seg
        return {'x': _w((lambda *s: torch.randn(*s, dtype=torch.bfloat16) * 0.05)(B, S, Dm)), 'mem0': _w((lambda *s: torch.randn(*s, dtype=torch.bfloat16) * 0.8)(B, M, Dm)), 'Wq': _w((lambda *s: torch.randn(*s, dtype=torch.bfloat16) * 1.6)(Dm, H, Dh) * Dm ** (-0.5)), 'Wk': _w((lambda *s: torch.randn(*s, dtype=torch.bfloat16) * 1.6)(Dm, H, Dh) * Dm ** (-0.5)), 'Wv': _w((lambda *s: torch.randn(*s, dtype=torch.bfloat16) * 0.8)(Dm, H, Dh) * Dm ** (-0.5)), 'Wo': _w((lambda *s: torch.randn(*s, dtype=torch.bfloat16) * 0.8)(H, Dh, Dm) * (H * Dh) ** (-0.5)), 'seg_len': seg}
    _A_in = _A_setup()

    def _B_setup():
        B, S, D, F = (1, 2048, 448, 1792)
        return {'x': _w((lambda *s: torch.randn(*s, dtype=torch.bfloat16) * 0.05)(B, S, D)), 'w1': _w((lambda *s: torch.randn(*s, dtype=torch.bfloat16) * 1.6)(D, F) * D ** (-0.5)), 'b1': _w((lambda *s: torch.randn(*s, dtype=torch.bfloat16) * 0.4)(F)), 'w2': _w((lambda *s: torch.randn(*s, dtype=torch.bfloat16) * 0.05)(F, D) * F ** (-0.5)), 'b2': _w((lambda *s: torch.randn(*s, dtype=torch.bfloat16) * 0.05)(D))}
    _B_in = _B_setup()
    return {'A_x': _A_in['x'], 'A_mem0': _A_in['mem0'], 'A_Wq': _A_in['Wq'], 'A_Wk': _A_in['Wk'], 'A_Wv': _A_in['Wv'], 'A_Wo': _A_in['Wo'], 'A_seg_len': _A_in['seg_len'], 'B_x': _B_in['x'], 'B_w1': _B_in['w1'], 'B_b1': _B_in['b1'], 'B_w2': _B_in['w2'], 'B_b2': _B_in['b2'], 'gate_w': _w((lambda *s: torch.randn(*s, dtype=torch.bfloat16) * 0.05)(448) * 16.0)}

def reference(A_x, A_mem0, A_Wq, A_Wk, A_Wv, A_Wo, A_seg_len, B_x, B_w1, B_b1, B_w2, B_b2, gate_w):

    def _A_ref(x, mem0, Wq, Wk, Wv, Wo, seg_len):
        B, S, Dm = x.shape
        H, Dh = (Wq.shape[1], Wq.shape[2])
        M = mem0.shape[1]
        scale = Dh ** (-0.5)
        n_seg = S // seg_len
        L = M + seg_len
        idx = torch.arange(L)
        mask = (idx[:, None] < M) | (idx[:, None] >= idx[None, :])
        mem = mem0
        outs = []
        for s in range(n_seg):
            xs = x[:, s * seg_len:(s + 1) * seg_len, :].clone()
            h = torch.concatenate([mem, xs], axis=1)
            q = torch.einsum('btd,dhe->bhte', h, Wq)
            k = torch.einsum('btd,dhe->bhte', h, Wk)
            v = torch.einsum('btd,dhe->bhte', h, Wv)
            scores = torch.einsum('bhqe,bhke->bhqk', q, k) * scale
            scores = torch.where(mask[None, None], scores, -1000000000.0)
            p = _softmax(scores, axis=-1)
            o = torch.einsum('bhqk,bhke->bhqe', p, v)
            o = torch.einsum('bhte,hed->btd', o, Wo)
            mem = o[:, :M, :].clone()
            outs.append(o[:, M:, :])
        return torch.concatenate(outs, axis=1)

    def _B_ref(x, w1, b1, w2, b2):
        y = _layernorm(x, axis=-1)
        h = _gelu(torch.einsum('bsd,df->bsf', y, w1) + b1)
        return torch.einsum('bsf,fd->bsd', h, w2) + b2
    x = A_x
    g = _sigmoid((x * gate_w).sum(-1, keepdims=True))
    a = _A_ref(x, A_mem0, A_Wq, A_Wk, A_Wv, A_Wo, A_seg_len)
    b = _B_ref(x, B_w1, B_b1, B_w2, B_b2)
    return g * a + (1 - g) * b
```

```asm
; @launch grid=(256,1,1) block=(256,1,1) lds=163840
.amdgcn_target "amdgcn-amd-amdhsa--gfx950"
.text
.globl gated_mix__memory_aug_recurrent_mem_tr__mixer_channel_mlp__prompt_kernel
.p2align 8
.type gated_mix__memory_aug_recurrent_mem_tr__mixer_channel_mlp__prompt_kernel,@function
gated_mix__memory_aug_recurrent_mem_tr__mixer_channel_mlp__prompt_kernel:
s_cmp_ge_u32 s2,256
s_cbranch_scc1 L_exit
s_load_dwordx16 s[64:79],s[0:1],0
s_load_dwordx16 s[80:95],s[0:1],64
s_getreg_b32 s96, hwreg(HW_REG_XCC_ID, 0, 4)
v_lshrrev_b32 v1,6,v0
s_nop 0
v_readfirstlane_b32 s24,v1
s_mov_b32 s38,0
s_mov_b32 s61,0
s_mov_b32 s26,0
s_mov_b32 s29,0
s_getpc_b64 s[4:5]
s_and_b32 s4,s4,0xffffff00
s_mov_b32 s6,L_codeend-gated_mix__memory_aug_recurrent_mem_tr__mixer_channel_mlp__prompt_kernel
s_mov_b32 s7,0x20000
s_lshr_b32 s30,s2,3
v_and_b32 v2,63,v0
v_lshlrev_b32 v2,5,v2
v_add_u32 v2,s30,v2
v_lshlrev_b32 v2,7,v2
s_cmp_lg_u32 s24,3
s_cbranch_scc1 L_nocpf
buffer_load_dword v255,v2,s[4:7],0 offen
L_nocpf:
s_xor_b32 s96,s96,3
v_mov_b32 v199,0
v_mov_b32 v207,1
s_waitcnt lgkmcnt(0)
s_mov_b32 s16,s92
s_mov_b32 s17,s93
s_mov_b32 s18,256
s_mov_b32 s19,0x20000
s_cmp_lg_u32 s24,0
s_cbranch_scc1 L_norank
s_lshl_b32 s30,s96,5
s_lshr_b32 s31,s30,4
s_and_b32 s31,s31,16
s_and_b32 s30,s30,0xe0
s_or_b32 s30,s30,s31
s_mov_b64 exec,1
buffer_atomic_add v207,v199,s[16:19],s30 offen sc0
s_mov_b64 exec,-1
L_norank:
s_mov_b32 s20,s64
s_mov_b32 s21,s65
s_mov_b32 s22,1835008
s_mov_b32 s23,0x20000
s_mov_b32 s4,s64
s_mov_b32 s5,s65
s_mov_b32 s6,1835008
s_mov_b32 s7,0x20000
s_sub_u32 s30,s96,1
s_cmp_ge_u32 s30,7
s_cbranch_scc1 ft_1
s_lshl_b32 s30,s30,5
s_lshr_b32 s31,s2,3
s_add_u32 s31,s31,s30
s_mul_i32 s97,s31,9363
s_lshr_b32 s97,s97,16
s_mul_i32 s62,s97,7
s_sub_u32 s99,s31,s62
s_lshr_b32 s98,s97,1
s_and_b32 s97,s97,1
s_lshl_b32 s97,s97,4
s_add_u32 s97,s97,s98
s_add_u32 s32,s62,6
s_xor_b32 s62,s62,s32
s_cmp_ge_u32 s97,16
s_cselect_b32 s20,s72,s68
s_cselect_b32 s21,s73,s69
s_cselect_b32 s4,s74,s70
s_cselect_b32 s5,s75,s71
s_mov_b32 s22,3670016
s_mov_b32 s6,3670016
s_mov_b32 s23,0x20000
s_mov_b32 s7,0x20000
v_lshrrev_b32 v208,2,v0
v_lshlrev_b32 v208,13,v208
v_and_b32 v209,3,v0
v_lshl_add_u32 v208,v209,7,v208
v_mul_u32_u24 v209,896,v0
s_lshl_b32 s100,s98,9
s_lshl_b32 s56,s99,19
s_add_u32 s56,s56,s100
s_mul_i32 s57,s98,229376
s_lshl_b32 s58,s99,7
s_add_u32 s57,s57,s58
s_cmp_ge_u32 s97,16
s_cselect_b32 s56,s57,s56
s_cselect_b64 vcc,-1,0
v_cndmask_b32 v209,v208,v209,vcc
buffer_load_dword v255,v209,s[4:7],s56 offen nt
s_mul_i32 s56,s99,74
v_min_u32 v208,73,v0
v_add_u32 v208,s56,v208
v_min_u32 v208,511,v208
v_lshrrev_b32 v209,8,v208
v_mul_u32_u24 v209,640,v209
v_add_u32 v208,v208,v209
v_lshrrev_b32 v209,2,v208
v_lshlrev_b32 v209,13,v209
v_and_b32 v208,3,v208
v_lshl_add_u32 v208,v208,7,v209
s_cmp_ge_u32 s62,32
s_cbranch_scc1 ftl_2
buffer_load_dword v255,v208,s[20:23],s100 offen nt
s_branch ft_1
ftl_2:
buffer_load_dword v255,v208,s[20:23],s100 offen
ft_1:
s_mov_b32 s12,s64
s_mov_b32 s13,s65
s_mov_b32 s14,1835008
s_mov_b32 s15,0x20000
s_mov_b32 s8,s94
s_mov_b32 s9,s95
s_mov_b32 s10,268435456
s_mov_b32 s11,0x20000
v_mbcnt_lo_u32_b32 v208,-1,0
v_mbcnt_hi_u32_b32 v208,-1,v208
v_lshlrev_b32 v192,4,v208
v_add_u32 v193,57344,v192
s_mul_i32 s30,s24,7168
v_add_u32 v194,s30,v192
v_lshlrev_b32 v198,2,v208
v_mov_b32 v199,0
v_lshrrev_b32 v209,4,v208
v_xor_b32 v209,v209,v208
v_and_b32 v209,3,v209
v_lshlrev_b32 v209,4,v209
v_lshrrev_b32 v210,2,v208
v_mul_u32_u24 v195,896,v210
v_add_u32 v195,v195,v209
v_lshrrev_b32 v211,5,v208
v_bfe_u32 v212,v208,2,2
v_xor_b32 v212,v212,v211
v_lshlrev_b32 v212,4,v212
v_and_b32 v213,31,v208
v_lshl_add_u32 v196,v213,6,v212
v_xor_b32 v197,32,v196
v_lshlrev_b32 v206,4,v211
v_bfe_u32 v212,v208,2,2
v_lshlrev_b32 v212,6,v212
v_and_b32 v213,3,v208
v_lshl_add_u32 v212,v213,3,v212
v_bfe_u32 v213,v208,4,1
v_lshl_add_u32 v212,v213,5,v212
v_lshl_add_u32 v200,v211,9,v212
v_add_u32 v201,57344,v200
v_lshl_add_u32 v202,v211,8,v212
v_add_u32 v203,57344,v202
s_mul_i32 s30,s24,112
v_add_u32 v210,s30,v210
v_and_b32 v213,3,v208
v_lshlrev_b32 v213,4,v213
v_mul_u32_u24 v204,3584,v210
v_add_u32 v204,v204,v213
v_mul_u32_u24 v205,896,v210
v_add_u32 v205,v205,v213
v_mov_b32 v209,163824
s_cmp_lg_u32 s24,0
s_cbranch_scc1 L_slotw
s_waitcnt vmcnt(2)
s_sub_u32 s30,s96,1
s_cmp_lt_u32 s30,7
s_cbranch_scc1 L_rkok
s_waitcnt vmcnt(0)
L_rkok:
v_readfirstlane_b32 s30,v207
s_lshl_b32 s39,s96,5
s_add_u32 s39,s39,s30
s_cmp_ge_u32 s96,8
s_cbranch_scc1 L_ovf
s_cmp_lt_u32 s30,32
s_cbranch_scc1 L_slotok
L_ovf:
v_mov_b32 v208,1
s_mov_b64 exec,1
buffer_atomic_add v208,v199,s[16:19],0 offen offset:8 sc0
s_waitcnt vmcnt(0)
s_mov_b64 exec,-1
v_readfirstlane_b32 s58,v208
s_mov_b32 s27,0
L_cl:
buffer_load_dword v208,v192,s[16:19],0 offen sc1
s_waitcnt vmcnt(0)
v_readlane_b32 s31,v208,0
v_readlane_b32 s30,v208,1
s_add_u32 s31,s31,s30
v_readlane_b32 s30,v208,2
s_add_u32 s31,s31,s30
v_readlane_b32 s30,v208,3
s_add_u32 s31,s31,s30
v_readlane_b32 s30,v208,4
s_add_u32 s31,s31,s30
v_readlane_b32 s30,v208,5
s_add_u32 s31,s31,s30
v_readlane_b32 s30,v208,6
s_add_u32 s31,s31,s30
v_readlane_b32 s30,v208,7
s_add_u32 s31,s31,s30
v_readlane_b32 s30,v208,8
s_add_u32 s31,s31,s30
v_readlane_b32 s30,v208,9
s_add_u32 s31,s31,s30
v_readlane_b32 s30,v208,10
s_add_u32 s31,s31,s30
v_readlane_b32 s30,v208,11
s_add_u32 s31,s31,s30
v_readlane_b32 s30,v208,12
s_add_u32 s31,s31,s30
v_readlane_b32 s30,v208,13
s_add_u32 s31,s31,s30
v_readlane_b32 s30,v208,14
s_add_u32 s31,s31,s30
v_readlane_b32 s30,v208,15
s_add_u32 s31,s31,s30
s_cmp_ge_u32 s31,256
s_cbranch_scc1 L_all
s_sleep 4
s_add_u32 s27,s27,1
s_cmp_lt_u32 s27,32768
s_cbranch_scc1 L_cl
s_mov_b32 s39,0xffff
s_branch L_slotok
L_all:
v_readlane_b32 s30,v208,0
s_min_u32 s30,s30,32
s_add_u32 s58,s58,s30
s_add_u32 s39,s58,0
s_cmp_lt_u32 s58,32
s_cbranch_scc1 L_slotok
s_sub_u32 s58,s58,32
v_readlane_b32 s30,v208,2
s_min_u32 s30,s30,32
s_add_u32 s58,s58,s30
s_add_u32 s39,s58,32
s_cmp_lt_u32 s58,32
s_cbranch_scc1 L_slotok
s_sub_u32 s58,s58,32
v_readlane_b32 s30,v208,4
s_min_u32 s30,s30,32
s_add_u32 s58,s58,s30
s_add_u32 s39,s58,64
s_cmp_lt_u32 s58,32
s_cbranch_scc1 L_slotok
s_sub_u32 s58,s58,32
v_readlane_b32 s30,v208,6
s_min_u32 s30,s30,32
s_add_u32 s58,s58,s30
s_add_u32 s39,s58,96
s_cmp_lt_u32 s58,32
s_cbranch_scc1 L_slotok
s_sub_u32 s58,s58,32
v_readlane_b32 s30,v208,8
s_min_u32 s30,s30,32
s_add_u32 s58,s58,s30
s_add_u32 s39,s58,128
s_cmp_lt_u32 s58,32
s_cbranch_scc1 L_slotok
s_sub_u32 s58,s58,32
v_readlane_b32 s30,v208,10
s_min_u32 s30,s30,32
s_add_u32 s58,s58,s30
s_add_u32 s39,s58,160
s_cmp_lt_u32 s58,32
s_cbranch_scc1 L_slotok
s_sub_u32 s58,s58,32
v_readlane_b32 s30,v208,12
s_min_u32 s30,s30,32
s_add_u32 s58,s58,s30
s_add_u32 s39,s58,192
s_cmp_lt_u32 s58,32
s_cbranch_scc1 L_slotok
s_sub_u32 s58,s58,32
v_readlane_b32 s30,v208,14
s_min_u32 s30,s30,32
s_add_u32 s58,s58,s30
s_add_u32 s39,s58,224
s_cmp_lt_u32 s58,32
s_cbranch_scc1 L_slotok
s_sub_u32 s58,s58,32
s_mov_b32 s39,0xffff
L_slotok:
v_mov_b32 v208,s39
ds_write_b32 v209,v208
s_waitcnt lgkmcnt(0)
L_slotw:
s_barrier
ds_read_b32 v208,v209
s_waitcnt lgkmcnt(0)
v_readfirstlane_b32 s30,v208
s_barrier
s_mov_b32 s39,s30
s_mov_b32 s25,s39
s_cmp_ge_u32 s39,256
s_cbranch_scc1 L_exit
s_cmp_ge_u32 s39,32
s_cbranch_scc1 L_worker
v_mov_b32 v209,163824
s_cmp_lg_u32 s24,0
s_cbranch_scc1 pr_5
s_getreg_b32 s31, hwreg(HW_REG_HW_ID, 14, 1)
s_lshl_b32 s56,s31,3
v_mov_b32 v208,1
s_mov_b64 exec,1
buffer_atomic_add v208,v199,s[16:19],s56 offen offset:12 sc0
s_waitcnt vmcnt(0)
s_mov_b64 exec,-1
v_readfirstlane_b32 s30,v208
s_sub_u32 s56,31,s30
s_xor_b32 s57,s31,1
s_cmp_ge_u32 s30,16
s_cselect_b32 s30,s56,s30
s_cselect_b32 s31,s57,s31
s_and_b32 s56,s30,12
s_add_u32 s30,s30,s56
s_lshl_b32 s31,s31,2
s_add_u32 s30,s30,s31
v_mov_b32 v208,s30
ds_write_b32 v209,v208
s_waitcnt lgkmcnt(0)
pr_5:
s_barrier
ds_read_b32 v208,v209
s_waitcnt lgkmcnt(0)
v_readfirstlane_b32 s39,v208
s_barrier
s_and_b32 s39,s39,31
s_mov_b32 s25,s39
s_lshl_b32 s30,s39,2
s_add_u32 s30,s30,s24
s_lshl_b32 s30,s30,14
s_add_u32 s31,s30,8192
v_lshlrev_b32 v208,3,v192
buffer_load_dword v255,v208,s[12:15],s30 offen
buffer_load_dword v255,v208,s[12:15],s31 offen
s_cmp_lt_u32 s39,16
s_cbranch_scc1 L_roleA
s_cmp_lg_u32 s39,30
s_cbranch_scc1 L_nozero
v_mov_b32 v0,0
v_mov_b32 v1,0
v_mov_b32 v2,0
v_mov_b32 v3,0
s_mul_i32 s30,s24,9216
s_add_u32 s30,s30,50593792
s_add_u32 s31,s30,4096
s_add_u32 s56,s30,8192
buffer_store_dwordx4 v[0:3],v192,s[8:11],s30 offen sc1
buffer_store_dwordx4 v[0:3],v192,s[8:11],s30 offen offset:1024 sc1
buffer_store_dwordx4 v[0:3],v192,s[8:11],s30 offen offset:2048 sc1
buffer_store_dwordx4 v[0:3],v192,s[8:11],s30 offen offset:3072 sc1
buffer_store_dwordx4 v[0:3],v192,s[8:11],s31 offen sc1
buffer_store_dwordx4 v[0:3],v192,s[8:11],s31 offen offset:1024 sc1
buffer_store_dwordx4 v[0:3],v192,s[8:11],s31 offen offset:2048 sc1
buffer_store_dwordx4 v[0:3],v192,s[8:11],s31 offen offset:3072 sc1
buffer_store_dwordx4 v[0:3],v192,s[8:11],s56 offen sc1
s_waitcnt vmcnt(0)
s_barrier
v_mov_b32 v208,1
buffer_store_dword v208,v199,s[16:19],0 offen offset:4 sc1
L_nozero:
s_cmp_lt_u32 s39,30
s_cbranch_scc1 L_roleB
s_cmp_eq_u32 s39,30
s_cbranch_scc1 L_nopol2
s_waitcnt vmcnt(0)
s_barrier
s_cmp_lg_u32 s24,0
s_cbranch_scc1 L_polw2
s_mov_b32 s30,50331648
v_lshlrev_b32 v210,2,v192
buffer_load_dword v208,v210,s[8:11],s30 offen sc1
s_waitcnt vmcnt(0)
s_mov_b32 s31,-1
s_mov_b32 s56,-1
s_mov_b32 s57,0
L_pol:
s_memtime s[44:45]
s_waitcnt lgkmcnt(0)
buffer_load_dword v208,v199,s[8:11],s30 offen sc1
s_waitcnt vmcnt(0)
s_memtime s[46:47]
s_waitcnt lgkmcnt(0)
s_sub_u32 s46,s46,s44
s_min_u32 s31,s31,s46
s_memtime s[44:45]
s_waitcnt lgkmcnt(0)
buffer_load_dword v208,v199,s[8:11],s30 offen offset:2048 sc1
s_waitcnt vmcnt(0)
s_memtime s[46:47]
s_waitcnt lgkmcnt(0)
s_sub_u32 s46,s46,s44
s_min_u32 s56,s56,s46
s_add_u32 s57,s57,256
s_and_b32 s30,s57,0x700
s_add_u32 s30,s30,50331648
s_cmp_le_u32 s57,2048
s_cbranch_scc1 L_pol
s_cmp_gt_u32 s31,s56
s_cselect_b32 s31,1,0
s_getreg_b32 s56, hwreg(HW_REG_HW_ID, 14, 1)
s_xor_b32 s31,s31,s56
s_lshl_b32 s31,s31,11
s_or_b32 s31,s31,1
v_mov_b32 v208,s31
buffer_store_dword v208,v199,s[16:19],0 offen offset:24 sc1
L_polw2:
s_barrier
L_nopol2:
v_mbcnt_lo_u32_b32 v209,-1,0
v_and_b32 v209,15,v209
v_lshlrev_b32 v209,4,v209
s_mov_b32 s27,0
cen_6:
buffer_load_dword v208,v209,s[16:19],0 offen sc1
s_waitcnt vmcnt(0)
v_readlane_b32 s33,v208,0
s_mov_b32 s61,0
s_cmp_ge_u32 s33,32
s_cbranch_scc1 cend_7
s_mov_b32 s61,1
v_readlane_b32 s30,v208,1
s_add_u32 s33,s33,s30
v_readlane_b32 s30,v208,2
s_add_u32 s33,s33,s30
v_readlane_b32 s30,v208,3
s_add_u32 s33,s33,s30
v_readlane_b32 s30,v208,4
s_add_u32 s33,s33,s30
v_readlane_b32 s30,v208,5
s_add_u32 s33,s33,s30
v_readlane_b32 s30,v208,6
s_add_u32 s33,s33,s30
v_readlane_b32 s30,v208,7
s_add_u32 s33,s33,s30
v_readlane_b32 s30,v208,8
s_add_u32 s33,s33,s30
v_readlane_b32 s30,v208,9
s_add_u32 s33,s33,s30
v_readlane_b32 s30,v208,10
s_add_u32 s33,s33,s30
v_readlane_b32 s30,v208,11
s_add_u32 s33,s33,s30
v_readlane_b32 s30,v208,12
s_add_u32 s33,s33,s30
v_readlane_b32 s30,v208,13
s_add_u32 s33,s33,s30
v_readlane_b32 s30,v208,14
s_add_u32 s33,s33,s30
v_readlane_b32 s30,v208,15
s_add_u32 s33,s33,s30
s_cmp_ge_u32 s33,256
s_cbranch_scc1 cend_7
s_sleep 2
s_add_u32 s27,s27,1
s_cmp_lt_u32 s27,32768
s_cbranch_scc1 cen_6
s_mov_b32 s38,7
s_branch L_end
cend_7:
v_mov_b32 v208,0
v_mov_b32 v209,0
s_mov_b32 s27,0
dw_8:
v_cmp_eq_u32 vcc,0,v208
s_cbranch_vccz dwd_9
buffer_load_dword v208,v209,s[16:19],0 offen offset:4 sc1
s_waitcnt vmcnt(0)
s_add_u32 s27,s27,1
s_cmp_lt_u32 s27,32768
s_cbranch_scc1 dw_8
s_branch L_exit
dwd_9:
v_mov_b32 v208,0
v_mov_b32 v209,0
s_mov_b32 s27,0
dw_10:
v_cmp_eq_u32 vcc,0,v208
s_cbranch_vccz dwd_11
buffer_load_dword v208,v209,s[16:19],0 offen offset:24 sc1
s_waitcnt vmcnt(0)
s_add_u32 s27,s27,1
s_cmp_lt_u32 s27,32768
s_cbranch_scc1 dw_10
s_branch L_exit
dwd_11:
v_readfirstlane_b32 s97,v208
s_and_b32 s97,s97,0x800
s_lshr_b32 s98,s97,9
s_xor_b32 s98,s98,4
s_cmp_eq_u32 s39,31
s_cbranch_scc1 L_roleW
s_branch L_roleR
L_roleA:
s_lshr_b32 s58,s24,1
s_and_b32 s59,s24,1
s_mov_b32 s99,0
s_mov_b32 s97,0
s_mov_b32 s98,4
v_mbcnt_lo_u32_b32 v0,-1,0
v_mbcnt_hi_u32_b32 v0,-1,v0
v_lshrrev_b32 v1,4,v0
v_and_b32 v2,15,v0
v_and_b32 v3,1,v0
v_mov_b32 v108,0x4444
v_mov_b32 v4,0xeeee
v_cmp_eq_u32 vcc,1,v3
s_nop 1
v_cndmask_b32 v108,v108,v4,vcc
v_lshlrev_b32 v109,4,v0
s_lshl_b32 s30,s24,11
v_add_u32 v110,s30,v109
s_lshl_b32 s30,s24,13
v_add_u32 v111,s30,v109
v_add_u32 v112,4096,v111
s_lshl_b32 s30,s24,11
v_lshlrev_b32 v5,6,v1
v_add_u32 v5,s30,v5
v_lshrrev_b32 v3,3,v2
v_lshl_add_u32 v113,v3,8,v5
v_and_b32 v3,1,v2
v_lshl_add_u32 v113,v3,4,v113
v_bfe_u32 v4,v2,1,2
v_lshl_add_u32 v113,v4,2,v113
s_lshl_b32 s30,s58,9
v_add_u32 v114,s30,v113
v_lshl_add_u32 v115,v3,4,v5
v_lshl_add_u32 v115,v4,2,v115
v_lshrrev_b32 v4,3,v2
v_lshl_add_u32 v115,v4,1,v115
s_lshl_b32 s30,s58,8
s_sub_u32 s30,512,s30
v_add_u32 v115,s30,v115
v_mov_b32 v8,0
v_mov_b32 v9,0
v_mov_b32 v10,0
v_mov_b32 v11,0
ds_write_b128 v110,v[8:11] offset:1024
v_mov_b32 v15,-0.5
ds_write_b128 v110,v[12:15] offset:8192
ds_write_b128 v110,v[12:15] offset:9216
s_waitcnt lgkmcnt(0)
s_lshl_b32 s30,s59,5
v_lshrrev_b32 v3,3,v2
v_lshlrev_b32 v3,8,v3
v_lshl_add_u32 v3,v1,6,v3
v_add_u32 v3,s30,v3
v_and_b32 v4,7,v2
v_lshl_add_u32 v116,v4,2,v3
s_lshl_b32 s31,s25,9
v_add_u32 v116,s31,v116
v_lshrrev_b32 v4,2,v2
v_lshlrev_b32 v117,6,v4
v_lshl_add_u32 v117,v1,4,v117
v_and_b32 v4,2,v2
v_add_u32 v117,v117,v4
s_and_b32 s31,s25,2
s_lshl_b32 s31,s31,7
s_lshl_b32 s56,s59,3
s_add_u32 s31,s31,s56
s_and_b32 s56,s25,1
s_lshl_b32 s56,s56,2
s_add_u32 s31,s31,s56
s_and_b32 s56,s25,4
s_lshl_b32 s56,s56,9
s_add_u32 s31,s31,s56
s_and_b32 s56,s25,8
s_lshl_b32 s56,s56,7
s_add_u32 s31,s31,s56
s_add_u32 s31,s31,8192
v_add_u32 v117,s31,v117
s_mov_b32 s32,63930368
v_lshlrev_b32 v118,9,v0
s_and_b32 s30,s25,4
s_xor_b32 s30,s30,s98
s_lshl_b32 s30,s30,8
s_add_u32 s30,s30,s25
s_lshl_b32 s30,s30,1
s_add_u32 s30,s30,50622464
v_add_u32 v118,s30,v118
v_mov_b32 v3,0x7f000000
v_cmp_gt_u32 vcc,4,v0
s_nop 1
v_cndmask_b32 v118,v3,v118,vcc
v_min_u32 v3,13,v0
v_and_b32 v4,4,v3
v_xor_b32 v4,s98,v4
v_lshl_add_u32 v3,v4,8,v3
s_and_b32 s30,s25,3
s_lshl_b32 s30,s30,9
s_add_u32 s30,s30,50622720
v_lshl_add_u32 v119,v3,1,s30
s_add_u32 s28,s97,50331648
s_add_u32 s62,s97,50335744
s_add_u32 s29,s97,50397184
s_add_u32 s34,s97,50446336
s_mov_b32 s32,63963136
s_mov_b32 s37,0.5
s_mov_b32 s35,2.0
s_xor_b32 s36,s61,1
s_mov_b32 s63,s36
s_mov_b32 s4,s94
s_mov_b32 s5,s95
s_mov_b32 s6,0
s_mov_b32 s7,0x20000
s_mov_b32 s10,0
s_mov_b32 s99,1
s_mov_b32 s26,62
s_mov_b32 s63,0
s_barrier
s_branch Adsp_12
Aback_13:
s_waitcnt vmcnt(0) lgkmcnt(0)
s_mov_b32 s10,0x10000000
s_mov_b32 s99,0
s_barrier
v_mbcnt_lo_u32_b32 v0,-1,0
v_mbcnt_hi_u32_b32 v0,-1,v0
v_lshrrev_b32 v1,4,v0
v_and_b32 v2,15,v0
v_and_b32 v3,1,v0
v_mov_b32 v108,0x4444
v_mov_b32 v4,0xeeee
v_cmp_eq_u32 vcc,1,v3
s_nop 1
v_cndmask_b32 v108,v108,v4,vcc
v_lshlrev_b32 v109,4,v0
s_lshl_b32 s30,s24,11
v_add_u32 v110,s30,v109
s_lshl_b32 s30,s24,13
v_add_u32 v111,s30,v109
v_add_u32 v112,4096,v111
v_lshlrev_b32 v3,9,v1
v_lshrrev_b32 v4,3,v2
v_mul_u32_u24 v5,28672,v4
v_add_u32 v5,v5,v3
v_and_b32 v6,7,v2
v_lshl_add_u32 v5,v6,4,v5
v_lshl_add_u32 v7,v4,7,v3
v_lshl_add_u32 v7,v6,4,v7
s_mul_i32 s30,s25,401408
s_lshl_b32 s31,s59,8
s_add_u32 s30,s30,s31
s_add_u32 s30,s30,0
s_mul_i32 s31,s58,114688
s_add_u32 s31,s31,s30
s_mul_i32 s56,s58,28672
s_add_u32 s56,s56,s30
s_lshl_b32 s34,s25,7
s_add_u32 s34,s34,50593792
s_lshl_b32 s30,s58,3
v_mov_b32 v8,20
v_writelane_b32 v8,s30,0
s_add_u32 s30,s30,4
v_writelane_b32 v8,s30,1
s_add_u32 s30,s30,12
v_writelane_b32 v8,s30,2
v_mbcnt_lo_u32_b32 v11,-1,0
v_and_b32 v11,15,v11
v_lshlrev_b32 v11,4,v11
s_mov_b32 s27,0
cen_15:
buffer_load_dword v10,v11,s[16:19],0 offen sc1
s_waitcnt vmcnt(0)
v_readlane_b32 s33,v10,0
s_mov_b32 s61,0
s_cmp_ge_u32 s33,32
s_cbranch_scc1 cend_16
s_mov_b32 s61,1
v_readlane_b32 s30,v10,1
s_add_u32 s33,s33,s30
v_readlane_b32 s30,v10,2
s_add_u32 s33,s33,s30
v_readlane_b32 s30,v10,3
s_add_u32 s33,s33,s30
v_readlane_b32 s30,v10,4
s_add_u32 s33,s33,s30
v_readlane_b32 s30,v10,5
s_add_u32 s33,s33,s30
v_readlane_b32 s30,v10,6
s_add_u32 s33,s33,s30
v_readlane_b32 s30,v10,7
s_add_u32 s33,s33,s30
v_readlane_b32 s30,v10,8
s_add_u32 s33,s33,s30
v_readlane_b32 s30,v10,9
s_add_u32 s33,s33,s30
v_readlane_b32 s30,v10,10
s_add_u32 s33,s33,s30
v_readlane_b32 s30,v10,11
s_add_u32 s33,s33,s30
v_readlane_b32 s30,v10,12
s_add_u32 s33,s33,s30
v_readlane_b32 s30,v10,13
s_add_u32 s33,s33,s30
v_readlane_b32 s30,v10,14
s_add_u32 s33,s33,s30
v_readlane_b32 s30,v10,15
s_add_u32 s33,s33,s30
s_cmp_ge_u32 s33,256
s_cbranch_scc1 cend_16
s_sleep 2
s_add_u32 s27,s27,1
s_cmp_lt_u32 s27,32768
s_cbranch_scc1 cen_15
s_mov_b32 s38,7
s_branch L_end
cend_16:
v_mov_b32 v10,0
v_mov_b32 v11,0
s_mov_b32 s27,0
dw_17:
v_cmp_eq_u32 vcc,0,v10
s_cbranch_vccz dwd_18
buffer_load_dword v10,v11,s[16:19],0 offen offset:4 sc1
s_waitcnt vmcnt(0)
s_add_u32 s27,s27,1
s_cmp_lt_u32 s27,32768
s_cbranch_scc1 dw_17
s_branch L_exit
dwd_18:
s_mov_b32 s4,s94
s_mov_b32 s5,s95
s_mov_b32 s6,268435456
s_mov_b32 s7,0x20000
s_cmp_lg_u32 s61,0
s_cselect_b32 s6,0,s6
s_mov_b64 exec,0xf
s_mov_b32 s27,0
wf_19:
buffer_load_dword v10,v8,s[8:11],s34 offen sc1
s_waitcnt vmcnt(0)
v_cmp_gt_u32 vcc,1,v10
s_cbranch_vccz wfd_20
s_sleep 1
s_add_u32 s27,s27,1
s_cmp_lt_u32 s27,32768
s_cbranch_scc1 wf_19
s_mov_b32 s38,9
wfd_20:
s_mov_b64 exec,-1
s_add_u32 s32,s31,0
buffer_load_dwordx4 a[200:203],v5,s[8:11],s32 offen sc1
buffer_load_dwordx4 a[232:235],v5,s[8:11],s32 offen offset:128 sc1
s_add_u32 s32,s31,14336
buffer_load_dwordx4 a[228:231],v5,s[8:11],s32 offen sc1
buffer_load_dwordx4 v[124:127],v5,s[8:11],s32 offen offset:128 sc1
s_add_u32 s32,s31,57344
buffer_load_dwordx4 v[128:131],v5,s[8:11],s32 offen sc1
buffer_load_dwordx4 v[160:163],v5,s[8:11],s32 offen offset:128 sc1
s_add_u32 s32,s31,71680
buffer_load_dwordx4 v[156:159],v5,s[8:11],s32 offen sc1
buffer_load_dwordx4 v[188:191],v5,s[8:11],s32 offen offset:128 sc1
s_add_u32 s32,s31,229376
buffer_load_dwordx4 v[192:195],v5,s[8:11],s32 offen sc1
buffer_load_dwordx4 v[224:227],v5,s[8:11],s32 offen offset:128 sc1
s_add_u32 s32,s31,243712
buffer_load_dwordx4 v[220:223],v5,s[8:11],s32 offen sc1
buffer_load_dwordx4 v[252:255],v5,s[8:11],s32 offen offset:128 sc1
s_add_u32 s32,s56,286720
buffer_load_dwordx4 a[144:147],v7,s[8:11],s32 offen sc1
s_add_u32 s32,s56,301056
buffer_load_dwordx4 a[172:175],v7,s[8:11],s32 offen sc1
s_mov_b64 exec,0xf
s_mov_b32 s27,0
wf_21:
buffer_load_dword v10,v8,s[8:11],s34 offen sc1
s_waitcnt vmcnt(0)
v_cmp_gt_u32 vcc,2,v10
s_cbranch_vccz wfd_22
s_sleep 1
s_add_u32 s27,s27,1
s_cmp_lt_u32 s27,32768
s_cbranch_scc1 wf_21
s_mov_b32 s38,9
wfd_22:
s_mov_b64 exec,-1
s_add_u32 s32,s31,2048
buffer_load_dwordx4 a[204:207],v5,s[8:11],s32 offen sc1
buffer_load_dwordx4 a[236:239],v5,s[8:11],s32 offen offset:128 sc1
s_add_u32 s32,s31,4096
buffer_load_dwordx4 a[208:211],v5,s[8:11],s32 offen sc1
buffer_load_dwordx4 a[240:243],v5,s[8:11],s32 offen offset:128 sc1
s_add_u32 s32,s31,16384
buffer_load_dwordx4 a[0:3],v5,s[8:11],s32 offen sc1
buffer_load_dwordx4 a[24:27],v5,s[8:11],s32 offen offset:128 sc1
s_add_u32 s32,s31,18432
buffer_load_dwordx4 a[4:7],v5,s[8:11],s32 offen sc1
buffer_load_dwordx4 a[28:31],v5,s[8:11],s32 offen offset:128 sc1
s_add_u32 s32,s31,59392
buffer_load_dwordx4 v[132:135],v5,s[8:11],s32 offen sc1
buffer_load_dwordx4 v[164:167],v5,s[8:11],s32 offen offset:128 sc1
s_add_u32 s32,s31,61440
buffer_load_dwordx4 v[136:139],v5,s[8:11],s32 offen sc1
buffer_load_dwordx4 v[168:171],v5,s[8:11],s32 offen offset:128 sc1
s_add_u32 s32,s31,73728
buffer_load_dwordx4 a[48:51],v5,s[8:11],s32 offen sc1
buffer_load_dwordx4 a[72:75],v5,s[8:11],s32 offen offset:128 sc1
s_add_u32 s32,s31,75776
buffer_load_dwordx4 a[52:55],v5,s[8:11],s32 offen sc1
buffer_load_dwordx4 a[76:79],v5,s[8:11],s32 offen offset:128 sc1
s_add_u32 s32,s31,231424
buffer_load_dwordx4 v[196:199],v5,s[8:11],s32 offen sc1
buffer_load_dwordx4 v[228:231],v5,s[8:11],s32 offen offset:128 sc1
s_add_u32 s32,s31,233472
buffer_load_dwordx4 v[200:203],v5,s[8:11],s32 offen sc1
buffer_load_dwordx4 v[232:235],v5,s[8:11],s32 offen offset:128 sc1
s_add_u32 s32,s31,245760
buffer_load_dwordx4 a[96:99],v5,s[8:11],s32 offen sc1
buffer_load_dwordx4 a[120:123],v5,s[8:11],s32 offen offset:128 sc1
s_add_u32 s32,s31,247808
buffer_load_dwordx4 a[100:103],v5,s[8:11],s32 offen sc1
buffer_load_dwordx4 a[124:127],v5,s[8:11],s32 offen offset:128 sc1
s_add_u32 s32,s56,288768
buffer_load_dwordx4 a[148:151],v7,s[8:11],s32 offen sc1
s_add_u32 s32,s56,290816
buffer_load_dwordx4 a[152:155],v7,s[8:11],s32 offen sc1
s_add_u32 s32,s56,303104
buffer_load_dwordx4 a[176:179],v7,s[8:11],s32 offen sc1
s_add_u32 s32,s56,305152
buffer_load_dwordx4 a[180:183],v7,s[8:11],s32 offen sc1
v_mov_b32 v17,0
buffer_load_dword v16,v17,s[16:19],0 offen offset:24 sc1
s_mov_b64 exec,0xf
s_mov_b32 s27,0
wf_23:
buffer_load_dword v10,v8,s[8:11],s34 offen sc1
s_waitcnt vmcnt(0)
v_cmp_gt_u32 vcc,3,v10
s_cbranch_vccz wfd_24
s_sleep 1
s_add_u32 s27,s27,1
s_cmp_lt_u32 s27,32768
s_cbranch_scc1 wf_23
s_mov_b32 s38,9
wfd_24:
s_mov_b64 exec,-1
s_mov_b32 s27,0
dw_25:
v_cmp_eq_u32 vcc,0,v16
s_cbranch_vccz dwd_26
buffer_load_dword v16,v17,s[16:19],0 offen offset:24 sc1
s_waitcnt vmcnt(0)
s_add_u32 s27,s27,1
s_cmp_lt_u32 s27,32768
s_cbranch_scc1 dw_25
s_branch L_exit
dwd_26:
v_readfirstlane_b32 s97,v16
s_and_b32 s97,s97,0x800
s_lshr_b32 s98,s97,9
s_xor_b32 s98,s98,4
s_add_u32 s32,s31,6144
buffer_load_dwordx4 a[212:215],v5,s[8:11],s32 offen sc1
buffer_load_dwordx4 a[244:247],v5,s[8:11],s32 offen offset:128 sc1
s_add_u32 s32,s31,8192
buffer_load_dwordx4 a[216:219],v5,s[8:11],s32 offen sc1
buffer_load_dwordx4 a[248:251],v5,s[8:11],s32 offen offset:128 sc1
s_add_u32 s32,s31,10240
buffer_load_dwordx4 a[220:223],v5,s[8:11],s32 offen sc1
buffer_load_dwordx4 a[252:255],v5,s[8:11],s32 offen offset:128 sc1
s_add_u32 s32,s31,12288
buffer_load_dwordx4 a[224:227],v5,s[8:11],s32 offen sc1
buffer_load_dwordx4 v[120:123],v5,s[8:11],s32 offen offset:128 sc1
s_add_u32 s32,s31,20480
buffer_load_dwordx4 a[8:11],v5,s[8:11],s32 offen sc1
buffer_load_dwordx4 a[32:35],v5,s[8:11],s32 offen offset:128 sc1
s_add_u32 s32,s31,22528
buffer_load_dwordx4 a[12:15],v5,s[8:11],s32 offen sc1
buffer_load_dwordx4 a[36:39],v5,s[8:11],s32 offen offset:128 sc1
s_add_u32 s32,s31,24576
buffer_load_dwordx4 a[16:19],v5,s[8:11],s32 offen sc1
buffer_load_dwordx4 a[40:43],v5,s[8:11],s32 offen offset:128 sc1
s_add_u32 s32,s31,26624
buffer_load_dwordx4 a[20:23],v5,s[8:11],s32 offen sc1
buffer_load_dwordx4 a[44:47],v5,s[8:11],s32 offen offset:128 sc1
s_add_u32 s32,s31,63488
buffer_load_dwordx4 v[140:143],v5,s[8:11],s32 offen sc1
buffer_load_dwordx4 v[172:175],v5,s[8:11],s32 offen offset:128 sc1
s_add_u32 s32,s31,65536
buffer_load_dwordx4 v[144:147],v5,s[8:11],s32 offen sc1
buffer_load_dwordx4 v[176:179],v5,s[8:11],s32 offen offset:128 sc1
s_add_u32 s32,s31,67584
buffer_load_dwordx4 v[148:151],v5,s[8:11],s32 offen sc1
buffer_load_dwordx4 v[180:183],v5,s[8:11],s32 offen offset:128 sc1
s_add_u32 s32,s31,69632
buffer_load_dwordx4 v[152:155],v5,s[8:11],s32 offen sc1
buffer_load_dwordx4 v[184:187],v5,s[8:11],s32 offen offset:128 sc1
s_add_u32 s32,s31,77824
buffer_load_dwordx4 a[56:59],v5,s[8:11],s32 offen sc1
buffer_load_dwordx4 a[80:83],v5,s[8:11],s32 offen offset:128 sc1
s_add_u32 s32,s31,79872
buffer_load_dwordx4 a[60:63],v5,s[8:11],s32 offen sc1
buffer_load_dwordx4 a[84:87],v5,s[8:11],s32 offen offset:128 sc1
s_add_u32 s32,s31,81920
buffer_load_dwordx4 a[64:67],v5,s[8:11],s32 offen sc1
buffer_load_dwordx4 a[88:91],v5,s[8:11],s32 offen offset:128 sc1
s_add_u32 s32,s31,83968
buffer_load_dwordx4 a[68:71],v5,s[8:11],s32 offen sc1
buffer_load_dwordx4 a[92:95],v5,s[8:11],s32 offen offset:128 sc1
s_add_u32 s32,s31,235520
buffer_load_dwordx4 v[204:207],v5,s[8:11],s32 offen sc1
buffer_load_dwordx4 v[236:239],v5,s[8:11],s32 offen offset:128 sc1
s_add_u32 s32,s31,237568
buffer_load_dwordx4 v[208:211],v5,s[8:11],s32 offen sc1
buffer_load_dwordx4 v[240:243],v5,s[8:11],s32 offen offset:128 sc1
s_add_u32 s32,s31,239616
buffer_load_dwordx4 v[212:215],v5,s[8:11],s32 offen sc1
buffer_load_dwordx4 v[244:247],v5,s[8:11],s32 offen offset:128 sc1
s_add_u32 s32,s31,241664
buffer_load_dwordx4 v[216:219],v5,s[8:11],s32 offen sc1
buffer_load_dwordx4 v[248:251],v5,s[8:11],s32 offen offset:128 sc1
s_add_u32 s32,s31,249856
buffer_load_dwordx4 a[104:107],v5,s[8:11],s32 offen sc1
buffer_load_dwordx4 a[128:131],v5,s[8:11],s32 offen offset:128 sc1
s_add_u32 s32,s31,251904
buffer_load_dwordx4 a[108:111],v5,s[8:11],s32 offen sc1
buffer_load_dwordx4 a[132:135],v5,s[8:11],s32 offen offset:128 sc1
s_add_u32 s32,s31,253952
buffer_load_dwordx4 a[112:115],v5,s[8:11],s32 offen sc1
buffer_load_dwordx4 a[136:139],v5,s[8:11],s32 offen offset:128 sc1
s_add_u32 s32,s31,256000
buffer_load_dwordx4 a[116:119],v5,s[8:11],s32 offen sc1
buffer_load_dwordx4 a[140:143],v5,s[8:11],s32 offen offset:128 sc1
s_add_u32 s32,s56,292864
buffer_load_dwordx4 a[156:159],v7,s[8:11],s32 offen sc1
s_add_u32 s32,s56,294912
buffer_load_dwordx4 a[160:163],v7,s[8:11],s32 offen sc1
s_add_u32 s32,s56,296960
buffer_load_dwordx4 a[164:167],v7,s[8:11],s32 offen sc1
s_add_u32 s32,s56,299008
buffer_load_dwordx4 a[168:171],v7,s[8:11],s32 offen sc1
s_add_u32 s32,s56,307200
buffer_load_dwordx4 a[184:187],v7,s[8:11],s32 offen sc1
s_add_u32 s32,s56,309248
buffer_load_dwordx4 a[188:191],v7,s[8:11],s32 offen sc1
s_add_u32 s32,s56,311296
buffer_load_dwordx4 a[192:195],v7,s[8:11],s32 offen sc1
s_add_u32 s32,s56,313344
buffer_load_dwordx4 a[196:199],v7,s[8:11],s32 offen sc1
s_lshl_b32 s30,s24,11
v_lshlrev_b32 v5,6,v1
v_add_u32 v5,s30,v5
v_lshrrev_b32 v3,3,v2
v_lshl_add_u32 v113,v3,8,v5
v_and_b32 v3,1,v2
v_lshl_add_u32 v113,v3,4,v113
v_bfe_u32 v4,v2,1,2
v_lshl_add_u32 v113,v4,2,v113
s_lshl_b32 s30,s58,9
v_add_u32 v114,s30,v113
v_lshl_add_u32 v115,v3,4,v5
v_lshl_add_u32 v115,v4,2,v115
v_lshrrev_b32 v4,3,v2
v_lshl_add_u32 v115,v4,1,v115
s_lshl_b32 s30,s58,8
s_sub_u32 s30,512,s30
v_add_u32 v115,s30,v115
v_mov_b32 v8,0
v_mov_b32 v9,0
v_mov_b32 v10,0
v_mov_b32 v11,0
ds_write_b128 v110,v[8:11] offset:1024
v_mov_b32 v15,-0.5
ds_write_b128 v110,v[12:15] offset:8192
ds_write_b128 v110,v[12:15] offset:9216
s_waitcnt lgkmcnt(0)
s_lshl_b32 s30,s59,5
v_lshrrev_b32 v3,3,v2
v_lshlrev_b32 v3,8,v3
v_lshl_add_u32 v3,v1,6,v3
v_add_u32 v3,s30,v3
v_and_b32 v4,7,v2
v_lshl_add_u32 v116,v4,2,v3
s_lshl_b32 s31,s25,9
v_add_u32 v116,s31,v116
v_lshrrev_b32 v4,2,v2
v_lshlrev_b32 v117,6,v4
v_lshl_add_u32 v117,v1,4,v117
v_and_b32 v4,2,v2
v_add_u32 v117,v117,v4
s_and_b32 s31,s25,2
s_lshl_b32 s31,s31,7
s_lshl_b32 s56,s59,3
s_add_u32 s31,s31,s56
s_and_b32 s56,s25,1
s_lshl_b32 s56,s56,2
s_add_u32 s31,s31,s56
s_and_b32 s56,s25,4
s_lshl_b32 s56,s56,9
s_add_u32 s31,s31,s56
s_and_b32 s56,s25,8
s_lshl_b32 s56,s56,7
s_add_u32 s31,s31,s56
s_add_u32 s31,s31,8192
v_add_u32 v117,s31,v117
s_mov_b32 s32,63930368
v_lshlrev_b32 v118,9,v0
s_and_b32 s30,s25,4
s_xor_b32 s30,s30,s98
s_lshl_b32 s30,s30,8
s_add_u32 s30,s30,s25
s_lshl_b32 s30,s30,1
s_add_u32 s30,s30,50622464
v_add_u32 v118,s30,v118
v_mov_b32 v3,0x7f000000
v_cmp_gt_u32 vcc,4,v0
s_nop 1
v_cndmask_b32 v118,v3,v118,vcc
v_min_u32 v3,13,v0
v_and_b32 v4,4,v3
v_xor_b32 v4,s98,v4
v_lshl_add_u32 v3,v4,8,v3
s_and_b32 s30,s25,3
s_lshl_b32 s30,s30,9
s_add_u32 s30,s30,50622720
v_lshl_add_u32 v119,v3,1,s30
v_mov_b32 v12,-1
s_waitcnt vmcnt(24)
s_cmp_lg_u32 s61,0
s_cbranch_scc1 slow_27
s_add_u32 s30,s97,50397184
buffer_store_dword v12,v116,s[8:11],s30 offen
buffer_store_short v12,v117,s[8:11],s30 offen
s_add_u32 s30,s97,50413568
buffer_store_dword v12,v116,s[8:11],s30 offen
buffer_store_short v12,v117,s[8:11],s30 offen
s_add_u32 s30,s97,50429952
buffer_store_dword v12,v116,s[8:11],s30 offen
buffer_store_short v12,v117,s[8:11],s30 offen
s_add_u32 s30,s97,50446336
buffer_store_dword v12,v116,s[8:11],s30 offen
buffer_store_short v12,v117,s[8:11],s30 offen
slowr_28:
s_add_u32 s30,s97,50397184
buffer_load_ushort v13,v116,s[8:11],s30 offen sc1
buffer_load_ushort v13,v117,s[8:11],s30 offen sc1
s_add_u32 s30,s97,50413568
buffer_load_ushort v13,v116,s[8:11],s30 offen sc1
buffer_load_ushort v13,v117,s[8:11],s30 offen sc1
s_add_u32 s30,s97,50429952
buffer_load_ushort v13,v116,s[8:11],s30 offen sc1
buffer_load_ushort v13,v117,s[8:11],s30 offen sc1
s_add_u32 s30,s97,50446336
buffer_load_ushort v13,v116,s[8:11],s30 offen sc1
buffer_load_ushort v13,v117,s[8:11],s30 offen sc1
s_waitcnt vmcnt(0)
s_barrier
s_cmp_lg_u32 s24,3
s_cbranch_scc1 tbs_31
v_mov_b32 v8,1
v_mov_b32 v9,0
s_mov_b64 exec,1
s_lshl_b32 s30,s39,2
s_add_u32 s30,s30,50620544
s_cmp_lg_u32 s61,0
s_cbranch_scc1 slow_32
buffer_store_dword v8,v9,s[8:11],s30 offen
slowr_33:
s_mov_b64 exec,-1
tbs_31:
s_cmp_eq_u32 s61,0
s_cbranch_scc1 tbd_30
v_mbcnt_lo_u32_b32 v9,-1,0
v_min_u32 v9,29,v9
v_lshlrev_b32 v9,2,v9
s_mov_b32 s27,0
s_mov_b32 s30,50620544
tw_34:
buffer_load_dword v8,v9,s[8:11],s30 offen sc1
s_waitcnt vmcnt(0)
v_cmp_eq_u32 vcc,0,v8
s_cbranch_vccz tw_34_d
s_sleep 2
s_add_u32 s27,s27,1
s_cmp_lt_u32 s27,131072
s_cbranch_scc1 tw_34
s_mov_b32 s38,6
s_branch L_end
tw_34_d:
tbd_30:
s_mov_b32 s26,0
s_lshl_b32 s33,s25,11
s_lshl_b32 s30,s59,10
s_add_u32 s33,s33,s30
s_add_u32 s33,s33,64028672
s_add_u32 s28,s97,50331648
s_add_u32 s62,s97,50335744
s_add_u32 s29,s97,50397184
s_add_u32 s34,s97,50446336
s_mov_b32 s32,63963136
s_mov_b32 s37,0.5
s_mov_b32 s35,2.0
s_xor_b32 s36,s61,1
s_mov_b32 s63,s36
s_mov_b32 s30,50622530
v_mov_b32 v100,0
s_mov_b32 s27,0
buffer_load_ushort v101,v100,s[8:11],s30 offen sc1
fp_35:
s_waitcnt vmcnt(0)
v_cmp_gt_u32 vcc,1,v101
buffer_load_ushort v101,v100,s[8:11],s30 offen sc1
s_cbranch_vccz fpd_36
s_add_u32 s27,s27,1
s_cmp_lt_u32 s27,131072
s_cbranch_scc1 fp_35
s_mov_b32 s38,1
s_branch L_end
fpd_36:
buffer_load_dwordx4 v[28:31],v111,s[8:11],s32 offen sc1
buffer_load_dwordx4 v[32:35],v111,s[8:11],s32 offen offset:1024 sc1
buffer_load_dwordx4 v[44:47],v112,s[8:11],s32 offen sc1
buffer_load_dwordx4 v[48:51],v112,s[8:11],s32 offen offset:1024 sc1
Adsp_12:
s_and_b32 s30,s25,4
s_add_u32 s30,s30,s24
s_cmp_eq_u32 s30,1
s_cbranch_scc1 Aent_38
s_cmp_eq_u32 s30,2
s_cbranch_scc1 Aent_39
s_cmp_eq_u32 s30,3
s_cbranch_scc1 Aent_40
s_cmp_eq_u32 s30,4
s_cbranch_scc1 Aent_41
s_cmp_eq_u32 s30,5
s_cbranch_scc1 Aent_42
s_cmp_eq_u32 s30,6
s_cbranch_scc1 Aent_43
s_cmp_eq_u32 s30,7
s_cbranch_scc1 Aent_44
s_branch Aent_37
.p2align 6
Aloop_45:
s_sleep 4
buffer_load_dwordx4 v[28:31],v111,s[8:11],s32 offen sc1
buffer_load_dwordx4 v[32:35],v111,s[8:11],s32 offen offset:1024 sc1
buffer_load_dwordx4 v[44:47],v112,s[8:11],s32 offen sc1
buffer_load_dwordx4 v[48:51],v112,s[8:11],s32 offen offset:1024 sc1
s_sleep 3
Aent_37:
v_mov_b64 v[60:61],0
v_mov_b64 v[62:63],0
v_mov_b64 v[64:65],0
v_mov_b64 v[66:67],0
v_mov_b64 v[68:69],0
v_mov_b64 v[70:71],0
v_mov_b64 v[72:73],0
v_mov_b64 v[74:75],0
v_mov_b64 v[76:77],0
v_mov_b64 v[78:79],0
v_mov_b64 v[80:81],0
v_mov_b64 v[82:83],0
v_mov_b64 v[84:85],0
v_mov_b64 v[86:87],0
v_mov_b64 v[88:89],0
v_mov_b64 v[90:91],0
v_mov_b64 v[92:93],0
v_mov_b64 v[94:95],0
v_mov_b64 v[96:97],0
v_mov_b64 v[98:99],0
s_mov_b32 s27,0
buffer_load_ushort v100,v119,s[8:11],0 offen sc1
s_nop 9
buffer_load_ushort v101,v119,s[8:11],0 offen sc1
s_nop 9
buffer_load_ushort v102,v119,s[8:11],0 offen sc1
s_nop 9
buffer_load_ushort v103,v119,s[8:11],0 offen sc1
s_nop 9
buffer_load_ushort v104,v119,s[8:11],0 offen sc1
fp_48:
s_waitcnt vmcnt(4)
v_cmp_gt_u32 vcc,s63,v100
buffer_load_ushort v100,v119,s[8:11],0 offen sc1
s_cbranch_vccz fpd_49
s_waitcnt vmcnt(4)
v_cmp_gt_u32 vcc,s63,v101
buffer_load_ushort v101,v119,s[8:11],0 offen sc1
s_cbranch_vccz fpd_49
s_waitcnt vmcnt(4)
v_cmp_gt_u32 vcc,s63,v102
buffer_load_ushort v102,v119,s[8:11],0 offen sc1
s_cbranch_vccz fpd_49
s_waitcnt vmcnt(4)
v_cmp_gt_u32 vcc,s63,v103
buffer_load_ushort v103,v119,s[8:11],0 offen sc1
s_cbranch_vccz fpd_49
s_waitcnt vmcnt(4)
v_cmp_gt_u32 vcc,s63,v104
buffer_load_ushort v104,v119,s[8:11],0 offen sc1
s_cbranch_vccz fpd_49
s_waitcnt vmcnt(4)
v_cmp_gt_u32 vcc,s63,v100
buffer_load_ushort v100,v119,s[8:11],0 offen sc1
s_cbranch_vccz fpd_49
s_waitcnt vmcnt(4)
v_cmp_gt_u32 vcc,s63,v101
buffer_load_ushort v101,v119,s[8:11],0 offen sc1
s_cbranch_vccz fpd_49
s_waitcnt vmcnt(4)
v_cmp_gt_u32 vcc,s63,v102
buffer_load_ushort v102,v119,s[8:11],0 offen sc1
s_cbranch_vccz fpd_49
s_waitcnt vmcnt(4)
v_cmp_gt_u32 vcc,s63,v103
buffer_load_ushort v103,v119,s[8:11],0 offen sc1
s_cbranch_vccz fpd_49
s_waitcnt vmcnt(4)
v_cmp_gt_u32 vcc,s63,v104
buffer_load_ushort v104,v119,s[8:11],0 offen sc1
s_cbranch_vccz fpd_49
s_waitcnt vmcnt(4)
v_cmp_gt_u32 vcc,s63,v100
buffer_load_ushort v100,v119,s[8:11],0 offen sc1
s_cbranch_vccz fpd_49
s_waitcnt vmcnt(4)
v_cmp_gt_u32 vcc,s63,v101
buffer_load_ushort v101,v119,s[8:11],0 offen sc1
s_cbranch_vccz fpd_49
s_waitcnt vmcnt(4)
v_cmp_gt_u32 vcc,s63,v102
buffer_load_ushort v102,v119,s[8:11],0 offen sc1
s_cbranch_vccz fpd_49
s_waitcnt vmcnt(4)
v_cmp_gt_u32 vcc,s63,v103
buffer_load_ushort v103,v119,s[8:11],0 offen sc1
s_cbranch_vccz fpd_49
s_waitcnt vmcnt(4)
v_cmp_gt_u32 vcc,s63,v104
buffer_load_ushort v104,v119,s[8:11],0 offen sc1
s_cbranch_vccz fpd_49
s_add_u32 s27,s27,1
s_cmp_lt_u32 s27,131072
s_cbranch_scc1 fp_48
s_mov_b32 s38,1
s_branch L_end
fpd_49:
buffer_load_dwordx4 v[0:3],v109,s[8:11],s28 offen sc1
s_nop 12
buffer_load_dwordx4 v[4:7],v109,s[8:11],s28 offen offset:1024 sc1
s_nop 12
buffer_load_dwordx4 v[8:11],v109,s[8:11],s28 offen offset:2048 sc1
s_nop 12
buffer_load_dwordx4 v[12:15],v109,s[8:11],s28 offen offset:3072 sc1
Ago_46:
s_waitcnt vmcnt(3)
v_smfmac_f32_16x16x64_bf16 v[60:63],v[0:3],a[200:207],v108
buffer_load_dwordx4 v[16:19],v109,s[8:11],s62 offen sc1
v_smfmac_f32_16x16x64_bf16 v[64:67],v[0:3],a[232:239],v108
v_max3_u32 v100,v0,v1,v2
v_smfmac_f32_16x16x64_bf16 v[68:71],v[0:3],v[128:135],v108
v_max_u32 v100,v100,v3
v_smfmac_f32_16x16x64_bf16 v[72:75],v[0:3],v[160:167],v108
v_smfmac_f32_16x16x64_bf16 v[76:79],v[0:3],v[192:199],v108
buffer_load_dwordx4 v[20:23],v109,s[8:11],s62 offen offset:1024 sc1
v_smfmac_f32_16x16x64_bf16 v[80:83],v[0:3],v[224:231],v108
s_waitcnt vmcnt(4)
v_smfmac_f32_16x16x64_bf16 v[60:63],v[4:7],a[208:215],v108
v_smfmac_f32_16x16x64_bf16 v[64:67],v[4:7],a[240:247],v108
v_max3_u32 v100,v100,v4,v5
v_smfmac_f32_16x16x64_bf16 v[68:71],v[4:7],v[136:143],v108
buffer_load_dwordx4 v[24:27],v109,s[8:11],s62 offen offset:2048 sc1
v_max3_u32 v100,v100,v6,v7
v_smfmac_f32_16x16x64_bf16 v[72:75],v[4:7],v[168:175],v108
v_smfmac_f32_16x16x64_bf16 v[76:79],v[4:7],v[200:207],v108
v_smfmac_f32_16x16x64_bf16 v[80:83],v[4:7],v[232:239],v108
s_waitcnt vmcnt(4)
v_smfmac_f32_16x16x64_bf16 v[60:63],v[8:11],a[216:223],v108
buffer_load_dwordx4 v[36:39],v111,s[8:11],s32 offen offset:2048 sc1
v_smfmac_f32_16x16x64_bf16 v[64:67],v[8:11],a[248:255],v108
v_max3_u32 v100,v100,v8,v9
v_smfmac_f32_16x16x64_bf16 v[68:71],v[8:11],v[144:151],v108
v_max3_u32 v100,v100,v10,v11
v_smfmac_f32_16x16x64_bf16 v[72:75],v[8:11],v[176:183],v108
v_smfmac_f32_16x16x64_bf16 v[76:79],v[8:11],v[208:215],v108
buffer_load_dwordx4 v[40:43],v111,s[8:11],s32 offen offset:3072 sc1
v_smfmac_f32_16x16x64_bf16 v[80:83],v[8:11],v[240:247],v108
s_waitcnt vmcnt(5)
v_smfmac_f32_16x16x64_bf16 v[60:63],v[12:15],a[224:231],v108
v_max3_u32 v100,v100,v12,v13
v_smfmac_f32_16x16x64_bf16 v[64:67],v[12:15],v[120:127],v108
v_max3_u32 v100,v100,v14,v15
v_smfmac_f32_16x16x64_bf16 v[68:71],v[12:15],v[152:159],v108
buffer_load_dwordx4 v[52:55],v112,s[8:11],s32 offen offset:2048 sc1
v_smfmac_f32_16x16x64_bf16 v[72:75],v[12:15],v[184:191],v108
s_waitcnt vmcnt(5)
v_smfmac_f32_16x16x64_bf16 v[60:63],v[16:19],a[0:7],v108
v_max3_u32 v100,v100,v16,v17
v_smfmac_f32_16x16x64_bf16 v[64:67],v[16:19],a[24:31],v108
v_max3_u32 v100,v100,v18,v19
v_smfmac_f32_16x16x64_bf16 v[68:71],v[16:19],a[48:55],v108
buffer_load_dwordx4 v[56:59],v112,s[8:11],s32 offen offset:3072 sc1
v_smfmac_f32_16x16x64_bf16 v[72:75],v[16:19],a[72:79],v108
s_waitcnt vmcnt(5)
v_smfmac_f32_16x16x64_bf16 v[60:63],v[20:23],a[8:15],v108
v_max3_u32 v100,v100,v20,v21
v_smfmac_f32_16x16x64_bf16 v[64:67],v[20:23],a[32:39],v108
v_max3_u32 v100,v100,v22,v23
v_smfmac_f32_16x16x64_bf16 v[68:71],v[20:23],a[56:63],v108
v_smfmac_f32_16x16x64_bf16 v[72:75],v[20:23],a[80:87],v108
s_waitcnt vmcnt(4)
v_smfmac_f32_16x16x64_bf16 v[60:63],v[24:27],a[16:23],v108
v_max3_u32 v100,v100,v24,v25
v_smfmac_f32_16x16x64_bf16 v[64:67],v[24:27],a[40:47],v108
v_max3_u32 v100,v100,v26,v27
v_smfmac_f32_16x16x64_bf16 v[68:71],v[24:27],a[64:71],v108
v_cmp_eq_u32 vcc,-1,v100
v_smfmac_f32_16x16x64_bf16 v[72:75],v[24:27],a[88:95],v108
v_add_f32 v60,v60,v61
v_smfmac_f32_16x16x64_bf16 v[76:79],v[12:15],v[216:223],v108
v_add_f32 v62,v62,v63
v_smfmac_f32_16x16x64_bf16 v[76:79],v[16:19],a[96:103],v108
s_cbranch_vccnz Aredo_47
v_add_f32 v64,v64,v65
v_smfmac_f32_16x16x64_bf16 v[76:79],v[20:23],a[104:111],v108
v_cvt_pk_bf16_f32 v61,v60,v64
v_smfmac_f32_16x16x64_bf16 v[76:79],v[24:27],a[112:119],v108
ds_write_b32 v113,v61 offset:0
v_add_f32 v66,v66,v67
v_smfmac_f32_16x16x64_bf16 v[80:83],v[12:15],v[248:255],v108
v_cvt_pk_bf16_f32 v63,v62,v66
v_smfmac_f32_16x16x64_bf16 v[80:83],v[16:19],a[120:127],v108
ds_write_b32 v113,v63 offset:32
v_add_f32 v68,v68,v69
v_smfmac_f32_16x16x64_bf16 v[80:83],v[20:23],a[128:135],v108
v_add_f32 v70,v70,v71
v_smfmac_f32_16x16x64_bf16 v[80:83],v[24:27],a[136:143],v108
v_add_f32 v72,v72,v73
v_smfmac_f32_16x16x64_bf16 v[84:87],v[0:3],a[144:151],v108
v_cvt_pk_bf16_f32 v69,v68,v72
v_smfmac_f32_16x16x64_bf16 v[84:87],v[4:7],a[152:159],v108
ds_write_b32 v113,v69 offset:512
v_add_f32 v74,v74,v75
v_smfmac_f32_16x16x64_bf16 v[84:87],v[8:11],a[160:167],v108
v_cvt_pk_bf16_f32 v71,v70,v74
v_smfmac_f32_16x16x64_bf16 v[84:87],v[12:15],a[168:175],v108
ds_write_b32 v113,v71 offset:544
v_smfmac_f32_16x16x64_bf16 v[84:87],v[16:19],a[176:183],v108
ds_read_b128 v[100:103],v110 offset:0
v_add_f32 v76,v76,v77
v_smfmac_f32_16x16x64_bf16 v[84:87],v[20:23],a[184:191],v108
v_add_f32 v78,v78,v79
v_smfmac_f32_16x16x64_bf16 v[84:87],v[24:27],a[192:199],v108
v_add_f32 v80,v80,v81
v_cvt_pk_bf16_f32 v77,v76,v80
v_add_f32 v82,v82,v83
v_cvt_pk_bf16_f32 v79,v78,v82
ds_write_b32 v114,v77 offset:1024
ds_write_b32 v114,v79 offset:1056
s_nop 1
v_add_f32 v84,v84,v85
v_add_f32 v86,v86,v87
v_cvt_pk_bf16_f32 v84,v84,v86
ds_write_b16 v115,v84 offset:1024
ds_write_b16_d16_hi v115,v84 offset:1056
ds_read_b128 v[104:107],v110 offset:1024
s_waitcnt vmcnt(0) lgkmcnt(5)
v_smfmac_f32_16x16x64_bf16 v[88:91],v[100:103],v[28:35],v108
v_mov_b32 v63,s37
v_smfmac_f32_16x16x64_bf16 v[92:95],v[100:103],v[44:51],v108
v_mov_b32 v67,s37
v_smfmac_f32_16x16x64_bf16 v[96:99],v[100:103],v[0:7],v108
s_waitcnt lgkmcnt(0)
v_smfmac_f32_16x16x64_bf16 v[96:99],v[104:107],v[16:23],v108
v_smfmac_f32_16x16x64_bf16 v[88:91],v[104:107],v[36:43],v108
v_smfmac_f32_16x16x64_bf16 v[92:95],v[104:107],v[52:59],v108
s_nop 0
v_add_f32 v68,v96,v97
v_add_f32 v69,v98,v99
s_nop 1
v_add_f32 v60,v88,v89
v_add_f32 v64,v90,v91
v_mov_b32_dpp v62,v68 quad_perm:[0,0,2,2] row_mask:0xf bank_mask:0xf
v_mov_b32_dpp v66,v69 quad_perm:[0,0,2,2] row_mask:0xf bank_mask:0xf
v_add_f32 v65,v94,v95
ds_write_b128 v110,v[64:67] offset:9216
s_barrier
Arr_50:
ds_read_b128 v[72:75],v109 offset:10240
ds_read_b128 v[76:79],v109 offset:12288
ds_read_b128 v[80:83],v109 offset:14336
v_add_f32 v61,v92,v93
v_mov_b32 v29,-1
s_waitcnt lgkmcnt(2)
v_pk_add_f32 v[84:85],v[60:61],v[72:73]
v_pk_add_f32 v[86:87],v[62:63],v[74:75]
s_waitcnt lgkmcnt(1)
v_pk_add_f32 v[84:85],v[84:85],v[76:77]
v_pk_add_f32 v[86:87],v[86:87],v[78:79]
s_waitcnt lgkmcnt(0)
v_pk_add_f32 v[84:85],v[84:85],v[80:81]
v_pk_add_f32 v[86:87],v[86:87],v[82:83]
v_max3_f32 v72,v84,v85,v86
v_cmp_neq_f32 vcc,s35,v87
s_nop 0
v_max_f32_dpp v72,v72,v72 row_ror:1 row_mask:0xf bank_mask:0xf
s_nop 1
v_max_f32_dpp v72,v72,v72 row_ror:2 row_mask:0xf bank_mask:0xf
s_nop 1
v_max_f32_dpp v72,v72,v72 row_ror:4 row_mask:0xf bank_mask:0xf
s_nop 1
v_max_f32_dpp v72,v72,v72 row_ror:8 row_mask:0xf bank_mask:0xf
v_pk_add_f32 v[84:85],v[84:85],v[72:73] op_sel_hi:[1,0] neg_lo:[0,1] neg_hi:[0,1]
v_sub_f32 v86,v86,v72
v_exp_f32 v84,v84
v_exp_f32 v85,v85
v_exp_f32 v86,v86
v_add_f32 v72,v84,v85
v_fmac_f32 v72,0.5,v86
s_cmp_lg_u64 vcc,0
s_cselect_b32 s31,0x7f000000,s29
v_add_f32_dpp v72,v72,v72 row_ror:1 row_mask:0xf bank_mask:0xf
s_nop 1
v_add_f32_dpp v72,v72,v72 row_ror:2 row_mask:0xf bank_mask:0xf
s_nop 1
v_add_f32_dpp v72,v72,v72 row_ror:4 row_mask:0xf bank_mask:0xf
s_nop 1
v_add_f32_dpp v72,v72,v72 row_ror:8 row_mask:0xf bank_mask:0xf
v_rcp_f32 v72,v72
s_nop 0
v_pk_mul_f32 v[84:85],v[84:85],v[72:73] op_sel_hi:[1,0]
v_mul_f32 v86,v86,v72
v_cvt_pk_bf16_f32 v84,|v84|,|v85|
v_cvt_pk_bf16_f32 v86,|v86|,|v86|
buffer_store_dword v84,v116,s[4:7],s31 offen
buffer_store_short v86,v117,s[4:7],s31 offen
buffer_store_dword v29,v116,s[4:7],s34 offen
buffer_store_short v29,v117,s[4:7],s34 offen
s_cmp_lg_u32 s61,0
s_cbranch_scc1 slow_51
slowr_52:
s_cbranch_vccnz Arr_50
s_xor_b32 s37,s37,0x80000000
s_xor_b32 s35,s35,0x80000000
s_mov_b32 s34,s29
s_add_u32 s29,s29,0x4000
s_and_b32 s29,s29,0xc800
s_add_u32 s29,s29,50397184
s_add_u32 s28,s28,0x2000
s_and_b32 s28,s28,0x6800
s_add_u32 s28,s28,50331648
s_add_u32 s62,s28,4096
s_add_u32 s32,s32,32768
s_add_u32 s63,s63,s36
s_add_u32 s26,s26,1
s_cmp_lt_u32 s26,63
s_cbranch_scc1 Aloop_45
s_branch Aexit_14
.p2align 6
Aloop_53:
s_sleep 4
buffer_load_dwordx4 v[28:31],v111,s[8:11],s32 offen sc1
buffer_load_dwordx4 v[32:35],v111,s[8:11],s32 offen offset:1024 sc1
buffer_load_dwordx4 v[44:47],v112,s[8:11],s32 offen sc1
buffer_load_dwordx4 v[48:51],v112,s[8:11],s32 offen offset:1024 sc1
s_sleep 3
Aent_38:
v_mov_b64 v[60:61],0
v_mov_b64 v[62:63],0
v_mov_b64 v[64:65],0
v_mov_b64 v[66:67],0
v_mov_b64 v[68:69],0
v_mov_b64 v[70:71],0
v_mov_b64 v[72:73],0
v_mov_b64 v[74:75],0
v_mov_b64 v[76:77],0
v_mov_b64 v[78:79],0
v_mov_b64 v[80:81],0
v_mov_b64 v[82:83],0
v_mov_b64 v[84:85],0
v_mov_b64 v[86:87],0
v_mov_b64 v[88:89],0
v_mov_b64 v[90:91],0
v_mov_b64 v[92:93],0
v_mov_b64 v[94:95],0
v_mov_b64 v[96:97],0
v_mov_b64 v[98:99],0
s_mov_b32 s27,0
buffer_load_ushort v100,v119,s[8:11],0 offen sc1
s_nop 9
buffer_load_ushort v101,v119,s[8:11],0 offen sc1
s_nop 9
buffer_load_ushort v102,v119,s[8:11],0 offen sc1
s_nop 9
buffer_load_ushort v103,v119,s[8:11],0 offen sc1
s_nop 9
buffer_load_ushort v104,v119,s[8:11],0 offen sc1
fp_56:
s_waitcnt vmcnt(4)
v_cmp_gt_u32 vcc,s63,v100
buffer_load_ushort v100,v119,s[8:11],0 offen sc1
s_cbranch_vccz fpd_57
s_waitcnt vmcnt(4)
v_cmp_gt_u32 vcc,s63,v101
buffer_load_ushort v101,v119,s[8:11],0 offen sc1
s_cbranch_vccz fpd_57
s_waitcnt vmcnt(4)
v_cmp_gt_u32 vcc,s63,v102
buffer_load_ushort v102,v119,s[8:11],0 offen sc1
s_cbranch_vccz fpd_57
s_waitcnt vmcnt(4)
v_cmp_gt_u32 vcc,s63,v103
buffer_load_ushort v103,v119,s[8:11],0 offen sc1
s_cbranch_vccz fpd_57
s_waitcnt vmcnt(4)
v_cmp_gt_u32 vcc,s63,v104
buffer_load_ushort v104,v119,s[8:11],0 offen sc1
s_cbranch_vccz fpd_57
s_waitcnt vmcnt(4)
v_cmp_gt_u32 vcc,s63,v100
buffer_load_ushort v100,v119,s[8:11],0 offen sc1
s_cbranch_vccz fpd_57
s_waitcnt vmcnt(4)
v_cmp_gt_u32 vcc,s63,v101
buffer_load_ushort v101,v119,s[8:11],0 offen sc1
s_cbranch_vccz fpd_57
s_waitcnt vmcnt(4)
v_cmp_gt_u32 vcc,s63,v102
buffer_load_ushort v102,v119,s[8:11],0 offen sc1
s_cbranch_vccz fpd_57
s_waitcnt vmcnt(4)
v_cmp_gt_u32 vcc,s63,v103
buffer_load_ushort v103,v119,s[8:11],0 offen sc1
s_cbranch_vccz fpd_57
s_waitcnt vmcnt(4)
v_cmp_gt_u32 vcc,s63,v104
buffer_load_ushort v104,v119,s[8:11],0 offen sc1
s_cbranch_vccz fpd_57
s_waitcnt vmcnt(4)
v_cmp_gt_u32 vcc,s63,v100
buffer_load_ushort v100,v119,s[8:11],0 offen sc1
s_cbranch_vccz fpd_57
s_waitcnt vmcnt(4)
v_cmp_gt_u32 vcc,s63,v101
buffer_load_ushort v101,v119,s[8:11],0 offen sc1
s_cbranch_vccz fpd_57
s_waitcnt vmcnt(4)
v_cmp_gt_u32 vcc,s63,v102
buffer_load_ushort v102,v119,s[8:11],0 offen sc1
s_cbranch_vccz fpd_57
s_waitcnt vmcnt(4)
v_cmp_gt_u32 vcc,s63,v103
buffer_load_ushort v103,v119,s[8:11],0 offen sc1
s_cbranch_vccz fpd_57
s_waitcnt vmcnt(4)
v_cmp_gt_u32 vcc,s63,v104
buffer_load_ushort v104,v119,s[8:11],0 offen sc1
s_cbranch_vccz fpd_57
s_add_u32 s27,s27,1
s_cmp_lt_u32 s27,131072
s_cbranch_scc1 fp_56
s_mov_b32 s38,1
s_branch L_end
fpd_57:
buffer_load_dwordx4 v[4:7],v109,s[8:11],s28 offen offset:1024 sc1
s_nop 12
buffer_load_dwordx4 v[8:11],v109,s[8:11],s28 offen offset:2048 sc1
s_nop 12
buffer_load_dwordx4 v[12:15],v109,s[8:11],s28 offen offset:3072 sc1
s_nop 12
buffer_load_dwordx4 v[16:19],v109,s[8:11],s62 offen sc1
Ago_54:
s_waitcnt vmcnt(3)
v_smfmac_f32_16x16x64_bf16 v[60:63],v[4:7],a[208:215],v108
buffer_load_dwordx4 v[20:23],v109,s[8:11],s62 offen offset:1024 sc1
v_smfmac_f32_16x16x64_bf16 v[64:67],v[4:7],a[240:247],v108
v_max3_u32 v100,v4,v5,v6
v_smfmac_f32_16x16x64_bf16 v[68:71],v[4:7],v[136:143],v108
v_max_u32 v100,v100,v7
v_smfmac_f32_16x16x64_bf16 v[72:75],v[4:7],v[168:175],v108
v_smfmac_f32_16x16x64_bf16 v[76:79],v[4:7],v[200:207],v108
buffer_load_dwordx4 v[24:27],v109,s[8:11],s62 offen offset:2048 sc1
v_smfmac_f32_16x16x64_bf16 v[80:83],v[4:7],v[232:239],v108
s_waitcnt vmcnt(4)
v_smfmac_f32_16x16x64_bf16 v[60:63],v[8:11],a[216:223],v108
v_smfmac_f32_16x16x64_bf16 v[64:67],v[8:11],a[248:255],v108
v_max3_u32 v100,v100,v8,v9
v_smfmac_f32_16x16x64_bf16 v[68:71],v[8:11],v[144:151],v108
buffer_load_dwordx4 v[0:3],v109,s[8:11],s28 offen sc1
v_max3_u32 v100,v100,v10,v11
v_smfmac_f32_16x16x64_bf16 v[72:75],v[8:11],v[176:183],v108
v_smfmac_f32_16x16x64_bf16 v[76:79],v[8:11],v[208:215],v108
v_smfmac_f32_16x16x64_bf16 v[80:83],v[8:11],v[240:247],v108
s_waitcnt vmcnt(4)
v_smfmac_f32_16x16x64_bf16 v[60:63],v[12:15],a[224:231],v108
buffer_load_dwordx4 v[36:39],v111,s[8:11],s32 offen offset:2048 sc1
v_smfmac_f32_16x16x64_bf16 v[64:67],v[12:15],v[120:127],v108
v_max3_u32 v100,v100,v12,v13
v_smfmac_f32_16x16x64_bf16 v[68:71],v[12:15],v[152:159],v108
v_max3_u32 v100,v100,v14,v15
v_smfmac_f32_16x16x64_bf16 v[72:75],v[12:15],v[184:191],v108
v_smfmac_f32_16x16x64_bf16 v[76:79],v[12:15],v[216:223],v108
buffer_load_dwordx4 v[40:43],v111,s[8:11],s32 offen offset:3072 sc1
v_smfmac_f32_16x16x64_bf16 v[80:83],v[12:15],v[248:255],v108
s_waitcnt vmcnt(5)
v_smfmac_f32_16x16x64_bf16 v[60:63],v[16:19],a[0:7],v108
v_max3_u32 v100,v100,v16,v17
v_smfmac_f32_16x16x64_bf16 v[64:67],v[16:19],a[24:31],v108
v_max3_u32 v100,v100,v18,v19
v_smfmac_f32_16x16x64_bf16 v[68:71],v[16:19],a[48:55],v108
buffer_load_dwordx4 v[52:55],v112,s[8:11],s32 offen offset:2048 sc1
v_smfmac_f32_16x16x64_bf16 v[72:75],v[16:19],a[72:79],v108
s_waitcnt vmcnt(5)
v_smfmac_f32_16x16x64_bf16 v[60:63],v[20:23],a[8:15],v108
v_max3_u32 v100,v100,v20,v21
v_smfmac_f32_16x16x64_bf16 v[64:67],v[20:23],a[32:39],v108
v_max3_u32 v100,v100,v22,v23
v_smfmac_f32_16x16x64_bf16 v[68:71],v[20:23],a[56:63],v108
buffer_load_dwordx4 v[56:59],v112,s[8:11],s32 offen offset:3072 sc1
v_smfmac_f32_16x16x64_bf16 v[72:75],v[20:23],a[80:87],v108
s_waitcnt vmcnt(5)
v_smfmac_f32_16x16x64_bf16 v[60:63],v[24:27],a[16:23],v108
v_max3_u32 v100,v100,v24,v25
v_smfmac_f32_16x16x64_bf16 v[64:67],v[24:27],a[40:47],v108
v_max3_u32 v100,v100,v26,v27
v_smfmac_f32_16x16x64_bf16 v[68:71],v[24:27],a[64:71],v108
v_smfmac_f32_16x16x64_bf16 v[72:75],v[24:27],a[88:95],v108
s_waitcnt vmcnt(4)
v_smfmac_f32_16x16x64_bf16 v[60:63],v[0:3],a[200:207],v108
v_max3_u32 v100,v100,v0,v1
v_smfmac_f32_16x16x64_bf16 v[64:67],v[0:3],a[232:239],v108
v_max3_u32 v100,v100,v2,v3
v_smfmac_f32_16x16x64_bf16 v[68:71],v[0:3],v[128:135],v108
v_cmp_eq_u32 vcc,-1,v100
v_smfmac_f32_16x16x64_bf16 v[72:75],v[0:3],v[160:167],v108
v_add_f32 v60,v60,v61
v_smfmac_f32_16x16x64_bf16 v[76:79],v[16:19],a[96:103],v108
v_add_f32 v62,v62,v63
v_smfmac_f32_16x16x64_bf16 v[76:79],v[20:23],a[104:111],v108
s_cbranch_vccnz Aredo_55
v_add_f32 v64,v64,v65
v_smfmac_f32_16x16x64_bf16 v[76:79],v[24:27],a[112:119],v108
v_cvt_pk_bf16_f32 v61,v60,v64
v_smfmac_f32_16x16x64_bf16 v[76:79],v[0:3],v[192:199],v108
ds_write_b32 v113,v61 offset:0
v_add_f32 v66,v66,v67
v_smfmac_f32_16x16x64_bf16 v[80:83],v[16:19],a[120:127],v108
v_cvt_pk_bf16_f32 v63,v62,v66
v_smfmac_f32_16x16x64_bf16 v[80:83],v[20:23],a[128:135],v108
ds_write_b32 v113,v63 offset:32
v_add_f32 v68,v68,v69
v_smfmac_f32_16x16x64_bf16 v[80:83],v[24:27],a[136:143],v108
v_add_f32 v70,v70,v71
v_smfmac_f32_16x16x64_bf16 v[80:83],v[0:3],v[224:231],v108
v_add_f32 v72,v72,v73
v_smfmac_f32_16x16x64_bf16 v[84:87],v[4:7],a[152:159],v108
v_cvt_pk_bf16_f32 v69,v68,v72
v_smfmac_f32_16x16x64_bf16 v[84:87],v[8:11],a[160:167],v108
ds_write_b32 v113,v69 offset:512
v_add_f32 v74,v74,v75
v_smfmac_f32_16x16x64_bf16 v[84:87],v[12:15],a[168:175],v108
v_cvt_pk_bf16_f32 v71,v70,v74
v_smfmac_f32_16x16x64_bf16 v[84:87],v[16:19],a[176:183],v108
ds_write_b32 v113,v71 offset:544
v_smfmac_f32_16x16x64_bf16 v[84:87],v[20:23],a[184:191],v108
ds_read_b128 v[100:103],v110 offset:0
v_add_f32 v76,v76,v77
v_smfmac_f32_16x16x64_bf16 v[84:87],v[24:27],a[192:199],v108
v_add_f32 v78,v78,v79
v_smfmac_f32_16x16x64_bf16 v[84:87],v[0:3],a[144:151],v108
v_add_f32 v80,v80,v81
v_cvt_pk_bf16_f32 v77,v76,v80
v_add_f32 v82,v82,v83
v_cvt_pk_bf16_f32 v79,v78,v82
ds_write_b32 v114,v77 offset:1024
ds_write_b32 v114,v79 offset:1056
s_nop 1
v_add_f32 v84,v84,v85
v_add_f32 v86,v86,v87
v_cvt_pk_bf16_f32 v84,v84,v86
ds_write_b16 v115,v84 offset:1024
ds_write_b16_d16_hi v115,v84 offset:1056
ds_read_b128 v[104:107],v110 offset:1024
s_waitcnt vmcnt(0) lgkmcnt(5)
v_smfmac_f32_16x16x64_bf16 v[88:91],v[100:103],v[28:35],v108
v_mov_b32 v63,s37
v_smfmac_f32_16x16x64_bf16 v[92:95],v[100:103],v[44:51],v108
v_mov_b32 v67,s37
v_smfmac_f32_16x16x64_bf16 v[96:99],v[100:103],v[0:7],v108
s_waitcnt lgkmcnt(0)
v_smfmac_f32_16x16x64_bf16 v[96:99],v[104:107],v[16:23],v108
v_smfmac_f32_16x16x64_bf16 v[88:91],v[104:107],v[36:43],v108
v_smfmac_f32_16x16x64_bf16 v[92:95],v[104:107],v[52:59],v108
s_nop 0
v_add_f32 v68,v96,v97
v_add_f32 v69,v98,v99
s_nop 1
v_add_f32 v60,v88,v89
v_add_f32 v64,v90,v91
v_mov_b32_dpp v62,v68 quad_perm:[1,1,3,3] row_mask:0xf bank_mask:0xf
v_mov_b32_dpp v66,v69 quad_perm:[1,1,3,3] row_mask:0xf bank_mask:0xf
v_add_f32 v61,v92,v93
ds_write_b128 v110,v[60:63] offset:8192
s_barrier
Arr_58:
ds_read_b128 v[72:75],v109 offset:9216
ds_read_b128 v[76:79],v109 offset:13312
ds_read_b128 v[80:83],v109 offset:15360
v_add_f32 v65,v94,v95
v_mov_b32 v29,-1
s_waitcnt lgkmcnt(2)
v_pk_add_f32 v[84:85],v[64:65],v[72:73]
v_pk_add_f32 v[86:87],v[66:67],v[74:75]
s_waitcnt lgkmcnt(1)
v_pk_add_f32 v[84:85],v[84:85],v[76:77]
v_pk_add_f32 v[86:87],v[86:87],v[78:79]
s_waitcnt lgkmcnt(0)
v_pk_add_f32 v[84:85],v[84:85],v[80:81]
v_pk_add_f32 v[86:87],v[86:87],v[82:83]
v_max3_f32 v72,v84,v85,v86
v_cmp_neq_f32 vcc,s35,v87
s_nop 0
v_max_f32_dpp v72,v72,v72 row_ror:1 row_mask:0xf bank_mask:0xf
s_nop 1
v_max_f32_dpp v72,v72,v72 row_ror:2 row_mask:0xf bank_mask:0xf
s_nop 1
v_max_f32_dpp v72,v72,v72 row_ror:4 row_mask:0xf bank_mask:0xf
s_nop 1
v_max_f32_dpp v72,v72,v72 row_ror:8 row_mask:0xf bank_mask:0xf
v_pk_add_f32 v[84:85],v[84:85],v[72:73] op_sel_hi:[1,0] neg_lo:[0,1] neg_hi:[0,1]
v_sub_f32 v86,v86,v72
v_exp_f32 v84,v84
v_exp_f32 v85,v85
v_exp_f32 v86,v86
v_add_f32 v72,v84,v85
v_fmac_f32 v72,0.5,v86
s_cmp_lg_u64 vcc,0
s_cselect_b32 s31,0x7f000000,s29
v_add_f32_dpp v72,v72,v72 row_ror:1 row_mask:0xf bank_mask:0xf
s_nop 1
v_add_f32_dpp v72,v72,v72 row_ror:2 row_mask:0xf bank_mask:0xf
s_nop 1
v_add_f32_dpp v72,v72,v72 row_ror:4 row_mask:0xf bank_mask:0xf
s_nop 1
v_add_f32_dpp v72,v72,v72 row_ror:8 row_mask:0xf bank_mask:0xf
v_rcp_f32 v72,v72
s_nop 0
v_pk_mul_f32 v[84:85],v[84:85],v[72:73] op_sel_hi:[1,0]
v_mul_f32 v86,v86,v72
v_cvt_pk_bf16_f32 v84,|v84|,|v85|
v_cvt_pk_bf16_f32 v86,|v86|,|v86|
buffer_store_dword v84,v116,s[4:7],s31 offen
buffer_store_short v86,v117,s[4:7],s31 offen
buffer_store_dword v29,v116,s[4:7],s34 offen
buffer_store_short v29,v117,s[4:7],s34 offen
s_cmp_lg_u32 s61,0
s_cbranch_scc1 slow_59
slowr_60:
s_cbranch_vccnz Arr_58
s_xor_b32 s37,s37,0x80000000
s_xor_b32 s35,s35,0x80000000
s_mov_b32 s34,s29
s_add_u32 s29,s29,0x4000
s_and_b32 s29,s29,0xc800
s_add_u32 s29,s29,50397184
s_add_u32 s28,s28,0x2000
s_and_b32 s28,s28,0x6800
s_add_u32 s28,s28,50331648
s_add_u32 s62,s28,4096
s_add_u32 s32,s32,32768
s_add_u32 s63,s63,s36
s_add_u32 s26,s26,1
s_cmp_lt_u32 s26,63
s_cbranch_scc1 Aloop_53
s_branch Aexit_14
.p2align 6
Aloop_61:
s_sleep 9
buffer_load_dwordx4 v[28:31],v111,s[8:11],s32 offen sc1
buffer_load_dwordx4 v[32:35],v111,s[8:11],s32 offen offset:1024 sc1
buffer_load_dwordx4 v[44:47],v112,s[8:11],s32 offen sc1
buffer_load_dwordx4 v[48:51],v112,s[8:11],s32 offen offset:1024 sc1
s_sleep 3
Aent_39:
v_mov_b64 v[60:61],0
v_mov_b64 v[62:63],0
v_mov_b64 v[64:65],0
v_mov_b64 v[66:67],0
v_mov_b64 v[68:69],0
v_mov_b64 v[70:71],0
v_mov_b64 v[72:73],0
v_mov_b64 v[74:75],0
v_mov_b64 v[76:77],0
v_mov_b64 v[78:79],0
v_mov_b64 v[80:81],0
v_mov_b64 v[82:83],0
v_mov_b64 v[84:85],0
v_mov_b64 v[86:87],0
v_mov_b64 v[88:89],0
v_mov_b64 v[90:91],0
v_mov_b64 v[92:93],0
v_mov_b64 v[94:95],0
v_mov_b64 v[96:97],0
v_mov_b64 v[98:99],0
s_mov_b32 s27,0
buffer_load_ushort v100,v119,s[8:11],0 offen sc1
s_nop 9
buffer_load_ushort v101,v119,s[8:11],0 offen sc1
s_nop 9
buffer_load_ushort v102,v119,s[8:11],0 offen sc1
s_nop 9
buffer_load_ushort v103,v119,s[8:11],0 offen sc1
s_nop 9
buffer_load_ushort v104,v119,s[8:11],0 offen sc1
fp_64:
s_waitcnt vmcnt(4)
v_cmp_gt_u32 vcc,s63,v100
buffer_load_ushort v100,v119,s[8:11],0 offen sc1
s_cbranch_vccz fpd_65
s_waitcnt vmcnt(4)
v_cmp_gt_u32 vcc,s63,v101
buffer_load_ushort v101,v119,s[8:11],0 offen sc1
s_cbranch_vccz fpd_65
s_waitcnt vmcnt(4)
v_cmp_gt_u32 vcc,s63,v102
buffer_load_ushort v102,v119,s[8:11],0 offen sc1
s_cbranch_vccz fpd_65
s_waitcnt vmcnt(4)
v_cmp_gt_u32 vcc,s63,v103
buffer_load_ushort v103,v119,s[8:11],0 offen sc1
s_cbranch_vccz fpd_65
s_waitcnt vmcnt(4)
v_cmp_gt_u32 vcc,s63,v104
buffer_load_ushort v104,v119,s[8:11],0 offen sc1
s_cbranch_vccz fpd_65
s_waitcnt vmcnt(4)
v_cmp_gt_u32 vcc,s63,v100
buffer_load_ushort v100,v119,s[8:11],0 offen sc1
s_cbranch_vccz fpd_65
s_waitcnt vmcnt(4)
v_cmp_gt_u32 vcc,s63,v101
buffer_load_ushort v101,v119,s[8:11],0 offen sc1
s_cbranch_vccz fpd_65
s_waitcnt vmcnt(4)
v_cmp_gt_u32 vcc,s63,v102
buffer_load_ushort v102,v119,s[8:11],0 offen sc1
s_cbranch_vccz fpd_65
s_waitcnt vmcnt(4)
v_cmp_gt_u32 vcc,s63,v103
buffer_load_ushort v103,v119,s[8:11],0 offen sc1
s_cbranch_vccz fpd_65
s_waitcnt vmcnt(4)
v_cmp_gt_u32 vcc,s63,v104
buffer_load_ushort v104,v119,s[8:11],0 offen sc1
s_cbranch_vccz fpd_65
s_waitcnt vmcnt(4)
v_cmp_gt_u32 vcc,s63,v100
buffer_load_ushort v100,v119,s[8:11],0 offen sc1
s_cbranch_vccz fpd_65
s_waitcnt vmcnt(4)
v_cmp_gt_u32 vcc,s63,v101
buffer_load_ushort v101,v119,s[8:11],0 offen sc1
s_cbranch_vccz fpd_65
s_waitcnt vmcnt(4)
v_cmp_gt_u32 vcc,s63,v102
buffer_load_ushort v102,v119,s[8:11],0 offen sc1
s_cbranch_vccz fpd_65
s_waitcnt vmcnt(4)
v_cmp_gt_u32 vcc,s63,v103
buffer_load_ushort v103,v119,s[8:11],0 offen sc1
s_cbranch_vccz fpd_65
s_waitcnt vmcnt(4)
v_cmp_gt_u32 vcc,s63,v104
buffer_load_ushort v104,v119,s[8:11],0 offen sc1
s_cbranch_vccz fpd_65
s_add_u32 s27,s27,1
s_cmp_lt_u32 s27,131072
s_cbranch_scc1 fp_64
s_mov_b32 s38,1
s_branch L_end
fpd_65:
buffer_load_dwordx4 v[16:19],v109,s[8:11],s62 offen sc1
s_nop 12
buffer_load_dwordx4 v[20:23],v109,s[8:11],s62 offen offset:1024 sc1
s_nop 12
buffer_load_dwordx4 v[24:27],v109,s[8:11],s62 offen offset:2048 sc1
s_nop 12
buffer_load_dwordx4 v[0:3],v109,s[8:11],s28 offen sc1
Ago_62:
s_waitcnt vmcnt(3)
v_smfmac_f32_16x16x64_bf16 v[60:63],v[16:19],a[0:7],v108
buffer_load_dwordx4 v[4:7],v109,s[8:11],s28 offen offset:1024 sc1
v_smfmac_f32_16x16x64_bf16 v[64:67],v[16:19],a[24:31],v108
v_max3_u32 v100,v16,v17,v18
v_smfmac_f32_16x16x64_bf16 v[68:71],v[16:19],a[48:55],v108
v_max_u32 v100,v100,v19
v_smfmac_f32_16x16x64_bf16 v[72:75],v[16:19],a[72:79],v108
v_smfmac_f32_16x16x64_bf16 v[76:79],v[16:19],a[96:103],v108
buffer_load_dwordx4 v[8:11],v109,s[8:11],s28 offen offset:2048 sc1
v_smfmac_f32_16x16x64_bf16 v[80:83],v[16:19],a[120:127],v108
s_waitcnt vmcnt(4)
v_smfmac_f32_16x16x64_bf16 v[60:63],v[20:23],a[8:15],v108
v_smfmac_f32_16x16x64_bf16 v[64:67],v[20:23],a[32:39],v108
v_max3_u32 v100,v100,v20,v21
v_smfmac_f32_16x16x64_bf16 v[68:71],v[20:23],a[56:63],v108
buffer_load_dwordx4 v[12:15],v109,s[8:11],s28 offen offset:3072 sc1
v_max3_u32 v100,v100,v22,v23
v_smfmac_f32_16x16x64_bf16 v[72:75],v[20:23],a[80:87],v108
v_smfmac_f32_16x16x64_bf16 v[76:79],v[20:23],a[104:111],v108
v_smfmac_f32_16x16x64_bf16 v[80:83],v[20:23],a[128:135],v108
s_waitcnt vmcnt(4)
v_smfmac_f32_16x16x64_bf16 v[60:63],v[24:27],a[16:23],v108
buffer_load_dwordx4 v[36:39],v111,s[8:11],s32 offen offset:2048 sc1
v_smfmac_f32_16x16x64_bf16 v[64:67],v[24:27],a[40:47],v108
v_max3_u32 v100,v100,v24,v25
v_smfmac_f32_16x16x64_bf16 v[68:71],v[24:27],a[64:71],v108
v_max3_u32 v100,v100,v26,v27
v_smfmac_f32_16x16x64_bf16 v[72:75],v[24:27],a[88:95],v108
v_smfmac_f32_16x16x64_bf16 v[76:79],v[24:27],a[112:119],v108
buffer_load_dwordx4 v[40:43],v111,s[8:11],s32 offen offset:3072 sc1
v_smfmac_f32_16x16x64_bf16 v[80:83],v[24:27],a[136:143],v108
s_waitcnt vmcnt(5)
v_smfmac_f32_16x16x64_bf16 v[60:63],v[0:3],a[200:207],v108
v_max3_u32 v100,v100,v0,v1
v_smfmac_f32_16x16x64_bf16 v[64:67],v[0:3],a[232:239],v108
v_max3_u32 v100,v100,v2,v3
v_smfmac_f32_16x16x64_bf16 v[68:71],v[0:3],v[128:135],v108
buffer_load_dwordx4 v[52:55],v112,s[8:11],s32 offen offset:2048 sc1
v_smfmac_f32_16x16x64_bf16 v[72:75],v[0:3],v[160:167],v108
s_waitcnt vmcnt(5)
v_smfmac_f32_16x16x64_bf16 v[60:63],v[4:7],a[208:215],v108
v_max3_u32 v100,v100,v4,v5
v_smfmac_f32_16x16x64_bf16 v[64:67],v[4:7],a[240:247],v108
v_max3_u32 v100,v100,v6,v7
v_smfmac_f32_16x16x64_bf16 v[68:71],v[4:7],v[136:143],v108
buffer_load_dwordx4 v[56:59],v112,s[8:11],s32 offen offset:3072 sc1
v_smfmac_f32_16x16x64_bf16 v[72:75],v[4:7],v[168:175],v108
s_waitcnt vmcnt(5)
v_smfmac_f32_16x16x64_bf16 v[60:63],v[8:11],a[216:223],v108
v_max3_u32 v100,v100,v8,v9
v_smfmac_f32_16x16x64_bf16 v[64:67],v[8:11],a[248:255],v108
v_max3_u32 v100,v100,v10,v11
v_smfmac_f32_16x16x64_bf16 v[68:71],v[8:11],v[144:151],v108
v_smfmac_f32_16x16x64_bf16 v[72:75],v[8:11],v[176:183],v108
s_waitcnt vmcnt(4)
v_smfmac_f32_16x16x64_bf16 v[60:63],v[12:15],a[224:231],v108
v_max3_u32 v100,v100,v12,v13
v_smfmac_f32_16x16x64_bf16 v[64:67],v[12:15],v[120:127],v108
v_max3_u32 v100,v100,v14,v15
v_smfmac_f32_16x16x64_bf16 v[68:71],v[12:15],v[152:159],v108
v_cmp_eq_u32 vcc,-1,v100
v_smfmac_f32_16x16x64_bf16 v[72:75],v[12:15],v[184:191],v108
v_add_f32 v60,v60,v61
v_smfmac_f32_16x16x64_bf16 v[76:79],v[0:3],v[192:199],v108
v_add_f32 v62,v62,v63
v_smfmac_f32_16x16x64_bf16 v[76:79],v[4:7],v[200:207],v108
s_cbranch_vccnz Aredo_63
v_add_f32 v64,v64,v65
v_smfmac_f32_16x16x64_bf16 v[76:79],v[8:11],v[208:215],v108
v_cvt_pk_bf16_f32 v61,v60,v64
v_smfmac_f32_16x16x64_bf16 v[76:79],v[12:15],v[216:223],v108
ds_write_b32 v113,v61 offset:0
v_add_f32 v66,v66,v67
v_smfmac_f32_16x16x64_bf16 v[80:83],v[0:3],v[224:231],v108
v_cvt_pk_bf16_f32 v63,v62,v66
v_smfmac_f32_16x16x64_bf16 v[80:83],v[4:7],v[232:239],v108
ds_write_b32 v113,v63 offset:32
v_add_f32 v68,v68,v69
v_smfmac_f32_16x16x64_bf16 v[80:83],v[8:11],v[240:247],v108
v_add_f32 v70,v70,v71
v_smfmac_f32_16x16x64_bf16 v[80:83],v[12:15],v[248:255],v108
v_add_f32 v72,v72,v73
v_smfmac_f32_16x16x64_bf16 v[84:87],v[16:19],a[176:183],v108
v_cvt_pk_bf16_f32 v69,v68,v72
v_smfmac_f32_16x16x64_bf16 v[84:87],v[20:23],a[184:191],v108
ds_write_b32 v113,v69 offset:512
v_add_f32 v74,v74,v75
v_smfmac_f32_16x16x64_bf16 v[84:87],v[24:27],a[192:199],v108
v_cvt_pk_bf16_f32 v71,v70,v74
v_smfmac_f32_16x16x64_bf16 v[84:87],v[0:3],a[144:151],v108
ds_write_b32 v113,v71 offset:544
v_smfmac_f32_16x16x64_bf16 v[84:87],v[4:7],a[152:159],v108
ds_read_b128 v[100:103],v110 offset:0
v_add_f32 v76,v76,v77
v_smfmac_f32_16x16x64_bf16 v[84:87],v[8:11],a[160:167],v108
v_add_f32 v78,v78,v79
v_smfmac_f32_16x16x64_bf16 v[84:87],v[12:15],a[168:175],v108
v_add_f32 v80,v80,v81
v_cvt_pk_bf16_f32 v77,v76,v80
v_add_f32 v82,v82,v83
v_cvt_pk_bf16_f32 v79,v78,v82
ds_write_b32 v114,v77 offset:1024
ds_write_b32 v114,v79 offset:1056
s_nop 1
v_add_f32 v84,v84,v85
v_add_f32 v86,v86,v87
v_cvt_pk_bf16_f32 v84,v84,v86
ds_write_b16 v115,v84 offset:1024
ds_write_b16_d16_hi v115,v84 offset:1056
ds_read_b128 v[104:107],v110 offset:1024
s_waitcnt vmcnt(0) lgkmcnt(5)
v_smfmac_f32_16x16x64_bf16 v[88:91],v[100:103],v[28:35],v108
v_mov_b32 v63,s37
v_smfmac_f32_16x16x64_bf16 v[92:95],v[100:103],v[44:51],v108
v_mov_b32 v67,s37
v_smfmac_f32_16x16x64_bf16 v[96:99],v[100:103],v[8:15],v108
s_waitcnt lgkmcnt(0)
v_smfmac_f32_16x16x64_bf16 v[96:99],v[104:107],v[20:27],v108
v_smfmac_f32_16x16x64_bf16 v[88:91],v[104:107],v[36:43],v108
v_smfmac_f32_16x16x64_bf16 v[92:95],v[104:107],v[52:59],v108
s_nop 0
v_add_f32 v68,v96,v97
v_add_f32 v69,v98,v99
s_nop 1
v_add_f32 v60,v88,v89
v_add_f32 v64,v90,v91
v_mov_b32_dpp v62,v68 quad_perm:[0,0,2,2] row_mask:0xf bank_mask:0xf
v_mov_b32_dpp v66,v69 quad_perm:[0,0,2,2] row_mask:0xf bank_mask:0xf
v_add_f32 v61,v92,v93
v_add_f32 v65,v94,v95
ds_write_b128 v110,v[60:63] offset:8192
ds_write_b128 v110,v[64:67] offset:9216
s_barrier
s_xor_b32 s37,s37,0x80000000
s_xor_b32 s35,s35,0x80000000
s_mov_b32 s34,s29
s_add_u32 s29,s29,0x4000
s_and_b32 s29,s29,0xc800
s_add_u32 s29,s29,50397184
s_add_u32 s28,s28,0x2000
s_and_b32 s28,s28,0x6800
s_add_u32 s28,s28,50331648
s_add_u32 s62,s28,4096
s_add_u32 s32,s32,32768
s_add_u32 s63,s63,s36
s_add_u32 s26,s26,1
s_cmp_lt_u32 s26,63
s_cbranch_scc1 Aloop_61
s_branch Aexit_14
.p2align 6
Aloop_66:
s_sleep 6
buffer_load_dwordx4 v[28:31],v111,s[8:11],s32 offen sc1
buffer_load_dwordx4 v[32:35],v111,s[8:11],s32 offen offset:1024 sc1
buffer_load_dwordx4 v[44:47],v112,s[8:11],s32 offen sc1
buffer_load_dwordx4 v[48:51],v112,s[8:11],s32 offen offset:1024 sc1
s_sleep 3
Aent_40:
v_mov_b64 v[60:61],0
v_mov_b64 v[62:63],0
v_mov_b64 v[64:65],0
v_mov_b64 v[66:67],0
v_mov_b64 v[68:69],0
v_mov_b64 v[70:71],0
v_mov_b64 v[72:73],0
v_mov_b64 v[74:75],0
v_mov_b64 v[76:77],0
v_mov_b64 v[78:79],0
v_mov_b64 v[80:81],0
v_mov_b64 v[82:83],0
v_mov_b64 v[84:85],0
v_mov_b64 v[86:87],0
v_mov_b64 v[88:89],0
v_mov_b64 v[90:91],0
v_mov_b64 v[92:93],0
v_mov_b64 v[94:95],0
v_mov_b64 v[96:97],0
v_mov_b64 v[98:99],0
s_mov_b32 s27,0
buffer_load_ushort v100,v119,s[8:11],0 offen sc1
s_nop 9
buffer_load_ushort v101,v119,s[8:11],0 offen sc1
s_nop 9
buffer_load_ushort v102,v119,s[8:11],0 offen sc1
s_nop 9
buffer_load_ushort v103,v119,s[8:11],0 offen sc1
s_nop 9
buffer_load_ushort v104,v119,s[8:11],0 offen sc1
fp_69:
s_waitcnt vmcnt(4)
v_cmp_gt_u32 vcc,s63,v100
buffer_load_ushort v100,v119,s[8:11],0 offen sc1
s_cbranch_vccz fpd_70
s_waitcnt vmcnt(4)
v_cmp_gt_u32 vcc,s63,v101
buffer_load_ushort v101,v119,s[8:11],0 offen sc1
s_cbranch_vccz fpd_70
s_waitcnt vmcnt(4)
v_cmp_gt_u32 vcc,s63,v102
buffer_load_ushort v102,v119,s[8:11],0 offen sc1
s_cbranch_vccz fpd_70
s_waitcnt vmcnt(4)
v_cmp_gt_u32 vcc,s63,v103
buffer_load_ushort v103,v119,s[8:11],0 offen sc1
s_cbranch_vccz fpd_70
s_waitcnt vmcnt(4)
v_cmp_gt_u32 vcc,s63,v104
buffer_load_ushort v104,v119,s[8:11],0 offen sc1
s_cbranch_vccz fpd_70
s_waitcnt vmcnt(4)
v_cmp_gt_u32 vcc,s63,v100
buffer_load_ushort v100,v119,s[8:11],0 offen sc1
s_cbranch_vccz fpd_70
s_waitcnt vmcnt(4)
v_cmp_gt_u32 vcc,s63,v101
buffer_load_ushort v101,v119,s[8:11],0 offen sc1
s_cbranch_vccz fpd_70
s_waitcnt vmcnt(4)
v_cmp_gt_u32 vcc,s63,v102
buffer_load_ushort v102,v119,s[8:11],0 offen sc1
s_cbranch_vccz fpd_70
s_waitcnt vmcnt(4)
v_cmp_gt_u32 vcc,s63,v103
buffer_load_ushort v103,v119,s[8:11],0 offen sc1
s_cbranch_vccz fpd_70
s_waitcnt vmcnt(4)
v_cmp_gt_u32 vcc,s63,v104
buffer_load_ushort v104,v119,s[8:11],0 offen sc1
s_cbranch_vccz fpd_70
s_waitcnt vmcnt(4)
v_cmp_gt_u32 vcc,s63,v100
buffer_load_ushort v100,v119,s[8:11],0 offen sc1
s_cbranch_vccz fpd_70
s_waitcnt vmcnt(4)
v_cmp_gt_u32 vcc,s63,v101
buffer_load_ushort v101,v119,s[8:11],0 offen sc1
s_cbranch_vccz fpd_70
s_waitcnt vmcnt(4)
v_cmp_gt_u32 vcc,s63,v102
buffer_load_ushort v102,v119,s[8:11],0 offen sc1
s_cbranch_vccz fpd_70
s_waitcnt vmcnt(4)
v_cmp_gt_u32 vcc,s63,v103
buffer_load_ushort v103,v119,s[8:11],0 offen sc1
s_cbranch_vccz fpd_70
s_waitcnt vmcnt(4)
v_cmp_gt_u32 vcc,s63,v104
buffer_load_ushort v104,v119,s[8:11],0 offen sc1
s_cbranch_vccz fpd_70
s_add_u32 s27,s27,1
s_cmp_lt_u32 s27,131072
s_cbranch_scc1 fp_69
s_mov_b32 s38,1
s_branch L_end
fpd_70:
buffer_load_dwordx4 v[20:23],v109,s[8:11],s62 offen offset:1024 sc1
s_nop 12
buffer_load_dwordx4 v[24:27],v109,s[8:11],s62 offen offset:2048 sc1
s_nop 12
buffer_load_dwordx4 v[0:3],v109,s[8:11],s28 offen sc1
s_nop 12
buffer_load_dwordx4 v[4:7],v109,s[8:11],s28 offen offset:1024 sc1
Ago_67:
s_waitcnt vmcnt(3)
v_smfmac_f32_16x16x64_bf16 v[60:63],v[20:23],a[8:15],v108
buffer_load_dwordx4 v[8:11],v109,s[8:11],s28 offen offset:2048 sc1
v_smfmac_f32_16x16x64_bf16 v[64:67],v[20:23],a[32:39],v108
v_max3_u32 v100,v20,v21,v22
v_smfmac_f32_16x16x64_bf16 v[68:71],v[20:23],a[56:63],v108
v_max_u32 v100,v100,v23
v_smfmac_f32_16x16x64_bf16 v[72:75],v[20:23],a[80:87],v108
v_smfmac_f32_16x16x64_bf16 v[76:79],v[20:23],a[104:111],v108
buffer_load_dwordx4 v[12:15],v109,s[8:11],s28 offen offset:3072 sc1
v_smfmac_f32_16x16x64_bf16 v[80:83],v[20:23],a[128:135],v108
s_waitcnt vmcnt(4)
v_smfmac_f32_16x16x64_bf16 v[60:63],v[24:27],a[16:23],v108
v_smfmac_f32_16x16x64_bf16 v[64:67],v[24:27],a[40:47],v108
v_max3_u32 v100,v100,v24,v25
v_smfmac_f32_16x16x64_bf16 v[68:71],v[24:27],a[64:71],v108
buffer_load_dwordx4 v[16:19],v109,s[8:11],s62 offen sc1
v_max3_u32 v100,v100,v26,v27
v_smfmac_f32_16x16x64_bf16 v[72:75],v[24:27],a[88:95],v108
v_smfmac_f32_16x16x64_bf16 v[76:79],v[24:27],a[112:119],v108
v_smfmac_f32_16x16x64_bf16 v[80:83],v[24:27],a[136:143],v108
s_waitcnt vmcnt(4)
v_smfmac_f32_16x16x64_bf16 v[60:63],v[0:3],a[200:207],v108
buffer_load_dwordx4 v[36:39],v111,s[8:11],s32 offen offset:2048 sc1
v_smfmac_f32_16x16x64_bf16 v[64:67],v[0:3],a[232:239],v108
v_max3_u32 v100,v100,v0,v1
v_smfmac_f32_16x16x64_bf16 v[68:71],v[0:3],v[128:135],v108
v_max3_u32 v100,v100,v2,v3
v_smfmac_f32_16x16x64_bf16 v[72:75],v[0:3],v[160:167],v108
v_smfmac_f32_16x16x64_bf16 v[76:79],v[0:3],v[192:199],v108
buffer_load_dwordx4 v[40:43],v111,s[8:11],s32 offen offset:3072 sc1
v_smfmac_f32_16x16x64_bf16 v[80:83],v[0:3],v[224:231],v108
s_waitcnt vmcnt(5)
v_smfmac_f32_16x16x64_bf16 v[60:63],v[4:7],a[208:215],v108
v_max3_u32 v100,v100,v4,v5
v_smfmac_f32_16x16x64_bf16 v[64:67],v[4:7],a[240:247],v108
v_max3_u32 v100,v100,v6,v7
v_smfmac_f32_16x16x64_bf16 v[68:71],v[4:7],v[136:143],v108
buffer_load_dwordx4 v[52:55],v112,s[8:11],s32 offen offset:2048 sc1
v_smfmac_f32_16x16x64_bf16 v[72:75],v[4:7],v[168:175],v108
s_waitcnt vmcnt(5)
v_smfmac_f32_16x16x64_bf16 v[60:63],v[8:11],a[216:223],v108
v_max3_u32 v100,v100,v8,v9
v_smfmac_f32_16x16x64_bf16 v[64:67],v[8:11],a[248:255],v108
v_max3_u32 v100,v100,v10,v11
v_smfmac_f32_16x16x64_bf16 v[68:71],v[8:11],v[144:151],v108
buffer_load_dwordx4 v[56:59],v112,s[8:11],s32 offen offset:3072 sc1
v_smfmac_f32_16x16x64_bf16 v[72:75],v[8:11],v[176:183],v108
s_waitcnt vmcnt(5)
v_smfmac_f32_16x16x64_bf16 v[60:63],v[12:15],a[224:231],v108
v_max3_u32 v100,v100,v12,v13
v_smfmac_f32_16x16x64_bf16 v[64:67],v[12:15],v[120:127],v108
v_max3_u32 v100,v100,v14,v15
v_smfmac_f32_16x16x64_bf16 v[68:71],v[12:15],v[152:159],v108
v_smfmac_f32_16x16x64_bf16 v[72:75],v[12:15],v[184:191],v108
s_waitcnt vmcnt(4)
v_smfmac_f32_16x16x64_bf16 v[60:63],v[16:19],a[0:7],v108
v_max3_u32 v100,v100,v16,v17
v_smfmac_f32_16x16x64_bf16 v[64:67],v[16:19],a[24:31],v108
v_max3_u32 v100,v100,v18,v19
v_smfmac_f32_16x16x64_bf16 v[68:71],v[16:19],a[48:55],v108
v_cmp_eq_u32 vcc,-1,v100
v_smfmac_f32_16x16x64_bf16 v[72:75],v[16:19],a[72:79],v108
v_add_f32 v60,v60,v61
v_smfmac_f32_16x16x64_bf16 v[76:79],v[4:7],v[200:207],v108
v_add_f32 v62,v62,v63
v_smfmac_f32_16x16x64_bf16 v[76:79],v[8:11],v[208:215],v108
s_cbranch_vccnz Aredo_68
v_add_f32 v64,v64,v65
v_smfmac_f32_16x16x64_bf16 v[76:79],v[12:15],v[216:223],v108
v_cvt_pk_bf16_f32 v61,v60,v64
v_smfmac_f32_16x16x64_bf16 v[76:79],v[16:19],a[96:103],v108
ds_write_b32 v113,v61 offset:0
v_add_f32 v66,v66,v67
v_smfmac_f32_16x16x64_bf16 v[80:83],v[4:7],v[232:239],v108
v_cvt_pk_bf16_f32 v63,v62,v66
v_smfmac_f32_16x16x64_bf16 v[80:83],v[8:11],v[240:247],v108
ds_write_b32 v113,v63 offset:32
v_add_f32 v68,v68,v69
v_smfmac_f32_16x16x64_bf16 v[80:83],v[12:15],v[248:255],v108
v_add_f32 v70,v70,v71
v_smfmac_f32_16x16x64_bf16 v[80:83],v[16:19],a[120:127],v108
v_add_f32 v72,v72,v73
v_smfmac_f32_16x16x64_bf16 v[84:87],v[20:23],a[184:191],v108
v_cvt_pk_bf16_f32 v69,v68,v72
v_smfmac_f32_16x16x64_bf16 v[84:87],v[24:27],a[192:199],v108
ds_write_b32 v113,v69 offset:512
v_add_f32 v74,v74,v75
v_smfmac_f32_16x16x64_bf16 v[84:87],v[0:3],a[144:151],v108
v_cvt_pk_bf16_f32 v71,v70,v74
v_smfmac_f32_16x16x64_bf16 v[84:87],v[4:7],a[152:159],v108
ds_write_b32 v113,v71 offset:544
v_smfmac_f32_16x16x64_bf16 v[84:87],v[8:11],a[160:167],v108
ds_read_b128 v[100:103],v110 offset:0
v_add_f32 v76,v76,v77
v_smfmac_f32_16x16x64_bf16 v[84:87],v[12:15],a[168:175],v108
v_add_f32 v78,v78,v79
v_smfmac_f32_16x16x64_bf16 v[84:87],v[16:19],a[176:183],v108
v_add_f32 v80,v80,v81
v_cvt_pk_bf16_f32 v77,v76,v80
v_add_f32 v82,v82,v83
v_cvt_pk_bf16_f32 v79,v78,v82
ds_write_b32 v114,v77 offset:1024
ds_write_b32 v114,v79 offset:1056
s_nop 1
v_add_f32 v84,v84,v85
v_add_f32 v86,v86,v87
v_cvt_pk_bf16_f32 v84,v84,v86
ds_write_b16 v115,v84 offset:1024
ds_write_b16_d16_hi v115,v84 offset:1056
ds_read_b128 v[104:107],v110 offset:1024
s_waitcnt vmcnt(0) lgkmcnt(5)
v_smfmac_f32_16x16x64_bf16 v[88:91],v[100:103],v[28:35],v108
v_mov_b32 v63,s37
v_smfmac_f32_16x16x64_bf16 v[92:95],v[100:103],v[44:51],v108
v_mov_b32 v67,s37
v_smfmac_f32_16x16x64_bf16 v[96:99],v[100:103],v[8:15],v108
s_waitcnt lgkmcnt(0)
v_smfmac_f32_16x16x64_bf16 v[96:99],v[104:107],v[20:27],v108
v_smfmac_f32_16x16x64_bf16 v[88:91],v[104:107],v[36:43],v108
v_smfmac_f32_16x16x64_bf16 v[92:95],v[104:107],v[52:59],v108
s_nop 0
v_add_f32 v68,v96,v97
v_add_f32 v69,v98,v99
s_nop 1
v_add_f32 v60,v88,v89
v_add_f32 v64,v90,v91
v_mov_b32_dpp v62,v68 quad_perm:[1,1,3,3] row_mask:0xf bank_mask:0xf
v_mov_b32_dpp v66,v69 quad_perm:[1,1,3,3] row_mask:0xf bank_mask:0xf
v_add_f32 v61,v92,v93
v_add_f32 v65,v94,v95
ds_write_b128 v110,v[60:63] offset:8192
ds_write_b128 v110,v[64:67] offset:9216
s_barrier
s_add_u32 s30,s26,1
v_mov_b32 v28,s30
s_nop 15
s_nop 15
s_nop 1
buffer_store_short v28,v118,s[8:11],0 offen
s_xor_b32 s37,s37,0x80000000
s_xor_b32 s35,s35,0x80000000
s_mov_b32 s34,s29
s_add_u32 s29,s29,0x4000
s_and_b32 s29,s29,0xc800
s_add_u32 s29,s29,50397184
s_add_u32 s28,s28,0x2000
s_and_b32 s28,s28,0x6800
s_add_u32 s28,s28,50331648
s_add_u32 s62,s28,4096
s_add_u32 s32,s32,32768
s_add_u32 s63,s63,s36
s_add_u32 s26,s26,1
s_cmp_lt_u32 s26,63
s_cbranch_scc1 Aloop_66
s_branch Aexit_14
.p2align 6
Aloop_71:
s_sleep 4
buffer_load_dwordx4 v[28:31],v111,s[8:11],s32 offen sc1
buffer_load_dwordx4 v[32:35],v111,s[8:11],s32 offen offset:1024 sc1
buffer_load_dwordx4 v[44:47],v112,s[8:11],s32 offen sc1
buffer_load_dwordx4 v[48:51],v112,s[8:11],s32 offen offset:1024 sc1
s_sleep 3
Aent_41:
v_mov_b64 v[60:61],0
v_mov_b64 v[62:63],0
v_mov_b64 v[64:65],0
v_mov_b64 v[66:67],0
v_mov_b64 v[68:69],0
v_mov_b64 v[70:71],0
v_mov_b64 v[72:73],0
v_mov_b64 v[74:75],0
v_mov_b64 v[76:77],0
v_mov_b64 v[78:79],0
v_mov_b64 v[80:81],0
v_mov_b64 v[82:83],0
v_mov_b64 v[84:85],0
v_mov_b64 v[86:87],0
v_mov_b64 v[88:89],0
v_mov_b64 v[90:91],0
v_mov_b64 v[92:93],0
v_mov_b64 v[94:95],0
v_mov_b64 v[96:97],0
v_mov_b64 v[98:99],0
s_mov_b32 s27,0
buffer_load_ushort v100,v119,s[8:11],0 offen sc1
s_nop 9
buffer_load_ushort v101,v119,s[8:11],0 offen sc1
s_nop 9
buffer_load_ushort v102,v119,s[8:11],0 offen sc1
s_nop 9
buffer_load_ushort v103,v119,s[8:11],0 offen sc1
s_nop 9
buffer_load_ushort v104,v119,s[8:11],0 offen sc1
fp_74:
s_waitcnt vmcnt(4)
v_cmp_gt_u32 vcc,s63,v100
buffer_load_ushort v100,v119,s[8:11],0 offen sc1
s_cbranch_vccz fpd_75
s_waitcnt vmcnt(4)
v_cmp_gt_u32 vcc,s63,v101
buffer_load_ushort v101,v119,s[8:11],0 offen sc1
s_cbranch_vccz fpd_75
s_waitcnt vmcnt(4)
v_cmp_gt_u32 vcc,s63,v102
buffer_load_ushort v102,v119,s[8:11],0 offen sc1
s_cbranch_vccz fpd_75
s_waitcnt vmcnt(4)
v_cmp_gt_u32 vcc,s63,v103
buffer_load_ushort v103,v119,s[8:11],0 offen sc1
s_cbranch_vccz fpd_75
s_waitcnt vmcnt(4)
v_cmp_gt_u32 vcc,s63,v104
buffer_load_ushort v104,v119,s[8:11],0 offen sc1
s_cbranch_vccz fpd_75
s_waitcnt vmcnt(4)
v_cmp_gt_u32 vcc,s63,v100
buffer_load_ushort v100,v119,s[8:11],0 offen sc1
s_cbranch_vccz fpd_75
s_waitcnt vmcnt(4)
v_cmp_gt_u32 vcc,s63,v101
buffer_load_ushort v101,v119,s[8:11],0 offen sc1
s_cbranch_vccz fpd_75
s_waitcnt vmcnt(4)
v_cmp_gt_u32 vcc,s63,v102
buffer_load_ushort v102,v119,s[8:11],0 offen sc1
s_cbranch_vccz fpd_75
s_waitcnt vmcnt(4)
v_cmp_gt_u32 vcc,s63,v103
buffer_load_ushort v103,v119,s[8:11],0 offen sc1
s_cbranch_vccz fpd_75
s_waitcnt vmcnt(4)
v_cmp_gt_u32 vcc,s63,v104
buffer_load_ushort v104,v119,s[8:11],0 offen sc1
s_cbranch_vccz fpd_75
s_waitcnt vmcnt(4)
v_cmp_gt_u32 vcc,s63,v100
buffer_load_ushort v100,v119,s[8:11],0 offen sc1
s_cbranch_vccz fpd_75
s_waitcnt vmcnt(4)
v_cmp_gt_u32 vcc,s63,v101
buffer_load_ushort v101,v119,s[8:11],0 offen sc1
s_cbranch_vccz fpd_75
s_waitcnt vmcnt(4)
v_cmp_gt_u32 vcc,s63,v102
buffer_load_ushort v102,v119,s[8:11],0 offen sc1
s_cbranch_vccz fpd_75
s_waitcnt vmcnt(4)
v_cmp_gt_u32 vcc,s63,v103
buffer_load_ushort v103,v119,s[8:11],0 offen sc1
s_cbranch_vccz fpd_75
s_waitcnt vmcnt(4)
v_cmp_gt_u32 vcc,s63,v104
buffer_load_ushort v104,v119,s[8:11],0 offen sc1
s_cbranch_vccz fpd_75
s_add_u32 s27,s27,1
s_cmp_lt_u32 s27,131072
s_cbranch_scc1 fp_74
s_mov_b32 s38,1
s_branch L_end
fpd_75:
buffer_load_dwordx4 v[8:11],v109,s[8:11],s28 offen offset:2048 sc1
s_nop 12
buffer_load_dwordx4 v[12:15],v109,s[8:11],s28 offen offset:3072 sc1
s_nop 12
buffer_load_dwordx4 v[16:19],v109,s[8:11],s62 offen sc1
s_nop 12
buffer_load_dwordx4 v[20:23],v109,s[8:11],s62 offen offset:1024 sc1
Ago_72:
s_waitcnt vmcnt(3)
v_smfmac_f32_16x16x64_bf16 v[60:63],v[8:11],a[216:223],v108
buffer_load_dwordx4 v[24:27],v109,s[8:11],s62 offen offset:2048 sc1
v_smfmac_f32_16x16x64_bf16 v[64:67],v[8:11],a[248:255],v108
v_max3_u32 v100,v8,v9,v10
v_smfmac_f32_16x16x64_bf16 v[68:71],v[8:11],v[144:151],v108
v_max_u32 v100,v100,v11
v_smfmac_f32_16x16x64_bf16 v[72:75],v[8:11],v[176:183],v108
v_smfmac_f32_16x16x64_bf16 v[76:79],v[8:11],v[208:215],v108
buffer_load_dwordx4 v[0:3],v109,s[8:11],s28 offen sc1
v_smfmac_f32_16x16x64_bf16 v[80:83],v[8:11],v[240:247],v108
s_waitcnt vmcnt(4)
v_smfmac_f32_16x16x64_bf16 v[60:63],v[12:15],a[224:231],v108
v_smfmac_f32_16x16x64_bf16 v[64:67],v[12:15],v[120:127],v108
v_max3_u32 v100,v100,v12,v13
v_smfmac_f32_16x16x64_bf16 v[68:71],v[12:15],v[152:159],v108
buffer_load_dwordx4 v[4:7],v109,s[8:11],s28 offen offset:1024 sc1
v_max3_u32 v100,v100,v14,v15
v_smfmac_f32_16x16x64_bf16 v[72:75],v[12:15],v[184:191],v108
v_smfmac_f32_16x16x64_bf16 v[76:79],v[12:15],v[216:223],v108
v_smfmac_f32_16x16x64_bf16 v[80:83],v[12:15],v[248:255],v108
s_waitcnt vmcnt(4)
v_smfmac_f32_16x16x64_bf16 v[60:63],v[16:19],a[0:7],v108
buffer_load_dwordx4 v[36:39],v111,s[8:11],s32 offen offset:2048 sc1
v_smfmac_f32_16x16x64_bf16 v[64:67],v[16:19],a[24:31],v108
v_max3_u32 v100,v100,v16,v17
v_smfmac_f32_16x16x64_bf16 v[68:71],v[16:19],a[48:55],v108
v_max3_u32 v100,v100,v18,v19
v_smfmac_f32_16x16x64_bf16 v[72:75],v[16:19],a[72:79],v108
v_smfmac_f32_16x16x64_bf16 v[76:79],v[16:19],a[96:103],v108
buffer_load_dwordx4 v[40:43],v111,s[8:11],s32 offen offset:3072 sc1
v_smfmac_f32_16x16x64_bf16 v[80:83],v[16:19],a[120:127],v108
s_waitcnt vmcnt(5)
v_smfmac_f32_16x16x64_bf16 v[60:63],v[20:23],a[8:15],v108
v_max3_u32 v100,v100,v20,v21
v_smfmac_f32_16x16x64_bf16 v[64:67],v[20:23],a[32:39],v108
v_max3_u32 v100,v100,v22,v23
v_smfmac_f32_16x16x64_bf16 v[68:71],v[20:23],a[56:63],v108
buffer_load_dwordx4 v[52:55],v112,s[8:11],s32 offen offset:2048 sc1
v_smfmac_f32_16x16x64_bf16 v[72:75],v[20:23],a[80:87],v108
s_waitcnt vmcnt(5)
v_smfmac_f32_16x16x64_bf16 v[60:63],v[24:27],a[16:23],v108
v_max3_u32 v100,v100,v24,v25
v_smfmac_f32_16x16x64_bf16 v[64:67],v[24:27],a[40:47],v108
v_max3_u32 v100,v100,v26,v27
v_smfmac_f32_16x16x64_bf16 v[68:71],v[24:27],a[64:71],v108
buffer_load_dwordx4 v[56:59],v112,s[8:11],s32 offen offset:3072 sc1
v_smfmac_f32_16x16x64_bf16 v[72:75],v[24:27],a[88:95],v108
s_waitcnt vmcnt(5)
v_smfmac_f32_16x16x64_bf16 v[60:63],v[0:3],a[200:207],v108
v_max3_u32 v100,v100,v0,v1
v_smfmac_f32_16x16x64_bf16 v[64:67],v[0:3],a[232:239],v108
v_max3_u32 v100,v100,v2,v3
v_smfmac_f32_16x16x64_bf16 v[68:71],v[0:3],v[128:135],v108
v_smfmac_f32_16x16x64_bf16 v[72:75],v[0:3],v[160:167],v108
s_waitcnt vmcnt(4)
v_smfmac_f32_16x16x64_bf16 v[60:63],v[4:7],a[208:215],v108
v_max3_u32 v100,v100,v4,v5
v_smfmac_f32_16x16x64_bf16 v[64:67],v[4:7],a[240:247],v108
v_max3_u32 v100,v100,v6,v7
v_smfmac_f32_16x16x64_bf16 v[68:71],v[4:7],v[136:143],v108
v_cmp_eq_u32 vcc,-1,v100
v_smfmac_f32_16x16x64_bf16 v[72:75],v[4:7],v[168:175],v108
v_add_f32 v60,v60,v61
v_smfmac_f32_16x16x64_bf16 v[76:79],v[20:23],a[104:111],v108
v_add_f32 v62,v62,v63
v_smfmac_f32_16x16x64_bf16 v[76:79],v[24:27],a[112:119],v108
s_cbranch_vccnz Aredo_73
v_add_f32 v64,v64,v65
v_smfmac_f32_16x16x64_bf16 v[76:79],v[0:3],v[192:199],v108
v_cvt_pk_bf16_f32 v61,v60,v64
v_smfmac_f32_16x16x64_bf16 v[76:79],v[4:7],v[200:207],v108
ds_write_b32 v113,v61 offset:0
v_add_f32 v66,v66,v67
v_smfmac_f32_16x16x64_bf16 v[80:83],v[20:23],a[128:135],v108
v_cvt_pk_bf16_f32 v63,v62,v66
v_smfmac_f32_16x16x64_bf16 v[80:83],v[24:27],a[136:143],v108
ds_write_b32 v113,v63 offset:32
v_add_f32 v68,v68,v69
v_smfmac_f32_16x16x64_bf16 v[80:83],v[0:3],v[224:231],v108
v_add_f32 v70,v70,v71
v_smfmac_f32_16x16x64_bf16 v[80:83],v[4:7],v[232:239],v108
v_add_f32 v72,v72,v73
v_smfmac_f32_16x16x64_bf16 v[84:87],v[8:11],a[160:167],v108
v_cvt_pk_bf16_f32 v69,v68,v72
v_smfmac_f32_16x16x64_bf16 v[84:87],v[12:15],a[168:175],v108
ds_write_b32 v113,v69 offset:512
v_add_f32 v74,v74,v75
v_smfmac_f32_16x16x64_bf16 v[84:87],v[16:19],a[176:183],v108
v_cvt_pk_bf16_f32 v71,v70,v74
v_smfmac_f32_16x16x64_bf16 v[84:87],v[20:23],a[184:191],v108
ds_write_b32 v113,v71 offset:544
v_smfmac_f32_16x16x64_bf16 v[84:87],v[24:27],a[192:199],v108
ds_read_b128 v[100:103],v110 offset:0
v_add_f32 v76,v76,v77
v_smfmac_f32_16x16x64_bf16 v[84:87],v[0:3],a[144:151],v108
v_add_f32 v78,v78,v79
v_smfmac_f32_16x16x64_bf16 v[84:87],v[4:7],a[152:159],v108
v_add_f32 v80,v80,v81
v_cvt_pk_bf16_f32 v77,v76,v80
v_add_f32 v82,v82,v83
v_cvt_pk_bf16_f32 v79,v78,v82
ds_write_b32 v114,v77 offset:1024
ds_write_b32 v114,v79 offset:1056
s_nop 1
v_add_f32 v84,v84,v85
v_add_f32 v86,v86,v87
v_cvt_pk_bf16_f32 v84,v84,v86
ds_write_b16 v115,v84 offset:1024
ds_write_b16_d16_hi v115,v84 offset:1056
ds_read_b128 v[104:107],v110 offset:1024
s_waitcnt vmcnt(0) lgkmcnt(5)
v_smfmac_f32_16x16x64_bf16 v[88:91],v[100:103],v[28:35],v108
v_mov_b32 v63,s37
v_smfmac_f32_16x16x64_bf16 v[92:95],v[100:103],v[44:51],v108
v_mov_b32 v67,s37
v_smfmac_f32_16x16x64_bf16 v[96:99],v[100:103],v[0:7],v108
s_waitcnt lgkmcnt(0)
v_smfmac_f32_16x16x64_bf16 v[96:99],v[104:107],v[16:23],v108
v_smfmac_f32_16x16x64_bf16 v[88:91],v[104:107],v[36:43],v108
v_smfmac_f32_16x16x64_bf16 v[92:95],v[104:107],v[52:59],v108
s_nop 0
v_add_f32 v68,v96,v97
v_add_f32 v69,v98,v99
s_nop 1
v_add_f32 v60,v88,v89
v_add_f32 v64,v90,v91
v_mov_b32_dpp v62,v68 quad_perm:[0,0,2,2] row_mask:0xf bank_mask:0xf
v_mov_b32_dpp v66,v69 quad_perm:[0,0,2,2] row_mask:0xf bank_mask:0xf
v_add_f32 v65,v94,v95
ds_write_b128 v110,v[64:67] offset:9216
s_barrier
Arr_76:
ds_read_b128 v[72:75],v109 offset:10240
ds_read_b128 v[76:79],v109 offset:12288
ds_read_b128 v[80:83],v109 offset:14336
v_add_f32 v61,v92,v93
v_mov_b32 v29,-1
s_waitcnt lgkmcnt(2)
v_pk_add_f32 v[84:85],v[60:61],v[72:73]
v_pk_add_f32 v[86:87],v[62:63],v[74:75]
s_waitcnt lgkmcnt(1)
v_pk_add_f32 v[84:85],v[84:85],v[76:77]
v_pk_add_f32 v[86:87],v[86:87],v[78:79]
s_waitcnt lgkmcnt(0)
v_pk_add_f32 v[84:85],v[84:85],v[80:81]
v_pk_add_f32 v[86:87],v[86:87],v[82:83]
v_max3_f32 v72,v84,v85,v86
v_cmp_neq_f32 vcc,s35,v87
s_nop 0
v_max_f32_dpp v72,v72,v72 row_ror:1 row_mask:0xf bank_mask:0xf
s_nop 1
v_max_f32_dpp v72,v72,v72 row_ror:2 row_mask:0xf bank_mask:0xf
s_nop 1
v_max_f32_dpp v72,v72,v72 row_ror:4 row_mask:0xf bank_mask:0xf
s_nop 1
v_max_f32_dpp v72,v72,v72 row_ror:8 row_mask:0xf bank_mask:0xf
v_pk_add_f32 v[84:85],v[84:85],v[72:73] op_sel_hi:[1,0] neg_lo:[0,1] neg_hi:[0,1]
v_sub_f32 v86,v86,v72
v_exp_f32 v84,v84
v_exp_f32 v85,v85
v_exp_f32 v86,v86
v_add_f32 v72,v84,v85
v_fmac_f32 v72,0.5,v86
s_cmp_lg_u64 vcc,0
s_cselect_b32 s31,0x7f000000,s29
v_add_f32_dpp v72,v72,v72 row_ror:1 row_mask:0xf bank_mask:0xf
s_nop 1
v_add_f32_dpp v72,v72,v72 row_ror:2 row_mask:0xf bank_mask:0xf
s_nop 1
v_add_f32_dpp v72,v72,v72 row_ror:4 row_mask:0xf bank_mask:0xf
s_nop 1
v_add_f32_dpp v72,v72,v72 row_ror:8 row_mask:0xf bank_mask:0xf
v_rcp_f32 v72,v72
s_nop 0
v_pk_mul_f32 v[84:85],v[84:85],v[72:73] op_sel_hi:[1,0]
v_mul_f32 v86,v86,v72
v_cvt_pk_bf16_f32 v84,|v84|,|v85|
v_cvt_pk_bf16_f32 v86,|v86|,|v86|
buffer_store_dword v84,v116,s[4:7],s31 offen
buffer_store_short v86,v117,s[4:7],s31 offen
buffer_store_dword v29,v116,s[4:7],s34 offen
buffer_store_short v29,v117,s[4:7],s34 offen
s_cmp_lg_u32 s61,0
s_cbranch_scc1 slow_77
slowr_78:
s_cbranch_vccnz Arr_76
s_xor_b32 s37,s37,0x80000000
s_xor_b32 s35,s35,0x80000000
s_mov_b32 s34,s29
s_add_u32 s29,s29,0x4000
s_and_b32 s29,s29,0xc800
s_add_u32 s29,s29,50397184
s_add_u32 s28,s28,0x2000
s_and_b32 s28,s28,0x6800
s_add_u32 s28,s28,50331648
s_add_u32 s62,s28,4096
s_add_u32 s32,s32,32768
s_add_u32 s63,s63,s36
s_add_u32 s26,s26,1
s_cmp_lt_u32 s26,63
s_cbranch_scc1 Aloop_71
s_branch Aexit_14
.p2align 6
Aloop_79:
s_sleep 4
buffer_load_dwordx4 v[28:31],v111,s[8:11],s32 offen sc1
buffer_load_dwordx4 v[32:35],v111,s[8:11],s32 offen offset:1024 sc1
buffer_load_dwordx4 v[44:47],v112,s[8:11],s32 offen sc1
buffer_load_dwordx4 v[48:51],v112,s[8:11],s32 offen offset:1024 sc1
s_sleep 3
Aent_42:
v_mov_b64 v[60:61],0
v_mov_b64 v[62:63],0
v_mov_b64 v[64:65],0
v_mov_b64 v[66:67],0
v_mov_b64 v[68:69],0
v_mov_b64 v[70:71],0
v_mov_b64 v[72:73],0
v_mov_b64 v[74:75],0
v_mov_b64 v[76:77],0
v_mov_b64 v[78:79],0
v_mov_b64 v[80:81],0
v_mov_b64 v[82:83],0
v_mov_b64 v[84:85],0
v_mov_b64 v[86:87],0
v_mov_b64 v[88:89],0
v_mov_b64 v[90:91],0
v_mov_b64 v[92:93],0
v_mov_b64 v[94:95],0
v_mov_b64 v[96:97],0
v_mov_b64 v[98:99],0
s_mov_b32 s27,0
buffer_load_ushort v100,v119,s[8:11],0 offen sc1
s_nop 9
buffer_load_ushort v101,v119,s[8:11],0 offen sc1
s_nop 9
buffer_load_ushort v102,v119,s[8:11],0 offen sc1
s_nop 9
buffer_load_ushort v103,v119,s[8:11],0 offen sc1
s_nop 9
buffer_load_ushort v104,v119,s[8:11],0 offen sc1
fp_82:
s_waitcnt vmcnt(4)
v_cmp_gt_u32 vcc,s63,v100
buffer_load_ushort v100,v119,s[8:11],0 offen sc1
s_cbranch_vccz fpd_83
s_waitcnt vmcnt(4)
v_cmp_gt_u32 vcc,s63,v101
buffer_load_ushort v101,v119,s[8:11],0 offen sc1
s_cbranch_vccz fpd_83
s_waitcnt vmcnt(4)
v_cmp_gt_u32 vcc,s63,v102
buffer_load_ushort v102,v119,s[8:11],0 offen sc1
s_cbranch_vccz fpd_83
s_waitcnt vmcnt(4)
v_cmp_gt_u32 vcc,s63,v103
buffer_load_ushort v103,v119,s[8:11],0 offen sc1
s_cbranch_vccz fpd_83
s_waitcnt vmcnt(4)
v_cmp_gt_u32 vcc,s63,v104
buffer_load_ushort v104,v119,s[8:11],0 offen sc1
s_cbranch_vccz fpd_83
s_waitcnt vmcnt(4)
v_cmp_gt_u32 vcc,s63,v100
buffer_load_ushort v100,v119,s[8:11],0 offen sc1
s_cbranch_vccz fpd_83
s_waitcnt vmcnt(4)
v_cmp_gt_u32 vcc,s63,v101
buffer_load_ushort v101,v119,s[8:11],0 offen sc1
s_cbranch_vccz fpd_83
s_waitcnt vmcnt(4)
v_cmp_gt_u32 vcc,s63,v102
buffer_load_ushort v102,v119,s[8:11],0 offen sc1
s_cbranch_vccz fpd_83
s_waitcnt vmcnt(4)
v_cmp_gt_u32 vcc,s63,v103
buffer_load_ushort v103,v119,s[8:11],0 offen sc1
s_cbranch_vccz fpd_83
s_waitcnt vmcnt(4)
v_cmp_gt_u32 vcc,s63,v104
buffer_load_ushort v104,v119,s[8:11],0 offen sc1
s_cbranch_vccz fpd_83
s_waitcnt vmcnt(4)
v_cmp_gt_u32 vcc,s63,v100
buffer_load_ushort v100,v119,s[8:11],0 offen sc1
s_cbranch_vccz fpd_83
s_waitcnt vmcnt(4)
v_cmp_gt_u32 vcc,s63,v101
buffer_load_ushort v101,v119,s[8:11],0 offen sc1
s_cbranch_vccz fpd_83
s_waitcnt vmcnt(4)
v_cmp_gt_u32 vcc,s63,v102
buffer_load_ushort v102,v119,s[8:11],0 offen sc1
s_cbranch_vccz fpd_83
s_waitcnt vmcnt(4)
v_cmp_gt_u32 vcc,s63,v103
buffer_load_ushort v103,v119,s[8:11],0 offen sc1
s_cbranch_vccz fpd_83
s_waitcnt vmcnt(4)
v_cmp_gt_u32 vcc,s63,v104
buffer_load_ushort v104,v119,s[8:11],0 offen sc1
s_cbranch_vccz fpd_83
s_add_u32 s27,s27,1
s_cmp_lt_u32 s27,131072
s_cbranch_scc1 fp_82
s_mov_b32 s38,1
s_branch L_end
fpd_83:
buffer_load_dwordx4 v[12:15],v109,s[8:11],s28 offen offset:3072 sc1
s_nop 12
buffer_load_dwordx4 v[16:19],v109,s[8:11],s62 offen sc1
s_nop 12
buffer_load_dwordx4 v[20:23],v109,s[8:11],s62 offen offset:1024 sc1
s_nop 12
buffer_load_dwordx4 v[24:27],v109,s[8:11],s62 offen offset:2048 sc1
Ago_80:
s_waitcnt vmcnt(3)
v_smfmac_f32_16x16x64_bf16 v[60:63],v[12:15],a[224:231],v108
buffer_load_dwordx4 v[0:3],v109,s[8:11],s28 offen sc1
v_smfmac_f32_16x16x64_bf16 v[64:67],v[12:15],v[120:127],v108
v_max3_u32 v100,v12,v13,v14
v_smfmac_f32_16x16x64_bf16 v[68:71],v[12:15],v[152:159],v108
v_max_u32 v100,v100,v15
v_smfmac_f32_16x16x64_bf16 v[72:75],v[12:15],v[184:191],v108
v_smfmac_f32_16x16x64_bf16 v[76:79],v[12:15],v[216:223],v108
buffer_load_dwordx4 v[4:7],v109,s[8:11],s28 offen offset:1024 sc1
v_smfmac_f32_16x16x64_bf16 v[80:83],v[12:15],v[248:255],v108
s_waitcnt vmcnt(4)
v_smfmac_f32_16x16x64_bf16 v[60:63],v[16:19],a[0:7],v108
v_smfmac_f32_16x16x64_bf16 v[64:67],v[16:19],a[24:31],v108
v_max3_u32 v100,v100,v16,v17
v_smfmac_f32_16x16x64_bf16 v[68:71],v[16:19],a[48:55],v108
buffer_load_dwordx4 v[8:11],v109,s[8:11],s28 offen offset:2048 sc1
v_max3_u32 v100,v100,v18,v19
v_smfmac_f32_16x16x64_bf16 v[72:75],v[16:19],a[72:79],v108
v_smfmac_f32_16x16x64_bf16 v[76:79],v[16:19],a[96:103],v108
v_smfmac_f32_16x16x64_bf16 v[80:83],v[16:19],a[120:127],v108
s_waitcnt vmcnt(4)
v_smfmac_f32_16x16x64_bf16 v[60:63],v[20:23],a[8:15],v108
buffer_load_dwordx4 v[36:39],v111,s[8:11],s32 offen offset:2048 sc1
v_smfmac_f32_16x16x64_bf16 v[64:67],v[20:23],a[32:39],v108
v_max3_u32 v100,v100,v20,v21
v_smfmac_f32_16x16x64_bf16 v[68:71],v[20:23],a[56:63],v108
v_max3_u32 v100,v100,v22,v23
v_smfmac_f32_16x16x64_bf16 v[72:75],v[20:23],a[80:87],v108
v_smfmac_f32_16x16x64_bf16 v[76:79],v[20:23],a[104:111],v108
buffer_load_dwordx4 v[40:43],v111,s[8:11],s32 offen offset:3072 sc1
v_smfmac_f32_16x16x64_bf16 v[80:83],v[20:23],a[128:135],v108
s_waitcnt vmcnt(5)
v_smfmac_f32_16x16x64_bf16 v[60:63],v[24:27],a[16:23],v108
v_max3_u32 v100,v100,v24,v25
v_smfmac_f32_16x16x64_bf16 v[64:67],v[24:27],a[40:47],v108
v_max3_u32 v100,v100,v26,v27
v_smfmac_f32_16x16x64_bf16 v[68:71],v[24:27],a[64:71],v108
buffer_load_dwordx4 v[52:55],v112,s[8:11],s32 offen offset:2048 sc1
v_smfmac_f32_16x16x64_bf16 v[72:75],v[24:27],a[88:95],v108
s_waitcnt vmcnt(5)
v_smfmac_f32_16x16x64_bf16 v[60:63],v[0:3],a[200:207],v108
v_max3_u32 v100,v100,v0,v1
v_smfmac_f32_16x16x64_bf16 v[64:67],v[0:3],a[232:239],v108
v_max3_u32 v100,v100,v2,v3
v_smfmac_f32_16x16x64_bf16 v[68:71],v[0:3],v[128:135],v108
buffer_load_dwordx4 v[56:59],v112,s[8:11],s32 offen offset:3072 sc1
v_smfmac_f32_16x16x64_bf16 v[72:75],v[0:3],v[160:167],v108
s_waitcnt vmcnt(5)
v_smfmac_f32_16x16x64_bf16 v[60:63],v[4:7],a[208:215],v108
v_max3_u32 v100,v100,v4,v5
v_smfmac_f32_16x16x64_bf16 v[64:67],v[4:7],a[240:247],v108
v_max3_u32 v100,v100,v6,v7
v_smfmac_f32_16x16x64_bf16 v[68:71],v[4:7],v[136:143],v108
v_smfmac_f32_16x16x64_bf16 v[72:75],v[4:7],v[168:175],v108
s_waitcnt vmcnt(4)
v_smfmac_f32_16x16x64_bf16 v[60:63],v[8:11],a[216:223],v108
v_max3_u32 v100,v100,v8,v9
v_smfmac_f32_16x16x64_bf16 v[64:67],v[8:11],a[248:255],v108
v_max3_u32 v100,v100,v10,v11
v_smfmac_f32_16x16x64_bf16 v[68:71],v[8:11],v[144:151],v108
v_cmp_eq_u32 vcc,-1,v100
v_smfmac_f32_16x16x64_bf16 v[72:75],v[8:11],v[176:183],v108
v_add_f32 v60,v60,v61
v_smfmac_f32_16x16x64_bf16 v[76:79],v[24:27],a[112:119],v108
v_add_f32 v62,v62,v63
v_smfmac_f32_16x16x64_bf16 v[76:79],v[0:3],v[192:199],v108
s_cbranch_vccnz Aredo_81
v_add_f32 v64,v64,v65
v_smfmac_f32_16x16x64_bf16 v[76:79],v[4:7],v[200:207],v108
v_cvt_pk_bf16_f32 v61,v60,v64
v_smfmac_f32_16x16x64_bf16 v[76:79],v[8:11],v[208:215],v108
ds_write_b32 v113,v61 offset:0
v_add_f32 v66,v66,v67
v_smfmac_f32_16x16x64_bf16 v[80:83],v[24:27],a[136:143],v108
v_cvt_pk_bf16_f32 v63,v62,v66
v_smfmac_f32_16x16x64_bf16 v[80:83],v[0:3],v[224:231],v108
ds_write_b32 v113,v63 offset:32
v_add_f32 v68,v68,v69
v_smfmac_f32_16x16x64_bf16 v[80:83],v[4:7],v[232:239],v108
v_add_f32 v70,v70,v71
v_smfmac_f32_16x16x64_bf16 v[80:83],v[8:11],v[240:247],v108
v_add_f32 v72,v72,v73
v_smfmac_f32_16x16x64_bf16 v[84:87],v[12:15],a[168:175],v108
v_cvt_pk_bf16_f32 v69,v68,v72
v_smfmac_f32_16x16x64_bf16 v[84:87],v[16:19],a[176:183],v108
ds_write_b32 v113,v69 offset:512
v_add_f32 v74,v74,v75
v_smfmac_f32_16x16x64_bf16 v[84:87],v[20:23],a[184:191],v108
v_cvt_pk_bf16_f32 v71,v70,v74
v_smfmac_f32_16x16x64_bf16 v[84:87],v[24:27],a[192:199],v108
ds_write_b32 v113,v71 offset:544
v_smfmac_f32_16x16x64_bf16 v[84:87],v[0:3],a[144:151],v108
ds_read_b128 v[100:103],v110 offset:0
v_add_f32 v76,v76,v77
v_smfmac_f32_16x16x64_bf16 v[84:87],v[4:7],a[152:159],v108
v_add_f32 v78,v78,v79
v_smfmac_f32_16x16x64_bf16 v[84:87],v[8:11],a[160:167],v108
v_add_f32 v80,v80,v81
v_cvt_pk_bf16_f32 v77,v76,v80
v_add_f32 v82,v82,v83
v_cvt_pk_bf16_f32 v79,v78,v82
ds_write_b32 v114,v77 offset:1024
ds_write_b32 v114,v79 offset:1056
s_nop 1
v_add_f32 v84,v84,v85
v_add_f32 v86,v86,v87
v_cvt_pk_bf16_f32 v84,v84,v86
ds_write_b16 v115,v84 offset:1024
ds_write_b16_d16_hi v115,v84 offset:1056
ds_read_b128 v[104:107],v110 offset:1024
s_waitcnt vmcnt(0) lgkmcnt(5)
v_smfmac_f32_16x16x64_bf16 v[88:91],v[100:103],v[28:35],v108
v_mov_b32 v63,s37
v_smfmac_f32_16x16x64_bf16 v[92:95],v[100:103],v[44:51],v108
v_mov_b32 v67,s37
v_smfmac_f32_16x16x64_bf16 v[96:99],v[100:103],v[0:7],v108
s_waitcnt lgkmcnt(0)
v_smfmac_f32_16x16x64_bf16 v[96:99],v[104:107],v[16:23],v108
v_smfmac_f32_16x16x64_bf16 v[88:91],v[104:107],v[36:43],v108
v_smfmac_f32_16x16x64_bf16 v[92:95],v[104:107],v[52:59],v108
s_nop 0
v_add_f32 v68,v96,v97
v_add_f32 v69,v98,v99
s_nop 1
v_add_f32 v60,v88,v89
v_add_f32 v64,v90,v91
v_mov_b32_dpp v62,v68 quad_perm:[1,1,3,3] row_mask:0xf bank_mask:0xf
v_mov_b32_dpp v66,v69 quad_perm:[1,1,3,3] row_mask:0xf bank_mask:0xf
v_add_f32 v61,v92,v93
ds_write_b128 v110,v[60:63] offset:8192
s_barrier
Arr_84:
ds_read_b128 v[72:75],v109 offset:9216
ds_read_b128 v[76:79],v109 offset:13312
ds_read_b128 v[80:83],v109 offset:15360
v_add_f32 v65,v94,v95
v_mov_b32 v29,-1
s_waitcnt lgkmcnt(2)
v_pk_add_f32 v[84:85],v[64:65],v[72:73]
v_pk_add_f32 v[86:87],v[66:67],v[74:75]
s_waitcnt lgkmcnt(1)
v_pk_add_f32 v[84:85],v[84:85],v[76:77]
v_pk_add_f32 v[86:87],v[86:87],v[78:79]
s_waitcnt lgkmcnt(0)
v_pk_add_f32 v[84:85],v[84:85],v[80:81]
v_pk_add_f32 v[86:87],v[86:87],v[82:83]
v_max3_f32 v72,v84,v85,v86
v_cmp_neq_f32 vcc,s35,v87
s_nop 0
v_max_f32_dpp v72,v72,v72 row_ror:1 row_mask:0xf bank_mask:0xf
s_nop 1
v_max_f32_dpp v72,v72,v72 row_ror:2 row_mask:0xf bank_mask:0xf
s_nop 1
v_max_f32_dpp v72,v72,v72 row_ror:4 row_mask:0xf bank_mask:0xf
s_nop 1
v_max_f32_dpp v72,v72,v72 row_ror:8 row_mask:0xf bank_mask:0xf
v_pk_add_f32 v[84:85],v[84:85],v[72:73] op_sel_hi:[1,0] neg_lo:[0,1] neg_hi:[0,1]
v_sub_f32 v86,v86,v72
v_exp_f32 v84,v84
v_exp_f32 v85,v85
v_exp_f32 v86,v86
v_add_f32 v72,v84,v85
v_fmac_f32 v72,0.5,v86
s_cmp_lg_u64 vcc,0
s_cselect_b32 s31,0x7f000000,s29
v_add_f32_dpp v72,v72,v72 row_ror:1 row_mask:0xf bank_mask:0xf
s_nop 1
v_add_f32_dpp v72,v72,v72 row_ror:2 row_mask:0xf bank_mask:0xf
s_nop 1
v_add_f32_dpp v72,v72,v72 row_ror:4 row_mask:0xf bank_mask:0xf
s_nop 1
v_add_f32_dpp v72,v72,v72 row_ror:8 row_mask:0xf bank_mask:0xf
v_rcp_f32 v72,v72
s_nop 0
v_pk_mul_f32 v[84:85],v[84:85],v[72:73] op_sel_hi:[1,0]
v_mul_f32 v86,v86,v72
v_cvt_pk_bf16_f32 v84,|v84|,|v85|
v_cvt_pk_bf16_f32 v86,|v86|,|v86|
buffer_store_dword v84,v116,s[4:7],s31 offen
buffer_store_short v86,v117,s[4:7],s31 offen
buffer_store_dword v29,v116,s[4:7],s34 offen
buffer_store_short v29,v117,s[4:7],s34 offen
s_cmp_lg_u32 s61,0
s_cbranch_scc1 slow_85
slowr_86:
s_cbranch_vccnz Arr_84
s_xor_b32 s37,s37,0x80000000
s_xor_b32 s35,s35,0x80000000
s_mov_b32 s34,s29
s_add_u32 s29,s29,0x4000
s_and_b32 s29,s29,0xc800
s_add_u32 s29,s29,50397184
s_add_u32 s28,s28,0x2000
s_and_b32 s28,s28,0x6800
s_add_u32 s28,s28,50331648
s_add_u32 s62,s28,4096
s_add_u32 s32,s32,32768
s_add_u32 s63,s63,s36
s_add_u32 s26,s26,1
s_cmp_lt_u32 s26,63
s_cbranch_scc1 Aloop_79
s_branch Aexit_14
.p2align 6
Aloop_87:
s_sleep 9
buffer_load_dwordx4 v[28:31],v111,s[8:11],s32 offen sc1
buffer_load_dwordx4 v[32:35],v111,s[8:11],s32 offen offset:1024 sc1
buffer_load_dwordx4 v[44:47],v112,s[8:11],s32 offen sc1
buffer_load_dwordx4 v[48:51],v112,s[8:11],s32 offen offset:1024 sc1
s_sleep 3
Aent_43:
v_mov_b64 v[60:61],0
v_mov_b64 v[62:63],0
v_mov_b64 v[64:65],0
v_mov_b64 v[66:67],0
v_mov_b64 v[68:69],0
v_mov_b64 v[70:71],0
v_mov_b64 v[72:73],0
v_mov_b64 v[74:75],0
v_mov_b64 v[76:77],0
v_mov_b64 v[78:79],0
v_mov_b64 v[80:81],0
v_mov_b64 v[82:83],0
v_mov_b64 v[84:85],0
v_mov_b64 v[86:87],0
v_mov_b64 v[88:89],0
v_mov_b64 v[90:91],0
v_mov_b64 v[92:93],0
v_mov_b64 v[94:95],0
v_mov_b64 v[96:97],0
v_mov_b64 v[98:99],0
s_mov_b32 s27,0
buffer_load_ushort v100,v119,s[8:11],0 offen sc1
s_nop 9
buffer_load_ushort v101,v119,s[8:11],0 offen sc1
s_nop 9
buffer_load_ushort v102,v119,s[8:11],0 offen sc1
s_nop 9
buffer_load_ushort v103,v119,s[8:11],0 offen sc1
s_nop 9
buffer_load_ushort v104,v119,s[8:11],0 offen sc1
fp_90:
s_waitcnt vmcnt(4)
v_cmp_gt_u32 vcc,s63,v100
buffer_load_ushort v100,v119,s[8:11],0 offen sc1
s_cbranch_vccz fpd_91
s_waitcnt vmcnt(4)
v_cmp_gt_u32 vcc,s63,v101
buffer_load_ushort v101,v119,s[8:11],0 offen sc1
s_cbranch_vccz fpd_91
s_waitcnt vmcnt(4)
v_cmp_gt_u32 vcc,s63,v102
buffer_load_ushort v102,v119,s[8:11],0 offen sc1
s_cbranch_vccz fpd_91
s_waitcnt vmcnt(4)
v_cmp_gt_u32 vcc,s63,v103
buffer_load_ushort v103,v119,s[8:11],0 offen sc1
s_cbranch_vccz fpd_91
s_waitcnt vmcnt(4)
v_cmp_gt_u32 vcc,s63,v104
buffer_load_ushort v104,v119,s[8:11],0 offen sc1
s_cbranch_vccz fpd_91
s_waitcnt vmcnt(4)
v_cmp_gt_u32 vcc,s63,v100
buffer_load_ushort v100,v119,s[8:11],0 offen sc1
s_cbranch_vccz fpd_91
s_waitcnt vmcnt(4)
v_cmp_gt_u32 vcc,s63,v101
buffer_load_ushort v101,v119,s[8:11],0 offen sc1
s_cbranch_vccz fpd_91
s_waitcnt vmcnt(4)
v_cmp_gt_u32 vcc,s63,v102
buffer_load_ushort v102,v119,s[8:11],0 offen sc1
s_cbranch_vccz fpd_91
s_waitcnt vmcnt(4)
v_cmp_gt_u32 vcc,s63,v103
buffer_load_ushort v103,v119,s[8:11],0 offen sc1
s_cbranch_vccz fpd_91
s_waitcnt vmcnt(4)
v_cmp_gt_u32 vcc,s63,v104
buffer_load_ushort v104,v119,s[8:11],0 offen sc1
s_cbranch_vccz fpd_91
s_waitcnt vmcnt(4)
v_cmp_gt_u32 vcc,s63,v100
buffer_load_ushort v100,v119,s[8:11],0 offen sc1
s_cbranch_vccz fpd_91
s_waitcnt vmcnt(4)
v_cmp_gt_u32 vcc,s63,v101
buffer_load_ushort v101,v119,s[8:11],0 offen sc1
s_cbranch_vccz fpd_91
s_waitcnt vmcnt(4)
v_cmp_gt_u32 vcc,s63,v102
buffer_load_ushort v102,v119,s[8:11],0 offen sc1
s_cbranch_vccz fpd_91
s_waitcnt vmcnt(4)
v_cmp_gt_u32 vcc,s63,v103
buffer_load_ushort v103,v119,s[8:11],0 offen sc1
s_cbranch_vccz fpd_91
s_waitcnt vmcnt(4)
v_cmp_gt_u32 vcc,s63,v104
buffer_load_ushort v104,v119,s[8:11],0 offen sc1
s_cbranch_vccz fpd_91
s_add_u32 s27,s27,1
s_cmp_lt_u32 s27,131072
s_cbranch_scc1 fp_90
s_mov_b32 s38,1
s_branch L_end
fpd_91:
buffer_load_dwordx4 v[24:27],v109,s[8:11],s62 offen offset:2048 sc1
s_nop 12
buffer_load_dwordx4 v[0:3],v109,s[8:11],s28 offen sc1
s_nop 12
buffer_load_dwordx4 v[4:7],v109,s[8:11],s28 offen offset:1024 sc1
s_nop 12
buffer_load_dwordx4 v[8:11],v109,s[8:11],s28 offen offset:2048 sc1
Ago_88:
s_waitcnt vmcnt(3)
v_smfmac_f32_16x16x64_bf16 v[60:63],v[24:27],a[16:23],v108
buffer_load_dwordx4 v[12:15],v109,s[8:11],s28 offen offset:3072 sc1
v_smfmac_f32_16x16x64_bf16 v[64:67],v[24:27],a[40:47],v108
v_max3_u32 v100,v24,v25,v26
v_smfmac_f32_16x16x64_bf16 v[68:71],v[24:27],a[64:71],v108
v_max_u32 v100,v100,v27
v_smfmac_f32_16x16x64_bf16 v[72:75],v[24:27],a[88:95],v108
v_smfmac_f32_16x16x64_bf16 v[76:79],v[24:27],a[112:119],v108
buffer_load_dwordx4 v[16:19],v109,s[8:11],s62 offen sc1
v_smfmac_f32_16x16x64_bf16 v[80:83],v[24:27],a[136:143],v108
s_waitcnt vmcnt(4)
v_smfmac_f32_16x16x64_bf16 v[60:63],v[0:3],a[200:207],v108
v_smfmac_f32_16x16x64_bf16 v[64:67],v[0:3],a[232:239],v108
v_max3_u32 v100,v100,v0,v1
v_smfmac_f32_16x16x64_bf16 v[68:71],v[0:3],v[128:135],v108
buffer_load_dwordx4 v[20:23],v109,s[8:11],s62 offen offset:1024 sc1
v_max3_u32 v100,v100,v2,v3
v_smfmac_f32_16x16x64_bf16 v[72:75],v[0:3],v[160:167],v108
v_smfmac_f32_16x16x64_bf16 v[76:79],v[0:3],v[192:199],v108
v_smfmac_f32_16x16x64_bf16 v[80:83],v[0:3],v[224:231],v108
s_waitcnt vmcnt(4)
v_smfmac_f32_16x16x64_bf16 v[60:63],v[4:7],a[208:215],v108
buffer_load_dwordx4 v[36:39],v111,s[8:11],s32 offen offset:2048 sc1
v_smfmac_f32_16x16x64_bf16 v[64:67],v[4:7],a[240:247],v108
v_max3_u32 v100,v100,v4,v5
v_smfmac_f32_16x16x64_bf16 v[68:71],v[4:7],v[136:143],v108
v_max3_u32 v100,v100,v6,v7
v_smfmac_f32_16x16x64_bf16 v[72:75],v[4:7],v[168:175],v108
v_smfmac_f32_16x16x64_bf16 v[76:79],v[4:7],v[200:207],v108
buffer_load_dwordx4 v[40:43],v111,s[8:11],s32 offen offset:3072 sc1
v_smfmac_f32_16x16x64_bf16 v[80:83],v[4:7],v[232:239],v108
s_waitcnt vmcnt(5)
v_smfmac_f32_16x16x64_bf16 v[60:63],v[8:11],a[216:223],v108
v_max3_u32 v100,v100,v8,v9
v_smfmac_f32_16x16x64_bf16 v[64:67],v[8:11],a[248:255],v108
v_max3_u32 v100,v100,v10,v11
v_smfmac_f32_16x16x64_bf16 v[68:71],v[8:11],v[144:151],v108
buffer_load_dwordx4 v[52:55],v112,s[8:11],s32 offen offset:2048 sc1
v_smfmac_f32_16x16x64_bf16 v[72:75],v[8:11],v[176:183],v108
s_waitcnt vmcnt(5)
v_smfmac_f32_16x16x64_bf16 v[60:63],v[12:15],a[224:231],v108
v_max3_u32 v100,v100,v12,v13
v_smfmac_f32_16x16x64_bf16 v[64:67],v[12:15],v[120:127],v108
v_max3_u32 v100,v100,v14,v15
v_smfmac_f32_16x16x64_bf16 v[68:71],v[12:15],v[152:159],v108
buffer_load_dwordx4 v[56:59],v112,s[8:11],s32 offen offset:3072 sc1
v_smfmac_f32_16x16x64_bf16 v[72:75],v[12:15],v[184:191],v108
s_waitcnt vmcnt(5)
v_smfmac_f32_16x16x64_bf16 v[60:63],v[16:19],a[0:7],v108
v_max3_u32 v100,v100,v16,v17
v_smfmac_f32_16x16x64_bf16 v[64:67],v[16:19],a[24:31],v108
v_max3_u32 v100,v100,v18,v19
v_smfmac_f32_16x16x64_bf16 v[68:71],v[16:19],a[48:55],v108
v_smfmac_f32_16x16x64_bf16 v[72:75],v[16:19],a[72:79],v108
s_waitcnt vmcnt(4)
v_smfmac_f32_16x16x64_bf16 v[60:63],v[20:23],a[8:15],v108
v_max3_u32 v100,v100,v20,v21
v_smfmac_f32_16x16x64_bf16 v[64:67],v[20:23],a[32:39],v108
v_max3_u32 v100,v100,v22,v23
v_smfmac_f32_16x16x64_bf16 v[68:71],v[20:23],a[56:63],v108
v_cmp_eq_u32 vcc,-1,v100
v_smfmac_f32_16x16x64_bf16 v[72:75],v[20:23],a[80:87],v108
v_add_f32 v60,v60,v61
v_smfmac_f32_16x16x64_bf16 v[76:79],v[8:11],v[208:215],v108
v_add_f32 v62,v62,v63
v_smfmac_f32_16x16x64_bf16 v[76:79],v[12:15],v[216:223],v108
s_cbranch_vccnz Aredo_89
v_add_f32 v64,v64,v65
v_smfmac_f32_16x16x64_bf16 v[76:79],v[16:19],a[96:103],v108
v_cvt_pk_bf16_f32 v61,v60,v64
v_smfmac_f32_16x16x64_bf16 v[76:79],v[20:23],a[104:111],v108
ds_write_b32 v113,v61 offset:0
v_add_f32 v66,v66,v67
v_smfmac_f32_16x16x64_bf16 v[80:83],v[8:11],v[240:247],v108
v_cvt_pk_bf16_f32 v63,v62,v66
v_smfmac_f32_16x16x64_bf16 v[80:83],v[12:15],v[248:255],v108
ds_write_b32 v113,v63 offset:32
v_add_f32 v68,v68,v69
v_smfmac_f32_16x16x64_bf16 v[80:83],v[16:19],a[120:127],v108
v_add_f32 v70,v70,v71
v_smfmac_f32_16x16x64_bf16 v[80:83],v[20:23],a[128:135],v108
v_add_f32 v72,v72,v73
v_smfmac_f32_16x16x64_bf16 v[84:87],v[24:27],a[192:199],v108
v_cvt_pk_bf16_f32 v69,v68,v72
v_smfmac_f32_16x16x64_bf16 v[84:87],v[0:3],a[144:151],v108
ds_write_b32 v113,v69 offset:512
v_add_f32 v74,v74,v75
v_smfmac_f32_16x16x64_bf16 v[84:87],v[4:7],a[152:159],v108
v_cvt_pk_bf16_f32 v71,v70,v74
v_smfmac_f32_16x16x64_bf16 v[84:87],v[8:11],a[160:167],v108
ds_write_b32 v113,v71 offset:544
v_smfmac_f32_16x16x64_bf16 v[84:87],v[12:15],a[168:175],v108
ds_read_b128 v[100:103],v110 offset:0
v_add_f32 v76,v76,v77
v_smfmac_f32_16x16x64_bf16 v[84:87],v[16:19],a[176:183],v108
v_add_f32 v78,v78,v79
v_smfmac_f32_16x16x64_bf16 v[84:87],v[20:23],a[184:191],v108
v_add_f32 v80,v80,v81
v_cvt_pk_bf16_f32 v77,v76,v80
v_add_f32 v82,v82,v83
v_cvt_pk_bf16_f32 v79,v78,v82
ds_write_b32 v114,v77 offset:1024
ds_write_b32 v114,v79 offset:1056
s_nop 1
v_add_f32 v84,v84,v85
v_add_f32 v86,v86,v87
v_cvt_pk_bf16_f32 v84,v84,v86
ds_write_b16 v115,v84 offset:1024
ds_write_b16_d16_hi v115,v84 offset:1056
ds_read_b128 v[104:107],v110 offset:1024
s_waitcnt vmcnt(0) lgkmcnt(5)
v_smfmac_f32_16x16x64_bf16 v[88:91],v[100:103],v[28:35],v108
v_mov_b32 v63,s37
v_smfmac_f32_16x16x64_bf16 v[92:95],v[100:103],v[44:51],v108
v_mov_b32 v67,s37
v_smfmac_f32_16x16x64_bf16 v[96:99],v[100:103],v[8:15],v108
s_waitcnt lgkmcnt(0)
v_smfmac_f32_16x16x64_bf16 v[96:99],v[104:107],v[20:27],v108
v_smfmac_f32_16x16x64_bf16 v[88:91],v[104:107],v[36:43],v108
v_smfmac_f32_16x16x64_bf16 v[92:95],v[104:107],v[52:59],v108
s_nop 0
v_add_f32 v68,v96,v97
v_add_f32 v69,v98,v99
s_nop 1
v_add_f32 v60,v88,v89
v_add_f32 v64,v90,v91
v_mov_b32_dpp v62,v68 quad_perm:[0,0,2,2] row_mask:0xf bank_mask:0xf
v_mov_b32_dpp v66,v69 quad_perm:[0,0,2,2] row_mask:0xf bank_mask:0xf
v_add_f32 v61,v92,v93
v_add_f32 v65,v94,v95
ds_write_b128 v110,v[60:63] offset:8192
ds_write_b128 v110,v[64:67] offset:9216
s_barrier
s_xor_b32 s37,s37,0x80000000
s_xor_b32 s35,s35,0x80000000
s_mov_b32 s34,s29
s_add_u32 s29,s29,0x4000
s_and_b32 s29,s29,0xc800
s_add_u32 s29,s29,50397184
s_add_u32 s28,s28,0x2000
s_and_b32 s28,s28,0x6800
s_add_u32 s28,s28,50331648
s_add_u32 s62,s28,4096
s_add_u32 s32,s32,32768
s_add_u32 s63,s63,s36
s_add_u32 s26,s26,1
s_cmp_lt_u32 s26,63
s_cbranch_scc1 Aloop_87
s_branch Aexit_14
.p2align 6
Aloop_92:
s_sleep 6
buffer_load_dwordx4 v[28:31],v111,s[8:11],s32 offen sc1
buffer_load_dwordx4 v[32:35],v111,s[8:11],s32 offen offset:1024 sc1
buffer_load_dwordx4 v[44:47],v112,s[8:11],s32 offen sc1
buffer_load_dwordx4 v[48:51],v112,s[8:11],s32 offen offset:1024 sc1
s_sleep 3
Aent_44:
v_mov_b64 v[60:61],0
v_mov_b64 v[62:63],0
v_mov_b64 v[64:65],0
v_mov_b64 v[66:67],0
v_mov_b64 v[68:69],0
v_mov_b64 v[70:71],0
v_mov_b64 v[72:73],0
v_mov_b64 v[74:75],0
v_mov_b64 v[76:77],0
v_mov_b64 v[78:79],0
v_mov_b64 v[80:81],0
v_mov_b64 v[82:83],0
v_mov_b64 v[84:85],0
v_mov_b64 v[86:87],0
v_mov_b64 v[88:89],0
v_mov_b64 v[90:91],0
v_mov_b64 v[92:93],0
v_mov_b64 v[94:95],0
v_mov_b64 v[96:97],0
v_mov_b64 v[98:99],0
s_mov_b32 s27,0
buffer_load_ushort v100,v119,s[8:11],0 offen sc1
s_nop 9
buffer_load_ushort v101,v119,s[8:11],0 offen sc1
s_nop 9
buffer_load_ushort v102,v119,s[8:11],0 offen sc1
s_nop 9
buffer_load_ushort v103,v119,s[8:11],0 offen sc1
s_nop 9
buffer_load_ushort v104,v119,s[8:11],0 offen sc1
fp_95:
s_waitcnt vmcnt(4)
v_cmp_gt_u32 vcc,s63,v100
buffer_load_ushort v100,v119,s[8:11],0 offen sc1
s_cbranch_vccz fpd_96
s_waitcnt vmcnt(4)
v_cmp_gt_u32 vcc,s63,v101
buffer_load_ushort v101,v119,s[8:11],0 offen sc1
s_cbranch_vccz fpd_96
s_waitcnt vmcnt(4)
v_cmp_gt_u32 vcc,s63,v102
buffer_load_ushort v102,v119,s[8:11],0 offen sc1
s_cbranch_vccz fpd_96
s_waitcnt vmcnt(4)
v_cmp_gt_u32 vcc,s63,v103
buffer_load_ushort v103,v119,s[8:11],0 offen sc1
s_cbranch_vccz fpd_96
s_waitcnt vmcnt(4)
v_cmp_gt_u32 vcc,s63,v104
buffer_load_ushort v104,v119,s[8:11],0 offen sc1
s_cbranch_vccz fpd_96
s_waitcnt vmcnt(4)
v_cmp_gt_u32 vcc,s63,v100
buffer_load_ushort v100,v119,s[8:11],0 offen sc1
s_cbranch_vccz fpd_96
s_waitcnt vmcnt(4)
v_cmp_gt_u32 vcc,s63,v101
buffer_load_ushort v101,v119,s[8:11],0 offen sc1
s_cbranch_vccz fpd_96
s_waitcnt vmcnt(4)
v_cmp_gt_u32 vcc,s63,v102
buffer_load_ushort v102,v119,s[8:11],0 offen sc1
s_cbranch_vccz fpd_96
s_waitcnt vmcnt(4)
v_cmp_gt_u32 vcc,s63,v103
buffer_load_ushort v103,v119,s[8:11],0 offen sc1
s_cbranch_vccz fpd_96
s_waitcnt vmcnt(4)
v_cmp_gt_u32 vcc,s63,v104
buffer_load_ushort v104,v119,s[8:11],0 offen sc1
s_cbranch_vccz fpd_96
s_waitcnt vmcnt(4)
v_cmp_gt_u32 vcc,s63,v100
buffer_load_ushort v100,v119,s[8:11],0 offen sc1
s_cbranch_vccz fpd_96
s_waitcnt vmcnt(4)
v_cmp_gt_u32 vcc,s63,v101
buffer_load_ushort v101,v119,s[8:11],0 offen sc1
s_cbranch_vccz fpd_96
s_waitcnt vmcnt(4)
v_cmp_gt_u32 vcc,s63,v102
buffer_load_ushort v102,v119,s[8:11],0 offen sc1
s_cbranch_vccz fpd_96
s_waitcnt vmcnt(4)
v_cmp_gt_u32 vcc,s63,v103
buffer_load_ushort v103,v119,s[8:11],0 offen sc1
s_cbranch_vccz fpd_96
s_waitcnt vmcnt(4)
v_cmp_gt_u32 vcc,s63,v104
buffer_load_ushort v104,v119,s[8:11],0 offen sc1
s_cbranch_vccz fpd_96
s_add_u32 s27,s27,1
s_cmp_lt_u32 s27,131072
s_cbranch_scc1 fp_95
s_mov_b32 s38,1
s_branch L_end
fpd_96:
buffer_load_dwordx4 v[12:15],v109,s[8:11],s28 offen offset:3072 sc1
s_nop 12
buffer_load_dwordx4 v[8:11],v109,s[8:11],s28 offen offset:2048 sc1
s_nop 12
buffer_load_dwordx4 v[4:7],v109,s[8:11],s28 offen offset:1024 sc1
s_nop 12
buffer_load_dwordx4 v[0:3],v109,s[8:11],s28 offen sc1
Ago_93:
s_waitcnt vmcnt(3)
v_smfmac_f32_16x16x64_bf16 v[60:63],v[12:15],a[224:231],v108
buffer_load_dwordx4 v[24:27],v109,s[8:11],s62 offen offset:2048 sc1
v_smfmac_f32_16x16x64_bf16 v[64:67],v[12:15],v[120:127],v108
v_max3_u32 v100,v12,v13,v14
v_smfmac_f32_16x16x64_bf16 v[68:71],v[12:15],v[152:159],v108
v_max_u32 v100,v100,v15
v_smfmac_f32_16x16x64_bf16 v[72:75],v[12:15],v[184:191],v108
v_smfmac_f32_16x16x64_bf16 v[76:79],v[12:15],v[216:223],v108
buffer_load_dwordx4 v[20:23],v109,s[8:11],s62 offen offset:1024 sc1
v_smfmac_f32_16x16x64_bf16 v[80:83],v[12:15],v[248:255],v108
s_waitcnt vmcnt(4)
v_smfmac_f32_16x16x64_bf16 v[60:63],v[8:11],a[216:223],v108
v_smfmac_f32_16x16x64_bf16 v[64:67],v[8:11],a[248:255],v108
v_max3_u32 v100,v100,v8,v9
v_smfmac_f32_16x16x64_bf16 v[68:71],v[8:11],v[144:151],v108
buffer_load_dwordx4 v[16:19],v109,s[8:11],s62 offen sc1
v_max3_u32 v100,v100,v10,v11
v_smfmac_f32_16x16x64_bf16 v[72:75],v[8:11],v[176:183],v108
v_smfmac_f32_16x16x64_bf16 v[76:79],v[8:11],v[208:215],v108
v_smfmac_f32_16x16x64_bf16 v[80:83],v[8:11],v[240:247],v108
s_waitcnt vmcnt(4)
v_smfmac_f32_16x16x64_bf16 v[60:63],v[4:7],a[208:215],v108
buffer_load_dwordx4 v[36:39],v111,s[8:11],s32 offen offset:2048 sc1
v_smfmac_f32_16x16x64_bf16 v[64:67],v[4:7],a[240:247],v108
v_max3_u32 v100,v100,v4,v5
v_smfmac_f32_16x16x64_bf16 v[68:71],v[4:7],v[136:143],v108
v_max3_u32 v100,v100,v6,v7
v_smfmac_f32_16x16x64_bf16 v[72:75],v[4:7],v[168:175],v108
v_smfmac_f32_16x16x64_bf16 v[76:79],v[4:7],v[200:207],v108
buffer_load_dwordx4 v[40:43],v111,s[8:11],s32 offen offset:3072 sc1
v_smfmac_f32_16x16x64_bf16 v[80:83],v[4:7],v[232:239],v108
s_waitcnt vmcnt(5)
v_smfmac_f32_16x16x64_bf16 v[60:63],v[0:3],a[200:207],v108
v_max3_u32 v100,v100,v0,v1
v_smfmac_f32_16x16x64_bf16 v[64:67],v[0:3],a[232:239],v108
v_max3_u32 v100,v100,v2,v3
v_smfmac_f32_16x16x64_bf16 v[68:71],v[0:3],v[128:135],v108
buffer_load_dwordx4 v[52:55],v112,s[8:11],s32 offen offset:2048 sc1
v_smfmac_f32_16x16x64_bf16 v[72:75],v[0:3],v[160:167],v108
s_waitcnt vmcnt(5)
v_smfmac_f32_16x16x64_bf16 v[60:63],v[24:27],a[16:23],v108
v_max3_u32 v100,v100,v24,v25
v_smfmac_f32_16x16x64_bf16 v[64:67],v[24:27],a[40:47],v108
v_max3_u32 v100,v100,v26,v27
v_smfmac_f32_16x16x64_bf16 v[68:71],v[24:27],a[64:71],v108
buffer_load_dwordx4 v[56:59],v112,s[8:11],s32 offen offset:3072 sc1
v_smfmac_f32_16x16x64_bf16 v[72:75],v[24:27],a[88:95],v108
s_waitcnt vmcnt(5)
v_smfmac_f32_16x16x64_bf16 v[60:63],v[20:23],a[8:15],v108
v_max3_u32 v100,v100,v20,v21
v_smfmac_f32_16x16x64_bf16 v[64:67],v[20:23],a[32:39],v108
v_max3_u32 v100,v100,v22,v23
v_smfmac_f32_16x16x64_bf16 v[68:71],v[20:23],a[56:63],v108
v_smfmac_f32_16x16x64_bf16 v[72:75],v[20:23],a[80:87],v108
s_waitcnt vmcnt(4)
v_smfmac_f32_16x16x64_bf16 v[60:63],v[16:19],a[0:7],v108
v_max3_u32 v100,v100,v16,v17
v_smfmac_f32_16x16x64_bf16 v[64:67],v[16:19],a[24:31],v108
v_max3_u32 v100,v100,v18,v19
v_smfmac_f32_16x16x64_bf16 v[68:71],v[16:19],a[48:55],v108
v_cmp_eq_u32 vcc,-1,v100
v_smfmac_f32_16x16x64_bf16 v[72:75],v[16:19],a[72:79],v108
v_add_f32 v60,v60,v61
v_smfmac_f32_16x16x64_bf16 v[76:79],v[0:3],v[192:199],v108
v_add_f32 v62,v62,v63
v_smfmac_f32_16x16x64_bf16 v[76:79],v[24:27],a[112:119],v108
s_cbranch_vccnz Aredo_94
v_add_f32 v64,v64,v65
v_smfmac_f32_16x16x64_bf16 v[76:79],v[20:23],a[104:111],v108
v_cvt_pk_bf16_f32 v61,v60,v64
v_smfmac_f32_16x16x64_bf16 v[76:79],v[16:19],a[96:103],v108
ds_write_b32 v113,v61 offset:0
v_add_f32 v66,v66,v67
v_smfmac_f32_16x16x64_bf16 v[80:83],v[0:3],v[224:231],v108
v_cvt_pk_bf16_f32 v63,v62,v66
v_smfmac_f32_16x16x64_bf16 v[80:83],v[24:27],a[136:143],v108
ds_write_b32 v113,v63 offset:32
v_add_f32 v68,v68,v69
v_smfmac_f32_16x16x64_bf16 v[80:83],v[20:23],a[128:135],v108
v_add_f32 v70,v70,v71
v_smfmac_f32_16x16x64_bf16 v[80:83],v[16:19],a[120:127],v108
v_add_f32 v72,v72,v73
v_smfmac_f32_16x16x64_bf16 v[84:87],v[12:15],a[168:175],v108
v_cvt_pk_bf16_f32 v69,v68,v72
v_smfmac_f32_16x16x64_bf16 v[84:87],v[8:11],a[160:167],v108
ds_write_b32 v113,v69 offset:512
v_add_f32 v74,v74,v75
v_smfmac_f32_16x16x64_bf16 v[84:87],v[4:7],a[152:159],v108
v_cvt_pk_bf16_f32 v71,v70,v74
v_smfmac_f32_16x16x64_bf16 v[84:87],v[0:3],a[144:151],v108
ds_write_b32 v113,v71 offset:544
v_smfmac_f32_16x16x64_bf16 v[84:87],v[24:27],a[192:199],v108
ds_read_b128 v[100:103],v110 offset:0
v_add_f32 v76,v76,v77
v_smfmac_f32_16x16x64_bf16 v[84:87],v[20:23],a[184:191],v108
v_add_f32 v78,v78,v79
v_smfmac_f32_16x16x64_bf16 v[84:87],v[16:19],a[176:183],v108
v_add_f32 v80,v80,v81
v_cvt_pk_bf16_f32 v77,v76,v80
v_add_f32 v82,v82,v83
v_cvt_pk_bf16_f32 v79,v78,v82
ds_write_b32 v114,v77 offset:1024
ds_write_b32 v114,v79 offset:1056
s_nop 1
v_add_f32 v84,v84,v85
v_add_f32 v86,v86,v87
v_cvt_pk_bf16_f32 v84,v84,v86
ds_write_b16 v115,v84 offset:1024
ds_write_b16_d16_hi v115,v84 offset:1056
ds_read_b128 v[104:107],v110 offset:1024
s_waitcnt vmcnt(0) lgkmcnt(5)
v_smfmac_f32_16x16x64_bf16 v[88:91],v[100:103],v[28:35],v108
v_mov_b32 v63,s37
v_smfmac_f32_16x16x64_bf16 v[92:95],v[100:103],v[44:51],v108
v_mov_b32 v67,s37
v_smfmac_f32_16x16x64_bf16 v[96:99],v[100:103],v[8:15],v108
s_waitcnt lgkmcnt(0)
v_smfmac_f32_16x16x64_bf16 v[96:99],v[104:107],v[20:27],v108
v_smfmac_f32_16x16x64_bf16 v[88:91],v[104:107],v[36:43],v108
v_smfmac_f32_16x16x64_bf16 v[92:95],v[104:107],v[52:59],v108
s_nop 0
v_add_f32 v68,v96,v97
v_add_f32 v69,v98,v99
s_nop 1
v_add_f32 v60,v88,v89
v_add_f32 v64,v90,v91
v_mov_b32_dpp v62,v68 quad_perm:[1,1,3,3] row_mask:0xf bank_mask:0xf
v_mov_b32_dpp v66,v69 quad_perm:[1,1,3,3] row_mask:0xf bank_mask:0xf
v_add_f32 v61,v92,v93
v_add_f32 v65,v94,v95
ds_write_b128 v110,v[60:63] offset:8192
ds_write_b128 v110,v[64:67] offset:9216
s_barrier
s_add_u32 s30,s26,1
v_mov_b32 v28,s30
s_nop 15
s_nop 15
s_nop 1
buffer_store_short v28,v118,s[8:11],0 offen
s_xor_b32 s37,s37,0x80000000
s_xor_b32 s35,s35,0x80000000
s_mov_b32 s34,s29
s_add_u32 s29,s29,0x4000
s_and_b32 s29,s29,0xc800
s_add_u32 s29,s29,50397184
s_add_u32 s28,s28,0x2000
s_and_b32 s28,s28,0x6800
s_add_u32 s28,s28,50331648
s_add_u32 s62,s28,4096
s_add_u32 s32,s32,32768
s_add_u32 s63,s63,s36
s_add_u32 s26,s26,1
s_cmp_lt_u32 s26,63
s_cbranch_scc1 Aloop_92
s_branch Aexit_14
Aexit_14:
s_cmp_lg_u32 s99,0
s_cbranch_scc1 Aback_13
s_branch L_end
slow_27:
s_add_u32 s30,s97,50397184
buffer_store_dword v12,v116,s[8:11],s30 offen sc1
buffer_store_short v12,v117,s[8:11],s30 offen sc1
s_add_u32 s30,s97,50413568
buffer_store_dword v12,v116,s[8:11],s30 offen sc1
buffer_store_short v12,v117,s[8:11],s30 offen sc1
s_add_u32 s30,s97,50429952
buffer_store_dword v12,v116,s[8:11],s30 offen sc1
buffer_store_short v12,v117,s[8:11],s30 offen sc1
s_add_u32 s30,s97,50446336
buffer_store_dword v12,v116,s[8:11],s30 offen sc1
buffer_store_short v12,v117,s[8:11],s30 offen sc1
s_branch slowr_28
slow_32:
buffer_store_dword v8,v9,s[8:11],s30 offen sc1
s_branch slowr_33
Aredo_47:
buffer_load_dwordx4 v[0:3],v109,s[8:11],s28 offen sc1
buffer_load_dwordx4 v[4:7],v109,s[8:11],s28 offen offset:1024 sc1
buffer_load_dwordx4 v[8:11],v109,s[8:11],s28 offen offset:2048 sc1
buffer_load_dwordx4 v[12:15],v109,s[8:11],s28 offen offset:3072 sc1
buffer_load_dwordx4 v[16:19],v109,s[8:11],s62 offen sc1
buffer_load_dwordx4 v[20:23],v109,s[8:11],s62 offen offset:1024 sc1
buffer_load_dwordx4 v[24:27],v109,s[8:11],s62 offen offset:2048 sc1
s_waitcnt vmcnt(0)
v_max3_u32 v100,v0,v1,v2
v_max3_u32 v100,v100,v3,v4
v_max3_u32 v100,v100,v5,v6
v_max3_u32 v100,v100,v7,v8
v_max3_u32 v100,v100,v9,v10
v_max3_u32 v100,v100,v11,v12
v_max3_u32 v100,v100,v13,v14
v_max3_u32 v100,v100,v15,v16
v_max3_u32 v100,v100,v17,v18
v_max3_u32 v100,v100,v19,v20
v_max3_u32 v100,v100,v21,v22
v_max3_u32 v100,v100,v23,v24
v_max3_u32 v100,v100,v25,v26
v_max_u32 v100,v100,v27
v_cmp_eq_u32 vcc,-1,v100
s_cbranch_vccz Aredo_47_ok
s_add_u32 s27,s27,1
s_cmp_lt_u32 s27,131072
s_cbranch_scc1 Aredo_47
s_mov_b32 s38,1
s_branch L_end
Aredo_47_ok:
v_mov_b64 v[60:61],0
v_mov_b64 v[62:63],0
v_mov_b64 v[64:65],0
v_mov_b64 v[66:67],0
v_mov_b64 v[68:69],0
v_mov_b64 v[70:71],0
v_mov_b64 v[72:73],0
v_mov_b64 v[74:75],0
v_mov_b64 v[76:77],0
v_mov_b64 v[78:79],0
v_mov_b64 v[80:81],0
v_mov_b64 v[82:83],0
v_mov_b64 v[84:85],0
v_mov_b64 v[86:87],0
s_nop 1
s_branch Ago_46
slow_51:
buffer_store_dword v84,v116,s[8:11],s31 offen sc1
buffer_store_short v86,v117,s[8:11],s31 offen sc1
buffer_store_dword v29,v116,s[8:11],s34 offen sc1
buffer_store_short v29,v117,s[8:11],s34 offen sc1
s_branch slowr_52
Aredo_55:
buffer_load_dwordx4 v[0:3],v109,s[8:11],s28 offen sc1
buffer_load_dwordx4 v[4:7],v109,s[8:11],s28 offen offset:1024 sc1
buffer_load_dwordx4 v[8:11],v109,s[8:11],s28 offen offset:2048 sc1
buffer_load_dwordx4 v[12:15],v109,s[8:11],s28 offen offset:3072 sc1
buffer_load_dwordx4 v[16:19],v109,s[8:11],s62 offen sc1
buffer_load_dwordx4 v[20:23],v109,s[8:11],s62 offen offset:1024 sc1
buffer_load_dwordx4 v[24:27],v109,s[8:11],s62 offen offset:2048 sc1
s_waitcnt vmcnt(0)
v_max3_u32 v100,v0,v1,v2
v_max3_u32 v100,v100,v3,v4
v_max3_u32 v100,v100,v5,v6
v_max3_u32 v100,v100,v7,v8
v_max3_u32 v100,v100,v9,v10
v_max3_u32 v100,v100,v11,v12
v_max3_u32 v100,v100,v13,v14
v_max3_u32 v100,v100,v15,v16
v_max3_u32 v100,v100,v17,v18
v_max3_u32 v100,v100,v19,v20
v_max3_u32 v100,v100,v21,v22
v_max3_u32 v100,v100,v23,v24
v_max3_u32 v100,v100,v25,v26
v_max_u32 v100,v100,v27
v_cmp_eq_u32 vcc,-1,v100
s_cbranch_vccz Aredo_55_ok
s_add_u32 s27,s27,1
s_cmp_lt_u32 s27,131072
s_cbranch_scc1 Aredo_55
s_mov_b32 s38,1
s_branch L_end
Aredo_55_ok:
v_mov_b64 v[60:61],0
v_mov_b64 v[62:63],0
v_mov_b64 v[64:65],0
v_mov_b64 v[66:67],0
v_mov_b64 v[68:69],0
v_mov_b64 v[70:71],0
v_mov_b64 v[72:73],0
v_mov_b64 v[74:75],0
v_mov_b64 v[76:77],0
v_mov_b64 v[78:79],0
v_mov_b64 v[80:81],0
v_mov_b64 v[82:83],0
v_mov_b64 v[84:85],0
v_mov_b64 v[86:87],0
s_nop 1
s_branch Ago_54
slow_59:
buffer_store_dword v84,v116,s[8:11],s31 offen sc1
buffer_store_short v86,v117,s[8:11],s31 offen sc1
buffer_store_dword v29,v116,s[8:11],s34 offen sc1
buffer_store_short v29,v117,s[8:11],s34 offen sc1
s_branch slowr_60
Aredo_63:
buffer_load_dwordx4 v[0:3],v109,s[8:11],s28 offen sc1
buffer_load_dwordx4 v[4:7],v109,s[8:11],s28 offen offset:1024 sc1
buffer_load_dwordx4 v[8:11],v109,s[8:11],s28 offen offset:2048 sc1
buffer_load_dwordx4 v[12:15],v109,s[8:11],s28 offen offset:3072 sc1
buffer_load_dwordx4 v[16:19],v109,s[8:11],s62 offen sc1
buffer_load_dwordx4 v[20:23],v109,s[8:11],s62 offen offset:1024 sc1
buffer_load_dwordx4 v[24:27],v109,s[8:11],s62 offen offset:2048 sc1
s_waitcnt vmcnt(0)
v_max3_u32 v100,v0,v1,v2
v_max3_u32 v100,v100,v3,v4
v_max3_u32 v100,v100,v5,v6
v_max3_u32 v100,v100,v7,v8
v_max3_u32 v100,v100,v9,v10
v_max3_u32 v100,v100,v11,v12
v_max3_u32 v100,v100,v13,v14
v_max3_u32 v100,v100,v15,v16
v_max3_u32 v100,v100,v17,v18
v_max3_u32 v100,v100,v19,v20
v_max3_u32 v100,v100,v21,v22
v_max3_u32 v100,v100,v23,v24
v_max3_u32 v100,v100,v25,v26
v_max_u32 v100,v100,v27
v_cmp_eq_u32 vcc,-1,v100
s_cbranch_vccz Aredo_63_ok
s_add_u32 s27,s27,1
s_cmp_lt_u32 s27,131072
s_cbranch_scc1 Aredo_63
s_mov_b32 s38,1
s_branch L_end
Aredo_63_ok:
v_mov_b64 v[60:61],0
v_mov_b64 v[62:63],0
v_mov_b64 v[64:65],0
v_mov_b64 v[66:67],0
v_mov_b64 v[68:69],0
v_mov_b64 v[70:71],0
v_mov_b64 v[72:73],0
v_mov_b64 v[74:75],0
v_mov_b64 v[76:77],0
v_mov_b64 v[78:79],0
v_mov_b64 v[80:81],0
v_mov_b64 v[82:83],0
v_mov_b64 v[84:85],0
v_mov_b64 v[86:87],0
s_nop 1
s_branch Ago_62
Aredo_68:
buffer_load_dwordx4 v[0:3],v109,s[8:11],s28 offen sc1
buffer_load_dwordx4 v[4:7],v109,s[8:11],s28 offen offset:1024 sc1
buffer_load_dwordx4 v[8:11],v109,s[8:11],s28 offen offset:2048 sc1
buffer_load_dwordx4 v[12:15],v109,s[8:11],s28 offen offset:3072 sc1
buffer_load_dwordx4 v[16:19],v109,s[8:11],s62 offen sc1
buffer_load_dwordx4 v[20:23],v109,s[8:11],s62 offen offset:1024 sc1
buffer_load_dwordx4 v[24:27],v109,s[8:11],s62 offen offset:2048 sc1
s_waitcnt vmcnt(0)
v_max3_u32 v100,v0,v1,v2
v_max3_u32 v100,v100,v3,v4
v_max3_u32 v100,v100,v5,v6
v_max3_u32 v100,v100,v7,v8
v_max3_u32 v100,v100,v9,v10
v_max3_u32 v100,v100,v11,v12
v_max3_u32 v100,v100,v13,v14
v_max3_u32 v100,v100,v15,v16
v_max3_u32 v100,v100,v17,v18
v_max3_u32 v100,v100,v19,v20
v_max3_u32 v100,v100,v21,v22
v_max3_u32 v100,v100,v23,v24
v_max3_u32 v100,v100,v25,v26
v_max_u32 v100,v100,v27
v_cmp_eq_u32 vcc,-1,v100
s_cbranch_vccz Aredo_68_ok
s_add_u32 s27,s27,1
s_cmp_lt_u32 s27,131072
s_cbranch_scc1 Aredo_68
s_mov_b32 s38,1
s_branch L_end
Aredo_68_ok:
v_mov_b64 v[60:61],0
v_mov_b64 v[62:63],0
v_mov_b64 v[64:65],0
v_mov_b64 v[66:67],0
v_mov_b64 v[68:69],0
v_mov_b64 v[70:71],0
v_mov_b64 v[72:73],0
v_mov_b64 v[74:75],0
v_mov_b64 v[76:77],0
v_mov_b64 v[78:79],0
v_mov_b64 v[80:81],0
v_mov_b64 v[82:83],0
v_mov_b64 v[84:85],0
v_mov_b64 v[86:87],0
s_nop 1
s_branch Ago_67
Aredo_73:
buffer_load_dwordx4 v[0:3],v109,s[8:11],s28 offen sc1
buffer_load_dwordx4 v[4:7],v109,s[8:11],s28 offen offset:1024 sc1
buffer_load_dwordx4 v[8:11],v109,s[8:11],s28 offen offset:2048 sc1
buffer_load_dwordx4 v[12:15],v109,s[8:11],s28 offen offset:3072 sc1
buffer_load_dwordx4 v[16:19],v109,s[8:11],s62 offen sc1
buffer_load_dwordx4 v[20:23],v109,s[8:11],s62 offen offset:1024 sc1
buffer_load_dwordx4 v[24:27],v109,s[8:11],s62 offen offset:2048 sc1
s_waitcnt vmcnt(0)
v_max3_u32 v100,v0,v1,v2
v_max3_u32 v100,v100,v3,v4
v_max3_u32 v100,v100,v5,v6
v_max3_u32 v100,v100,v7,v8
v_max3_u32 v100,v100,v9,v10
v_max3_u32 v100,v100,v11,v12
v_max3_u32 v100,v100,v13,v14
v_max3_u32 v100,v100,v15,v16
v_max3_u32 v100,v100,v17,v18
v_max3_u32 v100,v100,v19,v20
v_max3_u32 v100,v100,v21,v22
v_max3_u32 v100,v100,v23,v24
v_max3_u32 v100,v100,v25,v26
v_max_u32 v100,v100,v27
v_cmp_eq_u32 vcc,-1,v100
s_cbranch_vccz Aredo_73_ok
s_add_u32 s27,s27,1
s_cmp_lt_u32 s27,131072
s_cbranch_scc1 Aredo_73
s_mov_b32 s38,1
s_branch L_end
Aredo_73_ok:
v_mov_b64 v[60:61],0
v_mov_b64 v[62:63],0
v_mov_b64 v[64:65],0
v_mov_b64 v[66:67],0
v_mov_b64 v[68:69],0
v_mov_b64 v[70:71],0
v_mov_b64 v[72:73],0
v_mov_b64 v[74:75],0
v_mov_b64 v[76:77],0
v_mov_b64 v[78:79],0
v_mov_b64 v[80:81],0
v_mov_b64 v[82:83],0
v_mov_b64 v[84:85],0
v_mov_b64 v[86:87],0
s_nop 1
s_branch Ago_72
slow_77:
buffer_store_dword v84,v116,s[8:11],s31 offen sc1
buffer_store_short v86,v117,s[8:11],s31 offen sc1
buffer_store_dword v29,v116,s[8:11],s34 offen sc1
buffer_store_short v29,v117,s[8:11],s34 offen sc1
s_branch slowr_78
Aredo_81:
buffer_load_dwordx4 v[0:3],v109,s[8:11],s28 offen sc1
buffer_load_dwordx4 v[4:7],v109,s[8:11],s28 offen offset:1024 sc1
buffer_load_dwordx4 v[8:11],v109,s[8:11],s28 offen offset:2048 sc1
buffer_load_dwordx4 v[12:15],v109,s[8:11],s28 offen offset:3072 sc1
buffer_load_dwordx4 v[16:19],v109,s[8:11],s62 offen sc1
buffer_load_dwordx4 v[20:23],v109,s[8:11],s62 offen offset:1024 sc1
buffer_load_dwordx4 v[24:27],v109,s[8:11],s62 offen offset:2048 sc1
s_waitcnt vmcnt(0)
v_max3_u32 v100,v0,v1,v2
v_max3_u32 v100,v100,v3,v4
v_max3_u32 v100,v100,v5,v6
v_max3_u32 v100,v100,v7,v8
v_max3_u32 v100,v100,v9,v10
v_max3_u32 v100,v100,v11,v12
v_max3_u32 v100,v100,v13,v14
v_max3_u32 v100,v100,v15,v16
v_max3_u32 v100,v100,v17,v18
v_max3_u32 v100,v100,v19,v20
v_max3_u32 v100,v100,v21,v22
v_max3_u32 v100,v100,v23,v24
v_max3_u32 v100,v100,v25,v26
v_max_u32 v100,v100,v27
v_cmp_eq_u32 vcc,-1,v100
s_cbranch_vccz Aredo_81_ok
s_add_u32 s27,s27,1
s_cmp_lt_u32 s27,131072
s_cbranch_scc1 Aredo_81
s_mov_b32 s38,1
s_branch L_end
Aredo_81_ok:
v_mov_b64 v[60:61],0
v_mov_b64 v[62:63],0
v_mov_b64 v[64:65],0
v_mov_b64 v[66:67],0
v_mov_b64 v[68:69],0
v_mov_b64 v[70:71],0
v_mov_b64 v[72:73],0
v_mov_b64 v[74:75],0
v_mov_b64 v[76:77],0
v_mov_b64 v[78:79],0
v_mov_b64 v[80:81],0
v_mov_b64 v[82:83],0
v_mov_b64 v[84:85],0
v_mov_b64 v[86:87],0
s_nop 1
s_branch Ago_80
slow_85:
buffer_store_dword v84,v116,s[8:11],s31 offen sc1
buffer_store_short v86,v117,s[8:11],s31 offen sc1
buffer_store_dword v29,v116,s[8:11],s34 offen sc1
buffer_store_short v29,v117,s[8:11],s34 offen sc1
s_branch slowr_86
Aredo_89:
buffer_load_dwordx4 v[0:3],v109,s[8:11],s28 offen sc1
buffer_load_dwordx4 v[4:7],v109,s[8:11],s28 offen offset:1024 sc1
buffer_load_dwordx4 v[8:11],v109,s[8:11],s28 offen offset:2048 sc1
buffer_load_dwordx4 v[12:15],v109,s[8:11],s28 offen offset:3072 sc1
buffer_load_dwordx4 v[16:19],v109,s[8:11],s62 offen sc1
buffer_load_dwordx4 v[20:23],v109,s[8:11],s62 offen offset:1024 sc1
buffer_load_dwordx4 v[24:27],v109,s[8:11],s62 offen offset:2048 sc1
s_waitcnt vmcnt(0)
v_max3_u32 v100,v0,v1,v2
v_max3_u32 v100,v100,v3,v4
v_max3_u32 v100,v100,v5,v6
v_max3_u32 v100,v100,v7,v8
v_max3_u32 v100,v100,v9,v10
v_max3_u32 v100,v100,v11,v12
v_max3_u32 v100,v100,v13,v14
v_max3_u32 v100,v100,v15,v16
v_max3_u32 v100,v100,v17,v18
v_max3_u32 v100,v100,v19,v20
v_max3_u32 v100,v100,v21,v22
v_max3_u32 v100,v100,v23,v24
v_max3_u32 v100,v100,v25,v26
v_max_u32 v100,v100,v27
v_cmp_eq_u32 vcc,-1,v100
s_cbranch_vccz Aredo_89_ok
s_add_u32 s27,s27,1
s_cmp_lt_u32 s27,131072
s_cbranch_scc1 Aredo_89
s_mov_b32 s38,1
s_branch L_end
Aredo_89_ok:
v_mov_b64 v[60:61],0
v_mov_b64 v[62:63],0
v_mov_b64 v[64:65],0
v_mov_b64 v[66:67],0
v_mov_b64 v[68:69],0
v_mov_b64 v[70:71],0
v_mov_b64 v[72:73],0
v_mov_b64 v[74:75],0
v_mov_b64 v[76:77],0
v_mov_b64 v[78:79],0
v_mov_b64 v[80:81],0
v_mov_b64 v[82:83],0
v_mov_b64 v[84:85],0
v_mov_b64 v[86:87],0
s_nop 1
s_branch Ago_88
Aredo_94:
buffer_load_dwordx4 v[0:3],v109,s[8:11],s28 offen sc1
buffer_load_dwordx4 v[4:7],v109,s[8:11],s28 offen offset:1024 sc1
buffer_load_dwordx4 v[8:11],v109,s[8:11],s28 offen offset:2048 sc1
buffer_load_dwordx4 v[12:15],v109,s[8:11],s28 offen offset:3072 sc1
buffer_load_dwordx4 v[16:19],v109,s[8:11],s62 offen sc1
buffer_load_dwordx4 v[20:23],v109,s[8:11],s62 offen offset:1024 sc1
buffer_load_dwordx4 v[24:27],v109,s[8:11],s62 offen offset:2048 sc1
s_waitcnt vmcnt(0)
v_max3_u32 v100,v0,v1,v2
v_max3_u32 v100,v100,v3,v4
v_max3_u32 v100,v100,v5,v6
v_max3_u32 v100,v100,v7,v8
v_max3_u32 v100,v100,v9,v10
v_max3_u32 v100,v100,v11,v12
v_max3_u32 v100,v100,v13,v14
v_max3_u32 v100,v100,v15,v16
v_max3_u32 v100,v100,v17,v18
v_max3_u32 v100,v100,v19,v20
v_max3_u32 v100,v100,v21,v22
v_max3_u32 v100,v100,v23,v24
v_max3_u32 v100,v100,v25,v26
v_max_u32 v100,v100,v27
v_cmp_eq_u32 vcc,-1,v100
s_cbranch_vccz Aredo_94_ok
s_add_u32 s27,s27,1
s_cmp_lt_u32 s27,131072
s_cbranch_scc1 Aredo_94
s_mov_b32 s38,1
s_branch L_end
Aredo_94_ok:
v_mov_b64 v[60:61],0
v_mov_b64 v[62:63],0
v_mov_b64 v[64:65],0
v_mov_b64 v[66:67],0
v_mov_b64 v[68:69],0
v_mov_b64 v[70:71],0
v_mov_b64 v[72:73],0
v_mov_b64 v[74:75],0
v_mov_b64 v[76:77],0
v_mov_b64 v[78:79],0
v_mov_b64 v[80:81],0
v_mov_b64 v[82:83],0
v_mov_b64 v[84:85],0
v_mov_b64 v[86:87],0
s_nop 1
s_branch Ago_93
L_roleB:
s_sub_u32 s25,s25,16
s_mov_b32 s20,s66
s_mov_b32 s21,s67
s_mov_b32 s22,7168
s_mov_b32 s23,0x20000
s_mov_b32 s99,0
s_mov_b32 s97,0
s_mov_b32 s98,4
v_mbcnt_lo_u32_b32 v0,-1,0
v_mbcnt_hi_u32_b32 v0,-1,v0
v_lshrrev_b32 v1,4,v0
v_and_b32 v2,15,v0
v_and_b32 v3,1,v0
v_mov_b32 v164,0x4444
v_mov_b32 v4,0xeeee
v_cmp_eq_u32 vcc,1,v3
s_nop 1
v_cndmask_b32 v164,v164,v4,vcc
v_lshlrev_b32 v167,4,v0
s_lshl_b32 s30,s24,11
v_add_u32 v166,s30,v167
v_lshlrev_b32 v168,9,v1
v_lshl_add_u32 v168,v2,4,v168
s_lshl_b32 s30,s24,15
v_add_u32 v172,s30,v167
v_add_u32 v172,16384,v172
v_mov_b32 v169,v166
s_and_b32 s30,s24,1
s_lshl_b32 s30,s30,11
s_lshr_b32 s31,s24,1
s_lshl_b32 s31,s31,10
s_add_u32 s37,s30,s31
s_add_u32 s37,s37,8192
v_lshlrev_b32 v68,2,v0
v_mov_b32 v69,0x80008000
s_lshl_b32 s30,s25,9
s_lshl_b32 s31,s24,5
s_add_u32 s30,s30,s31
v_lshlrev_b32 v171,6,v1
v_lshrrev_b32 v3,3,v2
v_lshl_add_u32 v171,v3,8,v171
v_and_b32 v3,7,v2
v_lshl_add_u32 v171,v3,2,v171
v_add_u32 v171,s30,v171
v_lshrrev_b32 v173,1,v166
v_mov_b32 v4,0
ds_write_b64 v173,v[4:5] offset:8192
ds_write_b64 v173,v[4:5] offset:8704
s_waitcnt lgkmcnt(0)
v_add_u32 v165,4096,v167
v_and_b32 v112,3,v0
v_lshlrev_b32 v112,9,v112
v_and_b32 v3,4,v0
v_lshlrev_b32 v3,5,v3
v_sub_u32 v112,v112,v3
s_and_b32 s31,s25,4
s_xor_b32 s31,s31,s98
s_lshl_b32 s31,s31,8
s_add_u32 s31,s31,s25
s_lshl_b32 s31,s31,1
s_add_u32 s31,s31,50622720
v_add_u32 v112,s31,v112
v_mov_b32 v3,0x7f000000
v_cmp_gt_u32 vcc,8,v0
s_nop 1
v_cndmask_b32 v112,v3,v112,vcc
v_and_b32 v3,3,v0
s_mul_i32 s31,s24,8
v_lshl_add_u32 v3,v3,1,s31
v_cmp_gt_u32 vcc,32,v0
s_nop 1
v_cndmask_b32 v3,64,v3,vcc
s_and_b32 s56,s25,3
s_lshl_b32 s56,s56,9
s_add_u32 s56,s56,50622464
s_and_b32 s31,s24,1
s_lshl_b32 s31,s31,2
s_xor_b32 s31,s31,s98
s_lshl_b32 s31,s31,9
s_add_u32 s31,s31,s56
v_add_u32 v113,s31,v3
s_xor_b32 s31,s61,1
v_mov_b32 v3,s31
v_cndmask_b32 v174,1,v3,vcc
v_cndmask_b32 v166,-1,0,vcc
v_cmp_gt_u32 vcc,48,v0
v_add_u32 v3,2,v113
s_nop 0
v_cndmask_b32 v113,v3,v113,vcc
v_cndmask_b32 v166,1,v166,vcc
v_min_u32 v3,13,v0
v_and_b32 v4,4,v3
v_xor_b32 v4,s98,v4
v_lshl_add_u32 v3,v4,8,v3
s_add_u32 s30,s56,128
v_lshl_add_u32 v115,v3,1,s30
s_mov_b32 s26,0
s_mul_i32 s35,s25,32768
s_lshl_b32 s30,s24,13
s_add_u32 s35,s35,s30
s_add_u32 s35,s35,16777216
s_mov_b32 s62,0
s_add_u32 s28,s97,50331648
s_add_u32 s29,s97,50446336
s_xor_b32 s58,s61,1
s_add_u32 s32,s35,4096
v_lshrrev_b32 v180,1,v167
s_mov_b32 s59,0
v_mov_b32 v170,v171
v_mov_b32 v181,-1
v_mov_b32 v114,1
s_mov_b32 s27,0
s_mov_b32 s4,s94
s_mov_b32 s5,s95
s_mov_b32 s6,0
s_mov_b32 s7,0x20000
s_mov_b32 s10,0
s_mov_b32 s99,1
s_mov_b32 s26,62
s_mov_b32 s58,0
v_mov_b32 v166,0
v_mov_b32 v174,0
s_barrier
s_branch Bdsp_97
Bback_98:
s_waitcnt vmcnt(0) lgkmcnt(0)
s_mov_b32 s10,0x10000000
s_mov_b32 s99,0
s_barrier
v_mbcnt_lo_u32_b32 v0,-1,0
v_mbcnt_hi_u32_b32 v0,-1,v0
v_lshrrev_b32 v1,4,v0
v_and_b32 v2,15,v0
v_and_b32 v3,1,v0
v_mov_b32 v164,0x4444
v_mov_b32 v4,0xeeee
v_cmp_eq_u32 vcc,1,v3
s_nop 1
v_cndmask_b32 v164,v164,v4,vcc
v_lshlrev_b32 v167,4,v0
s_lshl_b32 s30,s24,11
v_add_u32 v166,s30,v167
v_lshlrev_b32 v168,9,v1
v_lshl_add_u32 v168,v2,4,v168
s_lshl_b32 s30,s24,15
v_add_u32 v172,s30,v167
v_add_u32 v172,16384,v172
v_lshl_add_u32 v3,v1,1,s24
v_mul_u32_u24 v3,896,v3
v_lshl_add_u32 v3,v2,2,v3
s_lshl_b32 s30,s25,6
buffer_load_dword v13,v3,s[20:23],s30 offen
v_lshlrev_b32 v3,7,v0
s_lshl_b32 s30,s24,9
s_lshr_b32 s31,s25,1
s_lshl_b32 s31,s31,2
s_add_u32 s30,s30,s31
s_add_u32 s30,s30,50595840
s_mov_b32 s34,s30
s_lshl_b32 s30,s24,2
s_mul_i32 s30,s30,401408
s_mul_i32 s31,s25,28672
s_add_u32 s31,s31,s30
s_add_u32 s31,s31,7340032
s_lshl_b32 s56,s24,15
s_add_u32 s56,s56,16384
v_mbcnt_lo_u32_b32 v9,-1,0
v_and_b32 v9,15,v9
v_lshlrev_b32 v9,4,v9
s_mov_b32 s27,0
cen_99:
buffer_load_dword v8,v9,s[16:19],0 offen sc1
s_waitcnt vmcnt(0)
v_readlane_b32 s33,v8,0
s_mov_b32 s61,0
s_cmp_ge_u32 s33,32
s_cbranch_scc1 cend_100
s_mov_b32 s61,1
v_readlane_b32 s30,v8,1
s_add_u32 s33,s33,s30
v_readlane_b32 s30,v8,2
s_add_u32 s33,s33,s30
v_readlane_b32 s30,v8,3
s_add_u32 s33,s33,s30
v_readlane_b32 s30,v8,4
s_add_u32 s33,s33,s30
v_readlane_b32 s30,v8,5
s_add_u32 s33,s33,s30
v_readlane_b32 s30,v8,6
s_add_u32 s33,s33,s30
v_readlane_b32 s30,v8,7
s_add_u32 s33,s33,s30
v_readlane_b32 s30,v8,8
s_add_u32 s33,s33,s30
v_readlane_b32 s30,v8,9
s_add_u32 s33,s33,s30
v_readlane_b32 s30,v8,10
s_add_u32 s33,s33,s30
v_readlane_b32 s30,v8,11
s_add_u32 s33,s33,s30
v_readlane_b32 s30,v8,12
s_add_u32 s33,s33,s30
v_readlane_b32 s30,v8,13
s_add_u32 s33,s33,s30
v_readlane_b32 s30,v8,14
s_add_u32 s33,s33,s30
v_readlane_b32 s30,v8,15
s_add_u32 s33,s33,s30
s_cmp_ge_u32 s33,256
s_cbranch_scc1 cend_100
s_sleep 2
s_add_u32 s27,s27,1
s_cmp_lt_u32 s27,32768
s_cbranch_scc1 cen_99
s_mov_b32 s38,7
s_branch L_end
cend_100:
v_mov_b32 v8,0
v_mov_b32 v9,0
s_mov_b32 s27,0
dw_101:
v_cmp_eq_u32 vcc,0,v8
s_cbranch_vccz dwd_102
buffer_load_dword v8,v9,s[16:19],0 offen offset:4 sc1
s_waitcnt vmcnt(0)
s_add_u32 s27,s27,1
s_cmp_lt_u32 s27,32768
s_cbranch_scc1 dw_101
s_branch L_exit
dwd_102:
s_mov_b32 s4,s94
s_mov_b32 s5,s95
s_mov_b32 s6,268435456
s_mov_b32 s7,0x20000
s_cmp_lg_u32 s61,0
s_cselect_b32 s6,0,s6
s_mov_b64 exec,0xf
s_mov_b32 s27,0
wf_103:
buffer_load_dword v8,v3,s[8:11],s34 offen sc1
s_waitcnt vmcnt(0)
v_cmp_gt_u32 vcc,1,v8
s_cbranch_vccz wfd_104
s_sleep 1
s_add_u32 s27,s27,1
s_cmp_lt_u32 s27,32768
s_cbranch_scc1 wf_103
s_mov_b32 s38,9
wfd_104:
s_mov_b64 exec,-1
s_add_u32 s32,s31,0
buffer_load_dwordx4 a[0:3],v168,s[8:11],s32 offen sc1
buffer_load_dwordx4 a[40:43],v168,s[8:11],s32 offen offset:256 sc1
s_add_u32 s32,s31,14336
buffer_load_dwordx4 a[28:31],v168,s[8:11],s32 offen sc1
buffer_load_dwordx4 a[68:71],v168,s[8:11],s32 offen offset:256 sc1
s_add_u32 s32,s31,401408
buffer_load_dwordx4 a[80:83],v168,s[8:11],s32 offen sc1
buffer_load_dwordx4 a[120:123],v168,s[8:11],s32 offen offset:256 sc1
s_add_u32 s32,s31,415744
buffer_load_dwordx4 a[108:111],v168,s[8:11],s32 offen sc1
buffer_load_dwordx4 a[148:151],v168,s[8:11],s32 offen offset:256 sc1
s_add_u32 s32,s31,802816
buffer_load_dwordx4 a[160:163],v168,s[8:11],s32 offen sc1
buffer_load_dwordx4 a[200:203],v168,s[8:11],s32 offen offset:256 sc1
s_add_u32 s32,s31,817152
buffer_load_dwordx4 a[188:191],v168,s[8:11],s32 offen sc1
buffer_load_dwordx4 a[228:231],v168,s[8:11],s32 offen offset:256 sc1
s_waitcnt vmcnt(40)
s_add_u32 s32,s31,1204224
buffer_load_dwordx4 a[240:243],v168,s[8:11],s32 offen sc1
buffer_load_dwordx4 v[216:219],v168,s[8:11],s32 offen offset:256 sc1
s_add_u32 s32,s31,1218560
buffer_load_dwordx4 v[204:207],v168,s[8:11],s32 offen sc1
buffer_load_dwordx4 v[244:247],v168,s[8:11],s32 offen offset:256 sc1
v_mov_b32 v15,0
buffer_load_dword v14,v15,s[16:19],0 offen offset:24 sc1
s_mov_b64 exec,0xf
s_mov_b32 s27,0
wf_105:
buffer_load_dword v8,v3,s[8:11],s34 offen sc1
s_waitcnt vmcnt(0)
v_cmp_gt_u32 vcc,2,v8
s_cbranch_vccz wfd_106
s_sleep 1
s_add_u32 s27,s27,1
s_cmp_lt_u32 s27,32768
s_cbranch_scc1 wf_105
s_mov_b32 s38,9
wfd_106:
s_mov_b64 exec,-1
s_mov_b32 s27,0
dw_107:
v_cmp_eq_u32 vcc,0,v14
s_cbranch_vccz dwd_108
buffer_load_dword v14,v15,s[16:19],0 offen offset:24 sc1
s_waitcnt vmcnt(0)
s_add_u32 s27,s27,1
s_cmp_lt_u32 s27,32768
s_cbranch_scc1 dw_107
s_branch L_exit
dwd_108:
v_readfirstlane_b32 s97,v14
s_and_b32 s97,s97,0x800
s_lshr_b32 s98,s97,9
s_xor_b32 s98,s98,4
s_add_u32 s32,s31,2048
buffer_load_dwordx4 a[4:7],v168,s[8:11],s32 offen sc1
buffer_load_dwordx4 a[44:47],v168,s[8:11],s32 offen offset:256 sc1
s_add_u32 s32,s31,4096
buffer_load_dwordx4 a[8:11],v168,s[8:11],s32 offen sc1
buffer_load_dwordx4 a[48:51],v168,s[8:11],s32 offen offset:256 sc1
s_add_u32 s32,s31,16384
buffer_load_dwordx4 a[32:35],v168,s[8:11],s32 offen sc1
buffer_load_dwordx4 a[72:75],v168,s[8:11],s32 offen offset:256 sc1
s_add_u32 s32,s31,18432
buffer_load_dwordx4 a[36:39],v168,s[8:11],s32 offen sc1
buffer_load_dwordx4 a[76:79],v168,s[8:11],s32 offen offset:256 sc1
s_add_u32 s32,s31,403456
buffer_load_dwordx4 a[84:87],v168,s[8:11],s32 offen sc1
buffer_load_dwordx4 a[124:127],v168,s[8:11],s32 offen offset:256 sc1
s_add_u32 s32,s31,405504
buffer_load_dwordx4 a[88:91],v168,s[8:11],s32 offen sc1
buffer_load_dwordx4 a[128:131],v168,s[8:11],s32 offen offset:256 sc1
s_add_u32 s32,s31,417792
buffer_load_dwordx4 a[112:115],v168,s[8:11],s32 offen sc1
buffer_load_dwordx4 a[152:155],v168,s[8:11],s32 offen offset:256 sc1
s_add_u32 s32,s31,419840
buffer_load_dwordx4 a[116:119],v168,s[8:11],s32 offen sc1
buffer_load_dwordx4 a[156:159],v168,s[8:11],s32 offen offset:256 sc1
s_add_u32 s32,s31,804864
buffer_load_dwordx4 a[164:167],v168,s[8:11],s32 offen sc1
buffer_load_dwordx4 a[204:207],v168,s[8:11],s32 offen offset:256 sc1
s_add_u32 s32,s31,806912
buffer_load_dwordx4 a[168:171],v168,s[8:11],s32 offen sc1
buffer_load_dwordx4 a[208:211],v168,s[8:11],s32 offen offset:256 sc1
s_add_u32 s32,s31,819200
buffer_load_dwordx4 a[192:195],v168,s[8:11],s32 offen sc1
buffer_load_dwordx4 a[232:235],v168,s[8:11],s32 offen offset:256 sc1
s_add_u32 s32,s31,821248
buffer_load_dwordx4 a[196:199],v168,s[8:11],s32 offen sc1
buffer_load_dwordx4 a[236:239],v168,s[8:11],s32 offen offset:256 sc1
s_waitcnt vmcnt(40)
s_add_u32 s32,s31,1206272
buffer_load_dwordx4 a[244:247],v168,s[8:11],s32 offen sc1
buffer_load_dwordx4 v[220:223],v168,s[8:11],s32 offen offset:256 sc1
s_add_u32 s32,s31,1208320
buffer_load_dwordx4 a[248:251],v168,s[8:11],s32 offen sc1
buffer_load_dwordx4 v[224:227],v168,s[8:11],s32 offen offset:256 sc1
s_add_u32 s32,s31,1220608
buffer_load_dwordx4 v[208:211],v168,s[8:11],s32 offen sc1
buffer_load_dwordx4 v[248:251],v168,s[8:11],s32 offen offset:256 sc1
s_add_u32 s32,s31,1222656
buffer_load_dwordx4 v[212:215],v168,s[8:11],s32 offen sc1
buffer_load_dwordx4 v[252:255],v168,s[8:11],s32 offen offset:256 sc1
s_mov_b32 s100,s31
s_mov_b32 s101,s56
v_mov_b32 v12,v3
v_mov_b32 v169,v166
s_and_b32 s30,s24,1
s_lshl_b32 s30,s30,11
s_lshr_b32 s31,s24,1
s_lshl_b32 s31,s31,10
s_add_u32 s37,s30,s31
s_add_u32 s37,s37,8192
v_lshlrev_b32 v68,2,v0
v_mov_b32 v69,0x80008000
s_lshl_b32 s30,s25,9
s_lshl_b32 s31,s24,5
s_add_u32 s30,s30,s31
v_lshlrev_b32 v171,6,v1
v_lshrrev_b32 v3,3,v2
v_lshl_add_u32 v171,v3,8,v171
v_and_b32 v3,7,v2
v_lshl_add_u32 v171,v3,2,v171
v_add_u32 v171,s30,v171
v_lshrrev_b32 v173,1,v166
v_mov_b32 v4,0
ds_write_b64 v173,v[4:5] offset:8192
ds_write_b64 v173,v[4:5] offset:8704
s_waitcnt lgkmcnt(0)
v_add_u32 v165,4096,v167
v_and_b32 v112,3,v0
v_lshlrev_b32 v112,9,v112
v_and_b32 v3,4,v0
v_lshlrev_b32 v3,5,v3
v_sub_u32 v112,v112,v3
s_and_b32 s31,s25,4
s_xor_b32 s31,s31,s98
s_lshl_b32 s31,s31,8
s_add_u32 s31,s31,s25
s_lshl_b32 s31,s31,1
s_add_u32 s31,s31,50622720
v_add_u32 v112,s31,v112
v_mov_b32 v3,0x7f000000
v_cmp_gt_u32 vcc,8,v0
s_nop 1
v_cndmask_b32 v112,v3,v112,vcc
v_and_b32 v3,3,v0
s_mul_i32 s31,s24,8
v_lshl_add_u32 v3,v3,1,s31
v_cmp_gt_u32 vcc,32,v0
s_nop 1
v_cndmask_b32 v3,64,v3,vcc
s_and_b32 s56,s25,3
s_lshl_b32 s56,s56,9
s_add_u32 s56,s56,50622464
s_and_b32 s31,s24,1
s_lshl_b32 s31,s31,2
s_xor_b32 s31,s31,s98
s_lshl_b32 s31,s31,9
s_add_u32 s31,s31,s56
v_add_u32 v113,s31,v3
s_xor_b32 s31,s61,1
v_mov_b32 v3,s31
v_cndmask_b32 v174,1,v3,vcc
v_cndmask_b32 v166,-1,0,vcc
v_cmp_gt_u32 vcc,48,v0
v_add_u32 v3,2,v113
s_nop 0
v_cndmask_b32 v113,v3,v113,vcc
v_cndmask_b32 v166,1,v166,vcc
v_min_u32 v3,13,v0
v_and_b32 v4,4,v3
v_xor_b32 v4,s98,v4
v_lshl_add_u32 v3,v4,8,v3
s_add_u32 s30,s56,128
v_lshl_add_u32 v115,v3,1,s30
s_cmp_ge_u32 s24,2
s_cbranch_scc1 Bi_109
v_mov_b32 v5,-1
s_add_u32 s30,s97,50331648
s_add_u32 s31,s97,50339840
s_add_u32 s56,s97,50348032
s_add_u32 s57,s97,50356224
v_min_u32 v175,-2,v13
s_cmp_lg_u32 s61,0
s_cbranch_scc1 slow_110
buffer_store_dword v175,v171,s[8:11],s30 offen
buffer_store_dword v5,v171,s[8:11],s31 offen
buffer_store_dword v5,v171,s[8:11],s56 offen
buffer_store_dword v5,v171,s[8:11],s57 offen
slowr_111:
Bi_109:
s_mov_b32 s31,s100
s_mov_b32 s56,s101
v_mov_b32 v3,v12
s_mov_b64 exec,0xf
s_mov_b32 s27,0
wf_112:
buffer_load_dword v8,v3,s[8:11],s34 offen sc1
s_waitcnt vmcnt(0)
v_cmp_gt_u32 vcc,3,v8
s_cbranch_vccz wfd_113
s_sleep 1
s_add_u32 s27,s27,1
s_cmp_lt_u32 s27,32768
s_cbranch_scc1 wf_112
s_mov_b32 s38,9
wfd_113:
s_mov_b64 exec,-1
s_waitcnt vmcnt(0)
s_barrier
s_cmp_lg_u32 s24,3
s_cbranch_scc1 tbs_116
v_mov_b32 v8,1
v_mov_b32 v9,0
s_mov_b64 exec,1
s_lshl_b32 s30,s39,2
s_add_u32 s30,s30,50620544
s_cmp_lg_u32 s61,0
s_cbranch_scc1 slow_117
buffer_store_dword v8,v9,s[8:11],s30 offen
slowr_118:
s_mov_b64 exec,-1
tbs_116:
s_cmp_eq_u32 s61,0
s_cbranch_scc1 tbd_115
v_mbcnt_lo_u32_b32 v9,-1,0
v_min_u32 v9,29,v9
v_lshlrev_b32 v9,2,v9
s_mov_b32 s27,0
s_mov_b32 s30,50620544
tw_119:
buffer_load_dword v8,v9,s[8:11],s30 offen sc1
s_waitcnt vmcnt(0)
v_cmp_eq_u32 vcc,0,v8
s_cbranch_vccz tw_119_d
s_sleep 2
s_add_u32 s27,s27,1
s_cmp_lt_u32 s27,131072
s_cbranch_scc1 tw_119
s_mov_b32 s38,6
s_branch L_end
tw_119_d:
tbd_115:
v_mov_b32 v114,1
buffer_store_short v114,v112,s[8:11],0 offen
s_add_u32 s32,s31,6144
buffer_load_dwordx4 a[12:15],v168,s[8:11],s32 offen sc1
buffer_load_dwordx4 a[52:55],v168,s[8:11],s32 offen offset:256 sc1
s_add_u32 s32,s31,8192
buffer_load_dwordx4 a[16:19],v168,s[8:11],s32 offen sc1
buffer_load_dwordx4 a[56:59],v168,s[8:11],s32 offen offset:256 sc1
s_add_u32 s32,s31,10240
buffer_load_dwordx4 a[20:23],v168,s[8:11],s32 offen sc1
buffer_load_dwordx4 a[60:63],v168,s[8:11],s32 offen offset:256 sc1
s_add_u32 s32,s31,12288
buffer_load_dwordx4 a[24:27],v168,s[8:11],s32 offen sc1
buffer_load_dwordx4 a[64:67],v168,s[8:11],s32 offen offset:256 sc1
s_add_u32 s32,s31,20480
s_add_u32 m0,s56,0
s_nop 0
buffer_load_dwordx4 v168,s[8:11],s32 offen sc1 lds
s_add_u32 m0,s56,3840
s_nop 0
buffer_load_dwordx4 v168,s[8:11],s32 offen offset:256 sc1 lds
s_add_u32 s32,s31,22528
s_add_u32 m0,s56,1024
s_nop 0
buffer_load_dwordx4 v168,s[8:11],s32 offen sc1 lds
s_add_u32 m0,s56,4864
s_nop 0
buffer_load_dwordx4 v168,s[8:11],s32 offen offset:256 sc1 lds
s_add_u32 s32,s31,24576
s_add_u32 m0,s56,2048
s_nop 0
buffer_load_dwordx4 v168,s[8:11],s32 offen sc1 lds
s_add_u32 m0,s56,5888
s_nop 0
buffer_load_dwordx4 v168,s[8:11],s32 offen offset:256 sc1 lds
s_add_u32 s32,s31,26624
s_add_u32 m0,s56,3072
s_nop 0
buffer_load_dwordx4 v168,s[8:11],s32 offen sc1 lds
s_add_u32 m0,s56,6912
s_nop 0
buffer_load_dwordx4 v168,s[8:11],s32 offen offset:256 sc1 lds
s_add_u32 s32,s31,407552
buffer_load_dwordx4 a[92:95],v168,s[8:11],s32 offen sc1
buffer_load_dwordx4 a[132:135],v168,s[8:11],s32 offen offset:256 sc1
s_add_u32 s32,s31,409600
buffer_load_dwordx4 a[96:99],v168,s[8:11],s32 offen sc1
buffer_load_dwordx4 a[136:139],v168,s[8:11],s32 offen offset:256 sc1
s_add_u32 s32,s31,411648
buffer_load_dwordx4 a[100:103],v168,s[8:11],s32 offen sc1
buffer_load_dwordx4 a[140:143],v168,s[8:11],s32 offen offset:256 sc1
s_add_u32 s32,s31,413696
buffer_load_dwordx4 a[104:107],v168,s[8:11],s32 offen sc1
buffer_load_dwordx4 a[144:147],v168,s[8:11],s32 offen offset:256 sc1
s_add_u32 s32,s31,421888
s_add_u32 m0,s56,8192
s_nop 0
buffer_load_dwordx4 v168,s[8:11],s32 offen sc1 lds
s_add_u32 m0,s56,12032
s_nop 0
buffer_load_dwordx4 v168,s[8:11],s32 offen offset:256 sc1 lds
s_add_u32 s32,s31,423936
s_add_u32 m0,s56,9216
s_nop 0
buffer_load_dwordx4 v168,s[8:11],s32 offen sc1 lds
s_add_u32 m0,s56,13056
s_nop 0
buffer_load_dwordx4 v168,s[8:11],s32 offen offset:256 sc1 lds
s_add_u32 s32,s31,425984
s_add_u32 m0,s56,10240
s_nop 0
buffer_load_dwordx4 v168,s[8:11],s32 offen sc1 lds
s_add_u32 m0,s56,14080
s_nop 0
buffer_load_dwordx4 v168,s[8:11],s32 offen offset:256 sc1 lds
s_add_u32 s32,s31,428032
s_add_u32 m0,s56,11264
s_nop 0
buffer_load_dwordx4 v168,s[8:11],s32 offen sc1 lds
s_add_u32 m0,s56,15104
s_nop 0
buffer_load_dwordx4 v168,s[8:11],s32 offen offset:256 sc1 lds
s_add_u32 s32,s31,808960
buffer_load_dwordx4 a[172:175],v168,s[8:11],s32 offen sc1
buffer_load_dwordx4 a[212:215],v168,s[8:11],s32 offen offset:256 sc1
s_add_u32 s32,s31,811008
buffer_load_dwordx4 a[176:179],v168,s[8:11],s32 offen sc1
buffer_load_dwordx4 a[216:219],v168,s[8:11],s32 offen offset:256 sc1
s_add_u32 s32,s31,813056
buffer_load_dwordx4 a[180:183],v168,s[8:11],s32 offen sc1
buffer_load_dwordx4 a[220:223],v168,s[8:11],s32 offen offset:256 sc1
s_add_u32 s32,s31,815104
buffer_load_dwordx4 a[184:187],v168,s[8:11],s32 offen sc1
buffer_load_dwordx4 a[224:227],v168,s[8:11],s32 offen offset:256 sc1
s_add_u32 s32,s31,823296
s_add_u32 m0,s56,16384
s_nop 0
buffer_load_dwordx4 v168,s[8:11],s32 offen sc1 lds
s_add_u32 m0,s56,20224
s_nop 0
buffer_load_dwordx4 v168,s[8:11],s32 offen offset:256 sc1 lds
s_add_u32 s32,s31,825344
s_add_u32 m0,s56,17408
s_nop 0
buffer_load_dwordx4 v168,s[8:11],s32 offen sc1 lds
s_add_u32 m0,s56,21248
s_nop 0
buffer_load_dwordx4 v168,s[8:11],s32 offen offset:256 sc1 lds
s_add_u32 s32,s31,827392
s_add_u32 m0,s56,18432
s_nop 0
buffer_load_dwordx4 v168,s[8:11],s32 offen sc1 lds
s_add_u32 m0,s56,22272
s_nop 0
buffer_load_dwordx4 v168,s[8:11],s32 offen offset:256 sc1 lds
s_add_u32 s32,s31,829440
s_add_u32 m0,s56,19456
s_nop 0
buffer_load_dwordx4 v168,s[8:11],s32 offen sc1 lds
s_add_u32 m0,s56,23296
s_nop 0
buffer_load_dwordx4 v168,s[8:11],s32 offen offset:256 sc1 lds
s_waitcnt vmcnt(40)
s_add_u32 s32,s31,1210368
buffer_load_dwordx4 a[252:255],v168,s[8:11],s32 offen sc1
buffer_load_dwordx4 v[228:231],v168,s[8:11],s32 offen offset:256 sc1
s_add_u32 s32,s31,1212416
buffer_load_dwordx4 v[192:195],v168,s[8:11],s32 offen sc1
buffer_load_dwordx4 v[232:235],v168,s[8:11],s32 offen offset:256 sc1
s_add_u32 s32,s31,1214464
buffer_load_dwordx4 v[196:199],v168,s[8:11],s32 offen sc1
buffer_load_dwordx4 v[236:239],v168,s[8:11],s32 offen offset:256 sc1
s_add_u32 s32,s31,1216512
buffer_load_dwordx4 v[200:203],v168,s[8:11],s32 offen sc1
buffer_load_dwordx4 v[240:243],v168,s[8:11],s32 offen offset:256 sc1
s_add_u32 s32,s31,1224704
s_add_u32 m0,s56,24576
s_nop 0
buffer_load_dwordx4 v168,s[8:11],s32 offen sc1 lds
s_add_u32 m0,s56,28416
s_nop 0
buffer_load_dwordx4 v168,s[8:11],s32 offen offset:256 sc1 lds
s_add_u32 s32,s31,1226752
s_add_u32 m0,s56,25600
s_nop 0
buffer_load_dwordx4 v168,s[8:11],s32 offen sc1 lds
s_add_u32 m0,s56,29440
s_nop 0
buffer_load_dwordx4 v168,s[8:11],s32 offen offset:256 sc1 lds
s_add_u32 s32,s31,1228800
s_add_u32 m0,s56,26624
s_nop 0
buffer_load_dwordx4 v168,s[8:11],s32 offen sc1 lds
s_add_u32 m0,s56,30464
s_nop 0
buffer_load_dwordx4 v168,s[8:11],s32 offen offset:256 sc1 lds
s_add_u32 s32,s31,1230848
s_add_u32 m0,s56,27648
s_nop 0
buffer_load_dwordx4 v168,s[8:11],s32 offen sc1 lds
s_add_u32 m0,s56,31488
s_nop 0
buffer_load_dwordx4 v168,s[8:11],s32 offen offset:256 sc1 lds
s_add_u32 s30,s97,50331648
buffer_load_dword v6,v171,s[8:11],s30 offen sc1
s_add_u32 s30,s97,50339840
buffer_load_dword v6,v171,s[8:11],s30 offen sc1
s_add_u32 s30,s97,50348032
buffer_load_dword v6,v171,s[8:11],s30 offen sc1
s_add_u32 s30,s97,50356224
buffer_load_dword v6,v171,s[8:11],s30 offen sc1
s_mov_b32 s26,0
s_mul_i32 s35,s25,32768
s_lshl_b32 s30,s24,13
s_add_u32 s35,s35,s30
s_add_u32 s35,s35,16777216
s_mov_b32 s62,0
s_add_u32 s28,s97,50331648
s_add_u32 s29,s97,50446336
s_xor_b32 s58,s61,1
s_add_u32 s32,s35,4096
v_lshrrev_b32 v180,1,v167
s_mov_b32 s59,0
v_mov_b32 v170,v171
v_mov_b32 v181,-1
v_mov_b32 v114,1
s_mov_b32 s27,0
s_waitcnt vmcnt(0)
v_max_i32 v176,0,v166
s_mov_b32 s27,0
buffer_load_ushort v124,v113,s[8:11],0 offen sc1
fp_120:
s_waitcnt vmcnt(0)
v_cmp_gt_u32 vcc,v176,v124
buffer_load_ushort v124,v113,s[8:11],0 offen sc1
s_cbranch_vccz fpd_121
s_add_u32 s27,s27,1
s_cmp_lt_u32 s27,131072
s_cbranch_scc1 fp_120
s_mov_b32 s38,4
s_branch L_end
fpd_121:
ds_read_b128 v[132:135],v172 offset:0
ds_read_b128 v[136:139],v172 offset:1024
ds_read_b128 v[140:143],v172 offset:2048
ds_read_b128 v[144:147],v172 offset:3072
ds_read_b128 v[148:151],v172 offset:4096
ds_read_b128 v[152:155],v172 offset:5120
ds_read_b128 v[156:159],v172 offset:6144
ds_read_b128 v[160:163],v172 offset:7168
Bdsp_97:
s_cmp_eq_u32 s24,3
s_cbranch_scc1 Bloop_122
Bh01_125:
s_cmp_eq_u32 s26,63
s_cbranch_scc1 Bfin_126
v_mov_b64 v[76:77],0
v_mov_b64 v[78:79],0
v_mov_b64 v[80:81],0
v_mov_b64 v[82:83],0
v_mov_b64 v[128:129],0
v_mov_b64 v[130:131],0
v_mov_b64 v[116:117],0
v_mov_b64 v[118:119],0
v_mov_b64 v[120:121],0
v_mov_b64 v[122:123],0
v_mov_b64 v[188:189],0
v_mov_b64 v[190:191],0
v_mov_b64 v[104:105],0
v_mov_b64 v[106:107],0
v_mov_b64 v[108:109],0
v_mov_b64 v[110:111],0
v_mov_b64 v[84:85],0
v_mov_b64 v[86:87],0
v_mov_b64 v[88:89],0
v_mov_b64 v[90:91],0
s_barrier
buffer_load_dwordx4 v[44:47],v168,s[8:11],s32 offen sc1
buffer_load_dwordx4 v[48:51],v168,s[8:11],s32 offen offset:2048 sc1
buffer_load_dwordx4 v[52:55],v168,s[8:11],s32 offen offset:256 sc1
buffer_load_dwordx4 v[56:59],v168,s[8:11],s32 offen offset:2304 sc1
s_waitcnt lgkmcnt(0)
s_branch mok_124
Bloop_122:
s_cmp_eq_u32 s26,63
s_cbranch_scc1 Bfin_126
s_mov_b32 s27,0
buffer_load_ushort v124,v115,s[8:11],0 offen sc1
s_nop 9
buffer_load_ushort v125,v115,s[8:11],0 offen sc1
s_nop 9
buffer_load_ushort v126,v115,s[8:11],0 offen sc1
s_nop 9
buffer_load_ushort v127,v115,s[8:11],0 offen sc1
fp_127:
s_waitcnt vmcnt(3)
v_cmp_gt_u32 vcc,s58,v124
buffer_load_ushort v124,v115,s[8:11],0 offen sc1
s_cbranch_vccz fpd_128
s_waitcnt vmcnt(3)
v_cmp_gt_u32 vcc,s58,v125
buffer_load_ushort v125,v115,s[8:11],0 offen sc1
s_cbranch_vccz fpd_128
s_waitcnt vmcnt(3)
v_cmp_gt_u32 vcc,s58,v126
buffer_load_ushort v126,v115,s[8:11],0 offen sc1
s_cbranch_vccz fpd_128
s_waitcnt vmcnt(3)
v_cmp_gt_u32 vcc,s58,v127
buffer_load_ushort v127,v115,s[8:11],0 offen sc1
s_cbranch_vccz fpd_128
s_waitcnt vmcnt(3)
v_cmp_gt_u32 vcc,s58,v124
buffer_load_ushort v124,v115,s[8:11],0 offen sc1
s_cbranch_vccz fpd_128
s_waitcnt vmcnt(3)
v_cmp_gt_u32 vcc,s58,v125
buffer_load_ushort v125,v115,s[8:11],0 offen sc1
s_cbranch_vccz fpd_128
s_waitcnt vmcnt(3)
v_cmp_gt_u32 vcc,s58,v126
buffer_load_ushort v126,v115,s[8:11],0 offen sc1
s_cbranch_vccz fpd_128
s_waitcnt vmcnt(3)
v_cmp_gt_u32 vcc,s58,v127
buffer_load_ushort v127,v115,s[8:11],0 offen sc1
s_cbranch_vccz fpd_128
s_waitcnt vmcnt(3)
v_cmp_gt_u32 vcc,s58,v124
buffer_load_ushort v124,v115,s[8:11],0 offen sc1
s_cbranch_vccz fpd_128
s_waitcnt vmcnt(3)
v_cmp_gt_u32 vcc,s58,v125
buffer_load_ushort v125,v115,s[8:11],0 offen sc1
s_cbranch_vccz fpd_128
s_waitcnt vmcnt(3)
v_cmp_gt_u32 vcc,s58,v126
buffer_load_ushort v126,v115,s[8:11],0 offen sc1
s_cbranch_vccz fpd_128
s_waitcnt vmcnt(3)
v_cmp_gt_u32 vcc,s58,v127
buffer_load_ushort v127,v115,s[8:11],0 offen sc1
s_cbranch_vccz fpd_128
s_add_u32 s27,s27,1
s_cmp_lt_u32 s27,131072
s_cbranch_scc1 fp_127
s_mov_b32 s38,2
s_branch L_end
fpd_128:
s_nop 2
s_mov_b32 m0,0
s_nop 0
buffer_load_dwordx4 v167,s[8:11],s28 offen sc1 lds
buffer_load_dwordx4 v167,s[8:11],s28 offen offset:1024 sc1 lds
buffer_load_dwordx4 v167,s[8:11],s28 offen offset:2048 sc1 lds
buffer_load_dwordx4 v167,s[8:11],s28 offen offset:3072 sc1 lds
s_mov_b32 m0,4096
s_nop 0
buffer_load_dwordx4 v165,s[8:11],s28 offen sc1 lds
buffer_load_dwordx4 v165,s[8:11],s28 offen offset:1024 sc1 lds
buffer_load_dwordx4 v165,s[8:11],s28 offen offset:2048 sc1 lds
s_barrier
buffer_load_dwordx4 v[44:47],v168,s[8:11],s32 offen sc1
buffer_load_dwordx4 v[48:51],v168,s[8:11],s32 offen offset:2048 sc1
buffer_load_dwordx4 v[52:55],v168,s[8:11],s32 offen offset:256 sc1
buffer_load_dwordx4 v[56:59],v168,s[8:11],s32 offen offset:2304 sc1
v_mov_b64 v[76:77],0
v_mov_b64 v[78:79],0
v_mov_b64 v[80:81],0
v_mov_b64 v[82:83],0
v_mov_b64 v[128:129],0
v_mov_b64 v[130:131],0
v_mov_b64 v[116:117],0
v_mov_b64 v[118:119],0
v_mov_b64 v[120:121],0
v_mov_b64 v[122:123],0
v_mov_b64 v[188:189],0
v_mov_b64 v[190:191],0
v_mov_b64 v[104:105],0
v_mov_b64 v[106:107],0
v_mov_b64 v[108:109],0
v_mov_b64 v[110:111],0
v_mov_b64 v[84:85],0
v_mov_b64 v[86:87],0
v_mov_b64 v[88:89],0
v_mov_b64 v[90:91],0
s_waitcnt vmcnt(4) lgkmcnt(0)
mok_124:
s_barrier
ds_read_b128 v[0:3],v167 offset:0
ds_read_b128 v[4:7],v167 offset:1024
ds_read_b128 v[8:11],v167 offset:2048
ds_read_b128 v[12:15],v167 offset:3072
ds_read_b128 v[16:19],v167 offset:4096
ds_read_b128 v[20:23],v167 offset:5120
ds_read_b128 v[24:27],v167 offset:6144
buffer_load_dwordx4 v[28:31],v168,s[8:11],s35 offen sc1
buffer_load_dwordx4 v[32:35],v168,s[8:11],s35 offen offset:2048 sc1
s_waitcnt lgkmcnt(6)
v_smfmac_f32_16x16x64_bf16 v[76:79],v[0:3],a[0:7],v164
buffer_load_dwordx4 v[36:39],v168,s[8:11],s35 offen offset:256 sc1
v_max3_u32 v176,v0,v1,v2
v_smfmac_f32_16x16x64_bf16 v[80:83],v[0:3],a[40:47],v164
s_waitcnt lgkmcnt(5)
v_max_u32 v176,v176,v3
v_smfmac_f32_16x16x64_bf16 v[76:79],v[4:7],a[8:15],v164
buffer_load_dwordx4 v[40:43],v168,s[8:11],s35 offen offset:2304 sc1
v_max3_u32 v176,v176,v4,v5
v_smfmac_f32_16x16x64_bf16 v[80:83],v[4:7],a[48:55],v164
s_waitcnt lgkmcnt(4)
v_max3_u32 v176,v176,v6,v7
v_smfmac_f32_16x16x64_bf16 v[76:79],v[8:11],a[16:23],v164
v_max3_u32 v176,v176,v8,v9
v_smfmac_f32_16x16x64_bf16 v[80:83],v[8:11],a[56:63],v164
s_waitcnt lgkmcnt(3)
v_max3_u32 v176,v176,v10,v11
v_smfmac_f32_16x16x64_bf16 v[76:79],v[12:15],a[24:31],v164
v_max3_u32 v176,v176,v12,v13
v_smfmac_f32_16x16x64_bf16 v[80:83],v[12:15],a[64:71],v164
s_waitcnt lgkmcnt(2)
v_max3_u32 v176,v176,v14,v15
v_smfmac_f32_16x16x64_bf16 v[76:79],v[16:19],a[32:39],v164
v_max3_u32 v176,v176,v16,v17
v_smfmac_f32_16x16x64_bf16 v[80:83],v[16:19],a[72:79],v164
s_waitcnt lgkmcnt(1)
v_max3_u32 v176,v176,v18,v19
v_smfmac_f32_16x16x64_bf16 v[76:79],v[20:23],v[132:139],v164
v_max3_u32 v176,v176,v20,v21
v_smfmac_f32_16x16x64_bf16 v[80:83],v[20:23],v[148:155],v164
s_waitcnt lgkmcnt(0)
v_max3_u32 v176,v176,v22,v23
v_smfmac_f32_16x16x64_bf16 v[76:79],v[24:27],v[140:147],v164
v_max3_u32 v176,v176,v24,v25
v_smfmac_f32_16x16x64_bf16 v[80:83],v[24:27],v[156:163],v164
ds_read_b128 v[132:135],v172 offset:8192
v_max3_u32 v176,v176,v26,v27
v_smfmac_f32_16x16x64_bf16 v[128:131],v[0:3],a[80:87],v164
ds_read_b128 v[136:139],v172 offset:9216
v_cmp_eq_u32 vcc,-1,v176
v_smfmac_f32_16x16x64_bf16 v[128:131],v[4:7],a[88:95],v164
ds_read_b128 v[140:143],v172 offset:10240
v_add_f32 v76,v76,v77
v_smfmac_f32_16x16x64_bf16 v[128:131],v[8:11],a[96:103],v164
ds_read_b128 v[144:147],v172 offset:11264
v_add_f32 v78,v78,v79
v_smfmac_f32_16x16x64_bf16 v[128:131],v[12:15],a[104:111],v164
s_cbranch_vccnz mpoll_123
ds_read_b128 v[148:151],v172 offset:12288
v_cvt_pk_bf16_f32 v60,v76,v78
v_smfmac_f32_16x16x64_bf16 v[128:131],v[16:19],a[112:119],v164
ds_read_b128 v[152:155],v172 offset:13312
s_waitcnt lgkmcnt(2)
v_add_f32 v80,v80,v81
v_smfmac_f32_16x16x64_bf16 v[128:131],v[20:23],v[132:139],v164
ds_read_b128 v[156:159],v172 offset:14336
v_add_f32 v82,v82,v83
v_smfmac_f32_16x16x64_bf16 v[128:131],v[24:27],v[140:147],v164
ds_read_b128 v[160:163],v172 offset:15360
v_cvt_pk_bf16_f32 v64,v80,v82
v_smfmac_f32_16x16x64_bf16 v[116:119],v[0:3],a[120:127],v164
ds_read_b128 v[132:135],v172 offset:16384
v_smfmac_f32_16x16x64_bf16 v[116:119],v[4:7],a[128:135],v164
ds_read_b128 v[136:139],v172 offset:17408
v_smfmac_f32_16x16x64_bf16 v[116:119],v[8:11],a[136:143],v164
ds_read_b128 v[140:143],v172 offset:18432
v_add_f32 v128,v128,v129
v_smfmac_f32_16x16x64_bf16 v[116:119],v[12:15],a[144:151],v164
ds_read_b128 v[144:147],v172 offset:19456
v_add_f32 v130,v130,v131
v_smfmac_f32_16x16x64_bf16 v[116:119],v[16:19],a[152:159],v164
s_waitcnt lgkmcnt(4)
v_cvt_pk_bf16_f32 v61,v128,v130
v_smfmac_f32_16x16x64_bf16 v[116:119],v[20:23],v[148:155],v164
v_smfmac_f32_16x16x64_bf16 v[116:119],v[24:27],v[156:163],v164
v_smfmac_f32_16x16x64_bf16 v[120:123],v[0:3],a[160:167],v164
s_add_u32 s35,s35,458752
ds_read_b128 v[148:151],v172 offset:20480
v_smfmac_f32_16x16x64_bf16 v[120:123],v[4:7],a[168:175],v164
s_add_u32 s32,s32,458752
ds_read_b128 v[152:155],v172 offset:21504
v_smfmac_f32_16x16x64_bf16 v[120:123],v[8:11],a[176:183],v164
s_xor_b32 s59,s59,1
ds_read_b128 v[156:159],v172 offset:22528
v_add_f32 v116,v116,v117
v_smfmac_f32_16x16x64_bf16 v[120:123],v[12:15],a[184:191],v164
s_add_u32 s29,s29,0x4000
ds_read_b128 v[160:163],v172 offset:23552
v_add_f32 v118,v118,v119
v_smfmac_f32_16x16x64_bf16 v[120:123],v[16:19],a[192:199],v164
s_and_b32 s29,s29,0xc800
s_waitcnt lgkmcnt(4)
v_cvt_pk_bf16_f32 v65,v116,v118
v_smfmac_f32_16x16x64_bf16 v[120:123],v[20:23],v[132:139],v164
s_add_u32 s29,s29,50397184
v_smfmac_f32_16x16x64_bf16 v[120:123],v[24:27],v[140:147],v164
s_add_u32 s33,s29,s37
v_smfmac_f32_16x16x64_bf16 v[188:191],v[0:3],a[200:207],v164
s_add_u32 s26,s26,1
ds_read_b128 v[132:135],v172 offset:24576
v_smfmac_f32_16x16x64_bf16 v[188:191],v[4:7],a[208:215],v164
s_add_u32 s34,s28,0x6000
ds_read_b128 v[136:139],v172 offset:25600
v_smfmac_f32_16x16x64_bf16 v[188:191],v[8:11],a[216:223],v164
s_and_b32 s34,s34,0x6800
ds_read_b128 v[140:143],v172 offset:26624
v_add_f32 v120,v120,v121
v_smfmac_f32_16x16x64_bf16 v[188:191],v[12:15],a[224:231],v164
s_add_u32 s34,s34,50331648
ds_read_b128 v[144:147],v172 offset:27648
v_add_f32 v122,v122,v123
v_smfmac_f32_16x16x64_bf16 v[188:191],v[16:19],a[232:239],v164
s_add_u32 s28,s28,0x2000
s_waitcnt lgkmcnt(4)
v_cvt_pk_bf16_f32 v62,v120,v122
v_smfmac_f32_16x16x64_bf16 v[188:191],v[20:23],v[148:155],v164
s_and_b32 s28,s28,0x6800
v_smfmac_f32_16x16x64_bf16 v[188:191],v[24:27],v[156:163],v164
s_add_u32 s28,s28,50331648
v_smfmac_f32_16x16x64_bf16 v[104:107],v[0:3],a[240:247],v164
s_xor_b32 s30,s61,1
ds_read_b128 v[148:151],v172 offset:28672
v_smfmac_f32_16x16x64_bf16 v[104:107],v[4:7],a[248:255],v164
s_add_u32 s58,s58,s30
ds_read_b128 v[152:155],v172 offset:29696
v_smfmac_f32_16x16x64_bf16 v[104:107],v[8:11],v[192:199],v164
ds_read_b128 v[156:159],v172 offset:30720
v_add_f32 v188,v188,v189
v_smfmac_f32_16x16x64_bf16 v[104:107],v[12:15],v[200:207],v164
ds_read_b128 v[160:163],v172 offset:31744
v_add_f32 v190,v190,v191
v_smfmac_f32_16x16x64_bf16 v[104:107],v[16:19],v[208:215],v164
s_waitcnt lgkmcnt(4)
v_cvt_pk_bf16_f32 v66,v188,v190
v_smfmac_f32_16x16x64_bf16 v[104:107],v[20:23],v[132:139],v164
v_add_u32 v166,v166,v174
v_smfmac_f32_16x16x64_bf16 v[104:107],v[24:27],v[140:147],v164
v_xor_b32 v170,0x40000000,v170
v_smfmac_f32_16x16x64_bf16 v[108:111],v[0:3],v[216:223],v164
ds_read_b128 v[132:135],v172 offset:0
v_smfmac_f32_16x16x64_bf16 v[108:111],v[4:7],v[224:231],v164
ds_read_b128 v[136:139],v172 offset:1024
v_smfmac_f32_16x16x64_bf16 v[108:111],v[8:11],v[232:239],v164
ds_read_b128 v[140:143],v172 offset:2048
v_add_f32 v104,v104,v105
v_smfmac_f32_16x16x64_bf16 v[108:111],v[12:15],v[240:247],v164
ds_read_b128 v[144:147],v172 offset:3072
v_add_f32 v106,v106,v107
v_smfmac_f32_16x16x64_bf16 v[108:111],v[16:19],v[248:255],v164
s_waitcnt lgkmcnt(4)
v_cvt_pk_bf16_f32 v63,v104,v106
v_smfmac_f32_16x16x64_bf16 v[108:111],v[20:23],v[148:155],v164
v_add_u32 v114,1,v114
v_smfmac_f32_16x16x64_bf16 v[108:111],v[24:27],v[156:163],v164
buffer_load_ushort v124,v113,s[8:11],0 offen sc1
ds_read_b128 v[148:151],v172 offset:4096
ds_read_b128 v[152:155],v172 offset:5120
ds_read_b128 v[156:159],v172 offset:6144
ds_read_b128 v[160:163],v172 offset:7168
s_nop 2
v_add_f32 v108,v108,v109
v_add_f32 v110,v110,v111
v_cvt_pk_bf16_f32 v67,v108,v110
buffer_load_ushort v125,v113,s[8:11],0 offen sc1
s_cmp_eq_u32 s24,1
s_cbranch_scc1 Btail_130
s_cmp_eq_u32 s24,2
s_cbranch_scc1 Btail_131
s_cmp_eq_u32 s24,3
s_cbranch_scc1 Btail_132
Btail_129:
s_mov_b32 s27,0
buffer_load_ushort v126,v113,s[8:11],0 offen sc1
s_nop 9
buffer_load_ushort v127,v113,s[8:11],0 offen sc1
s_nop 9
buffer_load_ushort v184,v113,s[8:11],0 offen sc1
fp_135:
s_waitcnt vmcnt(4)
v_cmp_gt_u32 vcc,v166,v124
buffer_load_ushort v124,v113,s[8:11],0 offen sc1
s_cbranch_vccz fpd_136
s_waitcnt vmcnt(4)
v_cmp_gt_u32 vcc,v166,v125
buffer_load_ushort v125,v113,s[8:11],0 offen sc1
s_cbranch_vccz fpd_136
s_waitcnt vmcnt(4)
v_cmp_gt_u32 vcc,v166,v126
buffer_load_ushort v126,v113,s[8:11],0 offen sc1
s_cbranch_vccz fpd_136
s_waitcnt vmcnt(4)
v_cmp_gt_u32 vcc,v166,v127
buffer_load_ushort v127,v113,s[8:11],0 offen sc1
s_cbranch_vccz fpd_136
s_waitcnt vmcnt(4)
v_cmp_gt_u32 vcc,v166,v184
buffer_load_ushort v184,v113,s[8:11],0 offen sc1
s_cbranch_vccz fpd_136
s_waitcnt vmcnt(4)
v_cmp_gt_u32 vcc,v166,v124
buffer_load_ushort v124,v113,s[8:11],0 offen sc1
s_cbranch_vccz fpd_136
s_waitcnt vmcnt(4)
v_cmp_gt_u32 vcc,v166,v125
buffer_load_ushort v125,v113,s[8:11],0 offen sc1
s_cbranch_vccz fpd_136
s_waitcnt vmcnt(4)
v_cmp_gt_u32 vcc,v166,v126
buffer_load_ushort v126,v113,s[8:11],0 offen sc1
s_cbranch_vccz fpd_136
s_waitcnt vmcnt(4)
v_cmp_gt_u32 vcc,v166,v127
buffer_load_ushort v127,v113,s[8:11],0 offen sc1
s_cbranch_vccz fpd_136
s_waitcnt vmcnt(4)
v_cmp_gt_u32 vcc,v166,v184
buffer_load_ushort v184,v113,s[8:11],0 offen sc1
s_cbranch_vccz fpd_136
s_waitcnt vmcnt(4)
v_cmp_gt_u32 vcc,v166,v124
buffer_load_ushort v124,v113,s[8:11],0 offen sc1
s_cbranch_vccz fpd_136
s_waitcnt vmcnt(4)
v_cmp_gt_u32 vcc,v166,v125
buffer_load_ushort v125,v113,s[8:11],0 offen sc1
s_cbranch_vccz fpd_136
s_waitcnt vmcnt(4)
v_cmp_gt_u32 vcc,v166,v126
buffer_load_ushort v126,v113,s[8:11],0 offen sc1
s_cbranch_vccz fpd_136
s_waitcnt vmcnt(4)
v_cmp_gt_u32 vcc,v166,v127
buffer_load_ushort v127,v113,s[8:11],0 offen sc1
s_cbranch_vccz fpd_136
s_waitcnt vmcnt(4)
v_cmp_gt_u32 vcc,v166,v184
buffer_load_ushort v184,v113,s[8:11],0 offen sc1
s_cbranch_vccz fpd_136
s_add_u32 s27,s27,1
s_cmp_lt_u32 s27,131072
s_cbranch_scc1 fp_135
s_mov_b32 s38,3
s_branch L_end
fpd_136:
buffer_load_dwordx4 v[92:95],v169,s[8:11],s29 offen sc1
s_nop 2
buffer_load_dwordx4 v[96:99],v169,s[8:11],s29 offen offset:1024 sc1
s_nop 2
buffer_load_dword v100,v68,s[8:11],s33 offen sc1
buffer_load_dword v101,v68,s[8:11],s33 offen offset:256 sc1
s_waitcnt vmcnt(3)
v_smfmac_f32_16x16x64_bf16 v[84:87],v[92:95],v[28:35],v164
v_or3_b32 v176,v92,v93,v94
v_smfmac_f32_16x16x64_bf16 v[88:91],v[92:95],v[36:43],v164
v_or_b32 v176,v176,v95
s_waitcnt vmcnt(2)
v_smfmac_f32_16x16x64_bf16 v[84:87],v[96:99],v[44:51],v164
v_or3_b32 v176,v176,v96,v97
v_smfmac_f32_16x16x64_bf16 v[88:91],v[96:99],v[52:59],v164
v_or3_b32 v176,v176,v98,v99
s_waitcnt vmcnt(0)
s_nop 0
v_smfmac_f32_16x16x32_bf16 v[84:87],v[100:101],v[60:63],v164
v_or3_b32 v176,v176,v100,v101
s_nop 0
v_smfmac_f32_16x16x32_bf16 v[88:91],v[100:101],v[64:67],v164
v_and_b32 v176,v69,v176
v_cmp_ne_u32 vcc,0,v176
Bgo_134:
s_nop 2
v_add_f32 v2,v86,v87
v_add_f32 v0,v84,v85
v_and_or_b32 v2,v2,-4,s59
s_cbranch_vccnz Bredo_133
v_add_f32 v3,v90,v91
ds_write_b64 v173,v[2:3] offset:8704
s_barrier
Brr_137:
ds_read_b64 v[4:5],v180 offset:9216
ds_read_b64 v[6:7],v180 offset:10240
ds_read_b64 v[8:9],v180 offset:11264
v_add_f32 v1,v88,v89
s_waitcnt lgkmcnt(2)
v_pk_add_f32 v[10:11],v[0:1],v[4:5]
s_waitcnt lgkmcnt(1)
v_pk_add_f32 v[10:11],v[10:11],v[6:7]
s_waitcnt lgkmcnt(0)
v_pk_add_f32 v[10:11],v[10:11],v[8:9]
v_add3_u32 v12,v4,v6,v8
v_lshl_add_u32 v12,v12,30,v170
v_cvt_pk_bf16_f32 v10,v10,v11
v_min_u32 v175,-2,v10
buffer_store_dword v175,v12,s[4:7],s28 offen
buffer_store_dword v181,v171,s[4:7],s34 offen
s_cmp_lg_u32 s61,0
s_cbranch_scc1 slow_138
slowr_139:
v_cmp_ne_u32 vcc,v12,v171
s_cbranch_vccnz Brr_137
s_branch Bh01_125
Btail_130:
s_mov_b32 s27,0
buffer_load_ushort v126,v113,s[8:11],0 offen sc1
s_nop 9
buffer_load_ushort v127,v113,s[8:11],0 offen sc1
s_nop 9
buffer_load_ushort v184,v113,s[8:11],0 offen sc1
fp_142:
s_waitcnt vmcnt(4)
v_cmp_gt_u32 vcc,v166,v124
buffer_load_ushort v124,v113,s[8:11],0 offen sc1
s_cbranch_vccz fpd_143
s_waitcnt vmcnt(4)
v_cmp_gt_u32 vcc,v166,v125
buffer_load_ushort v125,v113,s[8:11],0 offen sc1
s_cbranch_vccz fpd_143
s_waitcnt vmcnt(4)
v_cmp_gt_u32 vcc,v166,v126
buffer_load_ushort v126,v113,s[8:11],0 offen sc1
s_cbranch_vccz fpd_143
s_waitcnt vmcnt(4)
v_cmp_gt_u32 vcc,v166,v127
buffer_load_ushort v127,v113,s[8:11],0 offen sc1
s_cbranch_vccz fpd_143
s_waitcnt vmcnt(4)
v_cmp_gt_u32 vcc,v166,v184
buffer_load_ushort v184,v113,s[8:11],0 offen sc1
s_cbranch_vccz fpd_143
s_waitcnt vmcnt(4)
v_cmp_gt_u32 vcc,v166,v124
buffer_load_ushort v124,v113,s[8:11],0 offen sc1
s_cbranch_vccz fpd_143
s_waitcnt vmcnt(4)
v_cmp_gt_u32 vcc,v166,v125
buffer_load_ushort v125,v113,s[8:11],0 offen sc1
s_cbranch_vccz fpd_143
s_waitcnt vmcnt(4)
v_cmp_gt_u32 vcc,v166,v126
buffer_load_ushort v126,v113,s[8:11],0 offen sc1
s_cbranch_vccz fpd_143
s_waitcnt vmcnt(4)
v_cmp_gt_u32 vcc,v166,v127
buffer_load_ushort v127,v113,s[8:11],0 offen sc1
s_cbranch_vccz fpd_143
s_waitcnt vmcnt(4)
v_cmp_gt_u32 vcc,v166,v184
buffer_load_ushort v184,v113,s[8:11],0 offen sc1
s_cbranch_vccz fpd_143
s_waitcnt vmcnt(4)
v_cmp_gt_u32 vcc,v166,v124
buffer_load_ushort v124,v113,s[8:11],0 offen sc1
s_cbranch_vccz fpd_143
s_waitcnt vmcnt(4)
v_cmp_gt_u32 vcc,v166,v125
buffer_load_ushort v125,v113,s[8:11],0 offen sc1
s_cbranch_vccz fpd_143
s_waitcnt vmcnt(4)
v_cmp_gt_u32 vcc,v166,v126
buffer_load_ushort v126,v113,s[8:11],0 offen sc1
s_cbranch_vccz fpd_143
s_waitcnt vmcnt(4)
v_cmp_gt_u32 vcc,v166,v127
buffer_load_ushort v127,v113,s[8:11],0 offen sc1
s_cbranch_vccz fpd_143
s_waitcnt vmcnt(4)
v_cmp_gt_u32 vcc,v166,v184
buffer_load_ushort v184,v113,s[8:11],0 offen sc1
s_cbranch_vccz fpd_143
s_add_u32 s27,s27,1
s_cmp_lt_u32 s27,131072
s_cbranch_scc1 fp_142
s_mov_b32 s38,3
s_branch L_end
fpd_143:
buffer_load_dwordx4 v[92:95],v169,s[8:11],s29 offen sc1
s_nop 2
buffer_load_dwordx4 v[96:99],v169,s[8:11],s29 offen offset:1024 sc1
s_nop 2
buffer_load_dword v100,v68,s[8:11],s33 offen sc1
buffer_load_dword v101,v68,s[8:11],s33 offen offset:256 sc1
s_waitcnt vmcnt(3)
v_smfmac_f32_16x16x64_bf16 v[84:87],v[92:95],v[28:35],v164
v_or3_b32 v176,v92,v93,v94
v_smfmac_f32_16x16x64_bf16 v[88:91],v[92:95],v[36:43],v164
v_or_b32 v176,v176,v95
s_waitcnt vmcnt(2)
v_smfmac_f32_16x16x64_bf16 v[84:87],v[96:99],v[44:51],v164
v_or3_b32 v176,v176,v96,v97
v_smfmac_f32_16x16x64_bf16 v[88:91],v[96:99],v[52:59],v164
v_or3_b32 v176,v176,v98,v99
s_waitcnt vmcnt(0)
s_nop 0
v_smfmac_f32_16x16x32_bf16 v[84:87],v[100:101],v[60:63],v164
v_or3_b32 v176,v176,v100,v101
s_nop 0
v_smfmac_f32_16x16x32_bf16 v[88:91],v[100:101],v[64:67],v164
v_and_b32 v176,v69,v176
v_cmp_ne_u32 vcc,0,v176
Bgo_141:
s_nop 2
v_add_f32 v0,v84,v85
v_add_f32 v2,v86,v87
v_and_or_b32 v0,v0,-4,s59
s_cbranch_vccnz Bredo_140
v_add_f32 v1,v88,v89
ds_write_b64 v173,v[0:1] offset:8192
s_barrier
Brr_144:
ds_read_b64 v[4:5],v180 offset:8704
ds_read_b64 v[6:7],v180 offset:10752
ds_read_b64 v[8:9],v180 offset:11776
v_add_f32 v3,v90,v91
s_waitcnt lgkmcnt(2)
v_pk_add_f32 v[10:11],v[2:3],v[4:5]
s_waitcnt lgkmcnt(1)
v_pk_add_f32 v[10:11],v[10:11],v[6:7]
s_waitcnt lgkmcnt(0)
v_pk_add_f32 v[10:11],v[10:11],v[8:9]
v_add3_u32 v12,v4,v6,v8
v_lshl_add_u32 v12,v12,30,v170
v_cvt_pk_bf16_f32 v10,v10,v11
v_min_u32 v175,-2,v10
buffer_store_dword v175,v12,s[4:7],s28 offen
buffer_store_dword v181,v171,s[4:7],s34 offen
s_cmp_lg_u32 s61,0
s_cbranch_scc1 slow_145
slowr_146:
v_cmp_ne_u32 vcc,v12,v171
s_cbranch_vccnz Brr_144
s_branch Bh01_125
Btail_131:
s_mov_b32 s27,0
buffer_load_ushort v126,v113,s[8:11],0 offen sc1
s_nop 9
buffer_load_ushort v127,v113,s[8:11],0 offen sc1
s_nop 9
buffer_load_ushort v184,v113,s[8:11],0 offen sc1
fp_149:
s_waitcnt vmcnt(4)
v_cmp_gt_u32 vcc,v166,v124
buffer_load_ushort v124,v113,s[8:11],0 offen sc1
s_cbranch_vccz fpd_150
s_waitcnt vmcnt(4)
v_cmp_gt_u32 vcc,v166,v125
buffer_load_ushort v125,v113,s[8:11],0 offen sc1
s_cbranch_vccz fpd_150
s_waitcnt vmcnt(4)
v_cmp_gt_u32 vcc,v166,v126
buffer_load_ushort v126,v113,s[8:11],0 offen sc1
s_cbranch_vccz fpd_150
s_waitcnt vmcnt(4)
v_cmp_gt_u32 vcc,v166,v127
buffer_load_ushort v127,v113,s[8:11],0 offen sc1
s_cbranch_vccz fpd_150
s_waitcnt vmcnt(4)
v_cmp_gt_u32 vcc,v166,v184
buffer_load_ushort v184,v113,s[8:11],0 offen sc1
s_cbranch_vccz fpd_150
s_waitcnt vmcnt(4)
v_cmp_gt_u32 vcc,v166,v124
buffer_load_ushort v124,v113,s[8:11],0 offen sc1
s_cbranch_vccz fpd_150
s_waitcnt vmcnt(4)
v_cmp_gt_u32 vcc,v166,v125
buffer_load_ushort v125,v113,s[8:11],0 offen sc1
s_cbranch_vccz fpd_150
s_waitcnt vmcnt(4)
v_cmp_gt_u32 vcc,v166,v126
buffer_load_ushort v126,v113,s[8:11],0 offen sc1
s_cbranch_vccz fpd_150
s_waitcnt vmcnt(4)
v_cmp_gt_u32 vcc,v166,v127
buffer_load_ushort v127,v113,s[8:11],0 offen sc1
s_cbranch_vccz fpd_150
s_waitcnt vmcnt(4)
v_cmp_gt_u32 vcc,v166,v184
buffer_load_ushort v184,v113,s[8:11],0 offen sc1
s_cbranch_vccz fpd_150
s_waitcnt vmcnt(4)
v_cmp_gt_u32 vcc,v166,v124
buffer_load_ushort v124,v113,s[8:11],0 offen sc1
s_cbranch_vccz fpd_150
s_waitcnt vmcnt(4)
v_cmp_gt_u32 vcc,v166,v125
buffer_load_ushort v125,v113,s[8:11],0 offen sc1
s_cbranch_vccz fpd_150
s_waitcnt vmcnt(4)
v_cmp_gt_u32 vcc,v166,v126
buffer_load_ushort v126,v113,s[8:11],0 offen sc1
s_cbranch_vccz fpd_150
s_waitcnt vmcnt(4)
v_cmp_gt_u32 vcc,v166,v127
buffer_load_ushort v127,v113,s[8:11],0 offen sc1
s_cbranch_vccz fpd_150
s_waitcnt vmcnt(4)
v_cmp_gt_u32 vcc,v166,v184
buffer_load_ushort v184,v113,s[8:11],0 offen sc1
s_cbranch_vccz fpd_150
s_add_u32 s27,s27,1
s_cmp_lt_u32 s27,131072
s_cbranch_scc1 fp_149
s_mov_b32 s38,3
s_branch L_end
fpd_150:
buffer_load_dwordx4 v[92:95],v169,s[8:11],s29 offen sc1
s_nop 2
buffer_load_dwordx4 v[96:99],v169,s[8:11],s29 offen offset:1024 sc1
s_nop 2
buffer_load_dword v100,v68,s[8:11],s33 offen sc1
buffer_load_dword v101,v68,s[8:11],s33 offen offset:256 sc1
s_waitcnt vmcnt(3)
v_smfmac_f32_16x16x64_bf16 v[84:87],v[92:95],v[28:35],v164
v_or3_b32 v176,v92,v93,v94
v_smfmac_f32_16x16x64_bf16 v[88:91],v[92:95],v[36:43],v164
v_or_b32 v176,v176,v95
s_waitcnt vmcnt(2)
v_smfmac_f32_16x16x64_bf16 v[84:87],v[96:99],v[44:51],v164
v_or3_b32 v176,v176,v96,v97
v_smfmac_f32_16x16x64_bf16 v[88:91],v[96:99],v[52:59],v164
v_or3_b32 v176,v176,v98,v99
s_waitcnt vmcnt(0)
s_nop 0
v_smfmac_f32_16x16x32_bf16 v[84:87],v[100:101],v[60:63],v164
v_or3_b32 v176,v176,v100,v101
s_nop 0
v_smfmac_f32_16x16x32_bf16 v[88:91],v[100:101],v[64:67],v164
v_and_b32 v176,v69,v176
v_cmp_ne_u32 vcc,0,v176
Bgo_148:
s_nop 2
v_add_f32 v0,v84,v85
v_add_f32 v2,v86,v87
v_and_or_b32 v0,v0,-4,s59
v_and_or_b32 v2,v2,-4,s59
s_cbranch_vccnz Bredo_147
v_add_f32 v1,v88,v89
v_add_f32 v3,v90,v91
ds_write_b64 v173,v[0:1] offset:8192
ds_write_b64 v173,v[2:3] offset:8704
s_barrier
s_branch Bh01_125
Btail_132:
s_mov_b32 s27,0
buffer_load_ushort v126,v113,s[8:11],0 offen sc1
s_nop 9
buffer_load_ushort v127,v113,s[8:11],0 offen sc1
s_nop 9
buffer_load_ushort v184,v113,s[8:11],0 offen sc1
fp_153:
s_waitcnt vmcnt(4)
v_cmp_gt_u32 vcc,v166,v124
buffer_load_ushort v124,v113,s[8:11],0 offen sc1
s_cbranch_vccz fpd_154
s_waitcnt vmcnt(4)
v_cmp_gt_u32 vcc,v166,v125
buffer_load_ushort v125,v113,s[8:11],0 offen sc1
s_cbranch_vccz fpd_154
s_waitcnt vmcnt(4)
v_cmp_gt_u32 vcc,v166,v126
buffer_load_ushort v126,v113,s[8:11],0 offen sc1
s_cbranch_vccz fpd_154
s_waitcnt vmcnt(4)
v_cmp_gt_u32 vcc,v166,v127
buffer_load_ushort v127,v113,s[8:11],0 offen sc1
s_cbranch_vccz fpd_154
s_waitcnt vmcnt(4)
v_cmp_gt_u32 vcc,v166,v184
buffer_load_ushort v184,v113,s[8:11],0 offen sc1
s_cbranch_vccz fpd_154
s_waitcnt vmcnt(4)
v_cmp_gt_u32 vcc,v166,v124
buffer_load_ushort v124,v113,s[8:11],0 offen sc1
s_cbranch_vccz fpd_154
s_waitcnt vmcnt(4)
v_cmp_gt_u32 vcc,v166,v125
buffer_load_ushort v125,v113,s[8:11],0 offen sc1
s_cbranch_vccz fpd_154
s_waitcnt vmcnt(4)
v_cmp_gt_u32 vcc,v166,v126
buffer_load_ushort v126,v113,s[8:11],0 offen sc1
s_cbranch_vccz fpd_154
s_waitcnt vmcnt(4)
v_cmp_gt_u32 vcc,v166,v127
buffer_load_ushort v127,v113,s[8:11],0 offen sc1
s_cbranch_vccz fpd_154
s_waitcnt vmcnt(4)
v_cmp_gt_u32 vcc,v166,v184
buffer_load_ushort v184,v113,s[8:11],0 offen sc1
s_cbranch_vccz fpd_154
s_waitcnt vmcnt(4)
v_cmp_gt_u32 vcc,v166,v124
buffer_load_ushort v124,v113,s[8:11],0 offen sc1
s_cbranch_vccz fpd_154
s_waitcnt vmcnt(4)
v_cmp_gt_u32 vcc,v166,v125
buffer_load_ushort v125,v113,s[8:11],0 offen sc1
s_cbranch_vccz fpd_154
s_waitcnt vmcnt(4)
v_cmp_gt_u32 vcc,v166,v126
buffer_load_ushort v126,v113,s[8:11],0 offen sc1
s_cbranch_vccz fpd_154
s_waitcnt vmcnt(4)
v_cmp_gt_u32 vcc,v166,v127
buffer_load_ushort v127,v113,s[8:11],0 offen sc1
s_cbranch_vccz fpd_154
s_waitcnt vmcnt(4)
v_cmp_gt_u32 vcc,v166,v184
buffer_load_ushort v184,v113,s[8:11],0 offen sc1
s_cbranch_vccz fpd_154
s_add_u32 s27,s27,1
s_cmp_lt_u32 s27,131072
s_cbranch_scc1 fp_153
s_mov_b32 s38,3
s_branch L_end
fpd_154:
buffer_load_dwordx4 v[92:95],v169,s[8:11],s29 offen sc1
s_nop 2
buffer_load_dwordx4 v[96:99],v169,s[8:11],s29 offen offset:1024 sc1
s_nop 2
buffer_load_dword v100,v68,s[8:11],s33 offen sc1
buffer_load_dword v101,v68,s[8:11],s33 offen offset:256 sc1
s_waitcnt vmcnt(3)
v_smfmac_f32_16x16x64_bf16 v[84:87],v[92:95],v[28:35],v164
v_or3_b32 v176,v92,v93,v94
v_smfmac_f32_16x16x64_bf16 v[88:91],v[92:95],v[36:43],v164
v_or_b32 v176,v176,v95
s_waitcnt vmcnt(2)
v_smfmac_f32_16x16x64_bf16 v[84:87],v[96:99],v[44:51],v164
v_or3_b32 v176,v176,v96,v97
v_smfmac_f32_16x16x64_bf16 v[88:91],v[96:99],v[52:59],v164
v_or3_b32 v176,v176,v98,v99
s_waitcnt vmcnt(0)
s_nop 0
v_smfmac_f32_16x16x32_bf16 v[84:87],v[100:101],v[60:63],v164
v_or3_b32 v176,v176,v100,v101
s_nop 0
v_smfmac_f32_16x16x32_bf16 v[88:91],v[100:101],v[64:67],v164
v_and_b32 v176,v69,v176
v_cmp_ne_u32 vcc,0,v176
Bgo_152:
s_nop 2
v_add_f32 v0,v84,v85
v_add_f32 v2,v86,v87
v_and_or_b32 v0,v0,-4,s59
v_and_or_b32 v2,v2,-4,s59
s_cbranch_vccnz Bredo_151
v_add_f32 v1,v88,v89
v_add_f32 v3,v90,v91
ds_write_b64 v173,v[0:1] offset:8192
ds_write_b64 v173,v[2:3] offset:8704
s_barrier
buffer_store_short v114,v112,s[8:11],0 offen
s_branch Bloop_122
Bfin_126:
s_cmp_lg_u32 s99,0
s_cbranch_scc1 Bback_98
s_cmp_ge_u32 s24,2
s_cbranch_scc1 L_end
s_mov_b32 s30,51896320
buffer_store_dword v175,v171,s[8:11],s30 offen sc1
s_branch L_end
slow_110:
buffer_store_dword v175,v171,s[8:11],s30 offen sc1
buffer_store_dword v5,v171,s[8:11],s31 offen sc1
buffer_store_dword v5,v171,s[8:11],s56 offen sc1
buffer_store_dword v5,v171,s[8:11],s57 offen sc1
s_branch slowr_111
slow_117:
buffer_store_dword v8,v9,s[8:11],s30 offen sc1
s_branch slowr_118
mpoll_123:
s_waitcnt lgkmcnt(0)
s_barrier
s_cmp_lg_u32 s24,3
s_cbranch_scc1 mpoll_123_w
s_mov_b32 m0,0
s_nop 0
buffer_load_dwordx4 v167,s[8:11],s28 offen sc1 lds
buffer_load_dwordx4 v167,s[8:11],s28 offen offset:1024 sc1 lds
buffer_load_dwordx4 v167,s[8:11],s28 offen offset:2048 sc1 lds
buffer_load_dwordx4 v167,s[8:11],s28 offen offset:3072 sc1 lds
s_mov_b32 m0,4096
s_nop 0
buffer_load_dwordx4 v165,s[8:11],s28 offen sc1 lds
buffer_load_dwordx4 v165,s[8:11],s28 offen offset:1024 sc1 lds
buffer_load_dwordx4 v165,s[8:11],s28 offen offset:2048 sc1 lds
s_waitcnt vmcnt(0)
mpoll_123_w:
s_barrier
ds_read_b128 v[0:3],v167 offset:0
ds_read_b128 v[4:7],v167 offset:1024
ds_read_b128 v[8:11],v167 offset:2048
ds_read_b128 v[12:15],v167 offset:3072
ds_read_b128 v[16:19],v167 offset:4096
ds_read_b128 v[20:23],v167 offset:5120
ds_read_b128 v[24:27],v167 offset:6144
s_waitcnt lgkmcnt(0)
v_max3_u32 v176,v0,v1,v2
v_max_u32 v176,v176,v3
v_max3_u32 v176,v176,v4,v5
v_max3_u32 v176,v176,v6,v7
v_max3_u32 v176,v176,v8,v9
v_max3_u32 v176,v176,v10,v11
v_max3_u32 v176,v176,v12,v13
v_max3_u32 v176,v176,v14,v15
v_max3_u32 v176,v176,v16,v17
v_max3_u32 v176,v176,v18,v19
v_max3_u32 v176,v176,v20,v21
v_max3_u32 v176,v176,v22,v23
v_max3_u32 v176,v176,v24,v25
v_max3_u32 v176,v176,v26,v27
v_cmp_eq_u32 vcc,-1,v176
s_cbranch_vccz mpoll_123_ok
s_add_u32 s27,s27,1
s_cmp_lt_u32 s27,131072
s_cbranch_scc1 mpoll_123
s_mov_b32 s38,2
s_branch L_end
mpoll_123_ok:
ds_read_b128 v[132:135],v172 offset:0
ds_read_b128 v[136:139],v172 offset:1024
ds_read_b128 v[140:143],v172 offset:2048
ds_read_b128 v[144:147],v172 offset:3072
ds_read_b128 v[148:151],v172 offset:4096
ds_read_b128 v[152:155],v172 offset:5120
ds_read_b128 v[156:159],v172 offset:6144
ds_read_b128 v[160:163],v172 offset:7168
v_mov_b64 v[76:77],0
v_mov_b64 v[78:79],0
v_mov_b64 v[80:81],0
v_mov_b64 v[82:83],0
v_mov_b64 v[128:129],0
v_mov_b64 v[130:131],0
s_waitcnt lgkmcnt(0)
s_branch mok_124
Bredo_133:
buffer_load_dwordx4 v[92:95],v169,s[8:11],s29 offen sc1
buffer_load_dwordx4 v[96:99],v169,s[8:11],s29 offen offset:1024 sc1
buffer_load_dword v100,v68,s[8:11],s33 offen sc1
buffer_load_dword v101,v68,s[8:11],s33 offen offset:256 sc1
v_mov_b64 v[84:85],0
v_mov_b64 v[86:87],0
v_mov_b64 v[88:89],0
v_mov_b64 v[90:91],0
s_waitcnt vmcnt(0)
v_or3_b32 v176,v92,v93,v94
v_or_b32 v176,v176,v95
v_or3_b32 v176,v176,v96,v97
v_or3_b32 v176,v176,v98,v99
v_or3_b32 v176,v176,v100,v101
v_and_b32 v176,v69,v176
v_cmp_ne_u32 vcc,0,v176
s_cbranch_vccz Bredo_133_ok
s_add_u32 s27,s27,1
s_cmp_lt_u32 s27,131072
s_cbranch_scc1 Bredo_133
s_mov_b32 s38,3
s_branch L_end
Bredo_133_ok:
v_smfmac_f32_16x16x64_bf16 v[84:87],v[92:95],v[28:35],v164
v_smfmac_f32_16x16x64_bf16 v[88:91],v[92:95],v[36:43],v164
v_smfmac_f32_16x16x64_bf16 v[84:87],v[96:99],v[44:51],v164
v_smfmac_f32_16x16x64_bf16 v[88:91],v[96:99],v[52:59],v164
s_nop 2
v_smfmac_f32_16x16x32_bf16 v[84:87],v[100:101],v[60:63],v164
s_nop 1
v_smfmac_f32_16x16x32_bf16 v[88:91],v[100:101],v[64:67],v164
s_nop 7
s_branch Bgo_134
slow_138:
buffer_store_dword v175,v12,s[8:11],s28 offen sc1
buffer_store_dword v181,v171,s[8:11],s34 offen sc1
s_branch slowr_139
Bredo_140:
buffer_load_dwordx4 v[92:95],v169,s[8:11],s29 offen sc1
buffer_load_dwordx4 v[96:99],v169,s[8:11],s29 offen offset:1024 sc1
buffer_load_dword v100,v68,s[8:11],s33 offen sc1
buffer_load_dword v101,v68,s[8:11],s33 offen offset:256 sc1
v_mov_b64 v[84:85],0
v_mov_b64 v[86:87],0
v_mov_b64 v[88:89],0
v_mov_b64 v[90:91],0
s_waitcnt vmcnt(0)
v_or3_b32 v176,v92,v93,v94
v_or_b32 v176,v176,v95
v_or3_b32 v176,v176,v96,v97
v_or3_b32 v176,v176,v98,v99
v_or3_b32 v176,v176,v100,v101
v_and_b32 v176,v69,v176
v_cmp_ne_u32 vcc,0,v176
s_cbranch_vccz Bredo_140_ok
s_add_u32 s27,s27,1
s_cmp_lt_u32 s27,131072
s_cbranch_scc1 Bredo_140
s_mov_b32 s38,3
s_branch L_end
Bredo_140_ok:
v_smfmac_f32_16x16x64_bf16 v[84:87],v[92:95],v[28:35],v164
v_smfmac_f32_16x16x64_bf16 v[88:91],v[92:95],v[36:43],v164
v_smfmac_f32_16x16x64_bf16 v[84:87],v[96:99],v[44:51],v164
v_smfmac_f32_16x16x64_bf16 v[88:91],v[96:99],v[52:59],v164
s_nop 2
v_smfmac_f32_16x16x32_bf16 v[84:87],v[100:101],v[60:63],v164
s_nop 1
v_smfmac_f32_16x16x32_bf16 v[88:91],v[100:101],v[64:67],v164
s_nop 7
s_branch Bgo_141
slow_145:
buffer_store_dword v175,v12,s[8:11],s28 offen sc1
buffer_store_dword v181,v171,s[8:11],s34 offen sc1
s_branch slowr_146
Bredo_147:
buffer_load_dwordx4 v[92:95],v169,s[8:11],s29 offen sc1
buffer_load_dwordx4 v[96:99],v169,s[8:11],s29 offen offset:1024 sc1
buffer_load_dword v100,v68,s[8:11],s33 offen sc1
buffer_load_dword v101,v68,s[8:11],s33 offen offset:256 sc1
v_mov_b64 v[84:85],0
v_mov_b64 v[86:87],0
v_mov_b64 v[88:89],0
v_mov_b64 v[90:91],0
s_waitcnt vmcnt(0)
v_or3_b32 v176,v92,v93,v94
v_or_b32 v176,v176,v95
v_or3_b32 v176,v176,v96,v97
v_or3_b32 v176,v176,v98,v99
v_or3_b32 v176,v176,v100,v101
v_and_b32 v176,v69,v176
v_cmp_ne_u32 vcc,0,v176
s_cbranch_vccz Bredo_147_ok
s_add_u32 s27,s27,1
s_cmp_lt_u32 s27,131072
s_cbranch_scc1 Bredo_147
s_mov_b32 s38,3
s_branch L_end
Bredo_147_ok:
v_smfmac_f32_16x16x64_bf16 v[84:87],v[92:95],v[28:35],v164
v_smfmac_f32_16x16x64_bf16 v[88:91],v[92:95],v[36:43],v164
v_smfmac_f32_16x16x64_bf16 v[84:87],v[96:99],v[44:51],v164
v_smfmac_f32_16x16x64_bf16 v[88:91],v[96:99],v[52:59],v164
s_nop 2
v_smfmac_f32_16x16x32_bf16 v[84:87],v[100:101],v[60:63],v164
s_nop 1
v_smfmac_f32_16x16x32_bf16 v[88:91],v[100:101],v[64:67],v164
s_nop 7
s_branch Bgo_148
Bredo_151:
buffer_load_dwordx4 v[92:95],v169,s[8:11],s29 offen sc1
buffer_load_dwordx4 v[96:99],v169,s[8:11],s29 offen offset:1024 sc1
buffer_load_dword v100,v68,s[8:11],s33 offen sc1
buffer_load_dword v101,v68,s[8:11],s33 offen offset:256 sc1
v_mov_b64 v[84:85],0
v_mov_b64 v[86:87],0
v_mov_b64 v[88:89],0
v_mov_b64 v[90:91],0
s_waitcnt vmcnt(0)
v_or3_b32 v176,v92,v93,v94
v_or_b32 v176,v176,v95
v_or3_b32 v176,v176,v96,v97
v_or3_b32 v176,v176,v98,v99
v_or3_b32 v176,v176,v100,v101
v_and_b32 v176,v69,v176
v_cmp_ne_u32 vcc,0,v176
s_cbranch_vccz Bredo_151_ok
s_add_u32 s27,s27,1
s_cmp_lt_u32 s27,131072
s_cbranch_scc1 Bredo_151
s_mov_b32 s38,3
s_branch L_end
Bredo_151_ok:
v_smfmac_f32_16x16x64_bf16 v[84:87],v[92:95],v[28:35],v164
v_smfmac_f32_16x16x64_bf16 v[88:91],v[92:95],v[36:43],v164
v_smfmac_f32_16x16x64_bf16 v[84:87],v[96:99],v[44:51],v164
v_smfmac_f32_16x16x64_bf16 v[88:91],v[96:99],v[52:59],v164
s_nop 2
v_smfmac_f32_16x16x32_bf16 v[84:87],v[100:101],v[60:63],v164
s_nop 1
v_smfmac_f32_16x16x32_bf16 v[88:91],v[100:101],v[64:67],v164
s_nop 7
s_branch Bgo_152
L_roleR:
s_cmp_ge_u32 s24,2
s_cbranch_scc1 L_end
v_lshlrev_b32 v209,5,v198
v_mov_b32 v210,0x7f000000
v_cmp_gt_u32 vcc,32,v198
v_lshlrev_b32 v211,2,v209
s_nop 0
v_cndmask_b32 v211,v210,v211,vcc
s_cmp_eq_u32 s24,0
s_cbranch_scc1 rly_159
s_mov_b32 s31,50599968
s_mov_b64 exec,0xffff
s_mov_b32 s27,0
wf_160:
buffer_load_dword v248,v209,s[8:11],s31 offen sc1
s_waitcnt vmcnt(0)
v_cmp_gt_u32 vcc,1,v248
s_cbranch_vccz wfd_161
s_sleep 4
s_add_u32 s27,s27,1
s_cmp_lt_u32 s27,32768
s_cbranch_scc1 wf_160
s_mov_b32 s38,9
wfd_161:
s_mov_b64 exec,-1
s_mov_b32 s31,50597888
s_mov_b32 s56,50622530
s_mov_b32 s26,4
fwd_158:
s_mov_b32 exec_hi,0
s_mov_b32 s27,0
wf_162:
buffer_load_dword v248,v198,s[8:11],s31 offen sc1
s_waitcnt vmcnt(0)
v_cmp_gt_u32 vcc,0x01010101,v248
s_cbranch_vccz wfd_163
s_sleep 2
s_add_u32 s27,s27,1
s_cmp_lt_u32 s27,32768
s_cbranch_scc1 wf_162
s_mov_b32 s38,9
wfd_163:
s_mov_b64 exec,-1
s_cmp_lg_u32 s38,0
s_cbranch_scc1 L_end
v_mov_b32 v213,s26
s_cmp_lg_u32 s61,0
s_cbranch_scc1 slow_164
buffer_store_short v213,v211,s[8:11],s56 offen
slowr_165:
s_add_u32 s31,s31,128
s_add_u32 s26,s26,4
s_cmp_lg_u32 s38,0
s_cbranch_scc1 L_end
s_cmp_le_u32 s26,64
s_cbranch_scc1 fwd_158
s_branch L_end
rly_159:
v_mbcnt_lo_u32_b32 v217,-1,0
v_min_u32 v217,29,v217
v_lshlrev_b32 v217,2,v217
s_mov_b32 s27,0
s_mov_b32 s30,50620544
tw_166:
buffer_load_dword v216,v217,s[8:11],s30 offen sc1
s_waitcnt vmcnt(0)
v_cmp_eq_u32 vcc,0,v216
s_cbranch_vccz tw_166_d
s_sleep 2
s_add_u32 s27,s27,1
s_cmp_lt_u32 s27,131072
s_cbranch_scc1 tw_166
s_mov_b32 s38,6
s_branch L_end
tw_166_d:
s_mov_b32 s26,0
s_mov_b32 s37,51380224
s_mov_b32 s56,50622528
s_mov_b32 s57,50610176
relay_155:
s_and_b32 s30,s26,3
s_lshl_b32 s30,s30,13
s_add_u32 s30,s30,50331648
s_add_u32 s30,s30,s97
s_add_u32 s31,s30,4096
s_add_u32 s26,s26,1
v_mov_b32 v212,s26
s_mov_b32 s27,0
relayp_156:
buffer_load_dwordx4 v[0:3],v192,s[8:11],s30 offen sc1
buffer_load_dwordx4 v[4:7],v192,s[8:11],s30 offen offset:1024 sc1
buffer_load_dwordx4 v[8:11],v192,s[8:11],s30 offen offset:2048 sc1
buffer_load_dwordx4 v[12:15],v192,s[8:11],s30 offen offset:3072 sc1
buffer_load_dwordx4 v[16:19],v192,s[8:11],s31 offen sc1
buffer_load_dwordx4 v[20:23],v192,s[8:11],s31 offen offset:1024 sc1
buffer_load_dwordx4 v[24:27],v192,s[8:11],s31 offen offset:2048 sc1
s_waitcnt vmcnt(0)
v_max3_u32 v213,v0,v1,v2
v_max3_u32 v214,v3,v4,v5
v_max3_u32 v213,v213,v6,v7
v_max3_u32 v214,v214,v8,v9
v_max3_u32 v213,v213,v10,v11
v_max3_u32 v214,v214,v12,v13
v_max3_u32 v213,v213,v14,v15
v_max3_u32 v214,v214,v16,v17
v_max3_u32 v213,v213,v18,v19
v_max3_u32 v214,v214,v20,v21
v_max3_u32 v213,v213,v22,v23
v_max3_u32 v214,v214,v24,v25
v_max3_u32 v213,v213,v26,v27
v_max_u32 v213,v213,v214
v_cmp_eq_u32 vcc,-1,v213
s_cbranch_vccz relayok_157
s_add_u32 s27,s27,1
s_cmp_lt_u32 s27,131072
s_cbranch_scc1 relayp_156
s_mov_b32 s38,5
s_branch L_end
relayok_157:
s_add_u32 s31,s37,4096
buffer_store_dwordx4 v[0:3],v192,s[8:11],s37 offen sc1
buffer_store_dwordx4 v[4:7],v192,s[8:11],s37 offen offset:1024 sc1
buffer_store_dwordx4 v[8:11],v192,s[8:11],s37 offen offset:2048 sc1
buffer_store_dwordx4 v[12:15],v192,s[8:11],s37 offen offset:3072 sc1
buffer_store_dwordx4 v[16:19],v192,s[8:11],s31 offen sc1
buffer_store_dwordx4 v[20:23],v192,s[8:11],s31 offen offset:1024 sc1
buffer_store_dwordx4 v[24:27],v192,s[8:11],s31 offen offset:2048 sc1
s_cmp_lg_u32 s61,0
s_cbranch_scc1 slow_167
buffer_store_short v212,v211,s[8:11],s56 offen
slowr_168:
s_add_u32 s37,s37,8192
s_waitcnt vmcnt(1)
s_cmp_lg_u32 s61,0
s_cbranch_scc1 slow_169
buffer_store_dword v212,v199,s[8:11],s57 offen
slowr_170:
s_cmp_lt_u32 s26,63
s_cbranch_scc1 relay_155
s_branch L_end
slow_164:
buffer_store_short v213,v211,s[8:11],s56 offen sc1
s_branch slowr_165
slow_167:
buffer_store_short v212,v211,s[8:11],s56 offen sc1
s_branch slowr_168
slow_169:
buffer_store_dword v212,v199,s[8:11],s57 offen sc1
s_branch slowr_170
L_roleW:
v_lshlrev_b32 v209,5,v198
s_cmp_ge_u32 s24,2
s_cbranch_scc1 wm_174
s_cmp_eq_u32 s24,1
s_cbranch_scc1 kw_175
s_mov_b32 s26,1
s_mov_b32 s31,50610176
s_mov_b32 s56,50610432
ann_173:
s_mov_b64 exec,0xffff
s_mov_b32 s27,0
wf_176:
buffer_load_dword v248,v199,s[8:11],s31 offen sc1
s_waitcnt vmcnt(0)
v_cmp_gt_u32 vcc,s26,v248
s_cbranch_vccz wfd_177
s_sleep 1
s_add_u32 s27,s27,1
s_cmp_lt_u32 s27,32768
s_cbranch_scc1 wf_176
s_mov_b32 s38,9
wfd_177:
s_mov_b64 exec,-1
s_cmp_lg_u32 s38,0
s_cbranch_scc1 L_end
v_readfirstlane_b32 s26,v248
s_mov_b64 exec,0xffff
buffer_store_dword v248,v209,s[8:11],s56 offen sc1
s_mov_b64 exec,-1
s_add_u32 s26,s26,1
s_cmp_le_u32 s26,62
s_cbranch_scc1 ann_173
s_branch L_end
wm_174:
s_mov_b32 s30,50620544
s_mov_b64 exec,0x1
s_mov_b32 s27,0
wf_178:
buffer_load_dword v248,v199,s[8:11],s30 offen sc1
s_waitcnt vmcnt(0)
v_cmp_gt_u32 vcc,1,v248
s_cbranch_vccz wfd_179
s_sleep 4
s_add_u32 s27,s27,1
s_cmp_lt_u32 s27,32768
s_cbranch_scc1 wf_178
s_mov_b32 s38,9
wfd_179:
s_mov_b64 exec,-1
s_lshl_b32 s31,s24,14
s_add_u32 s31,s31,63930368
s_mov_b32 s30,50622528
s_mov_b32 s26,0
s_mov_b32 s27,0
warm_171:
s_lshr_b32 s57,s26,2
s_lshl_b32 s57,s57,7
s_add_u32 s57,s57,50599968
buffer_load_ushort v208,v199,s[8:11],s30 offen sc1
buffer_load_dword v211,v199,s[8:11],s57 offen sc1
s_waitcnt vmcnt(0)
v_readfirstlane_b32 s56,v208
v_readfirstlane_b32 s57,v211
s_cmp_eq_u32 s57,0
s_cbranch_scc1 warmn_172
s_add_u32 s56,s56,3
s_cmp_gt_u32 s26,s56
s_cbranch_scc1 warmn_172
buffer_load_dword v210,v209,s[8:11],s31 offen sc1
s_add_u32 s31,s31,8192
buffer_load_dword v210,v209,s[8:11],s31 offen sc1
s_add_u32 s31,s31,24576
s_add_u32 s26,s26,1
s_mov_b32 s27,0
s_cmp_lt_u32 s26,63
s_cbranch_scc1 warm_171
s_branch L_end
warmn_172:
s_sleep 8
s_add_u32 s27,s27,1
s_cmp_lt_u32 s27,32768
s_cbranch_scc1 warm_171
s_branch L_end
kw_175:
s_mov_b32 s27,0
s_mov_b32 s56,50622528
kw_175_l:
s_add_u32 s30,s97,50331648
buffer_load_dword v210,v209,s[8:11],s30 offen sc1
s_add_u32 s30,s97,50339840
buffer_load_dword v210,v209,s[8:11],s30 offen sc1
s_add_u32 s30,s97,50348032
buffer_load_dword v210,v209,s[8:11],s30 offen sc1
s_add_u32 s30,s97,50356224
buffer_load_dword v210,v209,s[8:11],s30 offen sc1
s_add_u32 s30,s97,50397184
buffer_load_dword v210,v209,s[8:11],s30 offen sc1
s_add_u32 s30,s97,50405376
buffer_load_dword v210,v209,s[8:11],s30 offen sc1
s_add_u32 s30,s97,50413568
buffer_load_dword v210,v209,s[8:11],s30 offen sc1
s_add_u32 s30,s97,50421760
buffer_load_dword v210,v209,s[8:11],s30 offen sc1
s_add_u32 s30,s97,50429952
buffer_load_dword v210,v209,s[8:11],s30 offen sc1
s_add_u32 s30,s97,50438144
buffer_load_dword v210,v209,s[8:11],s30 offen sc1
s_add_u32 s30,s97,50446336
buffer_load_dword v210,v209,s[8:11],s30 offen sc1
s_add_u32 s30,s97,50454528
buffer_load_dword v210,v209,s[8:11],s30 offen sc1
buffer_load_ushort v208,v199,s[8:11],s56 offen sc1
s_waitcnt vmcnt(0)
v_readfirstlane_b32 s31,v208
s_cmp_ge_u32 s31,2
s_cbranch_scc1 L_end
s_sleep 16
s_add_u32 s27,s27,1
s_cmp_lt_u32 s27,8192
s_cbranch_scc1 kw_175_l
s_branch L_end
L_roleF:
v_mbcnt_lo_u32_b32 v0,-1,0
v_mbcnt_hi_u32_b32 v0,-1,v0
v_lshrrev_b32 v1,4,v0
v_and_b32 v2,15,v0
v_and_b32 v3,1,v0
v_mov_b32 v164,0x4444
v_mov_b32 v4,0xeeee
v_cmp_eq_u32 vcc,1,v3
s_nop 1
v_cndmask_b32 v164,v164,v4,vcc
v_lshlrev_b32 v167,4,v0
s_lshl_b32 s30,s24,11
v_add_u32 v166,s30,v167
v_lshlrev_b32 v168,9,v1
v_lshl_add_u32 v168,v2,4,v168
s_lshl_b32 s30,s24,15
v_add_u32 v172,s30,v167
v_add_u32 v172,16384,v172
v_lshlrev_b32 v3,7,v0
s_lshl_b32 s30,s24,9
s_lshr_b32 s31,s25,1
s_lshl_b32 s31,s31,2
s_add_u32 s30,s30,s31
s_add_u32 s30,s30,50595840
s_mov_b32 s34,s30
s_lshl_b32 s30,s24,2
s_mul_i32 s30,s30,401408
s_mul_i32 s31,s25,28672
s_add_u32 s31,s31,s30
s_add_u32 s31,s31,7340032
s_lshl_b32 s56,s24,15
s_add_u32 s56,s56,16384
s_mov_b64 exec,0xf
s_mov_b32 s27,0
wf_180:
buffer_load_dword v8,v3,s[8:11],s34 offen sc1
s_waitcnt vmcnt(0)
v_cmp_gt_u32 vcc,1,v8
s_cbranch_vccz wfd_181
s_sleep 1
s_add_u32 s27,s27,1
s_cmp_lt_u32 s27,32768
s_cbranch_scc1 wf_180
s_mov_b32 s38,9
wfd_181:
s_mov_b64 exec,-1
s_add_u32 s32,s31,0
buffer_load_dwordx4 a[0:3],v168,s[8:11],s32 offen sc1
buffer_load_dwordx4 a[40:43],v168,s[8:11],s32 offen offset:256 sc1
s_add_u32 s32,s31,14336
buffer_load_dwordx4 a[28:31],v168,s[8:11],s32 offen sc1
buffer_load_dwordx4 a[68:71],v168,s[8:11],s32 offen offset:256 sc1
s_add_u32 s32,s31,401408
buffer_load_dwordx4 a[80:83],v168,s[8:11],s32 offen sc1
buffer_load_dwordx4 a[120:123],v168,s[8:11],s32 offen offset:256 sc1
s_add_u32 s32,s31,415744
buffer_load_dwordx4 a[108:111],v168,s[8:11],s32 offen sc1
buffer_load_dwordx4 a[148:151],v168,s[8:11],s32 offen offset:256 sc1
s_add_u32 s32,s31,802816
buffer_load_dwordx4 a[160:163],v168,s[8:11],s32 offen sc1
buffer_load_dwordx4 a[200:203],v168,s[8:11],s32 offen offset:256 sc1
s_add_u32 s32,s31,817152
buffer_load_dwordx4 a[188:191],v168,s[8:11],s32 offen sc1
buffer_load_dwordx4 a[228:231],v168,s[8:11],s32 offen offset:256 sc1
s_waitcnt vmcnt(40)
s_add_u32 s32,s31,1204224
buffer_load_dwordx4 a[240:243],v168,s[8:11],s32 offen sc1
buffer_load_dwordx4 v[216:219],v168,s[8:11],s32 offen offset:256 sc1
s_add_u32 s32,s31,1218560
buffer_load_dwordx4 v[204:207],v168,s[8:11],s32 offen sc1
buffer_load_dwordx4 v[244:247],v168,s[8:11],s32 offen offset:256 sc1
s_mov_b64 exec,0xf
s_mov_b32 s27,0
wf_182:
buffer_load_dword v8,v3,s[8:11],s34 offen sc1
s_waitcnt vmcnt(0)
v_cmp_gt_u32 vcc,2,v8
s_cbranch_vccz wfd_183
s_sleep 1
s_add_u32 s27,s27,1
s_cmp_lt_u32 s27,32768
s_cbranch_scc1 wf_182
s_mov_b32 s38,9
wfd_183:
s_mov_b64 exec,-1
s_add_u32 s32,s31,2048
buffer_load_dwordx4 a[4:7],v168,s[8:11],s32 offen sc1
buffer_load_dwordx4 a[44:47],v168,s[8:11],s32 offen offset:256 sc1
s_add_u32 s32,s31,4096
buffer_load_dwordx4 a[8:11],v168,s[8:11],s32 offen sc1
buffer_load_dwordx4 a[48:51],v168,s[8:11],s32 offen offset:256 sc1
s_add_u32 s32,s31,16384
buffer_load_dwordx4 a[32:35],v168,s[8:11],s32 offen sc1
buffer_load_dwordx4 a[72:75],v168,s[8:11],s32 offen offset:256 sc1
s_add_u32 s32,s31,18432
buffer_load_dwordx4 a[36:39],v168,s[8:11],s32 offen sc1
buffer_load_dwordx4 a[76:79],v168,s[8:11],s32 offen offset:256 sc1
s_add_u32 s32,s31,403456
buffer_load_dwordx4 a[84:87],v168,s[8:11],s32 offen sc1
buffer_load_dwordx4 a[124:127],v168,s[8:11],s32 offen offset:256 sc1
s_add_u32 s32,s31,405504
buffer_load_dwordx4 a[88:91],v168,s[8:11],s32 offen sc1
buffer_load_dwordx4 a[128:131],v168,s[8:11],s32 offen offset:256 sc1
s_add_u32 s32,s31,417792
buffer_load_dwordx4 a[112:115],v168,s[8:11],s32 offen sc1
buffer_load_dwordx4 a[152:155],v168,s[8:11],s32 offen offset:256 sc1
s_add_u32 s32,s31,419840
buffer_load_dwordx4 a[116:119],v168,s[8:11],s32 offen sc1
buffer_load_dwordx4 a[156:159],v168,s[8:11],s32 offen offset:256 sc1
s_add_u32 s32,s31,804864
buffer_load_dwordx4 a[164:167],v168,s[8:11],s32 offen sc1
buffer_load_dwordx4 a[204:207],v168,s[8:11],s32 offen offset:256 sc1
s_add_u32 s32,s31,806912
buffer_load_dwordx4 a[168:171],v168,s[8:11],s32 offen sc1
buffer_load_dwordx4 a[208:211],v168,s[8:11],s32 offen offset:256 sc1
s_add_u32 s32,s31,819200
buffer_load_dwordx4 a[192:195],v168,s[8:11],s32 offen sc1
buffer_load_dwordx4 a[232:235],v168,s[8:11],s32 offen offset:256 sc1
s_add_u32 s32,s31,821248
buffer_load_dwordx4 a[196:199],v168,s[8:11],s32 offen sc1
buffer_load_dwordx4 a[236:239],v168,s[8:11],s32 offen offset:256 sc1
s_waitcnt vmcnt(40)
s_add_u32 s32,s31,1206272
buffer_load_dwordx4 a[244:247],v168,s[8:11],s32 offen sc1
buffer_load_dwordx4 v[220:223],v168,s[8:11],s32 offen offset:256 sc1
s_add_u32 s32,s31,1208320
buffer_load_dwordx4 a[248:251],v168,s[8:11],s32 offen sc1
buffer_load_dwordx4 v[224:227],v168,s[8:11],s32 offen offset:256 sc1
s_add_u32 s32,s31,1220608
buffer_load_dwordx4 v[208:211],v168,s[8:11],s32 offen sc1
buffer_load_dwordx4 v[248:251],v168,s[8:11],s32 offen offset:256 sc1
s_add_u32 s32,s31,1222656
buffer_load_dwordx4 v[212:215],v168,s[8:11],s32 offen sc1
buffer_load_dwordx4 v[252:255],v168,s[8:11],s32 offen offset:256 sc1
s_mov_b64 exec,0xf
s_mov_b32 s27,0
wf_184:
buffer_load_dword v8,v3,s[8:11],s34 offen sc1
s_waitcnt vmcnt(0)
v_cmp_gt_u32 vcc,3,v8
s_cbranch_vccz wfd_185
s_sleep 1
s_add_u32 s27,s27,1
s_cmp_lt_u32 s27,32768
s_cbranch_scc1 wf_184
s_mov_b32 s38,9
wfd_185:
s_mov_b64 exec,-1
s_add_u32 s32,s31,6144
buffer_load_dwordx4 a[12:15],v168,s[8:11],s32 offen sc1
buffer_load_dwordx4 a[52:55],v168,s[8:11],s32 offen offset:256 sc1
s_add_u32 s32,s31,8192
buffer_load_dwordx4 a[16:19],v168,s[8:11],s32 offen sc1
buffer_load_dwordx4 a[56:59],v168,s[8:11],s32 offen offset:256 sc1
s_add_u32 s32,s31,10240
buffer_load_dwordx4 a[20:23],v168,s[8:11],s32 offen sc1
buffer_load_dwordx4 a[60:63],v168,s[8:11],s32 offen offset:256 sc1
s_add_u32 s32,s31,12288
buffer_load_dwordx4 a[24:27],v168,s[8:11],s32 offen sc1
buffer_load_dwordx4 a[64:67],v168,s[8:11],s32 offen offset:256 sc1
s_add_u32 s32,s31,20480
s_add_u32 m0,s56,0
s_nop 0
buffer_load_dwordx4 v168,s[8:11],s32 offen sc1 lds
s_add_u32 m0,s56,3840
s_nop 0
buffer_load_dwordx4 v168,s[8:11],s32 offen offset:256 sc1 lds
s_add_u32 s32,s31,22528
s_add_u32 m0,s56,1024
s_nop 0
buffer_load_dwordx4 v168,s[8:11],s32 offen sc1 lds
s_add_u32 m0,s56,4864
s_nop 0
buffer_load_dwordx4 v168,s[8:11],s32 offen offset:256 sc1 lds
s_add_u32 s32,s31,24576
s_add_u32 m0,s56,2048
s_nop 0
buffer_load_dwordx4 v168,s[8:11],s32 offen sc1 lds
s_add_u32 m0,s56,5888
s_nop 0
buffer_load_dwordx4 v168,s[8:11],s32 offen offset:256 sc1 lds
s_add_u32 s32,s31,26624
s_add_u32 m0,s56,3072
s_nop 0
buffer_load_dwordx4 v168,s[8:11],s32 offen sc1 lds
s_add_u32 m0,s56,6912
s_nop 0
buffer_load_dwordx4 v168,s[8:11],s32 offen offset:256 sc1 lds
s_add_u32 s32,s31,407552
buffer_load_dwordx4 a[92:95],v168,s[8:11],s32 offen sc1
buffer_load_dwordx4 a[132:135],v168,s[8:11],s32 offen offset:256 sc1
s_add_u32 s32,s31,409600
buffer_load_dwordx4 a[96:99],v168,s[8:11],s32 offen sc1
buffer_load_dwordx4 a[136:139],v168,s[8:11],s32 offen offset:256 sc1
s_add_u32 s32,s31,411648
buffer_load_dwordx4 a[100:103],v168,s[8:11],s32 offen sc1
buffer_load_dwordx4 a[140:143],v168,s[8:11],s32 offen offset:256 sc1
s_add_u32 s32,s31,413696
buffer_load_dwordx4 a[104:107],v168,s[8:11],s32 offen sc1
buffer_load_dwordx4 a[144:147],v168,s[8:11],s32 offen offset:256 sc1
s_add_u32 s32,s31,421888
s_add_u32 m0,s56,8192
s_nop 0
buffer_load_dwordx4 v168,s[8:11],s32 offen sc1 lds
s_add_u32 m0,s56,12032
s_nop 0
buffer_load_dwordx4 v168,s[8:11],s32 offen offset:256 sc1 lds
s_add_u32 s32,s31,423936
s_add_u32 m0,s56,9216
s_nop 0
buffer_load_dwordx4 v168,s[8:11],s32 offen sc1 lds
s_add_u32 m0,s56,13056
s_nop 0
buffer_load_dwordx4 v168,s[8:11],s32 offen offset:256 sc1 lds
s_add_u32 s32,s31,425984
s_add_u32 m0,s56,10240
s_nop 0
buffer_load_dwordx4 v168,s[8:11],s32 offen sc1 lds
s_add_u32 m0,s56,14080
s_nop 0
buffer_load_dwordx4 v168,s[8:11],s32 offen offset:256 sc1 lds
s_add_u32 s32,s31,428032
s_add_u32 m0,s56,11264
s_nop 0
buffer_load_dwordx4 v168,s[8:11],s32 offen sc1 lds
s_add_u32 m0,s56,15104
s_nop 0
buffer_load_dwordx4 v168,s[8:11],s32 offen offset:256 sc1 lds
s_add_u32 s32,s31,808960
buffer_load_dwordx4 a[172:175],v168,s[8:11],s32 offen sc1
buffer_load_dwordx4 a[212:215],v168,s[8:11],s32 offen offset:256 sc1
s_add_u32 s32,s31,811008
buffer_load_dwordx4 a[176:179],v168,s[8:11],s32 offen sc1
buffer_load_dwordx4 a[216:219],v168,s[8:11],s32 offen offset:256 sc1
s_add_u32 s32,s31,813056
buffer_load_dwordx4 a[180:183],v168,s[8:11],s32 offen sc1
buffer_load_dwordx4 a[220:223],v168,s[8:11],s32 offen offset:256 sc1
s_add_u32 s32,s31,815104
buffer_load_dwordx4 a[184:187],v168,s[8:11],s32 offen sc1
buffer_load_dwordx4 a[224:227],v168,s[8:11],s32 offen offset:256 sc1
s_add_u32 s32,s31,823296
s_add_u32 m0,s56,16384
s_nop 0
buffer_load_dwordx4 v168,s[8:11],s32 offen sc1 lds
s_add_u32 m0,s56,20224
s_nop 0
buffer_load_dwordx4 v168,s[8:11],s32 offen offset:256 sc1 lds
s_add_u32 s32,s31,825344
s_add_u32 m0,s56,17408
s_nop 0
buffer_load_dwordx4 v168,s[8:11],s32 offen sc1 lds
s_add_u32 m0,s56,21248
s_nop 0
buffer_load_dwordx4 v168,s[8:11],s32 offen offset:256 sc1 lds
s_add_u32 s32,s31,827392
s_add_u32 m0,s56,18432
s_nop 0
buffer_load_dwordx4 v168,s[8:11],s32 offen sc1 lds
s_add_u32 m0,s56,22272
s_nop 0
buffer_load_dwordx4 v168,s[8:11],s32 offen offset:256 sc1 lds
s_add_u32 s32,s31,829440
s_add_u32 m0,s56,19456
s_nop 0
buffer_load_dwordx4 v168,s[8:11],s32 offen sc1 lds
s_add_u32 m0,s56,23296
s_nop 0
buffer_load_dwordx4 v168,s[8:11],s32 offen offset:256 sc1 lds
s_waitcnt vmcnt(40)
s_add_u32 s32,s31,1210368
buffer_load_dwordx4 a[252:255],v168,s[8:11],s32 offen sc1
buffer_load_dwordx4 v[228:231],v168,s[8:11],s32 offen offset:256 sc1
s_add_u32 s32,s31,1212416
buffer_load_dwordx4 v[192:195],v168,s[8:11],s32 offen sc1
buffer_load_dwordx4 v[232:235],v168,s[8:11],s32 offen offset:256 sc1
s_add_u32 s32,s31,1214464
buffer_load_dwordx4 v[196:199],v168,s[8:11],s32 offen sc1
buffer_load_dwordx4 v[236:239],v168,s[8:11],s32 offen offset:256 sc1
s_add_u32 s32,s31,1216512
buffer_load_dwordx4 v[200:203],v168,s[8:11],s32 offen sc1
buffer_load_dwordx4 v[240:243],v168,s[8:11],s32 offen offset:256 sc1
s_add_u32 s32,s31,1224704
s_add_u32 m0,s56,24576
s_nop 0
buffer_load_dwordx4 v168,s[8:11],s32 offen sc1 lds
s_add_u32 m0,s56,28416
s_nop 0
buffer_load_dwordx4 v168,s[8:11],s32 offen offset:256 sc1 lds
s_add_u32 s32,s31,1226752
s_add_u32 m0,s56,25600
s_nop 0
buffer_load_dwordx4 v168,s[8:11],s32 offen sc1 lds
s_add_u32 m0,s56,29440
s_nop 0
buffer_load_dwordx4 v168,s[8:11],s32 offen offset:256 sc1 lds
s_add_u32 s32,s31,1228800
s_add_u32 m0,s56,26624
s_nop 0
buffer_load_dwordx4 v168,s[8:11],s32 offen sc1 lds
s_add_u32 m0,s56,30464
s_nop 0
buffer_load_dwordx4 v168,s[8:11],s32 offen offset:256 sc1 lds
s_add_u32 s32,s31,1230848
s_add_u32 m0,s56,27648
s_nop 0
buffer_load_dwordx4 v168,s[8:11],s32 offen sc1 lds
s_add_u32 m0,s56,31488
s_nop 0
buffer_load_dwordx4 v168,s[8:11],s32 offen offset:256 sc1 lds
s_mov_b32 s26,1
s_mov_b32 s37,51380224
s_lshl_b32 s63,s25,13
s_lshl_b32 s30,s24,11
s_add_u32 s63,s63,s30
s_add_u32 s63,s63,52559872
s_min_u32 s30,s30,5120
v_add_u32 v165,s30,v167
s_lshl_b32 s33,s25,7
s_lshl_b32 s30,s24,2
s_add_u32 s33,s33,s30
s_add_u32 s33,s33,50615552
v_mov_b32 v177,0
v_mov_b32 v178,0
s_mov_b32 s62,0
s_waitcnt vmcnt(0)
ds_read_b128 v[132:135],v172 offset:0
ds_read_b128 v[136:139],v172 offset:1024
ds_read_b128 v[140:143],v172 offset:2048
ds_read_b128 v[144:147],v172 offset:3072
ds_read_b128 v[148:151],v172 offset:4096
ds_read_b128 v[152:155],v172 offset:5120
ds_read_b128 v[156:159],v172 offset:6144
ds_read_b128 v[160:163],v172 offset:7168
s_and_b32 s34,s39,15
s_lshl_b32 s34,s34,7
s_add_u32 s34,s34,50610432
Fget_187:
s_sub_u32 s57,s26,2
s_cmp_gt_u32 s26,60
s_cselect_b32 s57,s57,s26
s_cmp_ge_u32 s62,s57
s_cbranch_scc1 Fkn_188
s_sub_u32 s30,s26,1
v_mov_b32 v178,s30
s_waitcnt vmcnt(0)
s_mov_b64 exec,1
buffer_store_dword v178,v177,s[8:11],s33 offen sc1
s_mov_b64 exec,-1
s_and_b32 s30,s39,15
s_lshl_b32 s30,s30,7
s_add_u32 s30,s30,50610432
s_mov_b32 s27,0
s_mov_b64 exec,1
wp_190:
buffer_load_dword v176,v177,s[8:11],s30 offen sc1
s_waitcnt vmcnt(0)
v_readfirstlane_b32 s58,v176
s_cmp_ge_u32 s58,s57
s_cbranch_scc1 wpd_191
s_add_u32 s58,s58,2
s_cmp_gt_u32 s58,s57
s_cbranch_scc1 wps_192
s_sleep 24
wps_192:
s_sleep 2
s_add_u32 s27,s27,1
s_cmp_lt_u32 s27,32768
s_cbranch_scc1 wp_190
s_mov_b32 s38,10
wpd_191:
s_mov_b64 exec,-1
s_mov_b32 s62,s58
Fkn_188:
s_mov_b32 s27,0
uv_193:
buffer_load_dwordx4 v[28:31],v165,s[8:11],s37 offen sc1
buffer_load_dwordx4 v[32:35],v165,s[8:11],s37 offen offset:1024 sc1
s_waitcnt vmcnt(1)
v_max3_u32 v176,v28,v29,v30
v_max_u32 v176,v176,v31
s_waitcnt vmcnt(0)
v_max3_u32 v176,v32,v33,v176
v_max3_u32 v176,v34,v35,v176
v_cmp_eq_u32 vcc,-1,v176
s_cbranch_vccz uvd_194
s_add_u32 s27,s27,1
s_cmp_lt_u32 s27,32768
s_cbranch_scc1 uv_193
s_mov_b32 s38,11
uvd_194:
s_cmp_lg_u32 s38,0
s_cbranch_scc1 L_end
Floop_186:
s_barrier
ds_write_b128 v165,v[28:31] offset:0
ds_write_b128 v165,v[32:35] offset:1024
v_mov_b64 v[76:77],0
v_mov_b64 v[78:79],0
v_mov_b64 v[80:81],0
v_mov_b64 v[82:83],0
v_mov_b64 v[128:129],0
v_mov_b64 v[130:131],0
v_mov_b64 v[116:117],0
v_mov_b64 v[118:119],0
v_mov_b64 v[120:121],0
v_mov_b64 v[122:123],0
v_mov_b64 v[188:189],0
v_mov_b64 v[190:191],0
v_mov_b64 v[92:93],0
v_mov_b64 v[94:95],0
v_mov_b64 v[96:97],0
v_mov_b64 v[98:99],0
s_waitcnt lgkmcnt(0)
s_barrier
ds_read_b128 v[0:3],v167 offset:0
ds_read_b128 v[4:7],v167 offset:1024
ds_read_b128 v[8:11],v167 offset:2048
ds_read_b128 v[12:15],v167 offset:3072
ds_read_b128 v[16:19],v167 offset:4096
ds_read_b128 v[20:23],v167 offset:5120
ds_read_b128 v[24:27],v167 offset:6144
s_add_u32 s26,s26,1
s_add_u32 s37,s37,8192
v_mov_b32 v28,-1
s_sub_u32 s57,s26,2
s_cmp_gt_u32 s26,60
s_cselect_b32 s57,s57,s26
s_cmp_ge_u32 s62,s57
s_cbranch_scc0 Fnp_189
buffer_load_dwordx4 v[28:31],v165,s[8:11],s37 offen sc1
buffer_load_dwordx4 v[32:35],v165,s[8:11],s37 offen offset:1024 sc1
Fnp_189:
buffer_load_dword v179,v177,s[8:11],s34 offen sc1
s_waitcnt lgkmcnt(6)
v_smfmac_f32_16x16x64_bf16 v[76:79],v[0:3],a[0:7],v164
v_smfmac_f32_16x16x64_bf16 v[80:83],v[0:3],a[40:47],v164
s_waitcnt lgkmcnt(5)
v_smfmac_f32_16x16x64_bf16 v[76:79],v[4:7],a[8:15],v164
v_smfmac_f32_16x16x64_bf16 v[80:83],v[4:7],a[48:55],v164
s_waitcnt lgkmcnt(4)
v_smfmac_f32_16x16x64_bf16 v[76:79],v[8:11],a[16:23],v164
v_smfmac_f32_16x16x64_bf16 v[80:83],v[8:11],a[56:63],v164
s_waitcnt lgkmcnt(3)
v_smfmac_f32_16x16x64_bf16 v[76:79],v[12:15],a[24:31],v164
v_smfmac_f32_16x16x64_bf16 v[80:83],v[12:15],a[64:71],v164
s_waitcnt lgkmcnt(2)
v_smfmac_f32_16x16x64_bf16 v[76:79],v[16:19],a[32:39],v164
v_smfmac_f32_16x16x64_bf16 v[80:83],v[16:19],a[72:79],v164
s_waitcnt lgkmcnt(1)
v_smfmac_f32_16x16x64_bf16 v[76:79],v[20:23],v[132:139],v164
v_smfmac_f32_16x16x64_bf16 v[80:83],v[20:23],v[148:155],v164
s_waitcnt lgkmcnt(0)
v_smfmac_f32_16x16x64_bf16 v[76:79],v[24:27],v[140:147],v164
v_smfmac_f32_16x16x64_bf16 v[80:83],v[24:27],v[156:163],v164
ds_read_b128 v[132:135],v172 offset:8192
v_smfmac_f32_16x16x64_bf16 v[128:131],v[0:3],a[80:87],v164
ds_read_b128 v[136:139],v172 offset:9216
v_smfmac_f32_16x16x64_bf16 v[128:131],v[4:7],a[88:95],v164
ds_read_b128 v[140:143],v172 offset:10240
v_add_f32 v76,v76,v77
v_smfmac_f32_16x16x64_bf16 v[128:131],v[8:11],a[96:103],v164
ds_read_b128 v[144:147],v172 offset:11264
v_add_f32 v78,v78,v79
v_smfmac_f32_16x16x64_bf16 v[128:131],v[12:15],a[104:111],v164
ds_read_b128 v[148:151],v172 offset:12288
v_cvt_pk_bf16_f32 v76,v76,v78
v_smfmac_f32_16x16x64_bf16 v[128:131],v[16:19],a[112:119],v164
ds_read_b128 v[152:155],v172 offset:13312
s_waitcnt lgkmcnt(2)
v_min_u32 v104,-2,v76
v_smfmac_f32_16x16x64_bf16 v[128:131],v[20:23],v[132:139],v164
ds_read_b128 v[156:159],v172 offset:14336
v_add_f32 v80,v80,v81
v_smfmac_f32_16x16x64_bf16 v[128:131],v[24:27],v[140:147],v164
ds_read_b128 v[160:163],v172 offset:15360
v_add_f32 v82,v82,v83
v_smfmac_f32_16x16x64_bf16 v[116:119],v[0:3],a[120:127],v164
ds_read_b128 v[132:135],v172 offset:16384
v_cvt_pk_bf16_f32 v80,v80,v82
v_smfmac_f32_16x16x64_bf16 v[116:119],v[4:7],a[128:135],v164
ds_read_b128 v[136:139],v172 offset:17408
v_min_u32 v108,-2,v80
v_smfmac_f32_16x16x64_bf16 v[116:119],v[8:11],a[136:143],v164
ds_read_b128 v[140:143],v172 offset:18432
v_add_f32 v128,v128,v129
v_smfmac_f32_16x16x64_bf16 v[116:119],v[12:15],a[144:151],v164
ds_read_b128 v[144:147],v172 offset:19456
v_add_f32 v130,v130,v131
v_smfmac_f32_16x16x64_bf16 v[116:119],v[16:19],a[152:159],v164
s_waitcnt lgkmcnt(4)
v_cvt_pk_bf16_f32 v128,v128,v130
v_smfmac_f32_16x16x64_bf16 v[116:119],v[20:23],v[148:155],v164
v_min_u32 v105,-2,v128
v_smfmac_f32_16x16x64_bf16 v[116:119],v[24:27],v[156:163],v164
v_smfmac_f32_16x16x64_bf16 v[120:123],v[0:3],a[160:167],v164
ds_read_b128 v[148:151],v172 offset:20480
v_smfmac_f32_16x16x64_bf16 v[120:123],v[4:7],a[168:175],v164
ds_read_b128 v[152:155],v172 offset:21504
v_smfmac_f32_16x16x64_bf16 v[120:123],v[8:11],a[176:183],v164
ds_read_b128 v[156:159],v172 offset:22528
v_add_f32 v116,v116,v117
v_smfmac_f32_16x16x64_bf16 v[120:123],v[12:15],a[184:191],v164
ds_read_b128 v[160:163],v172 offset:23552
v_add_f32 v118,v118,v119
v_smfmac_f32_16x16x64_bf16 v[120:123],v[16:19],a[192:199],v164
s_waitcnt lgkmcnt(4)
v_cvt_pk_bf16_f32 v116,v116,v118
v_smfmac_f32_16x16x64_bf16 v[120:123],v[20:23],v[132:139],v164
v_min_u32 v109,-2,v116
v_smfmac_f32_16x16x64_bf16 v[120:123],v[24:27],v[140:147],v164
v_smfmac_f32_16x16x64_bf16 v[188:191],v[0:3],a[200:207],v164
ds_read_b128 v[132:135],v172 offset:24576
v_smfmac_f32_16x16x64_bf16 v[188:191],v[4:7],a[208:215],v164
ds_read_b128 v[136:139],v172 offset:25600
v_smfmac_f32_16x16x64_bf16 v[188:191],v[8:11],a[216:223],v164
ds_read_b128 v[140:143],v172 offset:26624
v_add_f32 v120,v120,v121
v_smfmac_f32_16x16x64_bf16 v[188:191],v[12:15],a[224:231],v164
ds_read_b128 v[144:147],v172 offset:27648
v_add_f32 v122,v122,v123
v_smfmac_f32_16x16x64_bf16 v[188:191],v[16:19],a[232:239],v164
s_waitcnt lgkmcnt(4)
v_cvt_pk_bf16_f32 v120,v120,v122
v_smfmac_f32_16x16x64_bf16 v[188:191],v[20:23],v[148:155],v164
v_min_u32 v106,-2,v120
v_smfmac_f32_16x16x64_bf16 v[188:191],v[24:27],v[156:163],v164
v_smfmac_f32_16x16x64_bf16 v[92:95],v[0:3],a[240:247],v164
ds_read_b128 v[148:151],v172 offset:28672
v_smfmac_f32_16x16x64_bf16 v[92:95],v[4:7],a[248:255],v164
ds_read_b128 v[152:155],v172 offset:29696
v_smfmac_f32_16x16x64_bf16 v[92:95],v[8:11],v[192:199],v164
ds_read_b128 v[156:159],v172 offset:30720
v_add_f32 v188,v188,v189
v_smfmac_f32_16x16x64_bf16 v[92:95],v[12:15],v[200:207],v164
ds_read_b128 v[160:163],v172 offset:31744
v_add_f32 v190,v190,v191
v_smfmac_f32_16x16x64_bf16 v[92:95],v[16:19],v[208:215],v164
s_waitcnt lgkmcnt(4)
v_cvt_pk_bf16_f32 v188,v188,v190
v_smfmac_f32_16x16x64_bf16 v[92:95],v[20:23],v[132:139],v164
v_min_u32 v110,-2,v188
v_smfmac_f32_16x16x64_bf16 v[92:95],v[24:27],v[140:147],v164
v_smfmac_f32_16x16x64_bf16 v[96:99],v[0:3],v[216:223],v164
ds_read_b128 v[132:135],v172 offset:0
v_smfmac_f32_16x16x64_bf16 v[96:99],v[4:7],v[224:231],v164
ds_read_b128 v[136:139],v172 offset:1024
v_smfmac_f32_16x16x64_bf16 v[96:99],v[8:11],v[232:239],v164
ds_read_b128 v[140:143],v172 offset:2048
v_add_f32 v92,v92,v93
v_smfmac_f32_16x16x64_bf16 v[96:99],v[12:15],v[240:247],v164
ds_read_b128 v[144:147],v172 offset:3072
v_add_f32 v94,v94,v95
v_smfmac_f32_16x16x64_bf16 v[96:99],v[16:19],v[248:255],v164
s_waitcnt lgkmcnt(4)
v_cvt_pk_bf16_f32 v92,v92,v94
v_smfmac_f32_16x16x64_bf16 v[96:99],v[20:23],v[148:155],v164
v_min_u32 v107,-2,v92
v_smfmac_f32_16x16x64_bf16 v[96:99],v[24:27],v[156:163],v164
ds_read_b128 v[148:151],v172 offset:4096
ds_read_b128 v[152:155],v172 offset:5120
ds_read_b128 v[156:159],v172 offset:6144
ds_read_b128 v[160:163],v172 offset:7168
s_nop 3
v_add_f32 v96,v96,v97
v_add_f32 v98,v98,v99
v_cvt_pk_bf16_f32 v96,v96,v98
v_min_u32 v111,-2,v96
v_permlane32_swap_b32 v104,v106
v_permlane32_swap_b32 v105,v107
v_permlane32_swap_b32 v108,v110
v_permlane32_swap_b32 v109,v111
v_permlane16_swap_b32 v104,v105
v_permlane16_swap_b32 v106,v107
v_permlane16_swap_b32 v108,v109
v_permlane16_swap_b32 v110,v111
buffer_store_dwordx4 v[104:107],v168,s[8:11],s63 offen sc1
buffer_store_dwordx4 v[108:111],v168,s[8:11],s63 offen offset:256 sc1
s_cmp_gt_u32 s26,64
s_cbranch_scc1 L_end
s_add_u32 s63,s63,114688
s_sub_u32 s30,s26,2
v_mov_b32 v178,s30
s_waitcnt vmcnt(2)
s_mov_b64 exec,1
buffer_store_dword v178,v177,s[8:11],s33 offen sc1
s_mov_b64 exec,-1
v_readfirstlane_b32 s62,v179
v_max3_u32 v180,v28,v29,v30
v_max3_u32 v181,v31,v32,v33
v_max3_u32 v180,v180,v34,v35
v_max_u32 v180,v180,v181
v_cmp_eq_u32 vcc,-1,v180
s_cbranch_vccz Floop_186
s_branch Fget_187
L_end:
L_exit:
s_endpgm
L_worker:
s_sub_u32 s30,s39,32
s_mul_i32 s97,s30,9363
s_lshr_b32 s97,s97,16
s_mul_i32 s62,s97,7
s_sub_u32 s99,s30,s62
s_lshr_b32 s98,s97,1
s_and_b32 s97,s97,1
s_lshl_b32 s97,s97,4
s_add_u32 s97,s97,s98
s_add_u32 s32,s62,6
s_xor_b32 s62,s62,s32
s_cmp_ge_u32 s97,16
s_cselect_b32 s20,s72,s68
s_cselect_b32 s21,s73,s69
s_cselect_b32 s4,s74,s70
s_cselect_b32 s5,s75,s71
s_mov_b32 s22,3670016
s_mov_b32 s6,3670016
s_mov_b32 s23,0x20000
s_mov_b32 s7,0x20000
s_and_b32 s56,s24,1
s_lshr_b32 s57,s24,1
v_lshrrev_b32 v208,7,v192
v_lshlrev_b32 v216,13,v208
v_lshrrev_b32 v209,4,v192
v_and_b32 v209,0x30,v209
v_xor_b32 v209,v209,v192
v_and_b32 v209,0x70,v209
v_add_u32 v216,v216,v209
v_xor_b32 v218,64,v216
v_bfe_u32 v208,v192,5,3
v_lshlrev_b32 v208,4,v208
v_xor_b32 v208,v208,v206
v_and_b32 v209,0x1f0,v192
v_lshl_add_u32 v219,v209,3,v208
v_lshrrev_b32 v210,6,v192
v_mul_u32_u24 v210,896,v210
s_lshl_b32 s58,s56,14
s_add_u32 s58,s58,131072
s_lshl_b32 s59,s57,13
s_add_u32 s59,s59,s58
s_lshl_b32 s63,s99,1
s_add_u32 s63,s63,s56
s_cmp_ge_u32 s97,16
s_cbranch_scc1 prepB_197
s_lshl_b32 s30,s63,18
s_lshl_b32 s31,s98,9
s_add_u32 s30,s30,s31
s_lshl_b32 s31,s57,8
s_add_u32 s30,s30,s31
s_add_u32 s31,s30,0
s_add_u32 m0,s59,0
s_nop 0
buffer_load_dwordx4 v216,s[4:7],s31 offen lds
s_add_u32 m0,s59,3968
s_nop 0
buffer_load_dwordx4 v216,s[4:7],s31 offen offset:128 lds
s_add_u32 s31,s30,65536
s_add_u32 m0,s59,1024
s_nop 0
buffer_load_dwordx4 v218,s[4:7],s31 offen lds
s_add_u32 m0,s59,4992
s_nop 0
buffer_load_dwordx4 v218,s[4:7],s31 offen offset:128 lds
s_add_u32 s31,s30,131072
s_add_u32 m0,s59,2048
s_nop 0
buffer_load_dwordx4 v216,s[4:7],s31 offen lds
s_add_u32 m0,s59,6016
s_nop 0
buffer_load_dwordx4 v216,s[4:7],s31 offen offset:128 lds
s_add_u32 s31,s30,196608
s_add_u32 m0,s59,3072
s_nop 0
buffer_load_dwordx4 v218,s[4:7],s31 offen lds
s_add_u32 m0,s59,7040
s_nop 0
buffer_load_dwordx4 v218,s[4:7],s31 offen offset:128 lds
s_mov_b32 s33,0x3db8aa3b
s_mov_b32 s35,0
v_bfe_u32 v208,v192,5,2
v_bfe_u32 v209,v192,4,1
v_lshl_add_u32 v208,v209,3,v208
v_bfe_u32 v209,v192,7,1
v_lshl_add_u32 v208,v209,4,v208
v_bfe_u32 v209,v192,8,1
v_lshl_add_u32 v208,v209,2,v208
s_branch prepJ_198
prepB_197:
v_and_b32 v209,48,v192
v_add_u32 v210,v210,v209
s_mul_i32 s30,s98,229376
s_lshl_b32 s31,s63,6
s_add_u32 s30,s30,s31
s_mul_i32 s31,s57,114688
s_add_u32 s30,s30,s31
s_add_u32 m0,s59,0
s_nop 0
buffer_load_dwordx4 v210,s[4:7],s30 offen lds
s_add_u32 s30,s30,14336
s_add_u32 m0,s59,1024
s_nop 0
buffer_load_dwordx4 v210,s[4:7],s30 offen lds
s_add_u32 s30,s30,14336
s_add_u32 m0,s59,2048
s_nop 0
buffer_load_dwordx4 v210,s[4:7],s30 offen lds
s_add_u32 s30,s30,14336
s_add_u32 m0,s59,3072
s_nop 0
buffer_load_dwordx4 v210,s[4:7],s30 offen lds
s_add_u32 s30,s30,14336
s_add_u32 m0,s59,4096
s_nop 0
buffer_load_dwordx4 v210,s[4:7],s30 offen lds
s_add_u32 s30,s30,14336
s_add_u32 m0,s59,5120
s_nop 0
buffer_load_dwordx4 v210,s[4:7],s30 offen lds
s_add_u32 s30,s30,14336
s_add_u32 m0,s59,6144
s_nop 0
buffer_load_dwordx4 v210,s[4:7],s30 offen lds
s_add_u32 s30,s30,14336
s_add_u32 m0,s59,7168
s_nop 0
buffer_load_dwordx4 v210,s[4:7],s30 offen lds
s_add_u32 s30,s30,14336
s_mov_b32 s33,1.0
s_mov_b32 s35,7340032
v_bfe_u32 v208,v192,5,4
v_bfe_u32 v209,v192,4,1
v_lshl_add_u32 v208,v209,4,v208
prepJ_198:
s_mul_i32 s100,s57,1835008
s_lshl_b32 s30,s98,9
s_add_u32 s100,s100,s30
s_lshl_b32 s30,s56,8
s_add_u32 s100,s100,s30
s_lshl_b32 s101,s24,13
s_add_u32 s30,s100,0
s_add_u32 m0,s101,0
s_nop 0
buffer_load_dwordx4 v216,s[20:23],s30 offen lds
s_add_u32 m0,s101,3968
s_nop 0
buffer_load_dwordx4 v216,s[20:23],s30 offen offset:128 lds
s_add_u32 s30,s100,65536
s_add_u32 m0,s101,1024
s_nop 0
buffer_load_dwordx4 v218,s[20:23],s30 offen lds
s_add_u32 m0,s101,4992
s_nop 0
buffer_load_dwordx4 v218,s[20:23],s30 offen offset:128 lds
s_add_u32 s30,s100,131072
s_add_u32 m0,s101,2048
s_nop 0
buffer_load_dwordx4 v216,s[20:23],s30 offen lds
s_add_u32 m0,s101,6016
s_nop 0
buffer_load_dwordx4 v216,s[20:23],s30 offen offset:128 lds
s_add_u32 s30,s100,196608
s_add_u32 m0,s101,3072
s_nop 0
buffer_load_dwordx4 v218,s[20:23],s30 offen lds
s_add_u32 m0,s101,7040
s_nop 0
buffer_load_dwordx4 v218,s[20:23],s30 offen offset:128 lds
s_add_u32 s30,s100,262144
s_add_u32 m0,s101,32768
s_nop 0
buffer_load_dwordx4 v216,s[20:23],s30 offen lds
s_add_u32 m0,s101,36736
s_nop 0
buffer_load_dwordx4 v216,s[20:23],s30 offen offset:128 lds
s_add_u32 s30,s100,327680
s_add_u32 m0,s101,33792
s_nop 0
buffer_load_dwordx4 v218,s[20:23],s30 offen lds
s_add_u32 m0,s101,37760
s_nop 0
buffer_load_dwordx4 v218,s[20:23],s30 offen offset:128 lds
s_add_u32 s30,s100,393216
s_add_u32 m0,s101,34816
s_nop 0
buffer_load_dwordx4 v216,s[20:23],s30 offen lds
s_add_u32 m0,s101,38784
s_nop 0
buffer_load_dwordx4 v216,s[20:23],s30 offen offset:128 lds
s_add_u32 s30,s100,458752
s_add_u32 m0,s101,35840
s_nop 0
buffer_load_dwordx4 v218,s[20:23],s30 offen lds
s_add_u32 m0,s101,39808
s_nop 0
buffer_load_dwordx4 v218,s[20:23],s30 offen offset:128 lds
s_mul_i32 s30,s99,183
s_lshl_b32 s31,s24,6
v_lshrrev_b32 v211,4,v192
v_add_u32 v211,s31,v211
v_min_u32 v211,182,v211
v_add_u32 v211,s30,v211
v_min_u32 v211,1279,v211
v_cmp_lt_u32 vcc,639,v211
s_nop 1
v_cndmask_b32 v212,1,2,vcc
v_lshl_add_u32 v211,v212,8,v211
v_lshrrev_b32 v212,2,v211
v_lshlrev_b32 v212,13,v212
v_and_b32 v211,3,v211
v_lshl_add_u32 v211,v211,7,v212
s_lshl_b32 s30,s98,9
s_cmp_ge_u32 s62,32
s_cbranch_scc1 t2_201
buffer_load_dword v255,v211,s[20:23],s30 offen nt
s_branch t2k_202
t2_201:
buffer_load_dword v255,v211,s[20:23],s30 offen
t2k_202:
v_and_b32 v209,512,v192
v_lshl_add_u32 v217,v208,4,v209
s_mul_i32 s31,s98,401408
s_add_u32 s35,s35,s31
s_mul_i32 s30,s63,28672
s_add_u32 s35,s35,s30
s_mul_i32 s30,s57,14336
s_add_u32 s35,s35,s30
s_lshl_b32 s59,s57,14
s_lshl_b32 s34,s97,7
s_lshl_b32 s31,s99,2
s_add_u32 s34,s34,s31
s_add_u32 s34,s34,50593792
s_add_u32 s31,s58,0
v_add_u32 v220,s31,v219
v_xor_b32 v221,32,v220
v_xor_b32 v222,64,v220
v_xor_b32 v223,96,v220
s_waitcnt vmcnt(17)
s_barrier
s_cmp_ge_u32 s97,16
s_cbranch_scc1 prepB2_199
ds_read_b128 v[0:3],v220 offset:0
ds_read_b128 v[4:7],v221 offset:0
ds_read_b128 v[8:11],v222 offset:0
ds_read_b128 v[12:15],v223 offset:0
ds_read_b128 v[16:19],v220 offset:4096
ds_read_b128 v[20:23],v221 offset:4096
ds_read_b128 v[24:27],v222 offset:4096
ds_read_b128 v[28:31],v223 offset:4096
ds_read_b128 v[32:35],v220 offset:8192
ds_read_b128 v[36:39],v221 offset:8192
ds_read_b128 v[40:43],v222 offset:8192
ds_read_b128 v[44:47],v223 offset:8192
ds_read_b128 v[48:51],v220 offset:12288
ds_read_b128 v[52:55],v221 offset:12288
ds_read_b128 v[56:59],v222 offset:12288
ds_read_b128 v[60:63],v223 offset:12288
s_branch prepJ2_200
prepB2_199:
v_add_u32 v220,s58,v200
ds_read_b64_tr_b16 v[0:1],v220 offset:0
ds_read_b64_tr_b16 v[2:3],v220 offset:256
ds_read_b64_tr_b16 v[4:5],v220 offset:1024
ds_read_b64_tr_b16 v[6:7],v220 offset:1280
ds_read_b64_tr_b16 v[8:9],v220 offset:2048
ds_read_b64_tr_b16 v[10:11],v220 offset:2304
ds_read_b64_tr_b16 v[12:13],v220 offset:3072
ds_read_b64_tr_b16 v[14:15],v220 offset:3328
ds_read_b64_tr_b16 v[16:17],v220 offset:4096
ds_read_b64_tr_b16 v[18:19],v220 offset:4352
ds_read_b64_tr_b16 v[20:21],v220 offset:5120
ds_read_b64_tr_b16 v[22:23],v220 offset:5376
ds_read_b64_tr_b16 v[24:25],v220 offset:6144
ds_read_b64_tr_b16 v[26:27],v220 offset:6400
ds_read_b64_tr_b16 v[28:29],v220 offset:7168
ds_read_b64_tr_b16 v[30:31],v220 offset:7424
ds_read_b64_tr_b16 v[32:33],v220 offset:8192
ds_read_b64_tr_b16 v[34:35],v220 offset:8448
ds_read_b64_tr_b16 v[36:37],v220 offset:9216
ds_read_b64_tr_b16 v[38:39],v220 offset:9472
ds_read_b64_tr_b16 v[40:41],v220 offset:10240
ds_read_b64_tr_b16 v[42:43],v220 offset:10496
ds_read_b64_tr_b16 v[44:45],v220 offset:11264
ds_read_b64_tr_b16 v[46:47],v220 offset:11520
ds_read_b64_tr_b16 v[48:49],v220 offset:12288
ds_read_b64_tr_b16 v[50:51],v220 offset:12544
ds_read_b64_tr_b16 v[52:53],v220 offset:13312
ds_read_b64_tr_b16 v[54:55],v220 offset:13568
ds_read_b64_tr_b16 v[56:57],v220 offset:14336
ds_read_b64_tr_b16 v[58:59],v220 offset:14592
ds_read_b64_tr_b16 v[60:61],v220 offset:15360
ds_read_b64_tr_b16 v[62:63],v220 offset:15616
prepJ2_200:
s_waitcnt lgkmcnt(0)
s_add_u32 s31,s59,0
v_add_u32 v220,s31,v219
v_xor_b32 v221,32,v220
v_xor_b32 v222,64,v220
v_xor_b32 v223,96,v220
s_waitcnt vmcnt(9)
s_barrier
ds_read_b128 v[64:67],v220 offset:0
ds_read_b128 v[68:71],v221 offset:0
ds_read_b128 v[72:75],v222 offset:0
ds_read_b128 v[76:79],v223 offset:0
ds_read_b128 v[80:83],v220 offset:4096
ds_read_b128 v[84:87],v221 offset:4096
s_waitcnt lgkmcnt(5)
v_mfma_f32_32x32x16_bf16 v[128:143],v[64:67],v[0:3],0
ds_read_b128 v[88:91],v222 offset:4096
s_add_u32 s30,s100,524288
s_add_u32 m0,s101,65536
s_nop 0
buffer_load_dwordx4 v216,s[20:23],s30 offen lds
s_add_u32 s31,s59,32768
v_add_u32 v228,s31,v219
v_xor_b32 v229,32,v228
s_waitcnt lgkmcnt(5)
v_mfma_f32_32x32x16_bf16 v[128:143],v[68:71],v[4:7],v[128:143]
ds_read_b128 v[92:95],v223 offset:4096
s_add_u32 m0,s101,69504
s_nop 0
buffer_load_dwordx4 v216,s[20:23],s30 offen offset:128 lds
v_xor_b32 v230,64,v228
v_xor_b32 v231,96,v228
s_waitcnt lgkmcnt(5)
v_mfma_f32_32x32x16_bf16 v[128:143],v[72:75],v[8:11],v[128:143]
ds_read_b128 v[64:67],v220 offset:8192
s_add_u32 s30,s100,589824
s_add_u32 m0,s101,66560
s_nop 0
buffer_load_dwordx4 v218,s[20:23],s30 offen lds
s_waitcnt lgkmcnt(5)
v_mfma_f32_32x32x16_bf16 v[128:143],v[76:79],v[12:15],v[128:143]
ds_read_b128 v[68:71],v221 offset:8192
s_add_u32 m0,s101,70528
s_nop 0
buffer_load_dwordx4 v218,s[20:23],s30 offen offset:128 lds
s_waitcnt lgkmcnt(5)
v_mfma_f32_32x32x16_bf16 v[128:143],v[80:83],v[16:19],v[128:143]
ds_read_b128 v[72:75],v222 offset:8192
s_add_u32 s30,s100,655360
s_add_u32 m0,s101,67584
s_nop 0
buffer_load_dwordx4 v216,s[20:23],s30 offen lds
s_waitcnt lgkmcnt(5)
v_mfma_f32_32x32x16_bf16 v[128:143],v[84:87],v[20:23],v[128:143]
ds_read_b128 v[76:79],v223 offset:8192
s_add_u32 m0,s101,71552
s_nop 0
buffer_load_dwordx4 v216,s[20:23],s30 offen offset:128 lds
s_waitcnt lgkmcnt(5)
v_mfma_f32_32x32x16_bf16 v[128:143],v[88:91],v[24:27],v[128:143]
ds_read_b128 v[80:83],v220 offset:12288
s_add_u32 s30,s100,720896
s_add_u32 m0,s101,68608
s_nop 0
buffer_load_dwordx4 v218,s[20:23],s30 offen lds
s_waitcnt lgkmcnt(5)
v_mfma_f32_32x32x16_bf16 v[128:143],v[92:95],v[28:31],v[128:143]
ds_read_b128 v[84:87],v221 offset:12288
s_add_u32 m0,s101,72576
s_nop 0
buffer_load_dwordx4 v218,s[20:23],s30 offen offset:128 lds
s_waitcnt lgkmcnt(5)
v_mfma_f32_32x32x16_bf16 v[128:143],v[64:67],v[32:35],v[128:143]
ds_read_b128 v[88:91],v222 offset:12288
s_waitcnt vmcnt(9)
s_barrier
buffer_load_dword v227,v199,s[16:19],0 offen offset:4 sc1
s_waitcnt lgkmcnt(5)
v_mfma_f32_32x32x16_bf16 v[128:143],v[68:71],v[36:39],v[128:143]
ds_read_b128 v[92:95],v223 offset:12288
s_add_u32 s30,s100,786432
s_add_u32 m0,s101,98304
s_nop 0
buffer_load_dwordx4 v216,s[20:23],s30 offen lds
s_waitcnt lgkmcnt(5)
v_mfma_f32_32x32x16_bf16 v[128:143],v[72:75],v[40:43],v[128:143]
ds_read_b128 v[64:67],v228 offset:0
s_add_u32 m0,s101,102272
s_nop 0
buffer_load_dwordx4 v216,s[20:23],s30 offen offset:128 lds
s_waitcnt lgkmcnt(5)
v_mfma_f32_32x32x16_bf16 v[128:143],v[76:79],v[44:47],v[128:143]
ds_read_b128 v[68:71],v229 offset:0
s_add_u32 s30,s100,851968
s_add_u32 m0,s101,99328
s_nop 0
buffer_load_dwordx4 v218,s[20:23],s30 offen lds
s_waitcnt lgkmcnt(5)
v_mfma_f32_32x32x16_bf16 v[128:143],v[80:83],v[48:51],v[128:143]
ds_read_b128 v[72:75],v230 offset:0
s_add_u32 m0,s101,103296
s_nop 0
buffer_load_dwordx4 v218,s[20:23],s30 offen offset:128 lds
s_waitcnt lgkmcnt(5)
v_mfma_f32_32x32x16_bf16 v[128:143],v[84:87],v[52:55],v[128:143]
ds_read_b128 v[76:79],v231 offset:0
s_add_u32 s30,s100,917504
s_add_u32 m0,s101,100352
s_nop 0
buffer_load_dwordx4 v216,s[20:23],s30 offen lds
s_waitcnt lgkmcnt(5)
v_mfma_f32_32x32x16_bf16 v[128:143],v[88:91],v[56:59],v[128:143]
ds_read_b128 v[80:83],v228 offset:4096
s_add_u32 m0,s101,104320
s_nop 0
buffer_load_dwordx4 v216,s[20:23],s30 offen offset:128 lds
s_waitcnt lgkmcnt(5)
v_mfma_f32_32x32x16_bf16 v[128:143],v[92:95],v[60:63],v[128:143]
ds_read_b128 v[84:87],v229 offset:4096
s_add_u32 s30,s100,983040
s_add_u32 m0,s101,101376
s_nop 0
buffer_load_dwordx4 v218,s[20:23],s30 offen lds
s_waitcnt lgkmcnt(5)
v_mfma_f32_32x32x16_bf16 v[144:159],v[64:67],v[0:3],0
ds_read_b128 v[88:91],v230 offset:4096
s_add_u32 m0,s101,105344
s_nop 0
buffer_load_dwordx4 v218,s[20:23],s30 offen offset:128 lds
s_waitcnt lgkmcnt(5)
v_mfma_f32_32x32x16_bf16 v[144:159],v[68:71],v[4:7],v[144:159]
ds_read_b128 v[92:95],v231 offset:4096
s_waitcnt lgkmcnt(5)
v_mfma_f32_32x32x16_bf16 v[144:159],v[72:75],v[8:11],v[144:159]
ds_read_b128 v[64:67],v228 offset:8192
s_add_u32 s31,s59,65536
v_add_u32 v220,s31,v219
v_xor_b32 v221,32,v220
s_waitcnt lgkmcnt(5)
v_mfma_f32_32x32x16_bf16 v[144:159],v[76:79],v[12:15],v[144:159]
ds_read_b128 v[68:71],v229 offset:8192
v_xor_b32 v222,64,v220
v_xor_b32 v223,96,v220
v_mul_f32 v128,s33,v128
s_waitcnt lgkmcnt(5)
v_mfma_f32_32x32x16_bf16 v[144:159],v[80:83],v[16:19],v[144:159]
ds_read_b128 v[72:75],v230 offset:8192
v_mul_f32 v129,s33,v129
v_mul_f32 v130,s33,v130
v_mul_f32 v131,s33,v131
s_waitcnt lgkmcnt(5)
v_mfma_f32_32x32x16_bf16 v[144:159],v[84:87],v[20:23],v[144:159]
ds_read_b128 v[76:79],v231 offset:8192
v_mul_f32 v132,s33,v132
v_mul_f32 v133,s33,v133
v_mul_f32 v134,s33,v134
s_waitcnt lgkmcnt(5)
v_mfma_f32_32x32x16_bf16 v[144:159],v[88:91],v[24:27],v[144:159]
ds_read_b128 v[80:83],v228 offset:12288
v_mul_f32 v135,s33,v135
v_mul_f32 v136,s33,v136
v_mul_f32 v137,s33,v137
s_waitcnt lgkmcnt(5)
v_mfma_f32_32x32x16_bf16 v[144:159],v[92:95],v[28:31],v[144:159]
ds_read_b128 v[84:87],v229 offset:12288
v_mul_f32 v138,s33,v138
v_mul_f32 v139,s33,v139
v_mul_f32 v140,s33,v140
s_waitcnt lgkmcnt(5)
v_mfma_f32_32x32x16_bf16 v[144:159],v[64:67],v[32:35],v[144:159]
ds_read_b128 v[88:91],v230 offset:12288
v_mul_f32 v141,s33,v141
v_mul_f32 v142,s33,v142
v_mul_f32 v143,s33,v143
s_waitcnt vmcnt(9)
s_barrier
s_waitcnt lgkmcnt(5)
v_mfma_f32_32x32x16_bf16 v[144:159],v[68:71],v[36:39],v[144:159]
ds_read_b128 v[92:95],v231 offset:12288
v_cvt_pk_bf16_f32 v160,v128,v129
v_cvt_pk_bf16_f32 v161,v132,v133
v_cvt_pk_bf16_f32 v162,v130,v131
s_waitcnt lgkmcnt(5)
v_mfma_f32_32x32x16_bf16 v[144:159],v[72:75],v[40:43],v[144:159]
ds_read_b128 v[64:67],v220 offset:0
s_add_u32 s30,s100,1048576
s_add_u32 m0,s101,0
s_nop 0
buffer_load_dwordx4 v216,s[20:23],s30 offen lds
v_cvt_pk_bf16_f32 v163,v134,v135
v_cvt_pk_bf16_f32 v164,v136,v137
v_cvt_pk_bf16_f32 v165,v140,v141
s_waitcnt lgkmcnt(5)
v_mfma_f32_32x32x16_bf16 v[144:159],v[76:79],v[44:47],v[144:159]
ds_read_b128 v[68:71],v221 offset:0
v_cvt_pk_bf16_f32 v166,v138,v139
v_cvt_pk_bf16_f32 v167,v142,v143
s_add_u32 s31,s35,0
s_waitcnt lgkmcnt(5)
v_mfma_f32_32x32x16_bf16 v[144:159],v[80:83],v[48:51],v[144:159]
ds_read_b128 v[72:75],v222 offset:0
s_add_u32 m0,s101,3968
s_nop 0
buffer_load_dwordx4 v216,s[20:23],s30 offen offset:128 lds
buffer_store_dwordx4 v[160:163],v217,s[8:11],s31 offen sc1
buffer_store_dwordx4 v[164:167],v217,s[8:11],s31 offen offset:1024 sc1
s_waitcnt lgkmcnt(5)
v_mfma_f32_32x32x16_bf16 v[144:159],v[84:87],v[52:55],v[144:159]
ds_read_b128 v[76:79],v223 offset:0
s_waitcnt lgkmcnt(5)
v_mfma_f32_32x32x16_bf16 v[144:159],v[88:91],v[56:59],v[144:159]
ds_read_b128 v[80:83],v220 offset:4096
s_add_u32 s30,s100,1114112
s_add_u32 m0,s101,1024
s_nop 0
buffer_load_dwordx4 v218,s[20:23],s30 offen lds
s_waitcnt lgkmcnt(5)
v_mfma_f32_32x32x16_bf16 v[144:159],v[92:95],v[60:63],v[144:159]
ds_read_b128 v[84:87],v221 offset:4096
s_waitcnt lgkmcnt(5)
v_mfma_f32_32x32x16_bf16 v[128:143],v[64:67],v[0:3],0
ds_read_b128 v[88:91],v222 offset:4096
s_add_u32 m0,s101,4992
s_nop 0
buffer_load_dwordx4 v218,s[20:23],s30 offen offset:128 lds
s_waitcnt lgkmcnt(5)
v_mfma_f32_32x32x16_bf16 v[128:143],v[68:71],v[4:7],v[128:143]
ds_read_b128 v[92:95],v223 offset:4096
s_waitcnt lgkmcnt(5)
v_mfma_f32_32x32x16_bf16 v[128:143],v[72:75],v[8:11],v[128:143]
ds_read_b128 v[64:67],v220 offset:8192
s_add_u32 s30,s100,1179648
s_add_u32 m0,s101,2048
s_nop 0
buffer_load_dwordx4 v216,s[20:23],s30 offen lds
s_add_u32 s31,s59,98304
v_add_u32 v228,s31,v219
v_xor_b32 v229,32,v228
s_waitcnt lgkmcnt(5)
v_mfma_f32_32x32x16_bf16 v[128:143],v[76:79],v[12:15],v[128:143]
ds_read_b128 v[68:71],v221 offset:8192
v_xor_b32 v230,64,v228
v_xor_b32 v231,96,v228
v_mul_f32 v144,s33,v144
s_waitcnt lgkmcnt(5)
v_mfma_f32_32x32x16_bf16 v[128:143],v[80:83],v[16:19],v[128:143]
ds_read_b128 v[72:75],v222 offset:8192
s_add_u32 m0,s101,6016
s_nop 0
buffer_load_dwordx4 v216,s[20:23],s30 offen offset:128 lds
v_mul_f32 v145,s33,v145
v_mul_f32 v146,s33,v146
v_mul_f32 v147,s33,v147
s_waitcnt lgkmcnt(5)
v_mfma_f32_32x32x16_bf16 v[128:143],v[84:87],v[20:23],v[128:143]
ds_read_b128 v[76:79],v223 offset:8192
v_mul_f32 v148,s33,v148
v_mul_f32 v149,s33,v149
v_mul_f32 v150,s33,v150
s_waitcnt lgkmcnt(5)
v_mfma_f32_32x32x16_bf16 v[128:143],v[88:91],v[24:27],v[128:143]
ds_read_b128 v[80:83],v220 offset:12288
s_add_u32 s30,s100,1245184
s_add_u32 m0,s101,3072
s_nop 0
buffer_load_dwordx4 v218,s[20:23],s30 offen lds
v_mul_f32 v151,s33,v151
v_mul_f32 v152,s33,v152
v_mul_f32 v153,s33,v153
s_waitcnt lgkmcnt(5)
v_mfma_f32_32x32x16_bf16 v[128:143],v[92:95],v[28:31],v[128:143]
ds_read_b128 v[84:87],v221 offset:12288
v_mul_f32 v154,s33,v154
v_mul_f32 v155,s33,v155
v_mul_f32 v156,s33,v156
s_waitcnt lgkmcnt(5)
v_mfma_f32_32x32x16_bf16 v[128:143],v[64:67],v[32:35],v[128:143]
ds_read_b128 v[88:91],v222 offset:12288
s_add_u32 m0,s101,7040
s_nop 0
buffer_load_dwordx4 v218,s[20:23],s30 offen offset:128 lds
v_mul_f32 v157,s33,v157
v_mul_f32 v158,s33,v158
v_mul_f32 v159,s33,v159
s_waitcnt vmcnt(6)
s_barrier
s_cmp_lg_u32 s24,0
s_cbranch_scc1 pf_203
s_mov_b32 s27,0
wi_204:
v_cmp_eq_u32 vcc,0,v227
s_cbranch_vccz wid_205
buffer_load_dword v227,v199,s[16:19],0 offen offset:4 sc1
s_waitcnt vmcnt(0)
s_add_u32 s27,s27,1
s_cmp_lt_u32 s27,32768
s_cbranch_scc1 wi_204
s_branch L_exit
wid_205:
v_mov_b32 v248,1
s_mov_b64 exec,1
buffer_store_dword v248,v199,s[8:11],s34 offen sc1
s_mov_b64 exec,-1
pf_203:
s_waitcnt lgkmcnt(5)
v_mfma_f32_32x32x16_bf16 v[128:143],v[68:71],v[36:39],v[128:143]
ds_read_b128 v[92:95],v223 offset:12288
v_cvt_pk_bf16_f32 v160,v144,v145
v_cvt_pk_bf16_f32 v161,v148,v149
v_cvt_pk_bf16_f32 v162,v146,v147
s_waitcnt lgkmcnt(5)
v_mfma_f32_32x32x16_bf16 v[128:143],v[72:75],v[40:43],v[128:143]
ds_read_b128 v[64:67],v228 offset:0
s_add_u32 s30,s100,1310720
s_add_u32 m0,s101,32768
s_nop 0
buffer_load_dwordx4 v216,s[20:23],s30 offen lds
v_cvt_pk_bf16_f32 v163,v150,v151
v_cvt_pk_bf16_f32 v164,v152,v153
v_cvt_pk_bf16_f32 v165,v156,v157
s_waitcnt lgkmcnt(5)
v_mfma_f32_32x32x16_bf16 v[128:143],v[76:79],v[44:47],v[128:143]
ds_read_b128 v[68:71],v229 offset:0
v_cvt_pk_bf16_f32 v166,v154,v155
v_cvt_pk_bf16_f32 v167,v158,v159
s_add_u32 s31,s35,2048
s_waitcnt lgkmcnt(5)
v_mfma_f32_32x32x16_bf16 v[128:143],v[80:83],v[48:51],v[128:143]
ds_read_b128 v[72:75],v230 offset:0
s_add_u32 m0,s101,36736
s_nop 0
buffer_load_dwordx4 v216,s[20:23],s30 offen offset:128 lds
buffer_store_dwordx4 v[160:163],v217,s[8:11],s31 offen sc1
buffer_store_dwordx4 v[164:167],v217,s[8:11],s31 offen offset:1024 sc1
s_waitcnt lgkmcnt(5)
v_mfma_f32_32x32x16_bf16 v[128:143],v[84:87],v[52:55],v[128:143]
ds_read_b128 v[76:79],v231 offset:0
s_waitcnt lgkmcnt(5)
v_mfma_f32_32x32x16_bf16 v[128:143],v[88:91],v[56:59],v[128:143]
ds_read_b128 v[80:83],v228 offset:4096
s_add_u32 s30,s100,1376256
s_add_u32 m0,s101,33792
s_nop 0
buffer_load_dwordx4 v218,s[20:23],s30 offen lds
s_waitcnt lgkmcnt(5)
v_mfma_f32_32x32x16_bf16 v[128:143],v[92:95],v[60:63],v[128:143]
ds_read_b128 v[84:87],v229 offset:4096
s_waitcnt lgkmcnt(5)
v_mfma_f32_32x32x16_bf16 v[144:159],v[64:67],v[0:3],0
ds_read_b128 v[88:91],v230 offset:4096
s_add_u32 m0,s101,37760
s_nop 0
buffer_load_dwordx4 v218,s[20:23],s30 offen offset:128 lds
s_waitcnt lgkmcnt(5)
v_mfma_f32_32x32x16_bf16 v[144:159],v[68:71],v[4:7],v[144:159]
ds_read_b128 v[92:95],v231 offset:4096
s_waitcnt lgkmcnt(5)
v_mfma_f32_32x32x16_bf16 v[144:159],v[72:75],v[8:11],v[144:159]
ds_read_b128 v[64:67],v228 offset:8192
s_add_u32 s30,s100,1441792
s_add_u32 m0,s101,34816
s_nop 0
buffer_load_dwordx4 v216,s[20:23],s30 offen lds
s_add_u32 s31,s59,0
v_add_u32 v220,s31,v219
v_xor_b32 v221,32,v220
s_waitcnt lgkmcnt(5)
v_mfma_f32_32x32x16_bf16 v[144:159],v[76:79],v[12:15],v[144:159]
ds_read_b128 v[68:71],v229 offset:8192
v_xor_b32 v222,64,v220
v_xor_b32 v223,96,v220
v_mul_f32 v128,s33,v128
s_waitcnt lgkmcnt(5)
v_mfma_f32_32x32x16_bf16 v[144:159],v[80:83],v[16:19],v[144:159]
ds_read_b128 v[72:75],v230 offset:8192
s_add_u32 m0,s101,38784
s_nop 0
buffer_load_dwordx4 v216,s[20:23],s30 offen offset:128 lds
v_mul_f32 v129,s33,v129
v_mul_f32 v130,s33,v130
v_mul_f32 v131,s33,v131
s_waitcnt lgkmcnt(5)
v_mfma_f32_32x32x16_bf16 v[144:159],v[84:87],v[20:23],v[144:159]
ds_read_b128 v[76:79],v231 offset:8192
v_mul_f32 v132,s33,v132
v_mul_f32 v133,s33,v133
v_mul_f32 v134,s33,v134
s_waitcnt lgkmcnt(5)
v_mfma_f32_32x32x16_bf16 v[144:159],v[88:91],v[24:27],v[144:159]
ds_read_b128 v[80:83],v228 offset:12288
s_add_u32 s30,s100,1507328
s_add_u32 m0,s101,35840
s_nop 0
buffer_load_dwordx4 v218,s[20:23],s30 offen lds
v_mul_f32 v135,s33,v135
v_mul_f32 v136,s33,v136
v_mul_f32 v137,s33,v137
s_waitcnt lgkmcnt(5)
v_mfma_f32_32x32x16_bf16 v[144:159],v[92:95],v[28:31],v[144:159]
ds_read_b128 v[84:87],v229 offset:12288
v_mul_f32 v138,s33,v138
v_mul_f32 v139,s33,v139
v_mul_f32 v140,s33,v140
s_waitcnt lgkmcnt(5)
v_mfma_f32_32x32x16_bf16 v[144:159],v[64:67],v[32:35],v[144:159]
ds_read_b128 v[88:91],v230 offset:12288
s_add_u32 m0,s101,39808
s_nop 0
buffer_load_dwordx4 v218,s[20:23],s30 offen offset:128 lds
v_mul_f32 v141,s33,v141
v_mul_f32 v142,s33,v142
v_mul_f32 v143,s33,v143
s_waitcnt vmcnt(10)
s_barrier
s_waitcnt lgkmcnt(5)
v_mfma_f32_32x32x16_bf16 v[144:159],v[68:71],v[36:39],v[144:159]
ds_read_b128 v[92:95],v231 offset:12288
v_cvt_pk_bf16_f32 v160,v128,v129
v_cvt_pk_bf16_f32 v161,v132,v133
v_cvt_pk_bf16_f32 v162,v130,v131
s_waitcnt lgkmcnt(5)
v_mfma_f32_32x32x16_bf16 v[144:159],v[72:75],v[40:43],v[144:159]
ds_read_b128 v[64:67],v220 offset:0
s_add_u32 s30,s100,1572864
s_add_u32 m0,s101,65536
s_nop 0
buffer_load_dwordx4 v216,s[20:23],s30 offen lds
v_cvt_pk_bf16_f32 v163,v134,v135
v_cvt_pk_bf16_f32 v164,v136,v137
v_cvt_pk_bf16_f32 v165,v140,v141
s_waitcnt lgkmcnt(5)
v_mfma_f32_32x32x16_bf16 v[144:159],v[76:79],v[44:47],v[144:159]
ds_read_b128 v[68:71],v221 offset:0
v_cvt_pk_bf16_f32 v166,v138,v139
v_cvt_pk_bf16_f32 v167,v142,v143
s_add_u32 s31,s35,4096
s_waitcnt lgkmcnt(5)
v_mfma_f32_32x32x16_bf16 v[144:159],v[80:83],v[48:51],v[144:159]
ds_read_b128 v[72:75],v222 offset:0
s_add_u32 m0,s101,69504
s_nop 0
buffer_load_dwordx4 v216,s[20:23],s30 offen offset:128 lds
buffer_store_dwordx4 v[160:163],v217,s[8:11],s31 offen sc1
buffer_store_dwordx4 v[164:167],v217,s[8:11],s31 offen offset:1024 sc1
s_waitcnt lgkmcnt(5)
v_mfma_f32_32x32x16_bf16 v[144:159],v[84:87],v[52:55],v[144:159]
ds_read_b128 v[76:79],v223 offset:0
s_waitcnt lgkmcnt(5)
v_mfma_f32_32x32x16_bf16 v[144:159],v[88:91],v[56:59],v[144:159]
ds_read_b128 v[80:83],v220 offset:4096
s_add_u32 s30,s100,1638400
s_add_u32 m0,s101,66560
s_nop 0
buffer_load_dwordx4 v218,s[20:23],s30 offen lds
s_waitcnt lgkmcnt(5)
v_mfma_f32_32x32x16_bf16 v[144:159],v[92:95],v[60:63],v[144:159]
ds_read_b128 v[84:87],v221 offset:4096
s_waitcnt lgkmcnt(5)
v_mfma_f32_32x32x16_bf16 v[128:143],v[64:67],v[0:3],0
ds_read_b128 v[88:91],v222 offset:4096
s_add_u32 m0,s101,70528
s_nop 0
buffer_load_dwordx4 v218,s[20:23],s30 offen offset:128 lds
s_waitcnt lgkmcnt(5)
v_mfma_f32_32x32x16_bf16 v[128:143],v[68:71],v[4:7],v[128:143]
ds_read_b128 v[92:95],v223 offset:4096
s_waitcnt lgkmcnt(5)
v_mfma_f32_32x32x16_bf16 v[128:143],v[72:75],v[8:11],v[128:143]
ds_read_b128 v[64:67],v220 offset:8192
s_add_u32 s30,s100,1703936
s_add_u32 m0,s101,67584
s_nop 0
buffer_load_dwordx4 v216,s[20:23],s30 offen lds
s_add_u32 s31,s59,32768
v_add_u32 v228,s31,v219
v_xor_b32 v229,32,v228
s_waitcnt lgkmcnt(5)
v_mfma_f32_32x32x16_bf16 v[128:143],v[76:79],v[12:15],v[128:143]
ds_read_b128 v[68:71],v221 offset:8192
v_xor_b32 v230,64,v228
v_xor_b32 v231,96,v228
v_mul_f32 v144,s33,v144
s_waitcnt lgkmcnt(5)
v_mfma_f32_32x32x16_bf16 v[128:143],v[80:83],v[16:19],v[128:143]
ds_read_b128 v[72:75],v222 offset:8192
s_add_u32 m0,s101,71552
s_nop 0
buffer_load_dwordx4 v216,s[20:23],s30 offen offset:128 lds
v_mul_f32 v145,s33,v145
v_mul_f32 v146,s33,v146
v_mul_f32 v147,s33,v147
s_waitcnt lgkmcnt(5)
v_mfma_f32_32x32x16_bf16 v[128:143],v[84:87],v[20:23],v[128:143]
ds_read_b128 v[76:79],v223 offset:8192
v_mul_f32 v148,s33,v148
v_mul_f32 v149,s33,v149
v_mul_f32 v150,s33,v150
s_waitcnt lgkmcnt(5)
v_mfma_f32_32x32x16_bf16 v[128:143],v[88:91],v[24:27],v[128:143]
ds_read_b128 v[80:83],v220 offset:12288
s_add_u32 s30,s100,1769472
s_add_u32 m0,s101,68608
s_nop 0
buffer_load_dwordx4 v218,s[20:23],s30 offen lds
v_mul_f32 v151,s33,v151
v_mul_f32 v152,s33,v152
v_mul_f32 v153,s33,v153
s_waitcnt lgkmcnt(5)
v_mfma_f32_32x32x16_bf16 v[128:143],v[92:95],v[28:31],v[128:143]
ds_read_b128 v[84:87],v221 offset:12288
v_mul_f32 v154,s33,v154
v_mul_f32 v155,s33,v155
v_mul_f32 v156,s33,v156
s_waitcnt lgkmcnt(5)
v_mfma_f32_32x32x16_bf16 v[128:143],v[64:67],v[32:35],v[128:143]
ds_read_b128 v[88:91],v222 offset:12288
s_add_u32 m0,s101,72576
s_nop 0
buffer_load_dwordx4 v218,s[20:23],s30 offen offset:128 lds
v_mul_f32 v157,s33,v157
v_mul_f32 v158,s33,v158
v_mul_f32 v159,s33,v159
s_waitcnt vmcnt(6)
s_barrier
s_cmp_lg_u32 s24,0
s_cbranch_scc1 pf_206
v_mov_b32 v248,2
s_mov_b64 exec,1
buffer_store_dword v248,v199,s[8:11],s34 offen sc1
s_mov_b64 exec,-1
pf_206:
s_waitcnt lgkmcnt(5)
v_mfma_f32_32x32x16_bf16 v[128:143],v[68:71],v[36:39],v[128:143]
ds_read_b128 v[92:95],v223 offset:12288
v_cvt_pk_bf16_f32 v160,v144,v145
v_cvt_pk_bf16_f32 v161,v148,v149
v_cvt_pk_bf16_f32 v162,v146,v147
s_waitcnt lgkmcnt(5)
v_mfma_f32_32x32x16_bf16 v[128:143],v[72:75],v[40:43],v[128:143]
ds_read_b128 v[64:67],v228 offset:0
v_cvt_pk_bf16_f32 v163,v150,v151
v_cvt_pk_bf16_f32 v164,v152,v153
v_cvt_pk_bf16_f32 v165,v156,v157
s_waitcnt lgkmcnt(5)
v_mfma_f32_32x32x16_bf16 v[128:143],v[76:79],v[44:47],v[128:143]
ds_read_b128 v[68:71],v229 offset:0
v_cvt_pk_bf16_f32 v166,v154,v155
v_cvt_pk_bf16_f32 v167,v158,v159
s_add_u32 s31,s35,6144
s_waitcnt lgkmcnt(5)
v_mfma_f32_32x32x16_bf16 v[128:143],v[80:83],v[48:51],v[128:143]
ds_read_b128 v[72:75],v230 offset:0
buffer_store_dwordx4 v[160:163],v217,s[8:11],s31 offen sc1
buffer_store_dwordx4 v[164:167],v217,s[8:11],s31 offen offset:1024 sc1
s_waitcnt lgkmcnt(5)
v_mfma_f32_32x32x16_bf16 v[128:143],v[84:87],v[52:55],v[128:143]
ds_read_b128 v[76:79],v231 offset:0
s_waitcnt lgkmcnt(5)
v_mfma_f32_32x32x16_bf16 v[128:143],v[88:91],v[56:59],v[128:143]
ds_read_b128 v[80:83],v228 offset:4096
s_waitcnt lgkmcnt(5)
v_mfma_f32_32x32x16_bf16 v[128:143],v[92:95],v[60:63],v[128:143]
ds_read_b128 v[84:87],v229 offset:4096
s_waitcnt lgkmcnt(5)
v_mfma_f32_32x32x16_bf16 v[144:159],v[64:67],v[0:3],0
ds_read_b128 v[88:91],v230 offset:4096
s_waitcnt lgkmcnt(5)
v_mfma_f32_32x32x16_bf16 v[144:159],v[68:71],v[4:7],v[144:159]
ds_read_b128 v[92:95],v231 offset:4096
s_waitcnt lgkmcnt(5)
v_mfma_f32_32x32x16_bf16 v[144:159],v[72:75],v[8:11],v[144:159]
ds_read_b128 v[64:67],v228 offset:8192
s_add_u32 s31,s59,65536
v_add_u32 v220,s31,v219
v_xor_b32 v221,32,v220
s_waitcnt lgkmcnt(5)
v_mfma_f32_32x32x16_bf16 v[144:159],v[76:79],v[12:15],v[144:159]
ds_read_b128 v[68:71],v229 offset:8192
v_xor_b32 v222,64,v220
v_xor_b32 v223,96,v220
v_mul_f32 v128,s33,v128
s_waitcnt lgkmcnt(5)
v_mfma_f32_32x32x16_bf16 v[144:159],v[80:83],v[16:19],v[144:159]
ds_read_b128 v[72:75],v230 offset:8192
v_mul_f32 v129,s33,v129
v_mul_f32 v130,s33,v130
v_mul_f32 v131,s33,v131
s_waitcnt lgkmcnt(5)
v_mfma_f32_32x32x16_bf16 v[144:159],v[84:87],v[20:23],v[144:159]
ds_read_b128 v[76:79],v231 offset:8192
v_mul_f32 v132,s33,v132
v_mul_f32 v133,s33,v133
v_mul_f32 v134,s33,v134
s_waitcnt lgkmcnt(5)
v_mfma_f32_32x32x16_bf16 v[144:159],v[88:91],v[24:27],v[144:159]
ds_read_b128 v[80:83],v228 offset:12288
v_mul_f32 v135,s33,v135
v_mul_f32 v136,s33,v136
v_mul_f32 v137,s33,v137
s_waitcnt lgkmcnt(5)
v_mfma_f32_32x32x16_bf16 v[144:159],v[92:95],v[28:31],v[144:159]
ds_read_b128 v[84:87],v229 offset:12288
v_mul_f32 v138,s33,v138
v_mul_f32 v139,s33,v139
v_mul_f32 v140,s33,v140
s_waitcnt lgkmcnt(5)
v_mfma_f32_32x32x16_bf16 v[144:159],v[64:67],v[32:35],v[144:159]
ds_read_b128 v[88:91],v230 offset:12288
v_mul_f32 v141,s33,v141
v_mul_f32 v142,s33,v142
v_mul_f32 v143,s33,v143
s_waitcnt vmcnt(2)
s_barrier
s_waitcnt lgkmcnt(5)
v_mfma_f32_32x32x16_bf16 v[144:159],v[68:71],v[36:39],v[144:159]
ds_read_b128 v[92:95],v231 offset:12288
v_cvt_pk_bf16_f32 v160,v128,v129
v_cvt_pk_bf16_f32 v161,v132,v133
v_cvt_pk_bf16_f32 v162,v130,v131
s_waitcnt lgkmcnt(5)
v_mfma_f32_32x32x16_bf16 v[144:159],v[72:75],v[40:43],v[144:159]
ds_read_b128 v[64:67],v220 offset:0
v_cvt_pk_bf16_f32 v163,v134,v135
v_cvt_pk_bf16_f32 v164,v136,v137
v_cvt_pk_bf16_f32 v165,v140,v141
s_waitcnt lgkmcnt(5)
v_mfma_f32_32x32x16_bf16 v[144:159],v[76:79],v[44:47],v[144:159]
ds_read_b128 v[68:71],v221 offset:0
v_cvt_pk_bf16_f32 v166,v138,v139
v_cvt_pk_bf16_f32 v167,v142,v143
s_add_u32 s31,s35,8192
s_waitcnt lgkmcnt(5)
v_mfma_f32_32x32x16_bf16 v[144:159],v[80:83],v[48:51],v[144:159]
ds_read_b128 v[72:75],v222 offset:0
buffer_store_dwordx4 v[160:163],v217,s[8:11],s31 offen sc1
buffer_store_dwordx4 v[164:167],v217,s[8:11],s31 offen offset:1024 sc1
s_waitcnt lgkmcnt(5)
v_mfma_f32_32x32x16_bf16 v[144:159],v[84:87],v[52:55],v[144:159]
ds_read_b128 v[76:79],v223 offset:0
s_waitcnt lgkmcnt(5)
v_mfma_f32_32x32x16_bf16 v[144:159],v[88:91],v[56:59],v[144:159]
ds_read_b128 v[80:83],v220 offset:4096
s_waitcnt lgkmcnt(5)
v_mfma_f32_32x32x16_bf16 v[144:159],v[92:95],v[60:63],v[144:159]
ds_read_b128 v[84:87],v221 offset:4096
s_waitcnt lgkmcnt(5)
v_mfma_f32_32x32x16_bf16 v[128:143],v[64:67],v[0:3],0
ds_read_b128 v[88:91],v222 offset:4096
s_waitcnt lgkmcnt(5)
v_mfma_f32_32x32x16_bf16 v[128:143],v[68:71],v[4:7],v[128:143]
ds_read_b128 v[92:95],v223 offset:4096
s_waitcnt lgkmcnt(5)
v_mfma_f32_32x32x16_bf16 v[128:143],v[72:75],v[8:11],v[128:143]
ds_read_b128 v[64:67],v220 offset:8192
v_mul_f32 v144,s33,v144
v_mul_f32 v145,s33,v145
v_mul_f32 v146,s33,v146
s_waitcnt lgkmcnt(5)
v_mfma_f32_32x32x16_bf16 v[128:143],v[76:79],v[12:15],v[128:143]
ds_read_b128 v[68:71],v221 offset:8192
v_mul_f32 v147,s33,v147
v_mul_f32 v148,s33,v148
v_mul_f32 v149,s33,v149
s_waitcnt lgkmcnt(5)
v_mfma_f32_32x32x16_bf16 v[128:143],v[80:83],v[16:19],v[128:143]
ds_read_b128 v[72:75],v222 offset:8192
v_mul_f32 v150,s33,v150
v_mul_f32 v151,s33,v151
v_mul_f32 v152,s33,v152
s_waitcnt lgkmcnt(5)
v_mfma_f32_32x32x16_bf16 v[128:143],v[84:87],v[20:23],v[128:143]
ds_read_b128 v[76:79],v223 offset:8192
v_mul_f32 v153,s33,v153
v_mul_f32 v154,s33,v154
v_mul_f32 v155,s33,v155
s_waitcnt lgkmcnt(5)
v_mfma_f32_32x32x16_bf16 v[128:143],v[88:91],v[24:27],v[128:143]
ds_read_b128 v[80:83],v220 offset:12288
v_mul_f32 v156,s33,v156
v_mul_f32 v157,s33,v157
v_mul_f32 v158,s33,v158
s_waitcnt lgkmcnt(5)
v_mfma_f32_32x32x16_bf16 v[128:143],v[92:95],v[28:31],v[128:143]
ds_read_b128 v[84:87],v221 offset:12288
v_mul_f32 v159,s33,v159
v_cvt_pk_bf16_f32 v160,v144,v145
v_cvt_pk_bf16_f32 v161,v148,v149
s_waitcnt lgkmcnt(5)
v_mfma_f32_32x32x16_bf16 v[128:143],v[64:67],v[32:35],v[128:143]
ds_read_b128 v[88:91],v222 offset:12288
v_cvt_pk_bf16_f32 v162,v146,v147
v_cvt_pk_bf16_f32 v163,v150,v151
v_cvt_pk_bf16_f32 v164,v152,v153
s_waitcnt lgkmcnt(5)
v_mfma_f32_32x32x16_bf16 v[128:143],v[68:71],v[36:39],v[128:143]
ds_read_b128 v[92:95],v223 offset:12288
v_cvt_pk_bf16_f32 v165,v156,v157
v_cvt_pk_bf16_f32 v166,v154,v155
v_cvt_pk_bf16_f32 v167,v158,v159
s_waitcnt lgkmcnt(5)
v_mfma_f32_32x32x16_bf16 v[128:143],v[72:75],v[40:43],v[128:143]
s_add_u32 s31,s35,10240
buffer_store_dwordx4 v[160:163],v217,s[8:11],s31 offen sc1
buffer_store_dwordx4 v[164:167],v217,s[8:11],s31 offen offset:1024 sc1
s_waitcnt lgkmcnt(4)
v_mfma_f32_32x32x16_bf16 v[128:143],v[76:79],v[44:47],v[128:143]
s_waitcnt lgkmcnt(3)
v_mfma_f32_32x32x16_bf16 v[128:143],v[80:83],v[48:51],v[128:143]
s_waitcnt lgkmcnt(2)
v_mfma_f32_32x32x16_bf16 v[128:143],v[84:87],v[52:55],v[128:143]
s_waitcnt lgkmcnt(1)
v_mfma_f32_32x32x16_bf16 v[128:143],v[88:91],v[56:59],v[128:143]
s_waitcnt lgkmcnt(0)
v_mfma_f32_32x32x16_bf16 v[128:143],v[92:95],v[60:63],v[128:143]
s_nop 11
v_mul_f32 v128,s33,v128
v_mul_f32 v129,s33,v129
v_mul_f32 v130,s33,v130
v_mul_f32 v131,s33,v131
v_mul_f32 v132,s33,v132
v_mul_f32 v133,s33,v133
v_mul_f32 v134,s33,v134
v_mul_f32 v135,s33,v135
v_mul_f32 v136,s33,v136
v_mul_f32 v137,s33,v137
v_mul_f32 v138,s33,v138
v_mul_f32 v139,s33,v139
v_mul_f32 v140,s33,v140
v_mul_f32 v141,s33,v141
v_mul_f32 v142,s33,v142
v_mul_f32 v143,s33,v143
v_cvt_pk_bf16_f32 v160,v128,v129
v_cvt_pk_bf16_f32 v161,v132,v133
v_cvt_pk_bf16_f32 v162,v130,v131
v_cvt_pk_bf16_f32 v163,v134,v135
v_cvt_pk_bf16_f32 v164,v136,v137
v_cvt_pk_bf16_f32 v165,v140,v141
v_cvt_pk_bf16_f32 v166,v138,v139
v_cvt_pk_bf16_f32 v167,v142,v143
s_add_u32 s31,s35,12288
buffer_store_dwordx4 v[160:163],v217,s[8:11],s31 offen sc1
buffer_store_dwordx4 v[164:167],v217,s[8:11],s31 offen offset:1024 sc1
s_waitcnt vmcnt(0)
s_barrier
s_cmp_lg_u32 s24,0
s_cbranch_scc1 pf_207
v_mov_b32 v248,3
s_mov_b64 exec,1
buffer_store_dword v248,v199,s[8:11],s34 offen sc1
s_mov_b64 exec,-1
pf_207:
s_sub_u32 s30,s39,32
s_branch L_item
L_uV:
s_lshl_b32 s99,s97,2
s_add_u32 s99,s99,s24
s_lshl_b32 s59,s98,7
s_add_u32 s59,s59,50595840
s_mul_i32 s100,s98,401408
s_add_u32 s100,s100,7340032
s_mul_i32 s60,s24,7168
s_mul_i32 s31,s99,28672
s_add_u32 s56,s31,14336
s_mul_i32 s57,s24,28672
s_add_u32 s57,s57,28672
v_add_u32 v208,s57,v196
v_add_u32 v209,s57,v197
s_add_u32 m0,s57,0
s_nop 0
buffer_load_dwordx4 v195,s[12:15],s31 offen lds
s_add_u32 m0,s57,1024
s_nop 0
buffer_load_dwordx4 v195,s[12:15],s56 offen lds
s_add_u32 m0,s57,1984
s_nop 0
buffer_load_dwordx4 v195,s[12:15],s31 offen offset:64 lds
s_add_u32 m0,s57,3008
s_nop 0
buffer_load_dwordx4 v195,s[12:15],s56 offen offset:64 lds
s_add_u32 m0,s57,3968
s_nop 0
buffer_load_dwordx4 v195,s[12:15],s31 offen offset:128 lds
s_add_u32 m0,s57,4992
s_nop 0
buffer_load_dwordx4 v195,s[12:15],s56 offen offset:128 lds
s_add_u32 m0,s57,5952
s_nop 0
buffer_load_dwordx4 v195,s[12:15],s31 offen offset:192 lds
s_add_u32 m0,s57,6976
s_nop 0
buffer_load_dwordx4 v195,s[12:15],s56 offen offset:192 lds
s_add_u32 m0,s57,7936
s_nop 0
buffer_load_dwordx4 v195,s[12:15],s31 offen offset:256 lds
s_add_u32 m0,s57,8960
s_nop 0
buffer_load_dwordx4 v195,s[12:15],s56 offen offset:256 lds
s_add_u32 m0,s57,9920
s_nop 0
buffer_load_dwordx4 v195,s[12:15],s31 offen offset:320 lds
s_add_u32 m0,s57,10944
s_nop 0
buffer_load_dwordx4 v195,s[12:15],s56 offen offset:320 lds
s_add_u32 m0,s57,11904
s_nop 0
buffer_load_dwordx4 v195,s[12:15],s31 offen offset:384 lds
s_add_u32 m0,s57,12928
s_nop 0
buffer_load_dwordx4 v195,s[12:15],s56 offen offset:384 lds
s_add_u32 m0,s57,13888
s_nop 0
buffer_load_dwordx4 v195,s[12:15],s31 offen offset:448 lds
s_add_u32 m0,s57,14912
s_nop 0
buffer_load_dwordx4 v195,s[12:15],s56 offen offset:448 lds
s_add_u32 m0,s57,15872
s_nop 0
buffer_load_dwordx4 v195,s[12:15],s31 offen offset:512 lds
s_add_u32 m0,s57,16896
s_nop 0
buffer_load_dwordx4 v195,s[12:15],s56 offen offset:512 lds
s_add_u32 m0,s57,17856
s_nop 0
buffer_load_dwordx4 v195,s[12:15],s31 offen offset:576 lds
s_add_u32 m0,s57,18880
s_nop 0
buffer_load_dwordx4 v195,s[12:15],s56 offen offset:576 lds
s_add_u32 m0,s57,19840
s_nop 0
buffer_load_dwordx4 v195,s[12:15],s31 offen offset:640 lds
s_add_u32 m0,s57,20864
s_nop 0
buffer_load_dwordx4 v195,s[12:15],s56 offen offset:640 lds
s_add_u32 m0,s57,21824
s_nop 0
buffer_load_dwordx4 v195,s[12:15],s31 offen offset:704 lds
s_add_u32 m0,s57,22848
s_nop 0
buffer_load_dwordx4 v195,s[12:15],s56 offen offset:704 lds
s_add_u32 m0,s57,23808
s_nop 0
buffer_load_dwordx4 v195,s[12:15],s31 offen offset:768 lds
s_add_u32 m0,s57,24832
s_nop 0
buffer_load_dwordx4 v195,s[12:15],s56 offen offset:768 lds
s_add_u32 m0,s57,25792
s_nop 0
buffer_load_dwordx4 v195,s[12:15],s31 offen offset:832 lds
s_add_u32 m0,s57,26816
s_nop 0
buffer_load_dwordx4 v195,s[12:15],s56 offen offset:832 lds
s_waitcnt vmcnt(26)
ds_read_b128 v[0:3],v208 offset:0
ds_read_b128 v[4:7],v209 offset:0
s_waitcnt vmcnt(24)
ds_read_b128 v[8:11],v208 offset:2048
ds_read_b128 v[12:15],v209 offset:2048
s_waitcnt vmcnt(22)
ds_read_b128 v[16:19],v208 offset:4096
ds_read_b128 v[20:23],v209 offset:4096
s_waitcnt vmcnt(20)
ds_read_b128 v[24:27],v208 offset:6144
ds_read_b128 v[28:31],v209 offset:6144
s_waitcnt vmcnt(18)
ds_read_b128 v[32:35],v208 offset:8192
ds_read_b128 v[36:39],v209 offset:8192
s_waitcnt vmcnt(16)
ds_read_b128 v[40:43],v208 offset:10240
ds_read_b128 v[44:47],v209 offset:10240
s_waitcnt vmcnt(14)
ds_read_b128 v[48:51],v208 offset:12288
ds_read_b128 v[52:55],v209 offset:12288
s_waitcnt vmcnt(12)
ds_read_b128 v[56:59],v208 offset:14336
ds_read_b128 v[60:63],v209 offset:14336
s_waitcnt vmcnt(10)
ds_read_b128 v[64:67],v208 offset:16384
ds_read_b128 v[68:71],v209 offset:16384
s_waitcnt vmcnt(8)
ds_read_b128 v[72:75],v208 offset:18432
ds_read_b128 v[76:79],v209 offset:18432
s_waitcnt vmcnt(6)
ds_read_b128 v[80:83],v208 offset:20480
ds_read_b128 v[84:87],v209 offset:20480
s_waitcnt vmcnt(4)
ds_read_b128 v[88:91],v208 offset:22528
ds_read_b128 v[92:95],v209 offset:22528
s_waitcnt vmcnt(2)
ds_read_b128 v[96:99],v208 offset:24576
ds_read_b128 v[100:103],v209 offset:24576
s_waitcnt vmcnt(0)
ds_read_b128 v[104:107],v208 offset:26624
ds_read_b128 v[108:111],v209 offset:26624
s_waitcnt lgkmcnt(15)
v_permlane32_swap_b32 v0,v2
v_permlane32_swap_b32 v1,v3
s_waitcnt lgkmcnt(15)
v_permlane32_swap_b32 v4,v6
v_permlane32_swap_b32 v5,v7
s_waitcnt lgkmcnt(15)
v_permlane32_swap_b32 v8,v10
v_permlane32_swap_b32 v9,v11
s_waitcnt lgkmcnt(15)
v_permlane32_swap_b32 v12,v14
v_permlane32_swap_b32 v13,v15
s_waitcnt lgkmcnt(15)
v_permlane32_swap_b32 v16,v18
v_permlane32_swap_b32 v17,v19
s_waitcnt lgkmcnt(15)
v_permlane32_swap_b32 v20,v22
v_permlane32_swap_b32 v21,v23
s_waitcnt lgkmcnt(15)
v_permlane32_swap_b32 v24,v26
v_permlane32_swap_b32 v25,v27
s_waitcnt lgkmcnt(15)
v_permlane32_swap_b32 v28,v30
v_permlane32_swap_b32 v29,v31
s_waitcnt lgkmcnt(15)
v_permlane32_swap_b32 v32,v34
v_permlane32_swap_b32 v33,v35
s_waitcnt lgkmcnt(15)
v_permlane32_swap_b32 v36,v38
v_permlane32_swap_b32 v37,v39
s_waitcnt lgkmcnt(15)
v_permlane32_swap_b32 v40,v42
v_permlane32_swap_b32 v41,v43
s_waitcnt lgkmcnt(15)
v_permlane32_swap_b32 v44,v46
v_permlane32_swap_b32 v45,v47
s_waitcnt lgkmcnt(15)
v_permlane32_swap_b32 v48,v50
v_permlane32_swap_b32 v49,v51
s_waitcnt lgkmcnt(14)
v_permlane32_swap_b32 v52,v54
v_permlane32_swap_b32 v53,v55
s_waitcnt lgkmcnt(13)
v_permlane32_swap_b32 v56,v58
v_permlane32_swap_b32 v57,v59
s_waitcnt lgkmcnt(12)
v_permlane32_swap_b32 v60,v62
v_permlane32_swap_b32 v61,v63
s_waitcnt lgkmcnt(11)
v_permlane32_swap_b32 v64,v66
v_permlane32_swap_b32 v65,v67
s_waitcnt lgkmcnt(10)
v_permlane32_swap_b32 v68,v70
v_permlane32_swap_b32 v69,v71
s_waitcnt lgkmcnt(9)
v_permlane32_swap_b32 v72,v74
v_permlane32_swap_b32 v73,v75
s_waitcnt lgkmcnt(8)
v_permlane32_swap_b32 v76,v78
v_permlane32_swap_b32 v77,v79
s_waitcnt lgkmcnt(7)
v_permlane32_swap_b32 v80,v82
v_permlane32_swap_b32 v81,v83
s_waitcnt lgkmcnt(6)
v_permlane32_swap_b32 v84,v86
v_permlane32_swap_b32 v85,v87
s_waitcnt lgkmcnt(5)
v_permlane32_swap_b32 v88,v90
v_permlane32_swap_b32 v89,v91
s_waitcnt lgkmcnt(4)
v_permlane32_swap_b32 v92,v94
v_permlane32_swap_b32 v93,v95
s_waitcnt lgkmcnt(3)
v_permlane32_swap_b32 v96,v98
v_permlane32_swap_b32 v97,v99
s_waitcnt lgkmcnt(2)
v_permlane32_swap_b32 v100,v102
v_permlane32_swap_b32 v101,v103
s_waitcnt lgkmcnt(1)
v_permlane32_swap_b32 v104,v106
v_permlane32_swap_b32 v105,v107
s_waitcnt lgkmcnt(0)
v_permlane32_swap_b32 v108,v110
v_permlane32_swap_b32 v109,v111
v_accvgpr_write_b32 a0,v0
v_accvgpr_write_b32 a1,v2
v_accvgpr_write_b32 a2,v1
v_accvgpr_write_b32 a3,v3
v_accvgpr_write_b32 a4,v4
v_accvgpr_write_b32 a5,v6
v_accvgpr_write_b32 a6,v5
v_accvgpr_write_b32 a7,v7
v_accvgpr_write_b32 a8,v8
v_accvgpr_write_b32 a9,v10
v_accvgpr_write_b32 a10,v9
v_accvgpr_write_b32 a11,v11
v_accvgpr_write_b32 a12,v12
v_accvgpr_write_b32 a13,v14
v_accvgpr_write_b32 a14,v13
v_accvgpr_write_b32 a15,v15
v_accvgpr_write_b32 a16,v16
v_accvgpr_write_b32 a17,v18
v_accvgpr_write_b32 a18,v17
v_accvgpr_write_b32 a19,v19
v_accvgpr_write_b32 a20,v20
v_accvgpr_write_b32 a21,v22
v_accvgpr_write_b32 a22,v21
v_accvgpr_write_b32 a23,v23
v_accvgpr_write_b32 a24,v24
v_accvgpr_write_b32 a25,v26
v_accvgpr_write_b32 a26,v25
v_accvgpr_write_b32 a27,v27
v_accvgpr_write_b32 a28,v28
v_accvgpr_write_b32 a29,v30
v_accvgpr_write_b32 a30,v29
v_accvgpr_write_b32 a31,v31
v_accvgpr_write_b32 a32,v32
v_accvgpr_write_b32 a33,v34
v_accvgpr_write_b32 a34,v33
v_accvgpr_write_b32 a35,v35
v_accvgpr_write_b32 a36,v36
v_accvgpr_write_b32 a37,v38
v_accvgpr_write_b32 a38,v37
v_accvgpr_write_b32 a39,v39
v_accvgpr_write_b32 a40,v40
v_accvgpr_write_b32 a41,v42
v_accvgpr_write_b32 a42,v41
v_accvgpr_write_b32 a43,v43
v_accvgpr_write_b32 a44,v44
v_accvgpr_write_b32 a45,v46
v_accvgpr_write_b32 a46,v45
v_accvgpr_write_b32 a47,v47
v_accvgpr_write_b32 a48,v48
v_accvgpr_write_b32 a49,v50
v_accvgpr_write_b32 a50,v49
v_accvgpr_write_b32 a51,v51
v_accvgpr_write_b32 a52,v52
v_accvgpr_write_b32 a53,v54
v_accvgpr_write_b32 a54,v53
v_accvgpr_write_b32 a55,v55
v_accvgpr_write_b32 a56,v56
v_accvgpr_write_b32 a57,v58
v_accvgpr_write_b32 a58,v57
v_accvgpr_write_b32 a59,v59
v_accvgpr_write_b32 a60,v60
v_accvgpr_write_b32 a61,v62
v_accvgpr_write_b32 a62,v61
v_accvgpr_write_b32 a63,v63
v_accvgpr_write_b32 a64,v64
v_accvgpr_write_b32 a65,v66
v_accvgpr_write_b32 a66,v65
v_accvgpr_write_b32 a67,v67
v_accvgpr_write_b32 a68,v68
v_accvgpr_write_b32 a69,v70
v_accvgpr_write_b32 a70,v69
v_accvgpr_write_b32 a71,v71
v_accvgpr_write_b32 a72,v72
v_accvgpr_write_b32 a73,v74
v_accvgpr_write_b32 a74,v73
v_accvgpr_write_b32 a75,v75
v_accvgpr_write_b32 a76,v76
v_accvgpr_write_b32 a77,v78
v_accvgpr_write_b32 a78,v77
v_accvgpr_write_b32 a79,v79
v_accvgpr_write_b32 a80,v80
v_accvgpr_write_b32 a81,v82
v_accvgpr_write_b32 a82,v81
v_accvgpr_write_b32 a83,v83
v_accvgpr_write_b32 a84,v84
v_accvgpr_write_b32 a85,v86
v_accvgpr_write_b32 a86,v85
v_accvgpr_write_b32 a87,v87
v_accvgpr_write_b32 a88,v88
v_accvgpr_write_b32 a89,v90
v_accvgpr_write_b32 a90,v89
v_accvgpr_write_b32 a91,v91
v_accvgpr_write_b32 a92,v92
v_accvgpr_write_b32 a93,v94
v_accvgpr_write_b32 a94,v93
v_accvgpr_write_b32 a95,v95
v_accvgpr_write_b32 a96,v96
v_accvgpr_write_b32 a97,v98
v_accvgpr_write_b32 a98,v97
v_accvgpr_write_b32 a99,v99
v_accvgpr_write_b32 a100,v100
v_accvgpr_write_b32 a101,v102
v_accvgpr_write_b32 a102,v101
v_accvgpr_write_b32 a103,v103
v_accvgpr_write_b32 a104,v104
v_accvgpr_write_b32 a105,v106
v_accvgpr_write_b32 a106,v105
v_accvgpr_write_b32 a107,v107
v_accvgpr_write_b32 a108,v108
v_accvgpr_write_b32 a109,v110
v_accvgpr_write_b32 a110,v109
v_accvgpr_write_b32 a111,v111
s_barrier
s_mov_b64 exec,0x7f
s_mov_b32 s27,0
wf_208:
buffer_load_dword v248,v198,s[8:11],s59 offen sc1
s_waitcnt vmcnt(0)
v_cmp_gt_u32 vcc,3,v248
s_cbranch_vccz wfd_209
s_sleep 1
s_add_u32 s27,s27,1
s_cmp_lt_u32 s27,32768
s_cbranch_scc1 wf_208
s_mov_b32 s38,9
wfd_209:
s_mov_b64 exec,-1
s_add_u32 s30,s100,0
s_add_u32 m0,s60,0
s_nop 0
buffer_load_dwordx4 v194,s[8:11],s30 offen sc1 lds
buffer_load_dwordx4 v194,s[8:11],s30 offen offset:1024 sc1 lds
buffer_load_dwordx4 v194,s[8:11],s30 offen offset:2048 sc1 lds
buffer_load_dwordx4 v194,s[8:11],s30 offen offset:3072 sc1 lds
s_add_u32 s30,s100,4096
s_add_u32 m0,s60,4096
s_nop 0
buffer_load_dwordx4 v194,s[8:11],s30 offen sc1 lds
buffer_load_dwordx4 v194,s[8:11],s30 offen offset:1024 sc1 lds
buffer_load_dwordx4 v194,s[8:11],s30 offen offset:2048 sc1 lds
s_mul_i32 s101,s99,458752
s_lshl_b32 s31,s98,11
s_add_u32 s101,s101,s31
s_add_u32 s101,s101,16777216
s_add_u32 s30,s100,28672
s_add_u32 m0,s60,28672
s_nop 0
buffer_load_dwordx4 v194,s[8:11],s30 offen sc1 lds
buffer_load_dwordx4 v194,s[8:11],s30 offen offset:1024 sc1 lds
buffer_load_dwordx4 v194,s[8:11],s30 offen offset:2048 sc1 lds
buffer_load_dwordx4 v194,s[8:11],s30 offen offset:3072 sc1 lds
s_add_u32 s30,s100,32768
s_add_u32 m0,s60,32768
s_nop 0
buffer_load_dwordx4 v194,s[8:11],s30 offen sc1 lds
buffer_load_dwordx4 v194,s[8:11],s30 offen offset:1024 sc1 lds
buffer_load_dwordx4 v194,s[8:11],s30 offen offset:2048 sc1 lds
s_add_u32 s30,s100,57344
s_add_u32 m0,s60,57344
s_nop 0
buffer_load_dwordx4 v194,s[8:11],s30 offen sc1 lds
buffer_load_dwordx4 v194,s[8:11],s30 offen offset:1024 sc1 lds
buffer_load_dwordx4 v194,s[8:11],s30 offen offset:2048 sc1 lds
buffer_load_dwordx4 v194,s[8:11],s30 offen offset:3072 sc1 lds
s_add_u32 s30,s100,61440
s_add_u32 m0,s60,61440
s_nop 0
buffer_load_dwordx4 v194,s[8:11],s30 offen sc1 lds
buffer_load_dwordx4 v194,s[8:11],s30 offen offset:1024 sc1 lds
buffer_load_dwordx4 v194,s[8:11],s30 offen offset:2048 sc1 lds
s_waitcnt vmcnt(14)
s_barrier
ds_read_b128 a[112:115],v192 offset:0
ds_read_b128 a[116:119],v192 offset:1024
ds_read_b128 a[120:123],v192 offset:2048
ds_read_b128 a[124:127],v192 offset:3072
ds_read_b128 a[128:131],v192 offset:4096
ds_read_b128 a[132:135],v192 offset:5120
ds_read_b128 a[136:139],v192 offset:6144
s_waitcnt lgkmcnt(6)
v_mfma_f32_32x32x16_bf16 v[112:127],a[0:3],a[112:115],0
ds_read_b128 a[140:143],v192 offset:7168
s_waitcnt lgkmcnt(6)
v_mfma_f32_32x32x16_bf16 v[112:127],a[4:7],a[116:119],v[112:127]
ds_read_b128 a[112:115],v192 offset:8192
s_waitcnt lgkmcnt(6)
v_mfma_f32_32x32x16_bf16 v[112:127],a[8:11],a[120:123],v[112:127]
ds_read_b128 a[116:119],v192 offset:9216
s_waitcnt lgkmcnt(6)
v_mfma_f32_32x32x16_bf16 v[112:127],a[12:15],a[124:127],v[112:127]
ds_read_b128 a[120:123],v192 offset:10240
s_waitcnt lgkmcnt(6)
v_mfma_f32_32x32x16_bf16 v[112:127],a[16:19],a[128:131],v[112:127]
ds_read_b128 a[124:127],v192 offset:11264
s_waitcnt lgkmcnt(6)
v_mfma_f32_32x32x16_bf16 v[112:127],a[20:23],a[132:135],v[112:127]
ds_read_b128 a[128:131],v192 offset:12288
s_waitcnt lgkmcnt(6)
v_mfma_f32_32x32x16_bf16 v[112:127],a[24:27],a[136:139],v[112:127]
ds_read_b128 a[132:135],v192 offset:13312
s_waitcnt lgkmcnt(6)
v_mfma_f32_32x32x16_bf16 v[112:127],a[28:31],a[140:143],v[112:127]
ds_read_b128 a[136:139],v192 offset:14336
s_waitcnt lgkmcnt(6)
v_mfma_f32_32x32x16_bf16 v[112:127],a[32:35],a[112:115],v[112:127]
ds_read_b128 a[140:143],v192 offset:15360
s_waitcnt lgkmcnt(6)
v_mfma_f32_32x32x16_bf16 v[112:127],a[36:39],a[116:119],v[112:127]
ds_read_b128 a[112:115],v192 offset:16384
s_waitcnt lgkmcnt(6)
v_mfma_f32_32x32x16_bf16 v[112:127],a[40:43],a[120:123],v[112:127]
ds_read_b128 a[116:119],v192 offset:17408
s_waitcnt lgkmcnt(6)
v_mfma_f32_32x32x16_bf16 v[112:127],a[44:47],a[124:127],v[112:127]
ds_read_b128 a[120:123],v192 offset:18432
s_waitcnt lgkmcnt(6)
v_mfma_f32_32x32x16_bf16 v[112:127],a[48:51],a[128:131],v[112:127]
ds_read_b128 a[124:127],v192 offset:19456
s_waitcnt lgkmcnt(6)
v_mfma_f32_32x32x16_bf16 v[112:127],a[52:55],a[132:135],v[112:127]
ds_read_b128 a[128:131],v192 offset:20480
s_waitcnt lgkmcnt(6)
v_mfma_f32_32x32x16_bf16 v[112:127],a[56:59],a[136:139],v[112:127]
ds_read_b128 a[132:135],v192 offset:21504
s_waitcnt lgkmcnt(6)
v_mfma_f32_32x32x16_bf16 v[112:127],a[60:63],a[140:143],v[112:127]
ds_read_b128 a[136:139],v192 offset:22528
s_waitcnt lgkmcnt(6)
v_mfma_f32_32x32x16_bf16 v[112:127],a[64:67],a[112:115],v[112:127]
ds_read_b128 a[140:143],v192 offset:23552
s_waitcnt lgkmcnt(6)
v_mfma_f32_32x32x16_bf16 v[112:127],a[68:71],a[116:119],v[112:127]
ds_read_b128 a[112:115],v192 offset:24576
s_waitcnt lgkmcnt(6)
v_mfma_f32_32x32x16_bf16 v[112:127],a[72:75],a[120:123],v[112:127]
ds_read_b128 a[116:119],v192 offset:25600
s_waitcnt lgkmcnt(6)
v_mfma_f32_32x32x16_bf16 v[112:127],a[76:79],a[124:127],v[112:127]
ds_read_b128 a[120:123],v192 offset:26624
s_waitcnt vmcnt(7)
s_barrier
s_waitcnt lgkmcnt(6)
v_mfma_f32_32x32x16_bf16 v[112:127],a[80:83],a[128:131],v[112:127]
ds_read_b128 a[124:127],v192 offset:27648
s_add_u32 s30,s100,86016
s_add_u32 m0,s60,86016
s_nop 0
buffer_load_dwordx4 v194,s[8:11],s30 offen sc1 lds
s_waitcnt lgkmcnt(6)
v_mfma_f32_32x32x16_bf16 v[112:127],a[84:87],a[132:135],v[112:127]
ds_read_b128 a[128:131],v192 offset:28672
s_waitcnt lgkmcnt(6)
v_mfma_f32_32x32x16_bf16 v[112:127],a[88:91],a[136:139],v[112:127]
ds_read_b128 a[132:135],v192 offset:29696
s_waitcnt lgkmcnt(6)
v_mfma_f32_32x32x16_bf16 v[112:127],a[92:95],a[140:143],v[112:127]
ds_read_b128 a[136:139],v192 offset:30720
s_waitcnt lgkmcnt(6)
v_mfma_f32_32x32x16_bf16 v[112:127],a[96:99],a[112:115],v[112:127]
ds_read_b128 a[140:143],v192 offset:31744
buffer_load_dwordx4 v194,s[8:11],s30 offen offset:1024 sc1 lds
s_waitcnt lgkmcnt(6)
v_mfma_f32_32x32x16_bf16 v[112:127],a[100:103],a[116:119],v[112:127]
ds_read_b128 a[112:115],v192 offset:32768
s_waitcnt lgkmcnt(6)
v_mfma_f32_32x32x16_bf16 v[112:127],a[104:107],a[120:123],v[112:127]
ds_read_b128 a[116:119],v192 offset:33792
s_waitcnt lgkmcnt(6)
v_mfma_f32_32x32x16_bf16 v[112:127],a[108:111],a[124:127],v[112:127]
ds_read_b128 a[120:123],v192 offset:34816
s_waitcnt lgkmcnt(6)
v_mfma_f32_32x32x16_bf16 v[128:143],a[0:3],a[128:131],0
ds_read_b128 a[124:127],v192 offset:35840
buffer_load_dwordx4 v194,s[8:11],s30 offen offset:2048 sc1 lds
s_waitcnt lgkmcnt(6)
v_mfma_f32_32x32x16_bf16 v[128:143],a[4:7],a[132:135],v[128:143]
ds_read_b128 a[128:131],v192 offset:36864
s_waitcnt lgkmcnt(6)
v_mfma_f32_32x32x16_bf16 v[128:143],a[8:11],a[136:139],v[128:143]
ds_read_b128 a[132:135],v192 offset:37888
v_cvt_pk_bf16_f32 v160,v112,v113
s_waitcnt lgkmcnt(6)
v_mfma_f32_32x32x16_bf16 v[128:143],a[12:15],a[140:143],v[128:143]
ds_read_b128 a[136:139],v192 offset:38912
v_cvt_pk_bf16_f32 v161,v114,v115
s_waitcnt lgkmcnt(6)
v_mfma_f32_32x32x16_bf16 v[128:143],a[16:19],a[112:115],v[128:143]
ds_read_b128 a[140:143],v192 offset:39936
buffer_load_dwordx4 v194,s[8:11],s30 offen offset:3072 sc1 lds
v_cvt_pk_bf16_f32 v162,v116,v117
s_waitcnt lgkmcnt(6)
v_mfma_f32_32x32x16_bf16 v[128:143],a[20:23],a[116:119],v[128:143]
ds_read_b128 a[112:115],v192 offset:40960
v_cvt_pk_bf16_f32 v163,v118,v119
s_waitcnt lgkmcnt(6)
v_mfma_f32_32x32x16_bf16 v[128:143],a[24:27],a[120:123],v[128:143]
ds_read_b128 a[116:119],v192 offset:41984
v_cvt_pk_bf16_f32 v164,v120,v121
s_waitcnt lgkmcnt(6)
v_mfma_f32_32x32x16_bf16 v[128:143],a[28:31],a[124:127],v[128:143]
ds_read_b128 a[120:123],v192 offset:43008
v_cvt_pk_bf16_f32 v165,v122,v123
s_waitcnt lgkmcnt(6)
v_mfma_f32_32x32x16_bf16 v[128:143],a[32:35],a[128:131],v[128:143]
ds_read_b128 a[124:127],v192 offset:44032
s_add_u32 s30,s100,90112
s_add_u32 m0,s60,90112
s_nop 0
buffer_load_dwordx4 v194,s[8:11],s30 offen sc1 lds
v_cvt_pk_bf16_f32 v166,v124,v125
s_waitcnt lgkmcnt(6)
v_mfma_f32_32x32x16_bf16 v[128:143],a[36:39],a[132:135],v[128:143]
ds_read_b128 a[128:131],v192 offset:45056
v_cvt_pk_bf16_f32 v167,v126,v127
s_waitcnt lgkmcnt(6)
v_mfma_f32_32x32x16_bf16 v[128:143],a[40:43],a[136:139],v[128:143]
ds_read_b128 a[132:135],v192 offset:46080
s_add_u32 s31,s101,0
s_waitcnt lgkmcnt(6)
v_mfma_f32_32x32x16_bf16 v[128:143],a[44:47],a[140:143],v[128:143]
ds_read_b128 a[136:139],v192 offset:47104
buffer_store_dwordx4 v[160:163],v192,s[8:11],s31 offen sc1
s_waitcnt lgkmcnt(6)
v_mfma_f32_32x32x16_bf16 v[128:143],a[48:51],a[112:115],v[128:143]
ds_read_b128 a[140:143],v192 offset:48128
buffer_load_dwordx4 v194,s[8:11],s30 offen offset:1024 sc1 lds
buffer_store_dwordx4 v[164:167],v192,s[8:11],s31 offen offset:1024 sc1
s_waitcnt lgkmcnt(6)
v_mfma_f32_32x32x16_bf16 v[128:143],a[52:55],a[116:119],v[128:143]
ds_read_b128 a[112:115],v192 offset:49152
s_waitcnt lgkmcnt(6)
v_mfma_f32_32x32x16_bf16 v[128:143],a[56:59],a[120:123],v[128:143]
ds_read_b128 a[116:119],v192 offset:50176
s_waitcnt lgkmcnt(6)
v_mfma_f32_32x32x16_bf16 v[128:143],a[60:63],a[124:127],v[128:143]
ds_read_b128 a[120:123],v192 offset:51200
s_waitcnt lgkmcnt(6)
v_mfma_f32_32x32x16_bf16 v[128:143],a[64:67],a[128:131],v[128:143]
ds_read_b128 a[124:127],v192 offset:52224
buffer_load_dwordx4 v194,s[8:11],s30 offen offset:2048 sc1 lds
s_waitcnt lgkmcnt(6)
v_mfma_f32_32x32x16_bf16 v[128:143],a[68:71],a[132:135],v[128:143]
ds_read_b128 a[128:131],v192 offset:53248
s_waitcnt lgkmcnt(6)
v_mfma_f32_32x32x16_bf16 v[128:143],a[72:75],a[136:139],v[128:143]
ds_read_b128 a[132:135],v192 offset:54272
s_waitcnt lgkmcnt(6)
v_mfma_f32_32x32x16_bf16 v[128:143],a[76:79],a[140:143],v[128:143]
ds_read_b128 a[136:139],v192 offset:55296
s_waitcnt vmcnt(9)
s_barrier
s_waitcnt lgkmcnt(6)
v_mfma_f32_32x32x16_bf16 v[128:143],a[80:83],a[112:115],v[128:143]
ds_read_b128 a[140:143],v192 offset:56320
s_add_u32 s30,s100,114688
s_add_u32 m0,s60,0
s_nop 0
buffer_load_dwordx4 v194,s[8:11],s30 offen sc1 lds
s_waitcnt lgkmcnt(6)
v_mfma_f32_32x32x16_bf16 v[128:143],a[84:87],a[116:119],v[128:143]
ds_read_b128 a[112:115],v193 offset:0
s_waitcnt lgkmcnt(6)
v_mfma_f32_32x32x16_bf16 v[128:143],a[88:91],a[120:123],v[128:143]
ds_read_b128 a[116:119],v193 offset:1024
s_waitcnt lgkmcnt(6)
v_mfma_f32_32x32x16_bf16 v[128:143],a[92:95],a[124:127],v[128:143]
ds_read_b128 a[120:123],v193 offset:2048
s_waitcnt lgkmcnt(6)
v_mfma_f32_32x32x16_bf16 v[128:143],a[96:99],a[128:131],v[128:143]
ds_read_b128 a[124:127],v193 offset:3072
buffer_load_dwordx4 v194,s[8:11],s30 offen offset:1024 sc1 lds
s_waitcnt lgkmcnt(6)
v_mfma_f32_32x32x16_bf16 v[128:143],a[100:103],a[132:135],v[128:143]
ds_read_b128 a[128:131],v193 offset:4096
s_waitcnt lgkmcnt(6)
v_mfma_f32_32x32x16_bf16 v[128:143],a[104:107],a[136:139],v[128:143]
ds_read_b128 a[132:135],v193 offset:5120
s_waitcnt lgkmcnt(6)
v_mfma_f32_32x32x16_bf16 v[128:143],a[108:111],a[140:143],v[128:143]
ds_read_b128 a[136:139],v193 offset:6144
s_waitcnt lgkmcnt(6)
v_mfma_f32_32x32x16_bf16 v[112:127],a[0:3],a[112:115],0
ds_read_b128 a[140:143],v193 offset:7168
buffer_load_dwordx4 v194,s[8:11],s30 offen offset:2048 sc1 lds
s_waitcnt lgkmcnt(6)
v_mfma_f32_32x32x16_bf16 v[112:127],a[4:7],a[116:119],v[112:127]
ds_read_b128 a[112:115],v193 offset:8192
s_waitcnt lgkmcnt(6)
v_mfma_f32_32x32x16_bf16 v[112:127],a[8:11],a[120:123],v[112:127]
ds_read_b128 a[116:119],v193 offset:9216
v_cvt_pk_bf16_f32 v160,v128,v129
s_waitcnt lgkmcnt(6)
v_mfma_f32_32x32x16_bf16 v[112:127],a[12:15],a[124:127],v[112:127]
ds_read_b128 a[120:123],v193 offset:10240
v_cvt_pk_bf16_f32 v161,v130,v131
s_waitcnt lgkmcnt(6)
v_mfma_f32_32x32x16_bf16 v[112:127],a[16:19],a[128:131],v[112:127]
ds_read_b128 a[124:127],v193 offset:11264
buffer_load_dwordx4 v194,s[8:11],s30 offen offset:3072 sc1 lds
v_cvt_pk_bf16_f32 v162,v132,v133
s_waitcnt lgkmcnt(6)
v_mfma_f32_32x32x16_bf16 v[112:127],a[20:23],a[132:135],v[112:127]
ds_read_b128 a[128:131],v193 offset:12288
v_cvt_pk_bf16_f32 v163,v134,v135
s_waitcnt lgkmcnt(6)
v_mfma_f32_32x32x16_bf16 v[112:127],a[24:27],a[136:139],v[112:127]
ds_read_b128 a[132:135],v193 offset:13312
v_cvt_pk_bf16_f32 v164,v136,v137
s_waitcnt lgkmcnt(6)
v_mfma_f32_32x32x16_bf16 v[112:127],a[28:31],a[140:143],v[112:127]
ds_read_b128 a[136:139],v193 offset:14336
v_cvt_pk_bf16_f32 v165,v138,v139
s_waitcnt lgkmcnt(6)
v_mfma_f32_32x32x16_bf16 v[112:127],a[32:35],a[112:115],v[112:127]
ds_read_b128 a[140:143],v193 offset:15360
s_add_u32 s30,s100,118784
s_add_u32 m0,s60,4096
s_nop 0
buffer_load_dwordx4 v194,s[8:11],s30 offen sc1 lds
v_cvt_pk_bf16_f32 v166,v140,v141
s_waitcnt lgkmcnt(6)
v_mfma_f32_32x32x16_bf16 v[112:127],a[36:39],a[116:119],v[112:127]
ds_read_b128 a[112:115],v193 offset:16384
v_cvt_pk_bf16_f32 v167,v142,v143
s_waitcnt lgkmcnt(6)
v_mfma_f32_32x32x16_bf16 v[112:127],a[40:43],a[120:123],v[112:127]
ds_read_b128 a[116:119],v193 offset:17408
s_add_u32 s31,s101,32768
s_waitcnt lgkmcnt(6)
v_mfma_f32_32x32x16_bf16 v[112:127],a[44:47],a[124:127],v[112:127]
ds_read_b128 a[120:123],v193 offset:18432
buffer_store_dwordx4 v[160:163],v192,s[8:11],s31 offen sc1
s_waitcnt lgkmcnt(6)
v_mfma_f32_32x32x16_bf16 v[112:127],a[48:51],a[128:131],v[112:127]
ds_read_b128 a[124:127],v193 offset:19456
buffer_load_dwordx4 v194,s[8:11],s30 offen offset:1024 sc1 lds
buffer_store_dwordx4 v[164:167],v192,s[8:11],s31 offen offset:1024 sc1
s_waitcnt lgkmcnt(6)
v_mfma_f32_32x32x16_bf16 v[112:127],a[52:55],a[132:135],v[112:127]
ds_read_b128 a[128:131],v193 offset:20480
s_waitcnt lgkmcnt(6)
v_mfma_f32_32x32x16_bf16 v[112:127],a[56:59],a[136:139],v[112:127]
ds_read_b128 a[132:135],v193 offset:21504
s_waitcnt lgkmcnt(6)
v_mfma_f32_32x32x16_bf16 v[112:127],a[60:63],a[140:143],v[112:127]
ds_read_b128 a[136:139],v193 offset:22528
s_waitcnt lgkmcnt(6)
v_mfma_f32_32x32x16_bf16 v[112:127],a[64:67],a[112:115],v[112:127]
ds_read_b128 a[140:143],v193 offset:23552
buffer_load_dwordx4 v194,s[8:11],s30 offen offset:2048 sc1 lds
s_waitcnt lgkmcnt(6)
v_mfma_f32_32x32x16_bf16 v[112:127],a[68:71],a[116:119],v[112:127]
ds_read_b128 a[112:115],v193 offset:24576
s_waitcnt lgkmcnt(6)
v_mfma_f32_32x32x16_bf16 v[112:127],a[72:75],a[120:123],v[112:127]
ds_read_b128 a[116:119],v193 offset:25600
s_waitcnt lgkmcnt(6)
v_mfma_f32_32x32x16_bf16 v[112:127],a[76:79],a[124:127],v[112:127]
ds_read_b128 a[120:123],v193 offset:26624
s_waitcnt vmcnt(9)
s_barrier
s_waitcnt lgkmcnt(6)
v_mfma_f32_32x32x16_bf16 v[112:127],a[80:83],a[128:131],v[112:127]
ds_read_b128 a[124:127],v193 offset:27648
s_add_u32 s30,s100,143360
s_add_u32 m0,s60,28672
s_nop 0
buffer_load_dwordx4 v194,s[8:11],s30 offen sc1 lds
s_waitcnt lgkmcnt(6)
v_mfma_f32_32x32x16_bf16 v[112:127],a[84:87],a[132:135],v[112:127]
ds_read_b128 a[128:131],v193 offset:28672
s_waitcnt lgkmcnt(6)
v_mfma_f32_32x32x16_bf16 v[112:127],a[88:91],a[136:139],v[112:127]
ds_read_b128 a[132:135],v193 offset:29696
s_waitcnt lgkmcnt(6)
v_mfma_f32_32x32x16_bf16 v[112:127],a[92:95],a[140:143],v[112:127]
ds_read_b128 a[136:139],v193 offset:30720
s_waitcnt lgkmcnt(6)
v_mfma_f32_32x32x16_bf16 v[112:127],a[96:99],a[112:115],v[112:127]
ds_read_b128 a[140:143],v193 offset:31744
buffer_load_dwordx4 v194,s[8:11],s30 offen offset:1024 sc1 lds
s_waitcnt lgkmcnt(6)
v_mfma_f32_32x32x16_bf16 v[112:127],a[100:103],a[116:119],v[112:127]
ds_read_b128 a[112:115],v193 offset:32768
s_waitcnt lgkmcnt(6)
v_mfma_f32_32x32x16_bf16 v[112:127],a[104:107],a[120:123],v[112:127]
ds_read_b128 a[116:119],v193 offset:33792
s_waitcnt lgkmcnt(6)
v_mfma_f32_32x32x16_bf16 v[112:127],a[108:111],a[124:127],v[112:127]
ds_read_b128 a[120:123],v193 offset:34816
s_waitcnt lgkmcnt(6)
v_mfma_f32_32x32x16_bf16 v[128:143],a[0:3],a[128:131],0
ds_read_b128 a[124:127],v193 offset:35840
buffer_load_dwordx4 v194,s[8:11],s30 offen offset:2048 sc1 lds
s_waitcnt lgkmcnt(6)
v_mfma_f32_32x32x16_bf16 v[128:143],a[4:7],a[132:135],v[128:143]
ds_read_b128 a[128:131],v193 offset:36864
s_waitcnt lgkmcnt(6)
v_mfma_f32_32x32x16_bf16 v[128:143],a[8:11],a[136:139],v[128:143]
ds_read_b128 a[132:135],v193 offset:37888
v_cvt_pk_bf16_f32 v160,v112,v113
s_waitcnt lgkmcnt(6)
v_mfma_f32_32x32x16_bf16 v[128:143],a[12:15],a[140:143],v[128:143]
ds_read_b128 a[136:139],v193 offset:38912
v_cvt_pk_bf16_f32 v161,v114,v115
s_waitcnt lgkmcnt(6)
v_mfma_f32_32x32x16_bf16 v[128:143],a[16:19],a[112:115],v[128:143]
ds_read_b128 a[140:143],v193 offset:39936
buffer_load_dwordx4 v194,s[8:11],s30 offen offset:3072 sc1 lds
v_cvt_pk_bf16_f32 v162,v116,v117
s_waitcnt lgkmcnt(6)
v_mfma_f32_32x32x16_bf16 v[128:143],a[20:23],a[116:119],v[128:143]
ds_read_b128 a[112:115],v193 offset:40960
v_cvt_pk_bf16_f32 v163,v118,v119
s_waitcnt lgkmcnt(6)
v_mfma_f32_32x32x16_bf16 v[128:143],a[24:27],a[120:123],v[128:143]
ds_read_b128 a[116:119],v193 offset:41984
v_cvt_pk_bf16_f32 v164,v120,v121
s_waitcnt lgkmcnt(6)
v_mfma_f32_32x32x16_bf16 v[128:143],a[28:31],a[124:127],v[128:143]
ds_read_b128 a[120:123],v193 offset:43008
v_cvt_pk_bf16_f32 v165,v122,v123
s_waitcnt lgkmcnt(6)
v_mfma_f32_32x32x16_bf16 v[128:143],a[32:35],a[128:131],v[128:143]
ds_read_b128 a[124:127],v193 offset:44032
s_add_u32 s30,s100,147456
s_add_u32 m0,s60,32768
s_nop 0
buffer_load_dwordx4 v194,s[8:11],s30 offen sc1 lds
v_cvt_pk_bf16_f32 v166,v124,v125
s_waitcnt lgkmcnt(6)
v_mfma_f32_32x32x16_bf16 v[128:143],a[36:39],a[132:135],v[128:143]
ds_read_b128 a[128:131],v193 offset:45056
v_cvt_pk_bf16_f32 v167,v126,v127
s_waitcnt lgkmcnt(6)
v_mfma_f32_32x32x16_bf16 v[128:143],a[40:43],a[136:139],v[128:143]
ds_read_b128 a[132:135],v193 offset:46080
s_add_u32 s31,s101,65536
s_waitcnt lgkmcnt(6)
v_mfma_f32_32x32x16_bf16 v[128:143],a[44:47],a[140:143],v[128:143]
ds_read_b128 a[136:139],v193 offset:47104
buffer_store_dwordx4 v[160:163],v192,s[8:11],s31 offen sc1
s_waitcnt lgkmcnt(6)
v_mfma_f32_32x32x16_bf16 v[128:143],a[48:51],a[112:115],v[128:143]
ds_read_b128 a[140:143],v193 offset:48128
buffer_load_dwordx4 v194,s[8:11],s30 offen offset:1024 sc1 lds
buffer_store_dwordx4 v[164:167],v192,s[8:11],s31 offen offset:1024 sc1
s_waitcnt lgkmcnt(6)
v_mfma_f32_32x32x16_bf16 v[128:143],a[52:55],a[116:119],v[128:143]
ds_read_b128 a[112:115],v193 offset:49152
s_waitcnt lgkmcnt(6)
v_mfma_f32_32x32x16_bf16 v[128:143],a[56:59],a[120:123],v[128:143]
ds_read_b128 a[116:119],v193 offset:50176
s_waitcnt lgkmcnt(6)
v_mfma_f32_32x32x16_bf16 v[128:143],a[60:63],a[124:127],v[128:143]
ds_read_b128 a[120:123],v193 offset:51200
s_waitcnt lgkmcnt(6)
v_mfma_f32_32x32x16_bf16 v[128:143],a[64:67],a[128:131],v[128:143]
ds_read_b128 a[124:127],v193 offset:52224
buffer_load_dwordx4 v194,s[8:11],s30 offen offset:2048 sc1 lds
s_waitcnt lgkmcnt(6)
v_mfma_f32_32x32x16_bf16 v[128:143],a[68:71],a[132:135],v[128:143]
ds_read_b128 a[128:131],v193 offset:53248
s_waitcnt lgkmcnt(6)
v_mfma_f32_32x32x16_bf16 v[128:143],a[72:75],a[136:139],v[128:143]
ds_read_b128 a[132:135],v193 offset:54272
s_waitcnt lgkmcnt(6)
v_mfma_f32_32x32x16_bf16 v[128:143],a[76:79],a[140:143],v[128:143]
ds_read_b128 a[136:139],v193 offset:55296
s_waitcnt vmcnt(9)
s_barrier
s_waitcnt lgkmcnt(6)
v_mfma_f32_32x32x16_bf16 v[128:143],a[80:83],a[112:115],v[128:143]
ds_read_b128 a[140:143],v193 offset:56320
s_add_u32 s30,s100,172032
s_add_u32 m0,s60,57344
s_nop 0
buffer_load_dwordx4 v194,s[8:11],s30 offen sc1 lds
s_waitcnt lgkmcnt(6)
v_mfma_f32_32x32x16_bf16 v[128:143],a[84:87],a[116:119],v[128:143]
ds_read_b128 a[112:115],v192 offset:0
s_waitcnt lgkmcnt(6)
v_mfma_f32_32x32x16_bf16 v[128:143],a[88:91],a[120:123],v[128:143]
ds_read_b128 a[116:119],v192 offset:1024
s_waitcnt lgkmcnt(6)
v_mfma_f32_32x32x16_bf16 v[128:143],a[92:95],a[124:127],v[128:143]
ds_read_b128 a[120:123],v192 offset:2048
s_waitcnt lgkmcnt(6)
v_mfma_f32_32x32x16_bf16 v[128:143],a[96:99],a[128:131],v[128:143]
ds_read_b128 a[124:127],v192 offset:3072
buffer_load_dwordx4 v194,s[8:11],s30 offen offset:1024 sc1 lds
s_waitcnt lgkmcnt(6)
v_mfma_f32_32x32x16_bf16 v[128:143],a[100:103],a[132:135],v[128:143]
ds_read_b128 a[128:131],v192 offset:4096
s_waitcnt lgkmcnt(6)
v_mfma_f32_32x32x16_bf16 v[128:143],a[104:107],a[136:139],v[128:143]
ds_read_b128 a[132:135],v192 offset:5120
s_waitcnt lgkmcnt(6)
v_mfma_f32_32x32x16_bf16 v[128:143],a[108:111],a[140:143],v[128:143]
ds_read_b128 a[136:139],v192 offset:6144
s_waitcnt lgkmcnt(6)
v_mfma_f32_32x32x16_bf16 v[112:127],a[0:3],a[112:115],0
ds_read_b128 a[140:143],v192 offset:7168
buffer_load_dwordx4 v194,s[8:11],s30 offen offset:2048 sc1 lds
s_waitcnt lgkmcnt(6)
v_mfma_f32_32x32x16_bf16 v[112:127],a[4:7],a[116:119],v[112:127]
ds_read_b128 a[112:115],v192 offset:8192
s_waitcnt lgkmcnt(6)
v_mfma_f32_32x32x16_bf16 v[112:127],a[8:11],a[120:123],v[112:127]
ds_read_b128 a[116:119],v192 offset:9216
v_cvt_pk_bf16_f32 v160,v128,v129
s_waitcnt lgkmcnt(6)
v_mfma_f32_32x32x16_bf16 v[112:127],a[12:15],a[124:127],v[112:127]
ds_read_b128 a[120:123],v192 offset:10240
v_cvt_pk_bf16_f32 v161,v130,v131
s_waitcnt lgkmcnt(6)
v_mfma_f32_32x32x16_bf16 v[112:127],a[16:19],a[128:131],v[112:127]
ds_read_b128 a[124:127],v192 offset:11264
buffer_load_dwordx4 v194,s[8:11],s30 offen offset:3072 sc1 lds
v_cvt_pk_bf16_f32 v162,v132,v133
s_waitcnt lgkmcnt(6)
v_mfma_f32_32x32x16_bf16 v[112:127],a[20:23],a[132:135],v[112:127]
ds_read_b128 a[128:131],v192 offset:12288
v_cvt_pk_bf16_f32 v163,v134,v135
s_waitcnt lgkmcnt(6)
v_mfma_f32_32x32x16_bf16 v[112:127],a[24:27],a[136:139],v[112:127]
ds_read_b128 a[132:135],v192 offset:13312
v_cvt_pk_bf16_f32 v164,v136,v137
s_waitcnt lgkmcnt(6)
v_mfma_f32_32x32x16_bf16 v[112:127],a[28:31],a[140:143],v[112:127]
ds_read_b128 a[136:139],v192 offset:14336
v_cvt_pk_bf16_f32 v165,v138,v139
s_waitcnt lgkmcnt(6)
v_mfma_f32_32x32x16_bf16 v[112:127],a[32:35],a[112:115],v[112:127]
ds_read_b128 a[140:143],v192 offset:15360
s_add_u32 s30,s100,176128
s_add_u32 m0,s60,61440
s_nop 0
buffer_load_dwordx4 v194,s[8:11],s30 offen sc1 lds
v_cvt_pk_bf16_f32 v166,v140,v141
s_waitcnt lgkmcnt(6)
v_mfma_f32_32x32x16_bf16 v[112:127],a[36:39],a[116:119],v[112:127]
ds_read_b128 a[112:115],v192 offset:16384
v_cvt_pk_bf16_f32 v167,v142,v143
s_waitcnt lgkmcnt(6)
v_mfma_f32_32x32x16_bf16 v[112:127],a[40:43],a[120:123],v[112:127]
ds_read_b128 a[116:119],v192 offset:17408
s_add_u32 s31,s101,98304
s_waitcnt lgkmcnt(6)
v_mfma_f32_32x32x16_bf16 v[112:127],a[44:47],a[124:127],v[112:127]
ds_read_b128 a[120:123],v192 offset:18432
buffer_store_dwordx4 v[160:163],v192,s[8:11],s31 offen sc1
s_waitcnt lgkmcnt(6)
v_mfma_f32_32x32x16_bf16 v[112:127],a[48:51],a[128:131],v[112:127]
ds_read_b128 a[124:127],v192 offset:19456
buffer_load_dwordx4 v194,s[8:11],s30 offen offset:1024 sc1 lds
buffer_store_dwordx4 v[164:167],v192,s[8:11],s31 offen offset:1024 sc1
s_waitcnt lgkmcnt(6)
v_mfma_f32_32x32x16_bf16 v[112:127],a[52:55],a[132:135],v[112:127]
ds_read_b128 a[128:131],v192 offset:20480
s_waitcnt lgkmcnt(6)
v_mfma_f32_32x32x16_bf16 v[112:127],a[56:59],a[136:139],v[112:127]
ds_read_b128 a[132:135],v192 offset:21504
s_waitcnt lgkmcnt(6)
v_mfma_f32_32x32x16_bf16 v[112:127],a[60:63],a[140:143],v[112:127]
ds_read_b128 a[136:139],v192 offset:22528
s_waitcnt lgkmcnt(6)
v_mfma_f32_32x32x16_bf16 v[112:127],a[64:67],a[112:115],v[112:127]
ds_read_b128 a[140:143],v192 offset:23552
buffer_load_dwordx4 v194,s[8:11],s30 offen offset:2048 sc1 lds
s_waitcnt lgkmcnt(6)
v_mfma_f32_32x32x16_bf16 v[112:127],a[68:71],a[116:119],v[112:127]
ds_read_b128 a[112:115],v192 offset:24576
s_waitcnt lgkmcnt(6)
v_mfma_f32_32x32x16_bf16 v[112:127],a[72:75],a[120:123],v[112:127]
ds_read_b128 a[116:119],v192 offset:25600
s_waitcnt lgkmcnt(6)
v_mfma_f32_32x32x16_bf16 v[112:127],a[76:79],a[124:127],v[112:127]
ds_read_b128 a[120:123],v192 offset:26624
s_waitcnt vmcnt(9)
s_barrier
s_waitcnt lgkmcnt(6)
v_mfma_f32_32x32x16_bf16 v[112:127],a[80:83],a[128:131],v[112:127]
ds_read_b128 a[124:127],v192 offset:27648
s_add_u32 s30,s100,200704
s_add_u32 m0,s60,86016
s_nop 0
buffer_load_dwordx4 v194,s[8:11],s30 offen sc1 lds
s_waitcnt lgkmcnt(6)
v_mfma_f32_32x32x16_bf16 v[112:127],a[84:87],a[132:135],v[112:127]
ds_read_b128 a[128:131],v192 offset:28672
s_waitcnt lgkmcnt(6)
v_mfma_f32_32x32x16_bf16 v[112:127],a[88:91],a[136:139],v[112:127]
ds_read_b128 a[132:135],v192 offset:29696
s_waitcnt lgkmcnt(6)
v_mfma_f32_32x32x16_bf16 v[112:127],a[92:95],a[140:143],v[112:127]
ds_read_b128 a[136:139],v192 offset:30720
s_waitcnt lgkmcnt(6)
v_mfma_f32_32x32x16_bf16 v[112:127],a[96:99],a[112:115],v[112:127]
ds_read_b128 a[140:143],v192 offset:31744
buffer_load_dwordx4 v194,s[8:11],s30 offen offset:1024 sc1 lds
s_waitcnt lgkmcnt(6)
v_mfma_f32_32x32x16_bf16 v[112:127],a[100:103],a[116:119],v[112:127]
ds_read_b128 a[112:115],v192 offset:32768
s_waitcnt lgkmcnt(6)
v_mfma_f32_32x32x16_bf16 v[112:127],a[104:107],a[120:123],v[112:127]
ds_read_b128 a[116:119],v192 offset:33792
s_waitcnt lgkmcnt(6)
v_mfma_f32_32x32x16_bf16 v[112:127],a[108:111],a[124:127],v[112:127]
ds_read_b128 a[120:123],v192 offset:34816
s_waitcnt lgkmcnt(6)
v_mfma_f32_32x32x16_bf16 v[128:143],a[0:3],a[128:131],0
ds_read_b128 a[124:127],v192 offset:35840
buffer_load_dwordx4 v194,s[8:11],s30 offen offset:2048 sc1 lds
s_waitcnt lgkmcnt(6)
v_mfma_f32_32x32x16_bf16 v[128:143],a[4:7],a[132:135],v[128:143]
ds_read_b128 a[128:131],v192 offset:36864
s_waitcnt lgkmcnt(6)
v_mfma_f32_32x32x16_bf16 v[128:143],a[8:11],a[136:139],v[128:143]
ds_read_b128 a[132:135],v192 offset:37888
v_cvt_pk_bf16_f32 v160,v112,v113
s_waitcnt lgkmcnt(6)
v_mfma_f32_32x32x16_bf16 v[128:143],a[12:15],a[140:143],v[128:143]
ds_read_b128 a[136:139],v192 offset:38912
v_cvt_pk_bf16_f32 v161,v114,v115
s_waitcnt lgkmcnt(6)
v_mfma_f32_32x32x16_bf16 v[128:143],a[16:19],a[112:115],v[128:143]
ds_read_b128 a[140:143],v192 offset:39936
buffer_load_dwordx4 v194,s[8:11],s30 offen offset:3072 sc1 lds
v_cvt_pk_bf16_f32 v162,v116,v117
s_waitcnt lgkmcnt(6)
v_mfma_f32_32x32x16_bf16 v[128:143],a[20:23],a[116:119],v[128:143]
ds_read_b128 a[112:115],v192 offset:40960
v_cvt_pk_bf16_f32 v163,v118,v119
s_waitcnt lgkmcnt(6)
v_mfma_f32_32x32x16_bf16 v[128:143],a[24:27],a[120:123],v[128:143]
ds_read_b128 a[116:119],v192 offset:41984
v_cvt_pk_bf16_f32 v164,v120,v121
s_waitcnt lgkmcnt(6)
v_mfma_f32_32x32x16_bf16 v[128:143],a[28:31],a[124:127],v[128:143]
ds_read_b128 a[120:123],v192 offset:43008
v_cvt_pk_bf16_f32 v165,v122,v123
s_waitcnt lgkmcnt(6)
v_mfma_f32_32x32x16_bf16 v[128:143],a[32:35],a[128:131],v[128:143]
ds_read_b128 a[124:127],v192 offset:44032
s_add_u32 s30,s100,204800
s_add_u32 m0,s60,90112
s_nop 0
buffer_load_dwordx4 v194,s[8:11],s30 offen sc1 lds
v_cvt_pk_bf16_f32 v166,v124,v125
s_waitcnt lgkmcnt(6)
v_mfma_f32_32x32x16_bf16 v[128:143],a[36:39],a[132:135],v[128:143]
ds_read_b128 a[128:131],v192 offset:45056
v_cvt_pk_bf16_f32 v167,v126,v127
s_waitcnt lgkmcnt(6)
v_mfma_f32_32x32x16_bf16 v[128:143],a[40:43],a[136:139],v[128:143]
ds_read_b128 a[132:135],v192 offset:46080
s_add_u32 s31,s101,131072
s_waitcnt lgkmcnt(6)
v_mfma_f32_32x32x16_bf16 v[128:143],a[44:47],a[140:143],v[128:143]
ds_read_b128 a[136:139],v192 offset:47104
buffer_store_dwordx4 v[160:163],v192,s[8:11],s31 offen sc1
s_waitcnt lgkmcnt(6)
v_mfma_f32_32x32x16_bf16 v[128:143],a[48:51],a[112:115],v[128:143]
ds_read_b128 a[140:143],v192 offset:48128
buffer_load_dwordx4 v194,s[8:11],s30 offen offset:1024 sc1 lds
buffer_store_dwordx4 v[164:167],v192,s[8:11],s31 offen offset:1024 sc1
s_waitcnt lgkmcnt(6)
v_mfma_f32_32x32x16_bf16 v[128:143],a[52:55],a[116:119],v[128:143]
ds_read_b128 a[112:115],v192 offset:49152
s_waitcnt lgkmcnt(6)
v_mfma_f32_32x32x16_bf16 v[128:143],a[56:59],a[120:123],v[128:143]
ds_read_b128 a[116:119],v192 offset:50176
s_waitcnt lgkmcnt(6)
v_mfma_f32_32x32x16_bf16 v[128:143],a[60:63],a[124:127],v[128:143]
ds_read_b128 a[120:123],v192 offset:51200
s_waitcnt lgkmcnt(6)
v_mfma_f32_32x32x16_bf16 v[128:143],a[64:67],a[128:131],v[128:143]
ds_read_b128 a[124:127],v192 offset:52224
buffer_load_dwordx4 v194,s[8:11],s30 offen offset:2048 sc1 lds
s_waitcnt lgkmcnt(6)
v_mfma_f32_32x32x16_bf16 v[128:143],a[68:71],a[132:135],v[128:143]
ds_read_b128 a[128:131],v192 offset:53248
s_waitcnt lgkmcnt(6)
v_mfma_f32_32x32x16_bf16 v[128:143],a[72:75],a[136:139],v[128:143]
ds_read_b128 a[132:135],v192 offset:54272
s_waitcnt lgkmcnt(6)
v_mfma_f32_32x32x16_bf16 v[128:143],a[76:79],a[140:143],v[128:143]
ds_read_b128 a[136:139],v192 offset:55296
s_waitcnt vmcnt(9)
s_barrier
s_waitcnt lgkmcnt(6)
v_mfma_f32_32x32x16_bf16 v[128:143],a[80:83],a[112:115],v[128:143]
ds_read_b128 a[140:143],v192 offset:56320
s_add_u32 s30,s100,229376
s_add_u32 m0,s60,0
s_nop 0
buffer_load_dwordx4 v194,s[8:11],s30 offen sc1 lds
s_waitcnt lgkmcnt(6)
v_mfma_f32_32x32x16_bf16 v[128:143],a[84:87],a[116:119],v[128:143]
ds_read_b128 a[112:115],v193 offset:0
s_waitcnt lgkmcnt(6)
v_mfma_f32_32x32x16_bf16 v[128:143],a[88:91],a[120:123],v[128:143]
ds_read_b128 a[116:119],v193 offset:1024
s_waitcnt lgkmcnt(6)
v_mfma_f32_32x32x16_bf16 v[128:143],a[92:95],a[124:127],v[128:143]
ds_read_b128 a[120:123],v193 offset:2048
s_waitcnt lgkmcnt(6)
v_mfma_f32_32x32x16_bf16 v[128:143],a[96:99],a[128:131],v[128:143]
ds_read_b128 a[124:127],v193 offset:3072
buffer_load_dwordx4 v194,s[8:11],s30 offen offset:1024 sc1 lds
s_waitcnt lgkmcnt(6)
v_mfma_f32_32x32x16_bf16 v[128:143],a[100:103],a[132:135],v[128:143]
ds_read_b128 a[128:131],v193 offset:4096
s_waitcnt lgkmcnt(6)
v_mfma_f32_32x32x16_bf16 v[128:143],a[104:107],a[136:139],v[128:143]
ds_read_b128 a[132:135],v193 offset:5120
s_waitcnt lgkmcnt(6)
v_mfma_f32_32x32x16_bf16 v[128:143],a[108:111],a[140:143],v[128:143]
ds_read_b128 a[136:139],v193 offset:6144
s_waitcnt lgkmcnt(6)
v_mfma_f32_32x32x16_bf16 v[112:127],a[0:3],a[112:115],0
ds_read_b128 a[140:143],v193 offset:7168
buffer_load_dwordx4 v194,s[8:11],s30 offen offset:2048 sc1 lds
s_waitcnt lgkmcnt(6)
v_mfma_f32_32x32x16_bf16 v[112:127],a[4:7],a[116:119],v[112:127]
ds_read_b128 a[112:115],v193 offset:8192
s_waitcnt lgkmcnt(6)
v_mfma_f32_32x32x16_bf16 v[112:127],a[8:11],a[120:123],v[112:127]
ds_read_b128 a[116:119],v193 offset:9216
v_cvt_pk_bf16_f32 v160,v128,v129
s_waitcnt lgkmcnt(6)
v_mfma_f32_32x32x16_bf16 v[112:127],a[12:15],a[124:127],v[112:127]
ds_read_b128 a[120:123],v193 offset:10240
v_cvt_pk_bf16_f32 v161,v130,v131
s_waitcnt lgkmcnt(6)
v_mfma_f32_32x32x16_bf16 v[112:127],a[16:19],a[128:131],v[112:127]
ds_read_b128 a[124:127],v193 offset:11264
buffer_load_dwordx4 v194,s[8:11],s30 offen offset:3072 sc1 lds
v_cvt_pk_bf16_f32 v162,v132,v133
s_waitcnt lgkmcnt(6)
v_mfma_f32_32x32x16_bf16 v[112:127],a[20:23],a[132:135],v[112:127]
ds_read_b128 a[128:131],v193 offset:12288
v_cvt_pk_bf16_f32 v163,v134,v135
s_waitcnt lgkmcnt(6)
v_mfma_f32_32x32x16_bf16 v[112:127],a[24:27],a[136:139],v[112:127]
ds_read_b128 a[132:135],v193 offset:13312
v_cvt_pk_bf16_f32 v164,v136,v137
s_waitcnt lgkmcnt(6)
v_mfma_f32_32x32x16_bf16 v[112:127],a[28:31],a[140:143],v[112:127]
ds_read_b128 a[136:139],v193 offset:14336
v_cvt_pk_bf16_f32 v165,v138,v139
s_waitcnt lgkmcnt(6)
v_mfma_f32_32x32x16_bf16 v[112:127],a[32:35],a[112:115],v[112:127]
ds_read_b128 a[140:143],v193 offset:15360
s_add_u32 s30,s100,233472
s_add_u32 m0,s60,4096
s_nop 0
buffer_load_dwordx4 v194,s[8:11],s30 offen sc1 lds
v_cvt_pk_bf16_f32 v166,v140,v141
s_waitcnt lgkmcnt(6)
v_mfma_f32_32x32x16_bf16 v[112:127],a[36:39],a[116:119],v[112:127]
ds_read_b128 a[112:115],v193 offset:16384
v_cvt_pk_bf16_f32 v167,v142,v143
s_waitcnt lgkmcnt(6)
v_mfma_f32_32x32x16_bf16 v[112:127],a[40:43],a[120:123],v[112:127]
ds_read_b128 a[116:119],v193 offset:17408
s_add_u32 s31,s101,163840
s_waitcnt lgkmcnt(6)
v_mfma_f32_32x32x16_bf16 v[112:127],a[44:47],a[124:127],v[112:127]
ds_read_b128 a[120:123],v193 offset:18432
buffer_store_dwordx4 v[160:163],v192,s[8:11],s31 offen sc1
s_waitcnt lgkmcnt(6)
v_mfma_f32_32x32x16_bf16 v[112:127],a[48:51],a[128:131],v[112:127]
ds_read_b128 a[124:127],v193 offset:19456
buffer_load_dwordx4 v194,s[8:11],s30 offen offset:1024 sc1 lds
buffer_store_dwordx4 v[164:167],v192,s[8:11],s31 offen offset:1024 sc1
s_waitcnt lgkmcnt(6)
v_mfma_f32_32x32x16_bf16 v[112:127],a[52:55],a[132:135],v[112:127]
ds_read_b128 a[128:131],v193 offset:20480
s_waitcnt lgkmcnt(6)
v_mfma_f32_32x32x16_bf16 v[112:127],a[56:59],a[136:139],v[112:127]
ds_read_b128 a[132:135],v193 offset:21504
s_waitcnt lgkmcnt(6)
v_mfma_f32_32x32x16_bf16 v[112:127],a[60:63],a[140:143],v[112:127]
ds_read_b128 a[136:139],v193 offset:22528
s_waitcnt lgkmcnt(6)
v_mfma_f32_32x32x16_bf16 v[112:127],a[64:67],a[112:115],v[112:127]
ds_read_b128 a[140:143],v193 offset:23552
buffer_load_dwordx4 v194,s[8:11],s30 offen offset:2048 sc1 lds
s_waitcnt lgkmcnt(6)
v_mfma_f32_32x32x16_bf16 v[112:127],a[68:71],a[116:119],v[112:127]
ds_read_b128 a[112:115],v193 offset:24576
s_waitcnt lgkmcnt(6)
v_mfma_f32_32x32x16_bf16 v[112:127],a[72:75],a[120:123],v[112:127]
ds_read_b128 a[116:119],v193 offset:25600
s_waitcnt lgkmcnt(6)
v_mfma_f32_32x32x16_bf16 v[112:127],a[76:79],a[124:127],v[112:127]
ds_read_b128 a[120:123],v193 offset:26624
s_waitcnt vmcnt(9)
s_barrier
s_waitcnt lgkmcnt(6)
v_mfma_f32_32x32x16_bf16 v[112:127],a[80:83],a[128:131],v[112:127]
ds_read_b128 a[124:127],v193 offset:27648
s_add_u32 s30,s100,258048
s_add_u32 m0,s60,28672
s_nop 0
buffer_load_dwordx4 v194,s[8:11],s30 offen sc1 lds
s_waitcnt lgkmcnt(6)
v_mfma_f32_32x32x16_bf16 v[112:127],a[84:87],a[132:135],v[112:127]
ds_read_b128 a[128:131],v193 offset:28672
s_waitcnt lgkmcnt(6)
v_mfma_f32_32x32x16_bf16 v[112:127],a[88:91],a[136:139],v[112:127]
ds_read_b128 a[132:135],v193 offset:29696
s_waitcnt lgkmcnt(6)
v_mfma_f32_32x32x16_bf16 v[112:127],a[92:95],a[140:143],v[112:127]
ds_read_b128 a[136:139],v193 offset:30720
s_waitcnt lgkmcnt(6)
v_mfma_f32_32x32x16_bf16 v[112:127],a[96:99],a[112:115],v[112:127]
ds_read_b128 a[140:143],v193 offset:31744
buffer_load_dwordx4 v194,s[8:11],s30 offen offset:1024 sc1 lds
s_waitcnt lgkmcnt(6)
v_mfma_f32_32x32x16_bf16 v[112:127],a[100:103],a[116:119],v[112:127]
ds_read_b128 a[112:115],v193 offset:32768
s_waitcnt lgkmcnt(6)
v_mfma_f32_32x32x16_bf16 v[112:127],a[104:107],a[120:123],v[112:127]
ds_read_b128 a[116:119],v193 offset:33792
s_waitcnt lgkmcnt(6)
v_mfma_f32_32x32x16_bf16 v[112:127],a[108:111],a[124:127],v[112:127]
ds_read_b128 a[120:123],v193 offset:34816
s_waitcnt lgkmcnt(6)
v_mfma_f32_32x32x16_bf16 v[128:143],a[0:3],a[128:131],0
ds_read_b128 a[124:127],v193 offset:35840
buffer_load_dwordx4 v194,s[8:11],s30 offen offset:2048 sc1 lds
s_waitcnt lgkmcnt(6)
v_mfma_f32_32x32x16_bf16 v[128:143],a[4:7],a[132:135],v[128:143]
ds_read_b128 a[128:131],v193 offset:36864
s_waitcnt lgkmcnt(6)
v_mfma_f32_32x32x16_bf16 v[128:143],a[8:11],a[136:139],v[128:143]
ds_read_b128 a[132:135],v193 offset:37888
v_cvt_pk_bf16_f32 v160,v112,v113
s_waitcnt lgkmcnt(6)
v_mfma_f32_32x32x16_bf16 v[128:143],a[12:15],a[140:143],v[128:143]
ds_read_b128 a[136:139],v193 offset:38912
v_cvt_pk_bf16_f32 v161,v114,v115
s_waitcnt lgkmcnt(6)
v_mfma_f32_32x32x16_bf16 v[128:143],a[16:19],a[112:115],v[128:143]
ds_read_b128 a[140:143],v193 offset:39936
buffer_load_dwordx4 v194,s[8:11],s30 offen offset:3072 sc1 lds
v_cvt_pk_bf16_f32 v162,v116,v117
s_waitcnt lgkmcnt(6)
v_mfma_f32_32x32x16_bf16 v[128:143],a[20:23],a[116:119],v[128:143]
ds_read_b128 a[112:115],v193 offset:40960
v_cvt_pk_bf16_f32 v163,v118,v119
s_waitcnt lgkmcnt(6)
v_mfma_f32_32x32x16_bf16 v[128:143],a[24:27],a[120:123],v[128:143]
ds_read_b128 a[116:119],v193 offset:41984
v_cvt_pk_bf16_f32 v164,v120,v121
s_waitcnt lgkmcnt(6)
v_mfma_f32_32x32x16_bf16 v[128:143],a[28:31],a[124:127],v[128:143]
ds_read_b128 a[120:123],v193 offset:43008
v_cvt_pk_bf16_f32 v165,v122,v123
s_waitcnt lgkmcnt(6)
v_mfma_f32_32x32x16_bf16 v[128:143],a[32:35],a[128:131],v[128:143]
ds_read_b128 a[124:127],v193 offset:44032
s_add_u32 s30,s100,262144
s_add_u32 m0,s60,32768
s_nop 0
buffer_load_dwordx4 v194,s[8:11],s30 offen sc1 lds
v_cvt_pk_bf16_f32 v166,v124,v125
s_waitcnt lgkmcnt(6)
v_mfma_f32_32x32x16_bf16 v[128:143],a[36:39],a[132:135],v[128:143]
ds_read_b128 a[128:131],v193 offset:45056
v_cvt_pk_bf16_f32 v167,v126,v127
s_waitcnt lgkmcnt(6)
v_mfma_f32_32x32x16_bf16 v[128:143],a[40:43],a[136:139],v[128:143]
ds_read_b128 a[132:135],v193 offset:46080
s_add_u32 s31,s101,196608
s_waitcnt lgkmcnt(6)
v_mfma_f32_32x32x16_bf16 v[128:143],a[44:47],a[140:143],v[128:143]
ds_read_b128 a[136:139],v193 offset:47104
buffer_store_dwordx4 v[160:163],v192,s[8:11],s31 offen sc1
s_waitcnt lgkmcnt(6)
v_mfma_f32_32x32x16_bf16 v[128:143],a[48:51],a[112:115],v[128:143]
ds_read_b128 a[140:143],v193 offset:48128
buffer_load_dwordx4 v194,s[8:11],s30 offen offset:1024 sc1 lds
buffer_store_dwordx4 v[164:167],v192,s[8:11],s31 offen offset:1024 sc1
s_waitcnt lgkmcnt(6)
v_mfma_f32_32x32x16_bf16 v[128:143],a[52:55],a[116:119],v[128:143]
ds_read_b128 a[112:115],v193 offset:49152
s_waitcnt lgkmcnt(6)
v_mfma_f32_32x32x16_bf16 v[128:143],a[56:59],a[120:123],v[128:143]
ds_read_b128 a[116:119],v193 offset:50176
s_waitcnt lgkmcnt(6)
v_mfma_f32_32x32x16_bf16 v[128:143],a[60:63],a[124:127],v[128:143]
ds_read_b128 a[120:123],v193 offset:51200
s_waitcnt lgkmcnt(6)
v_mfma_f32_32x32x16_bf16 v[128:143],a[64:67],a[128:131],v[128:143]
ds_read_b128 a[124:127],v193 offset:52224
buffer_load_dwordx4 v194,s[8:11],s30 offen offset:2048 sc1 lds
s_waitcnt lgkmcnt(6)
v_mfma_f32_32x32x16_bf16 v[128:143],a[68:71],a[132:135],v[128:143]
ds_read_b128 a[128:131],v193 offset:53248
s_waitcnt lgkmcnt(6)
v_mfma_f32_32x32x16_bf16 v[128:143],a[72:75],a[136:139],v[128:143]
ds_read_b128 a[132:135],v193 offset:54272
s_waitcnt lgkmcnt(6)
v_mfma_f32_32x32x16_bf16 v[128:143],a[76:79],a[140:143],v[128:143]
ds_read_b128 a[136:139],v193 offset:55296
s_waitcnt vmcnt(9)
s_barrier
s_waitcnt lgkmcnt(6)
v_mfma_f32_32x32x16_bf16 v[128:143],a[80:83],a[112:115],v[128:143]
ds_read_b128 a[140:143],v193 offset:56320
s_add_u32 s30,s100,286720
s_add_u32 m0,s60,57344
s_nop 0
buffer_load_dwordx4 v194,s[8:11],s30 offen sc1 lds
s_waitcnt lgkmcnt(6)
v_mfma_f32_32x32x16_bf16 v[128:143],a[84:87],a[116:119],v[128:143]
ds_read_b128 a[112:115],v192 offset:0
s_waitcnt lgkmcnt(6)
v_mfma_f32_32x32x16_bf16 v[128:143],a[88:91],a[120:123],v[128:143]
ds_read_b128 a[116:119],v192 offset:1024
s_waitcnt lgkmcnt(6)
v_mfma_f32_32x32x16_bf16 v[128:143],a[92:95],a[124:127],v[128:143]
ds_read_b128 a[120:123],v192 offset:2048
s_waitcnt lgkmcnt(6)
v_mfma_f32_32x32x16_bf16 v[128:143],a[96:99],a[128:131],v[128:143]
ds_read_b128 a[124:127],v192 offset:3072
buffer_load_dwordx4 v194,s[8:11],s30 offen offset:1024 sc1 lds
s_waitcnt lgkmcnt(6)
v_mfma_f32_32x32x16_bf16 v[128:143],a[100:103],a[132:135],v[128:143]
ds_read_b128 a[128:131],v192 offset:4096
s_waitcnt lgkmcnt(6)
v_mfma_f32_32x32x16_bf16 v[128:143],a[104:107],a[136:139],v[128:143]
ds_read_b128 a[132:135],v192 offset:5120
s_waitcnt lgkmcnt(6)
v_mfma_f32_32x32x16_bf16 v[128:143],a[108:111],a[140:143],v[128:143]
ds_read_b128 a[136:139],v192 offset:6144
s_waitcnt lgkmcnt(6)
v_mfma_f32_32x32x16_bf16 v[112:127],a[0:3],a[112:115],0
ds_read_b128 a[140:143],v192 offset:7168
buffer_load_dwordx4 v194,s[8:11],s30 offen offset:2048 sc1 lds
s_waitcnt lgkmcnt(6)
v_mfma_f32_32x32x16_bf16 v[112:127],a[4:7],a[116:119],v[112:127]
ds_read_b128 a[112:115],v192 offset:8192
s_waitcnt lgkmcnt(6)
v_mfma_f32_32x32x16_bf16 v[112:127],a[8:11],a[120:123],v[112:127]
ds_read_b128 a[116:119],v192 offset:9216
v_cvt_pk_bf16_f32 v160,v128,v129
s_waitcnt lgkmcnt(6)
v_mfma_f32_32x32x16_bf16 v[112:127],a[12:15],a[124:127],v[112:127]
ds_read_b128 a[120:123],v192 offset:10240
v_cvt_pk_bf16_f32 v161,v130,v131
s_waitcnt lgkmcnt(6)
v_mfma_f32_32x32x16_bf16 v[112:127],a[16:19],a[128:131],v[112:127]
ds_read_b128 a[124:127],v192 offset:11264
buffer_load_dwordx4 v194,s[8:11],s30 offen offset:3072 sc1 lds
v_cvt_pk_bf16_f32 v162,v132,v133
s_waitcnt lgkmcnt(6)
v_mfma_f32_32x32x16_bf16 v[112:127],a[20:23],a[132:135],v[112:127]
ds_read_b128 a[128:131],v192 offset:12288
v_cvt_pk_bf16_f32 v163,v134,v135
s_waitcnt lgkmcnt(6)
v_mfma_f32_32x32x16_bf16 v[112:127],a[24:27],a[136:139],v[112:127]
ds_read_b128 a[132:135],v192 offset:13312
v_cvt_pk_bf16_f32 v164,v136,v137
s_waitcnt lgkmcnt(6)
v_mfma_f32_32x32x16_bf16 v[112:127],a[28:31],a[140:143],v[112:127]
ds_read_b128 a[136:139],v192 offset:14336
v_cvt_pk_bf16_f32 v165,v138,v139
s_waitcnt lgkmcnt(6)
v_mfma_f32_32x32x16_bf16 v[112:127],a[32:35],a[112:115],v[112:127]
ds_read_b128 a[140:143],v192 offset:15360
s_add_u32 s30,s100,290816
s_add_u32 m0,s60,61440
s_nop 0
buffer_load_dwordx4 v194,s[8:11],s30 offen sc1 lds
v_cvt_pk_bf16_f32 v166,v140,v141
s_waitcnt lgkmcnt(6)
v_mfma_f32_32x32x16_bf16 v[112:127],a[36:39],a[116:119],v[112:127]
ds_read_b128 a[112:115],v192 offset:16384
v_cvt_pk_bf16_f32 v167,v142,v143
s_waitcnt lgkmcnt(6)
v_mfma_f32_32x32x16_bf16 v[112:127],a[40:43],a[120:123],v[112:127]
ds_read_b128 a[116:119],v192 offset:17408
s_add_u32 s31,s101,229376
s_waitcnt lgkmcnt(6)
v_mfma_f32_32x32x16_bf16 v[112:127],a[44:47],a[124:127],v[112:127]
ds_read_b128 a[120:123],v192 offset:18432
buffer_store_dwordx4 v[160:163],v192,s[8:11],s31 offen sc1
s_waitcnt lgkmcnt(6)
v_mfma_f32_32x32x16_bf16 v[112:127],a[48:51],a[128:131],v[112:127]
ds_read_b128 a[124:127],v192 offset:19456
buffer_load_dwordx4 v194,s[8:11],s30 offen offset:1024 sc1 lds
buffer_store_dwordx4 v[164:167],v192,s[8:11],s31 offen offset:1024 sc1
s_waitcnt lgkmcnt(6)
v_mfma_f32_32x32x16_bf16 v[112:127],a[52:55],a[132:135],v[112:127]
ds_read_b128 a[128:131],v192 offset:20480
s_waitcnt lgkmcnt(6)
v_mfma_f32_32x32x16_bf16 v[112:127],a[56:59],a[136:139],v[112:127]
ds_read_b128 a[132:135],v192 offset:21504
s_waitcnt lgkmcnt(6)
v_mfma_f32_32x32x16_bf16 v[112:127],a[60:63],a[140:143],v[112:127]
ds_read_b128 a[136:139],v192 offset:22528
s_waitcnt lgkmcnt(6)
v_mfma_f32_32x32x16_bf16 v[112:127],a[64:67],a[112:115],v[112:127]
ds_read_b128 a[140:143],v192 offset:23552
buffer_load_dwordx4 v194,s[8:11],s30 offen offset:2048 sc1 lds
s_waitcnt lgkmcnt(6)
v_mfma_f32_32x32x16_bf16 v[112:127],a[68:71],a[116:119],v[112:127]
ds_read_b128 a[112:115],v192 offset:24576
s_waitcnt lgkmcnt(6)
v_mfma_f32_32x32x16_bf16 v[112:127],a[72:75],a[120:123],v[112:127]
ds_read_b128 a[116:119],v192 offset:25600
s_waitcnt lgkmcnt(6)
v_mfma_f32_32x32x16_bf16 v[112:127],a[76:79],a[124:127],v[112:127]
ds_read_b128 a[120:123],v192 offset:26624
s_waitcnt vmcnt(9)
s_barrier
s_waitcnt lgkmcnt(6)
v_mfma_f32_32x32x16_bf16 v[112:127],a[80:83],a[128:131],v[112:127]
ds_read_b128 a[124:127],v192 offset:27648
s_add_u32 s30,s100,315392
s_add_u32 m0,s60,86016
s_nop 0
buffer_load_dwordx4 v194,s[8:11],s30 offen sc1 lds
s_waitcnt lgkmcnt(6)
v_mfma_f32_32x32x16_bf16 v[112:127],a[84:87],a[132:135],v[112:127]
ds_read_b128 a[128:131],v192 offset:28672
s_waitcnt lgkmcnt(6)
v_mfma_f32_32x32x16_bf16 v[112:127],a[88:91],a[136:139],v[112:127]
ds_read_b128 a[132:135],v192 offset:29696
s_waitcnt lgkmcnt(6)
v_mfma_f32_32x32x16_bf16 v[112:127],a[92:95],a[140:143],v[112:127]
ds_read_b128 a[136:139],v192 offset:30720
s_waitcnt lgkmcnt(6)
v_mfma_f32_32x32x16_bf16 v[112:127],a[96:99],a[112:115],v[112:127]
ds_read_b128 a[140:143],v192 offset:31744
buffer_load_dwordx4 v194,s[8:11],s30 offen offset:1024 sc1 lds
s_waitcnt lgkmcnt(6)
v_mfma_f32_32x32x16_bf16 v[112:127],a[100:103],a[116:119],v[112:127]
ds_read_b128 a[112:115],v192 offset:32768
s_waitcnt lgkmcnt(6)
v_mfma_f32_32x32x16_bf16 v[112:127],a[104:107],a[120:123],v[112:127]
ds_read_b128 a[116:119],v192 offset:33792
s_waitcnt lgkmcnt(6)
v_mfma_f32_32x32x16_bf16 v[112:127],a[108:111],a[124:127],v[112:127]
ds_read_b128 a[120:123],v192 offset:34816
s_waitcnt lgkmcnt(6)
v_mfma_f32_32x32x16_bf16 v[128:143],a[0:3],a[128:131],0
ds_read_b128 a[124:127],v192 offset:35840
buffer_load_dwordx4 v194,s[8:11],s30 offen offset:2048 sc1 lds
s_waitcnt lgkmcnt(6)
v_mfma_f32_32x32x16_bf16 v[128:143],a[4:7],a[132:135],v[128:143]
ds_read_b128 a[128:131],v192 offset:36864
s_waitcnt lgkmcnt(6)
v_mfma_f32_32x32x16_bf16 v[128:143],a[8:11],a[136:139],v[128:143]
ds_read_b128 a[132:135],v192 offset:37888
v_cvt_pk_bf16_f32 v160,v112,v113
s_waitcnt lgkmcnt(6)
v_mfma_f32_32x32x16_bf16 v[128:143],a[12:15],a[140:143],v[128:143]
ds_read_b128 a[136:139],v192 offset:38912
v_cvt_pk_bf16_f32 v161,v114,v115
s_waitcnt lgkmcnt(6)
v_mfma_f32_32x32x16_bf16 v[128:143],a[16:19],a[112:115],v[128:143]
ds_read_b128 a[140:143],v192 offset:39936
buffer_load_dwordx4 v194,s[8:11],s30 offen offset:3072 sc1 lds
v_cvt_pk_bf16_f32 v162,v116,v117
s_waitcnt lgkmcnt(6)
v_mfma_f32_32x32x16_bf16 v[128:143],a[20:23],a[116:119],v[128:143]
ds_read_b128 a[112:115],v192 offset:40960
v_cvt_pk_bf16_f32 v163,v118,v119
s_waitcnt lgkmcnt(6)
v_mfma_f32_32x32x16_bf16 v[128:143],a[24:27],a[120:123],v[128:143]
ds_read_b128 a[116:119],v192 offset:41984
v_cvt_pk_bf16_f32 v164,v120,v121
s_waitcnt lgkmcnt(6)
v_mfma_f32_32x32x16_bf16 v[128:143],a[28:31],a[124:127],v[128:143]
ds_read_b128 a[120:123],v192 offset:43008
v_cvt_pk_bf16_f32 v165,v122,v123
s_waitcnt lgkmcnt(6)
v_mfma_f32_32x32x16_bf16 v[128:143],a[32:35],a[128:131],v[128:143]
ds_read_b128 a[124:127],v192 offset:44032
s_add_u32 s30,s100,319488
s_add_u32 m0,s60,90112
s_nop 0
buffer_load_dwordx4 v194,s[8:11],s30 offen sc1 lds
v_cvt_pk_bf16_f32 v166,v124,v125
s_waitcnt lgkmcnt(6)
v_mfma_f32_32x32x16_bf16 v[128:143],a[36:39],a[132:135],v[128:143]
ds_read_b128 a[128:131],v192 offset:45056
v_cvt_pk_bf16_f32 v167,v126,v127
s_waitcnt lgkmcnt(6)
v_mfma_f32_32x32x16_bf16 v[128:143],a[40:43],a[136:139],v[128:143]
ds_read_b128 a[132:135],v192 offset:46080
s_add_u32 s31,s101,262144
s_waitcnt lgkmcnt(6)
v_mfma_f32_32x32x16_bf16 v[128:143],a[44:47],a[140:143],v[128:143]
ds_read_b128 a[136:139],v192 offset:47104
buffer_store_dwordx4 v[160:163],v192,s[8:11],s31 offen sc1
s_waitcnt lgkmcnt(6)
v_mfma_f32_32x32x16_bf16 v[128:143],a[48:51],a[112:115],v[128:143]
ds_read_b128 a[140:143],v192 offset:48128
buffer_load_dwordx4 v194,s[8:11],s30 offen offset:1024 sc1 lds
buffer_store_dwordx4 v[164:167],v192,s[8:11],s31 offen offset:1024 sc1
s_waitcnt lgkmcnt(6)
v_mfma_f32_32x32x16_bf16 v[128:143],a[52:55],a[116:119],v[128:143]
ds_read_b128 a[112:115],v192 offset:49152
s_waitcnt lgkmcnt(6)
v_mfma_f32_32x32x16_bf16 v[128:143],a[56:59],a[120:123],v[128:143]
ds_read_b128 a[116:119],v192 offset:50176
s_waitcnt lgkmcnt(6)
v_mfma_f32_32x32x16_bf16 v[128:143],a[60:63],a[124:127],v[128:143]
ds_read_b128 a[120:123],v192 offset:51200
s_waitcnt lgkmcnt(6)
v_mfma_f32_32x32x16_bf16 v[128:143],a[64:67],a[128:131],v[128:143]
ds_read_b128 a[124:127],v192 offset:52224
buffer_load_dwordx4 v194,s[8:11],s30 offen offset:2048 sc1 lds
s_waitcnt lgkmcnt(6)
v_mfma_f32_32x32x16_bf16 v[128:143],a[68:71],a[132:135],v[128:143]
ds_read_b128 a[128:131],v192 offset:53248
s_waitcnt lgkmcnt(6)
v_mfma_f32_32x32x16_bf16 v[128:143],a[72:75],a[136:139],v[128:143]
ds_read_b128 a[132:135],v192 offset:54272
s_waitcnt lgkmcnt(6)
v_mfma_f32_32x32x16_bf16 v[128:143],a[76:79],a[140:143],v[128:143]
ds_read_b128 a[136:139],v192 offset:55296
s_waitcnt vmcnt(9)
s_barrier
s_waitcnt lgkmcnt(6)
v_mfma_f32_32x32x16_bf16 v[128:143],a[80:83],a[112:115],v[128:143]
ds_read_b128 a[140:143],v192 offset:56320
s_add_u32 s30,s100,344064
s_add_u32 m0,s60,0
s_nop 0
buffer_load_dwordx4 v194,s[8:11],s30 offen sc1 lds
s_waitcnt lgkmcnt(6)
v_mfma_f32_32x32x16_bf16 v[128:143],a[84:87],a[116:119],v[128:143]
ds_read_b128 a[112:115],v193 offset:0
s_waitcnt lgkmcnt(6)
v_mfma_f32_32x32x16_bf16 v[128:143],a[88:91],a[120:123],v[128:143]
ds_read_b128 a[116:119],v193 offset:1024
s_waitcnt lgkmcnt(6)
v_mfma_f32_32x32x16_bf16 v[128:143],a[92:95],a[124:127],v[128:143]
ds_read_b128 a[120:123],v193 offset:2048
s_waitcnt lgkmcnt(6)
v_mfma_f32_32x32x16_bf16 v[128:143],a[96:99],a[128:131],v[128:143]
ds_read_b128 a[124:127],v193 offset:3072
buffer_load_dwordx4 v194,s[8:11],s30 offen offset:1024 sc1 lds
s_waitcnt lgkmcnt(6)
v_mfma_f32_32x32x16_bf16 v[128:143],a[100:103],a[132:135],v[128:143]
ds_read_b128 a[128:131],v193 offset:4096
s_waitcnt lgkmcnt(6)
v_mfma_f32_32x32x16_bf16 v[128:143],a[104:107],a[136:139],v[128:143]
ds_read_b128 a[132:135],v193 offset:5120
s_waitcnt lgkmcnt(6)
v_mfma_f32_32x32x16_bf16 v[128:143],a[108:111],a[140:143],v[128:143]
ds_read_b128 a[136:139],v193 offset:6144
s_waitcnt lgkmcnt(6)
v_mfma_f32_32x32x16_bf16 v[112:127],a[0:3],a[112:115],0
ds_read_b128 a[140:143],v193 offset:7168
buffer_load_dwordx4 v194,s[8:11],s30 offen offset:2048 sc1 lds
s_waitcnt lgkmcnt(6)
v_mfma_f32_32x32x16_bf16 v[112:127],a[4:7],a[116:119],v[112:127]
ds_read_b128 a[112:115],v193 offset:8192
s_waitcnt lgkmcnt(6)
v_mfma_f32_32x32x16_bf16 v[112:127],a[8:11],a[120:123],v[112:127]
ds_read_b128 a[116:119],v193 offset:9216
v_cvt_pk_bf16_f32 v160,v128,v129
s_waitcnt lgkmcnt(6)
v_mfma_f32_32x32x16_bf16 v[112:127],a[12:15],a[124:127],v[112:127]
ds_read_b128 a[120:123],v193 offset:10240
v_cvt_pk_bf16_f32 v161,v130,v131
s_waitcnt lgkmcnt(6)
v_mfma_f32_32x32x16_bf16 v[112:127],a[16:19],a[128:131],v[112:127]
ds_read_b128 a[124:127],v193 offset:11264
buffer_load_dwordx4 v194,s[8:11],s30 offen offset:3072 sc1 lds
v_cvt_pk_bf16_f32 v162,v132,v133
s_waitcnt lgkmcnt(6)
v_mfma_f32_32x32x16_bf16 v[112:127],a[20:23],a[132:135],v[112:127]
ds_read_b128 a[128:131],v193 offset:12288
v_cvt_pk_bf16_f32 v163,v134,v135
s_waitcnt lgkmcnt(6)
v_mfma_f32_32x32x16_bf16 v[112:127],a[24:27],a[136:139],v[112:127]
ds_read_b128 a[132:135],v193 offset:13312
v_cvt_pk_bf16_f32 v164,v136,v137
s_waitcnt lgkmcnt(6)
v_mfma_f32_32x32x16_bf16 v[112:127],a[28:31],a[140:143],v[112:127]
ds_read_b128 a[136:139],v193 offset:14336
v_cvt_pk_bf16_f32 v165,v138,v139
s_waitcnt lgkmcnt(6)
v_mfma_f32_32x32x16_bf16 v[112:127],a[32:35],a[112:115],v[112:127]
ds_read_b128 a[140:143],v193 offset:15360
s_add_u32 s30,s100,348160
s_add_u32 m0,s60,4096
s_nop 0
buffer_load_dwordx4 v194,s[8:11],s30 offen sc1 lds
v_cvt_pk_bf16_f32 v166,v140,v141
s_waitcnt lgkmcnt(6)
v_mfma_f32_32x32x16_bf16 v[112:127],a[36:39],a[116:119],v[112:127]
ds_read_b128 a[112:115],v193 offset:16384
v_cvt_pk_bf16_f32 v167,v142,v143
s_waitcnt lgkmcnt(6)
v_mfma_f32_32x32x16_bf16 v[112:127],a[40:43],a[120:123],v[112:127]
ds_read_b128 a[116:119],v193 offset:17408
s_add_u32 s31,s101,294912
s_waitcnt lgkmcnt(6)
v_mfma_f32_32x32x16_bf16 v[112:127],a[44:47],a[124:127],v[112:127]
ds_read_b128 a[120:123],v193 offset:18432
buffer_store_dwordx4 v[160:163],v192,s[8:11],s31 offen sc1
s_waitcnt lgkmcnt(6)
v_mfma_f32_32x32x16_bf16 v[112:127],a[48:51],a[128:131],v[112:127]
ds_read_b128 a[124:127],v193 offset:19456
buffer_load_dwordx4 v194,s[8:11],s30 offen offset:1024 sc1 lds
buffer_store_dwordx4 v[164:167],v192,s[8:11],s31 offen offset:1024 sc1
s_waitcnt lgkmcnt(6)
v_mfma_f32_32x32x16_bf16 v[112:127],a[52:55],a[132:135],v[112:127]
ds_read_b128 a[128:131],v193 offset:20480
s_waitcnt lgkmcnt(6)
v_mfma_f32_32x32x16_bf16 v[112:127],a[56:59],a[136:139],v[112:127]
ds_read_b128 a[132:135],v193 offset:21504
s_waitcnt lgkmcnt(6)
v_mfma_f32_32x32x16_bf16 v[112:127],a[60:63],a[140:143],v[112:127]
ds_read_b128 a[136:139],v193 offset:22528
s_waitcnt lgkmcnt(6)
v_mfma_f32_32x32x16_bf16 v[112:127],a[64:67],a[112:115],v[112:127]
ds_read_b128 a[140:143],v193 offset:23552
buffer_load_dwordx4 v194,s[8:11],s30 offen offset:2048 sc1 lds
s_waitcnt lgkmcnt(6)
v_mfma_f32_32x32x16_bf16 v[112:127],a[68:71],a[116:119],v[112:127]
ds_read_b128 a[112:115],v193 offset:24576
s_waitcnt lgkmcnt(6)
v_mfma_f32_32x32x16_bf16 v[112:127],a[72:75],a[120:123],v[112:127]
ds_read_b128 a[116:119],v193 offset:25600
s_waitcnt lgkmcnt(6)
v_mfma_f32_32x32x16_bf16 v[112:127],a[76:79],a[124:127],v[112:127]
ds_read_b128 a[120:123],v193 offset:26624
s_waitcnt vmcnt(9)
s_barrier
s_waitcnt lgkmcnt(6)
v_mfma_f32_32x32x16_bf16 v[112:127],a[80:83],a[128:131],v[112:127]
ds_read_b128 a[124:127],v193 offset:27648
s_add_u32 s30,s100,372736
s_add_u32 m0,s60,28672
s_nop 0
buffer_load_dwordx4 v194,s[8:11],s30 offen sc1 lds
s_waitcnt lgkmcnt(6)
v_mfma_f32_32x32x16_bf16 v[112:127],a[84:87],a[132:135],v[112:127]
ds_read_b128 a[128:131],v193 offset:28672
s_waitcnt lgkmcnt(6)
v_mfma_f32_32x32x16_bf16 v[112:127],a[88:91],a[136:139],v[112:127]
ds_read_b128 a[132:135],v193 offset:29696
s_waitcnt lgkmcnt(6)
v_mfma_f32_32x32x16_bf16 v[112:127],a[92:95],a[140:143],v[112:127]
ds_read_b128 a[136:139],v193 offset:30720
s_waitcnt lgkmcnt(6)
v_mfma_f32_32x32x16_bf16 v[112:127],a[96:99],a[112:115],v[112:127]
ds_read_b128 a[140:143],v193 offset:31744
buffer_load_dwordx4 v194,s[8:11],s30 offen offset:1024 sc1 lds
s_waitcnt lgkmcnt(6)
v_mfma_f32_32x32x16_bf16 v[112:127],a[100:103],a[116:119],v[112:127]
ds_read_b128 a[112:115],v193 offset:32768
s_waitcnt lgkmcnt(6)
v_mfma_f32_32x32x16_bf16 v[112:127],a[104:107],a[120:123],v[112:127]
ds_read_b128 a[116:119],v193 offset:33792
s_waitcnt lgkmcnt(6)
v_mfma_f32_32x32x16_bf16 v[112:127],a[108:111],a[124:127],v[112:127]
ds_read_b128 a[120:123],v193 offset:34816
s_waitcnt lgkmcnt(6)
v_mfma_f32_32x32x16_bf16 v[128:143],a[0:3],a[128:131],0
ds_read_b128 a[124:127],v193 offset:35840
buffer_load_dwordx4 v194,s[8:11],s30 offen offset:2048 sc1 lds
s_waitcnt lgkmcnt(6)
v_mfma_f32_32x32x16_bf16 v[128:143],a[4:7],a[132:135],v[128:143]
ds_read_b128 a[128:131],v193 offset:36864
s_waitcnt lgkmcnt(6)
v_mfma_f32_32x32x16_bf16 v[128:143],a[8:11],a[136:139],v[128:143]
ds_read_b128 a[132:135],v193 offset:37888
v_cvt_pk_bf16_f32 v160,v112,v113
s_waitcnt lgkmcnt(6)
v_mfma_f32_32x32x16_bf16 v[128:143],a[12:15],a[140:143],v[128:143]
ds_read_b128 a[136:139],v193 offset:38912
v_cvt_pk_bf16_f32 v161,v114,v115
s_waitcnt lgkmcnt(6)
v_mfma_f32_32x32x16_bf16 v[128:143],a[16:19],a[112:115],v[128:143]
ds_read_b128 a[140:143],v193 offset:39936
buffer_load_dwordx4 v194,s[8:11],s30 offen offset:3072 sc1 lds
v_cvt_pk_bf16_f32 v162,v116,v117
s_waitcnt lgkmcnt(6)
v_mfma_f32_32x32x16_bf16 v[128:143],a[20:23],a[116:119],v[128:143]
ds_read_b128 a[112:115],v193 offset:40960
v_cvt_pk_bf16_f32 v163,v118,v119
s_waitcnt lgkmcnt(6)
v_mfma_f32_32x32x16_bf16 v[128:143],a[24:27],a[120:123],v[128:143]
ds_read_b128 a[116:119],v193 offset:41984
v_cvt_pk_bf16_f32 v164,v120,v121
s_waitcnt lgkmcnt(6)
v_mfma_f32_32x32x16_bf16 v[128:143],a[28:31],a[124:127],v[128:143]
ds_read_b128 a[120:123],v193 offset:43008
v_cvt_pk_bf16_f32 v165,v122,v123
s_waitcnt lgkmcnt(6)
v_mfma_f32_32x32x16_bf16 v[128:143],a[32:35],a[128:131],v[128:143]
ds_read_b128 a[124:127],v193 offset:44032
s_add_u32 s30,s100,376832
s_add_u32 m0,s60,32768
s_nop 0
buffer_load_dwordx4 v194,s[8:11],s30 offen sc1 lds
v_cvt_pk_bf16_f32 v166,v124,v125
s_waitcnt lgkmcnt(6)
v_mfma_f32_32x32x16_bf16 v[128:143],a[36:39],a[132:135],v[128:143]
ds_read_b128 a[128:131],v193 offset:45056
v_cvt_pk_bf16_f32 v167,v126,v127
s_waitcnt lgkmcnt(6)
v_mfma_f32_32x32x16_bf16 v[128:143],a[40:43],a[136:139],v[128:143]
ds_read_b128 a[132:135],v193 offset:46080
s_add_u32 s31,s101,327680
s_waitcnt lgkmcnt(6)
v_mfma_f32_32x32x16_bf16 v[128:143],a[44:47],a[140:143],v[128:143]
ds_read_b128 a[136:139],v193 offset:47104
buffer_store_dwordx4 v[160:163],v192,s[8:11],s31 offen sc1
s_waitcnt lgkmcnt(6)
v_mfma_f32_32x32x16_bf16 v[128:143],a[48:51],a[112:115],v[128:143]
ds_read_b128 a[140:143],v193 offset:48128
buffer_load_dwordx4 v194,s[8:11],s30 offen offset:1024 sc1 lds
buffer_store_dwordx4 v[164:167],v192,s[8:11],s31 offen offset:1024 sc1
s_waitcnt lgkmcnt(6)
v_mfma_f32_32x32x16_bf16 v[128:143],a[52:55],a[116:119],v[128:143]
ds_read_b128 a[112:115],v193 offset:49152
s_waitcnt lgkmcnt(6)
v_mfma_f32_32x32x16_bf16 v[128:143],a[56:59],a[120:123],v[128:143]
ds_read_b128 a[116:119],v193 offset:50176
s_waitcnt lgkmcnt(6)
v_mfma_f32_32x32x16_bf16 v[128:143],a[60:63],a[124:127],v[128:143]
ds_read_b128 a[120:123],v193 offset:51200
s_waitcnt lgkmcnt(6)
v_mfma_f32_32x32x16_bf16 v[128:143],a[64:67],a[128:131],v[128:143]
ds_read_b128 a[124:127],v193 offset:52224
buffer_load_dwordx4 v194,s[8:11],s30 offen offset:2048 sc1 lds
s_waitcnt lgkmcnt(6)
v_mfma_f32_32x32x16_bf16 v[128:143],a[68:71],a[132:135],v[128:143]
ds_read_b128 a[128:131],v193 offset:53248
s_waitcnt lgkmcnt(6)
v_mfma_f32_32x32x16_bf16 v[128:143],a[72:75],a[136:139],v[128:143]
ds_read_b128 a[132:135],v193 offset:54272
s_waitcnt lgkmcnt(6)
v_mfma_f32_32x32x16_bf16 v[128:143],a[76:79],a[140:143],v[128:143]
ds_read_b128 a[136:139],v193 offset:55296
s_waitcnt vmcnt(9)
s_barrier
s_waitcnt lgkmcnt(6)
v_mfma_f32_32x32x16_bf16 v[128:143],a[80:83],a[112:115],v[128:143]
ds_read_b128 a[140:143],v193 offset:56320
s_waitcnt lgkmcnt(6)
v_mfma_f32_32x32x16_bf16 v[128:143],a[84:87],a[116:119],v[128:143]
ds_read_b128 a[112:115],v192 offset:0
s_waitcnt lgkmcnt(6)
v_mfma_f32_32x32x16_bf16 v[128:143],a[88:91],a[120:123],v[128:143]
ds_read_b128 a[116:119],v192 offset:1024
s_waitcnt lgkmcnt(6)
v_mfma_f32_32x32x16_bf16 v[128:143],a[92:95],a[124:127],v[128:143]
ds_read_b128 a[120:123],v192 offset:2048
s_waitcnt lgkmcnt(6)
v_mfma_f32_32x32x16_bf16 v[128:143],a[96:99],a[128:131],v[128:143]
ds_read_b128 a[124:127],v192 offset:3072
s_waitcnt lgkmcnt(6)
v_mfma_f32_32x32x16_bf16 v[128:143],a[100:103],a[132:135],v[128:143]
ds_read_b128 a[128:131],v192 offset:4096
s_waitcnt lgkmcnt(6)
v_mfma_f32_32x32x16_bf16 v[128:143],a[104:107],a[136:139],v[128:143]
ds_read_b128 a[132:135],v192 offset:5120
s_waitcnt lgkmcnt(6)
v_mfma_f32_32x32x16_bf16 v[128:143],a[108:111],a[140:143],v[128:143]
ds_read_b128 a[136:139],v192 offset:6144
s_waitcnt lgkmcnt(6)
v_mfma_f32_32x32x16_bf16 v[112:127],a[0:3],a[112:115],0
ds_read_b128 a[140:143],v192 offset:7168
s_waitcnt lgkmcnt(6)
v_mfma_f32_32x32x16_bf16 v[112:127],a[4:7],a[116:119],v[112:127]
ds_read_b128 a[112:115],v192 offset:8192
s_waitcnt lgkmcnt(6)
v_mfma_f32_32x32x16_bf16 v[112:127],a[8:11],a[120:123],v[112:127]
ds_read_b128 a[116:119],v192 offset:9216
v_cvt_pk_bf16_f32 v160,v128,v129
s_waitcnt lgkmcnt(6)
v_mfma_f32_32x32x16_bf16 v[112:127],a[12:15],a[124:127],v[112:127]
ds_read_b128 a[120:123],v192 offset:10240
v_cvt_pk_bf16_f32 v161,v130,v131
s_waitcnt lgkmcnt(6)
v_mfma_f32_32x32x16_bf16 v[112:127],a[16:19],a[128:131],v[112:127]
ds_read_b128 a[124:127],v192 offset:11264
v_cvt_pk_bf16_f32 v162,v132,v133
s_waitcnt lgkmcnt(6)
v_mfma_f32_32x32x16_bf16 v[112:127],a[20:23],a[132:135],v[112:127]
ds_read_b128 a[128:131],v192 offset:12288
v_cvt_pk_bf16_f32 v163,v134,v135
s_waitcnt lgkmcnt(6)
v_mfma_f32_32x32x16_bf16 v[112:127],a[24:27],a[136:139],v[112:127]
ds_read_b128 a[132:135],v192 offset:13312
v_cvt_pk_bf16_f32 v164,v136,v137
s_waitcnt lgkmcnt(6)
v_mfma_f32_32x32x16_bf16 v[112:127],a[28:31],a[140:143],v[112:127]
ds_read_b128 a[136:139],v192 offset:14336
v_cvt_pk_bf16_f32 v165,v138,v139
s_waitcnt lgkmcnt(6)
v_mfma_f32_32x32x16_bf16 v[112:127],a[32:35],a[112:115],v[112:127]
ds_read_b128 a[140:143],v192 offset:15360
v_cvt_pk_bf16_f32 v166,v140,v141
s_waitcnt lgkmcnt(6)
v_mfma_f32_32x32x16_bf16 v[112:127],a[36:39],a[116:119],v[112:127]
ds_read_b128 a[112:115],v192 offset:16384
v_cvt_pk_bf16_f32 v167,v142,v143
s_waitcnt lgkmcnt(6)
v_mfma_f32_32x32x16_bf16 v[112:127],a[40:43],a[120:123],v[112:127]
ds_read_b128 a[116:119],v192 offset:17408
s_add_u32 s31,s101,360448
s_waitcnt lgkmcnt(6)
v_mfma_f32_32x32x16_bf16 v[112:127],a[44:47],a[124:127],v[112:127]
ds_read_b128 a[120:123],v192 offset:18432
buffer_store_dwordx4 v[160:163],v192,s[8:11],s31 offen sc1
s_waitcnt lgkmcnt(6)
v_mfma_f32_32x32x16_bf16 v[112:127],a[48:51],a[128:131],v[112:127]
ds_read_b128 a[124:127],v192 offset:19456
buffer_store_dwordx4 v[164:167],v192,s[8:11],s31 offen offset:1024 sc1
s_waitcnt lgkmcnt(6)
v_mfma_f32_32x32x16_bf16 v[112:127],a[52:55],a[132:135],v[112:127]
ds_read_b128 a[128:131],v192 offset:20480
s_waitcnt lgkmcnt(6)
v_mfma_f32_32x32x16_bf16 v[112:127],a[56:59],a[136:139],v[112:127]
ds_read_b128 a[132:135],v192 offset:21504
s_waitcnt lgkmcnt(6)
v_mfma_f32_32x32x16_bf16 v[112:127],a[60:63],a[140:143],v[112:127]
ds_read_b128 a[136:139],v192 offset:22528
s_waitcnt lgkmcnt(6)
v_mfma_f32_32x32x16_bf16 v[112:127],a[64:67],a[112:115],v[112:127]
ds_read_b128 a[140:143],v192 offset:23552
s_waitcnt lgkmcnt(6)
v_mfma_f32_32x32x16_bf16 v[112:127],a[68:71],a[116:119],v[112:127]
ds_read_b128 a[112:115],v192 offset:24576
s_waitcnt lgkmcnt(6)
v_mfma_f32_32x32x16_bf16 v[112:127],a[72:75],a[120:123],v[112:127]
ds_read_b128 a[116:119],v192 offset:25600
s_waitcnt lgkmcnt(6)
v_mfma_f32_32x32x16_bf16 v[112:127],a[76:79],a[124:127],v[112:127]
ds_read_b128 a[120:123],v192 offset:26624
s_waitcnt vmcnt(2)
s_barrier
s_waitcnt lgkmcnt(6)
v_mfma_f32_32x32x16_bf16 v[112:127],a[80:83],a[128:131],v[112:127]
ds_read_b128 a[124:127],v192 offset:27648
s_waitcnt lgkmcnt(6)
v_mfma_f32_32x32x16_bf16 v[112:127],a[84:87],a[132:135],v[112:127]
ds_read_b128 a[128:131],v192 offset:28672
s_waitcnt lgkmcnt(6)
v_mfma_f32_32x32x16_bf16 v[112:127],a[88:91],a[136:139],v[112:127]
ds_read_b128 a[132:135],v192 offset:29696
s_waitcnt lgkmcnt(6)
v_mfma_f32_32x32x16_bf16 v[112:127],a[92:95],a[140:143],v[112:127]
ds_read_b128 a[136:139],v192 offset:30720
s_waitcnt lgkmcnt(6)
v_mfma_f32_32x32x16_bf16 v[112:127],a[96:99],a[112:115],v[112:127]
ds_read_b128 a[140:143],v192 offset:31744
s_waitcnt lgkmcnt(6)
v_mfma_f32_32x32x16_bf16 v[112:127],a[100:103],a[116:119],v[112:127]
ds_read_b128 a[112:115],v192 offset:32768
s_waitcnt lgkmcnt(6)
v_mfma_f32_32x32x16_bf16 v[112:127],a[104:107],a[120:123],v[112:127]
ds_read_b128 a[116:119],v192 offset:33792
s_waitcnt lgkmcnt(6)
v_mfma_f32_32x32x16_bf16 v[112:127],a[108:111],a[124:127],v[112:127]
ds_read_b128 a[120:123],v192 offset:34816
s_waitcnt lgkmcnt(6)
v_mfma_f32_32x32x16_bf16 v[128:143],a[0:3],a[128:131],0
ds_read_b128 a[124:127],v192 offset:35840
s_waitcnt lgkmcnt(6)
v_mfma_f32_32x32x16_bf16 v[128:143],a[4:7],a[132:135],v[128:143]
ds_read_b128 a[128:131],v192 offset:36864
s_waitcnt lgkmcnt(6)
v_mfma_f32_32x32x16_bf16 v[128:143],a[8:11],a[136:139],v[128:143]
ds_read_b128 a[132:135],v192 offset:37888
v_cvt_pk_bf16_f32 v160,v112,v113
s_waitcnt lgkmcnt(6)
v_mfma_f32_32x32x16_bf16 v[128:143],a[12:15],a[140:143],v[128:143]
ds_read_b128 a[136:139],v192 offset:38912
v_cvt_pk_bf16_f32 v161,v114,v115
s_waitcnt lgkmcnt(6)
v_mfma_f32_32x32x16_bf16 v[128:143],a[16:19],a[112:115],v[128:143]
ds_read_b128 a[140:143],v192 offset:39936
v_cvt_pk_bf16_f32 v162,v116,v117
s_waitcnt lgkmcnt(6)
v_mfma_f32_32x32x16_bf16 v[128:143],a[20:23],a[116:119],v[128:143]
ds_read_b128 a[112:115],v192 offset:40960
v_cvt_pk_bf16_f32 v163,v118,v119
s_waitcnt lgkmcnt(6)
v_mfma_f32_32x32x16_bf16 v[128:143],a[24:27],a[120:123],v[128:143]
ds_read_b128 a[116:119],v192 offset:41984
v_cvt_pk_bf16_f32 v164,v120,v121
s_waitcnt lgkmcnt(6)
v_mfma_f32_32x32x16_bf16 v[128:143],a[28:31],a[124:127],v[128:143]
ds_read_b128 a[120:123],v192 offset:43008
v_cvt_pk_bf16_f32 v165,v122,v123
s_waitcnt lgkmcnt(6)
v_mfma_f32_32x32x16_bf16 v[128:143],a[32:35],a[128:131],v[128:143]
ds_read_b128 a[124:127],v192 offset:44032
v_cvt_pk_bf16_f32 v166,v124,v125
s_waitcnt lgkmcnt(6)
v_mfma_f32_32x32x16_bf16 v[128:143],a[36:39],a[132:135],v[128:143]
ds_read_b128 a[128:131],v192 offset:45056
v_cvt_pk_bf16_f32 v167,v126,v127
s_waitcnt lgkmcnt(6)
v_mfma_f32_32x32x16_bf16 v[128:143],a[40:43],a[136:139],v[128:143]
ds_read_b128 a[132:135],v192 offset:46080
s_add_u32 s31,s101,393216
s_waitcnt lgkmcnt(6)
v_mfma_f32_32x32x16_bf16 v[128:143],a[44:47],a[140:143],v[128:143]
ds_read_b128 a[136:139],v192 offset:47104
buffer_store_dwordx4 v[160:163],v192,s[8:11],s31 offen sc1
s_waitcnt lgkmcnt(6)
v_mfma_f32_32x32x16_bf16 v[128:143],a[48:51],a[112:115],v[128:143]
ds_read_b128 a[140:143],v192 offset:48128
buffer_store_dwordx4 v[164:167],v192,s[8:11],s31 offen offset:1024 sc1
s_waitcnt lgkmcnt(6)
v_mfma_f32_32x32x16_bf16 v[128:143],a[52:55],a[116:119],v[128:143]
ds_read_b128 a[112:115],v192 offset:49152
s_waitcnt lgkmcnt(6)
v_mfma_f32_32x32x16_bf16 v[128:143],a[56:59],a[120:123],v[128:143]
ds_read_b128 a[116:119],v192 offset:50176
s_waitcnt lgkmcnt(6)
v_mfma_f32_32x32x16_bf16 v[128:143],a[60:63],a[124:127],v[128:143]
ds_read_b128 a[120:123],v192 offset:51200
s_waitcnt lgkmcnt(6)
v_mfma_f32_32x32x16_bf16 v[128:143],a[64:67],a[128:131],v[128:143]
ds_read_b128 a[124:127],v192 offset:52224
s_waitcnt lgkmcnt(6)
v_mfma_f32_32x32x16_bf16 v[128:143],a[68:71],a[132:135],v[128:143]
ds_read_b128 a[128:131],v192 offset:53248
s_waitcnt lgkmcnt(6)
v_mfma_f32_32x32x16_bf16 v[128:143],a[72:75],a[136:139],v[128:143]
ds_read_b128 a[132:135],v192 offset:54272
s_waitcnt lgkmcnt(6)
v_mfma_f32_32x32x16_bf16 v[128:143],a[76:79],a[140:143],v[128:143]
ds_read_b128 a[136:139],v192 offset:55296
s_waitcnt lgkmcnt(6)
v_mfma_f32_32x32x16_bf16 v[128:143],a[80:83],a[112:115],v[128:143]
ds_read_b128 a[140:143],v192 offset:56320
s_waitcnt lgkmcnt(6)
v_mfma_f32_32x32x16_bf16 v[128:143],a[84:87],a[116:119],v[128:143]
s_waitcnt lgkmcnt(5)
v_mfma_f32_32x32x16_bf16 v[128:143],a[88:91],a[120:123],v[128:143]
s_waitcnt lgkmcnt(4)
v_mfma_f32_32x32x16_bf16 v[128:143],a[92:95],a[124:127],v[128:143]
s_waitcnt lgkmcnt(3)
v_mfma_f32_32x32x16_bf16 v[128:143],a[96:99],a[128:131],v[128:143]
s_waitcnt lgkmcnt(2)
v_mfma_f32_32x32x16_bf16 v[128:143],a[100:103],a[132:135],v[128:143]
s_waitcnt lgkmcnt(1)
v_mfma_f32_32x32x16_bf16 v[128:143],a[104:107],a[136:139],v[128:143]
s_waitcnt lgkmcnt(0)
v_mfma_f32_32x32x16_bf16 v[128:143],a[108:111],a[140:143],v[128:143]
s_nop 11
v_cvt_pk_bf16_f32 v160,v128,v129
v_cvt_pk_bf16_f32 v161,v130,v131
v_cvt_pk_bf16_f32 v162,v132,v133
v_cvt_pk_bf16_f32 v163,v134,v135
v_cvt_pk_bf16_f32 v164,v136,v137
v_cvt_pk_bf16_f32 v165,v138,v139
v_cvt_pk_bf16_f32 v166,v140,v141
v_cvt_pk_bf16_f32 v167,v142,v143
s_add_u32 s31,s101,425984
buffer_store_dwordx4 v[160:163],v192,s[8:11],s31 offen sc1
buffer_store_dwordx4 v[164:167],v192,s[8:11],s31 offen offset:1024 sc1
s_lshl_b32 s30,s97,7
s_lshl_b32 s31,s98,3
s_add_u32 s30,s30,s31
s_add_u32 s30,s30,50597888
s_waitcnt vmcnt(0)
s_barrier
s_cmp_lg_u32 s24,0
s_cbranch_scc1 sf_210
v_mov_b32 v248,0x01010101
s_mov_b64 exec,3
buffer_store_dword v248,v198,s[8:11],s30 offen sc1
s_mov_b64 exec,-1
sf_210:
L_next:
s_or_b32 s30,s38,s36
s_cbranch_scc1 L_end
v_mov_b32 v209,163824
s_cmp_lg_u32 s24,0
s_cbranch_scc1 L_popw
v_mov_b32 v208,1
s_mov_b64 exec,1
s_cmp_lt_u32 s39,64
s_cselect_b32 s31,128,0
s_add_u32 s31,s31,50620672
buffer_atomic_add v208,v199,s[8:11],s31 offen sc0
s_waitcnt vmcnt(0)
ds_write_b32 v209,v208
s_waitcnt lgkmcnt(0)
s_mov_b64 exec,-1
L_popw:
s_barrier
ds_read_b32 v208,v209
s_waitcnt lgkmcnt(0)
v_readfirstlane_b32 s30,v208
s_barrier
s_mov_b32 s31,224
s_mov_b32 s56,973
s_cmp_lt_u32 s39,64
s_cselect_b32 s31,s56,s31
s_cselect_b32 s56,1150,s56
s_add_u32 s30,s30,s31
s_cmp_ge_u32 s30,s56
s_cbranch_scc1 L_end
L_item:
s_getpc_b64 s[56:57]
s_add_u32 s56,s56,L_table@rel32@lo+4
s_addc_u32 s57,s57,L_table@rel32@hi+12
s_lshl_b32 s30,s30,2
s_load_dword s30,s[56:57],s30
s_waitcnt lgkmcnt(0)
s_and_b32 s98,s30,15
s_bfe_u32 s97,s30,0x60004
s_mov_b32 s99,s97
s_and_b32 s36,s30,0x400
s_mov_b32 s37,s30
s_bitcmp0_b32 s30,11
s_cbranch_scc1 L_go
s_mov_b32 s59,1
s_and_b32 s30,s39,15
s_lshl_b32 s30,s30,7
s_add_u32 s30,s30,50610432
s_mov_b32 s27,0
s_mov_b64 exec,1
wp_211:
buffer_load_dword v248,v199,s[8:11],s30 offen sc1
s_waitcnt vmcnt(0)
v_readfirstlane_b32 s58,v248
s_cmp_ge_u32 s58,s59
s_cbranch_scc1 wpd_212
s_add_u32 s58,s58,2
s_cmp_gt_u32 s58,s59
s_cbranch_scc1 wps_213
s_sleep 24
wps_213:
s_sleep 2
s_add_u32 s27,s27,1
s_cmp_lt_u32 s27,32768
s_cbranch_scc1 wp_211
s_mov_b32 s38,10
wpd_212:
s_mov_b64 exec,-1
s_mov_b32 s30,s37
L_go:
s_lshr_b32 s30,s30,12
s_cmp_eq_u32 s30,0
s_cbranch_scc1 L_uV
s_cmp_eq_u32 s30,1
s_cbranch_scc1 L_uQ
s_cmp_eq_u32 s30,2
s_cbranch_scc1 L_uM
s_cmp_eq_u32 s30,8
s_cbranch_scc1 L_uX
s_cmp_eq_u32 s30,4
s_cbranch_scc1 L_uH
s_mov_b32 s25,s98
s_cmp_eq_u32 s30,9
s_cbranch_scc1 L_roleF
s_cmp_eq_u32 s30,10
s_cbranch_scc1 L_end
s_lshr_b32 s97,s99,2
s_lshl_b32 s30,s97,7
s_lshl_b32 s59,s24,4
s_add_u32 s31,s30,s59
s_add_u32 s31,s31,s59
s_add_u32 s31,s31,50597888
s_add_u32 s56,s30,50599936
s_mov_b64 exec,0xff
s_mov_b32 s27,0
wf_214:
buffer_load_dword v248,v198,s[8:11],s31 offen sc1
s_waitcnt vmcnt(0)
v_cmp_gt_u32 vcc,0x01010101,v248
s_cbranch_vccz wfd_215
s_sleep 4
s_add_u32 s27,s27,1
s_cmp_lt_u32 s27,32768
s_cbranch_scc1 wf_214
s_mov_b32 s38,9
wfd_215:
s_mov_b64 exec,-1
s_mul_i32 s100,s99,458752
s_lshl_b32 s30,s98,16
s_add_u32 s100,s100,s30
s_lshl_b32 s30,s24,13
s_add_u32 s100,s100,s30
s_add_u32 s100,s100,16777216
s_add_u32 s30,s100,0
buffer_load_dwordx4 v[0:3],v192,s[8:11],s30 offen sc1
buffer_load_dwordx4 v[4:7],v192,s[8:11],s30 offen offset:1024 sc1
buffer_load_dwordx4 v[8:11],v192,s[8:11],s30 offen offset:2048 sc1
buffer_load_dwordx4 v[12:15],v192,s[8:11],s30 offen offset:3072 sc1
s_add_u32 s30,s100,4096
buffer_load_dwordx4 v[16:19],v192,s[8:11],s30 offen sc1
buffer_load_dwordx4 v[20:23],v192,s[8:11],s30 offen offset:1024 sc1
buffer_load_dwordx4 v[24:27],v192,s[8:11],s30 offen offset:2048 sc1
buffer_load_dwordx4 v[28:31],v192,s[8:11],s30 offen offset:3072 sc1
s_add_u32 s30,s100,32768
buffer_load_dwordx4 v[32:35],v192,s[8:11],s30 offen sc1
buffer_load_dwordx4 v[36:39],v192,s[8:11],s30 offen offset:1024 sc1
buffer_load_dwordx4 v[40:43],v192,s[8:11],s30 offen offset:2048 sc1
buffer_load_dwordx4 v[44:47],v192,s[8:11],s30 offen offset:3072 sc1
s_add_u32 s30,s100,36864
buffer_load_dwordx4 v[48:51],v192,s[8:11],s30 offen sc1
buffer_load_dwordx4 v[52:55],v192,s[8:11],s30 offen offset:1024 sc1
buffer_load_dwordx4 v[56:59],v192,s[8:11],s30 offen offset:2048 sc1
buffer_load_dwordx4 v[60:63],v192,s[8:11],s30 offen offset:3072 sc1
s_mov_b64 exec,0xf
s_mov_b32 s27,0
wf_216:
buffer_load_dword v248,v198,s[8:11],s56 offen sc1
s_waitcnt vmcnt(0)
v_cmp_gt_u32 vcc,1,v248
s_cbranch_vccz wfd_217
s_sleep 4
s_add_u32 s27,s27,1
s_cmp_lt_u32 s27,32768
s_cbranch_scc1 wf_216
s_mov_b32 s38,9
wfd_217:
s_mov_b64 exec,-1
v_and_b32 v208,0x1f0,v192
v_lshlrev_b32 v208,1,v208
v_lshl_add_u32 v208,v206,6,v208
s_mul_i32 s30,s99,57344
s_lshl_b32 s31,s98,13
s_add_u32 s30,s30,s31
s_lshl_b32 s31,s24,11
s_add_u32 s30,s30,s31
s_add_u32 s30,s30,67108864
buffer_load_dwordx4 v[152:155],v208,s[8:11],s30 offen sc1
buffer_load_dwordx4 v[156:159],v208,s[8:11],s30 offen offset:16 sc1
s_add_u32 s30,s30,3670016
buffer_load_dwordx4 v[160:163],v208,s[8:11],s30 offen sc1
buffer_load_dwordx4 v[164:167],v208,s[8:11],s30 offen offset:16 sc1
s_add_u32 s30,s30,3670016
buffer_load_dwordx4 v[168:171],v208,s[8:11],s30 offen sc1
buffer_load_dwordx4 v[172:175],v208,s[8:11],s30 offen offset:16 sc1
s_add_u32 s30,s30,3670016
buffer_load_dwordx4 v[176:179],v208,s[8:11],s30 offen sc1
buffer_load_dwordx4 v[180:183],v208,s[8:11],s30 offen offset:16 sc1
v_and_b32 v209,127,v198
s_lshl_b32 s30,s99,7
s_add_u32 s31,s30,51970048
buffer_load_dword v184,v209,s[8:11],s31 offen sc1
s_add_u32 s31,s30,s59
s_add_u32 s31,s31,50601984
s_cmp_ge_u32 s99,60
s_cselect_b32 s57,-1,1
s_add_u32 s57,s57,s99
s_and_b32 s30,s39,15
s_lshl_b32 s30,s30,7
s_add_u32 s30,s30,50610432
s_mov_b32 s27,0
s_mov_b64 exec,1
wp_218:
buffer_load_dword v248,v199,s[8:11],s30 offen sc1
s_waitcnt vmcnt(0)
v_readfirstlane_b32 s58,v248
s_cmp_ge_u32 s58,s57
s_cbranch_scc1 wpd_219
s_add_u32 s58,s58,2
s_cmp_gt_u32 s58,s57
s_cbranch_scc1 wps_220
s_sleep 24
wps_220:
s_sleep 2
s_add_u32 s27,s27,1
s_cmp_lt_u32 s27,32768
s_cbranch_scc1 wp_218
s_mov_b32 s38,10
wpd_219:
s_mov_b64 exec,-1
v_add_f32 v152,v152,v160
v_add_f32 v168,v168,v176
v_add_f32 v153,v153,v161
v_add_f32 v169,v169,v177
v_add_f32 v154,v154,v162
v_add_f32 v170,v170,v178
v_add_f32 v155,v155,v163
v_add_f32 v171,v171,v179
v_add_f32 v156,v156,v164
v_add_f32 v172,v172,v180
v_add_f32 v157,v157,v165
v_add_f32 v173,v173,v181
v_add_f32 v158,v158,v166
v_add_f32 v174,v174,v182
v_add_f32 v159,v159,v167
v_add_f32 v175,v175,v183
v_add_f32 v152,v152,v168
v_add_f32 v153,v153,v169
v_add_f32 v154,v154,v170
v_add_f32 v155,v155,v171
v_add_f32 v156,v156,v172
v_add_f32 v157,v157,v173
v_add_f32 v158,v158,v174
v_add_f32 v159,v159,v175
v_sub_f32 v185,1.0,v184
v_mul_f32 v152,v152,v185
v_mul_f32 v153,v153,v185
v_mul_f32 v154,v154,v185
v_mul_f32 v155,v155,v185
v_mul_f32 v156,v156,v185
v_mul_f32 v157,v157,v185
v_mul_f32 v158,v158,v185
v_mul_f32 v159,v159,v185
s_cmp_ge_u32 s99,60
s_cbranch_scc1 nowait_221
v_lshlrev_b32 v209,3,v192
s_lshl_b32 s56,s98,8
s_lshl_b32 s30,s24,2
s_add_u32 s56,s56,s30
s_add_u32 s56,s56,50615552
s_mov_b64 exec,0x3
s_mov_b32 s27,0
wf_222:
buffer_load_dword v248,v209,s[8:11],s56 offen sc1
s_waitcnt vmcnt(0)
v_cmp_gt_u32 vcc,s57,v248
s_cbranch_vccz wfd_223
s_sleep 4
s_add_u32 s27,s27,1
s_cmp_lt_u32 s27,32768
s_cbranch_scc1 wf_222
s_mov_b32 s38,9
wfd_223:
s_mov_b64 exec,-1
s_mov_b64 exec,0xf
s_mov_b32 s27,0
wf_224:
buffer_load_dword v248,v198,s[8:11],s31 offen sc1
s_waitcnt vmcnt(0)
v_cmp_gt_u32 vcc,1,v248
s_cbranch_vccz wfd_225
s_sleep 4
s_add_u32 s27,s27,1
s_cmp_lt_u32 s27,32768
s_cbranch_scc1 wf_224
s_mov_b32 s38,9
wfd_225:
s_mov_b64 exec,-1
nowait_221:
s_mov_b32 s59,s31
s_mov_b32 s20,s90
s_mov_b32 s21,s91
s_mov_b32 s22,1835008
s_mov_b32 s23,0x20000
v_bfe_u32 v208,v192,4,5
v_mul_u32_u24 v208,896,v208
v_add_u32 v208,v208,v206
s_mul_i32 s30,s99,28672
s_lshl_b32 s31,s98,7
s_add_u32 s30,s30,s31
s_lshl_b32 s31,s24,5
s_add_u32 s30,s30,s31
s_lshl_b32 s31,s24,13
v_add_u32 v209,s31,v192
s_lshr_b32 s31,s24,1
s_lshl_b32 s31,s31,12
s_and_b32 s56,s24,1
s_lshl_b32 s56,s56,10
s_add_u32 s31,s31,s56
v_add_u32 v210,s31,v192
s_mul_i32 s56,s99,40960
s_mul_i32 s31,s24,10240
s_add_u32 s56,s56,s31
s_add_u32 s56,s56,60817408
s_add_u32 s57,s56,4096
s_add_u32 s58,s56,8192
s_mul_i32 s100,s99,114688
s_lshl_b32 s31,s98,14
s_add_u32 s100,s100,s31
s_lshl_b32 s31,s24,11
s_add_u32 s100,s100,s31
s_add_u32 s100,s100,52559872
s_add_u32 s101,s100,8192
s_mov_b32 s27,0
uv_226:
buffer_load_dwordx4 v[96:99],v192,s[8:11],s58 offen sc1
buffer_load_dwordx4 v[100:103],v192,s[8:11],s58 offen offset:1024 sc1
s_waitcnt vmcnt(1)
v_max3_u32 v211,v96,v97,v98
v_max_u32 v211,v211,v99
s_waitcnt vmcnt(0)
v_max3_u32 v211,v100,v101,v211
v_max3_u32 v211,v102,v103,v211
v_cmp_eq_u32 vcc,-1,v211
s_cbranch_vccz uvd_227
s_add_u32 s27,s27,1
s_cmp_lt_u32 s27,32768
s_cbranch_scc1 uv_226
s_mov_b32 s38,11
uvd_227:
s_mov_b32 s27,0
again_228:
buffer_load_dwordx4 v[64:67],v192,s[8:11],s56 offen sc1
buffer_load_dwordx4 v[68:71],v192,s[8:11],s56 offen offset:1024 sc1
buffer_load_dwordx4 v[72:75],v192,s[8:11],s56 offen offset:2048 sc1
buffer_load_dwordx4 v[76:79],v192,s[8:11],s56 offen offset:3072 sc1
buffer_load_dwordx4 v[80:83],v192,s[8:11],s57 offen sc1
buffer_load_dwordx4 v[84:87],v192,s[8:11],s57 offen offset:1024 sc1
buffer_load_dwordx4 v[88:91],v192,s[8:11],s57 offen offset:2048 sc1
buffer_load_dwordx4 v[92:95],v192,s[8:11],s57 offen offset:3072 sc1
buffer_load_dwordx4 v[104:107],v192,s[8:11],s100 offen sc1
buffer_load_dwordx4 v[108:111],v192,s[8:11],s100 offen offset:1024 sc1
buffer_load_dwordx4 v[112:115],v192,s[8:11],s101 offen sc1
buffer_load_dwordx4 v[116:119],v192,s[8:11],s101 offen offset:1024 sc1
s_waitcnt vmcnt(11)
v_mfma_f32_32x32x16_bf16 v[120:135],v[0:3],v[64:67],0
v_max3_u32 v211,v64,v65,v66
v_max_u32 v211,v211,v67
v_mfma_f32_32x32x16_bf16 v[136:151],v[32:35],v[64:67],0
s_waitcnt vmcnt(10)
v_mfma_f32_32x32x16_bf16 v[120:135],v[4:7],v[68:71],v[120:135]
v_max3_u32 v211,v68,v69,v211
v_max3_u32 v211,v70,v71,v211
v_mfma_f32_32x32x16_bf16 v[136:151],v[36:39],v[68:71],v[136:151]
s_waitcnt vmcnt(9)
v_mfma_f32_32x32x16_bf16 v[120:135],v[8:11],v[72:75],v[120:135]
v_max3_u32 v211,v72,v73,v211
v_max3_u32 v211,v74,v75,v211
v_mfma_f32_32x32x16_bf16 v[136:151],v[40:43],v[72:75],v[136:151]
s_waitcnt vmcnt(8)
v_mfma_f32_32x32x16_bf16 v[120:135],v[12:15],v[76:79],v[120:135]
v_max3_u32 v211,v76,v77,v211
v_max3_u32 v211,v78,v79,v211
v_mfma_f32_32x32x16_bf16 v[136:151],v[44:47],v[76:79],v[136:151]
s_waitcnt vmcnt(7)
v_mfma_f32_32x32x16_bf16 v[120:135],v[16:19],v[80:83],v[120:135]
v_max3_u32 v211,v80,v81,v211
v_max3_u32 v211,v82,v83,v211
v_mfma_f32_32x32x16_bf16 v[136:151],v[48:51],v[80:83],v[136:151]
s_waitcnt vmcnt(6)
v_mfma_f32_32x32x16_bf16 v[120:135],v[20:23],v[84:87],v[120:135]
v_max3_u32 v211,v84,v85,v211
v_max3_u32 v211,v86,v87,v211
v_mfma_f32_32x32x16_bf16 v[136:151],v[52:55],v[84:87],v[136:151]
s_waitcnt vmcnt(5)
v_mfma_f32_32x32x16_bf16 v[120:135],v[24:27],v[88:91],v[120:135]
v_max3_u32 v211,v88,v89,v211
v_max3_u32 v211,v90,v91,v211
v_mfma_f32_32x32x16_bf16 v[136:151],v[56:59],v[88:91],v[136:151]
s_waitcnt vmcnt(4)
v_mfma_f32_32x32x16_bf16 v[120:135],v[28:31],v[92:95],v[120:135]
v_max3_u32 v211,v92,v93,v211
v_max3_u32 v211,v94,v95,v211
v_mfma_f32_32x32x16_bf16 v[136:151],v[60:63],v[92:95],v[136:151]
v_cmp_eq_u32 vcc,-1,v211
s_cbranch_vccz again_228_d
s_add_u32 s27,s27,1
s_cmp_lt_u32 s27,32768
s_cbranch_scc1 again_228
s_mov_b32 s38,12
again_228_d:
s_waitcnt vmcnt(0)
v_max3_u32 v211,v104,v105,v119
v_max3_u32 v211,v106,v107,v211
v_max3_u32 v211,v108,v109,v211
v_max3_u32 v211,v110,v111,v211
v_max3_u32 v211,v112,v113,v211
v_max3_u32 v211,v114,v115,v211
v_max3_u32 v211,v116,v117,v211
v_max_u32 v211,v118,v211
v_cmp_eq_u32 vcc,-1,v211
s_cbranch_vccz again_228_m
s_mov_b32 s27,0
uv_229:
buffer_load_dwordx4 v[104:107],v192,s[8:11],s100 offen sc1
buffer_load_dwordx4 v[108:111],v192,s[8:11],s100 offen offset:1024 sc1
buffer_load_dwordx4 v[112:115],v192,s[8:11],s101 offen sc1
buffer_load_dwordx4 v[116:119],v192,s[8:11],s101 offen offset:1024 sc1
s_waitcnt vmcnt(3)
v_max3_u32 v211,v104,v105,v106
v_max_u32 v211,v211,v107
s_waitcnt vmcnt(2)
v_max3_u32 v211,v108,v109,v211
v_max3_u32 v211,v110,v111,v211
s_waitcnt vmcnt(1)
v_max3_u32 v211,v112,v113,v211
v_max3_u32 v211,v114,v115,v211
s_waitcnt vmcnt(0)
v_max3_u32 v211,v116,v117,v211
v_max3_u32 v211,v118,v119,v211
v_cmp_eq_u32 vcc,-1,v211
s_cbranch_vccz uvd_230
s_add_u32 s27,s27,1
s_cmp_lt_u32 s27,32768
s_cbranch_scc1 uv_229
s_mov_b32 s38,11
uvd_230:
again_228_m:
v_mfma_f32_32x32x16_bf16 v[120:135],v[104:107],v[96:99],v[120:135]
v_mfma_f32_32x32x16_bf16 v[136:151],v[112:115],v[96:99],v[136:151]
v_mfma_f32_32x32x16_bf16 v[120:135],v[108:111],v[100:103],v[120:135]
v_mfma_f32_32x32x16_bf16 v[136:151],v[116:119],v[100:103],v[136:151]
s_nop 4
ds_write_b128 v209,v[120:123] offset:0
ds_write_b128 v209,v[124:127] offset:1024
ds_write_b128 v209,v[128:131] offset:2048
ds_write_b128 v209,v[132:135] offset:3072
s_nop 2
ds_write_b128 v209,v[136:139] offset:4096
ds_write_b128 v209,v[140:143] offset:5120
ds_write_b128 v209,v[144:147] offset:6144
ds_write_b128 v209,v[148:151] offset:7168
s_waitcnt lgkmcnt(0)
s_barrier
ds_read_b128 v[0:3],v210 offset:0
ds_read_b128 v[4:7],v210 offset:2048
ds_read_b128 v[8:11],v210 offset:8192
ds_read_b128 v[12:15],v210 offset:10240
ds_read_b128 v[16:19],v210 offset:16384
ds_read_b128 v[20:23],v210 offset:18432
ds_read_b128 v[24:27],v210 offset:24576
ds_read_b128 v[28:31],v210 offset:26624
s_waitcnt lgkmcnt(0)
v_add_f32 v0,v0,v8
v_add_f32 v16,v16,v24
v_add_f32 v1,v1,v9
v_add_f32 v17,v17,v25
v_add_f32 v2,v2,v10
v_add_f32 v18,v18,v26
v_add_f32 v3,v3,v11
v_add_f32 v19,v19,v27
v_add_f32 v4,v4,v12
v_add_f32 v20,v20,v28
v_add_f32 v5,v5,v13
v_add_f32 v21,v21,v29
v_add_f32 v6,v6,v14
v_add_f32 v22,v22,v30
v_add_f32 v7,v7,v15
v_add_f32 v23,v23,v31
v_add_f32 v0,v0,v16
v_add_f32 v1,v1,v17
v_add_f32 v2,v2,v18
v_add_f32 v3,v3,v19
v_add_f32 v4,v4,v20
v_add_f32 v5,v5,v21
v_add_f32 v6,v6,v22
v_add_f32 v7,v7,v23
v_fma_f32 v152,v0,v184,v152
v_fma_f32 v153,v4,v184,v153
v_fma_f32 v154,v1,v184,v154
v_fma_f32 v155,v5,v184,v155
v_fma_f32 v156,v2,v184,v156
v_fma_f32 v157,v6,v184,v157
v_fma_f32 v158,v3,v184,v158
v_fma_f32 v159,v7,v184,v159
v_cvt_pk_bf16_f32 v160,v152,v153
v_cvt_pk_bf16_f32 v161,v154,v155
v_cvt_pk_bf16_f32 v162,v156,v157
v_cvt_pk_bf16_f32 v163,v158,v159
buffer_store_dwordx4 v[160:163],v208,s[20:23],s30 offen
s_branch L_next
L_uH:
s_mov_b32 s62,s97
s_lshl_b32 s63,s97,1
s_mov_b32 s97,0
s_lshl_b32 s99,s97,2
s_add_u32 s99,s99,s24
s_lshl_b32 s59,s98,7
s_add_u32 s59,s59,50595840
s_mul_i32 s100,s98,401408
s_add_u32 s100,s100,7340032
s_mul_i32 s60,s24,7168
s_mul_i32 s30,s63,28672
s_add_u32 s100,s100,s30
s_add_u32 s30,s100,0
s_add_u32 m0,s60,0
s_nop 0
buffer_load_dwordx4 v194,s[8:11],s30 offen sc1 lds
buffer_load_dwordx4 v194,s[8:11],s30 offen offset:1024 sc1 lds
buffer_load_dwordx4 v194,s[8:11],s30 offen offset:2048 sc1 lds
buffer_load_dwordx4 v194,s[8:11],s30 offen offset:3072 sc1 lds
s_add_u32 s30,s100,4096
s_add_u32 m0,s60,4096
s_nop 0
buffer_load_dwordx4 v194,s[8:11],s30 offen sc1 lds
buffer_load_dwordx4 v194,s[8:11],s30 offen offset:1024 sc1 lds
buffer_load_dwordx4 v194,s[8:11],s30 offen offset:2048 sc1 lds
s_mul_i32 s31,s99,28672
s_add_u32 s56,s31,14336
s_mul_i32 s57,s24,28672
s_add_u32 s57,s57,28672
v_add_u32 v208,s57,v196
v_add_u32 v209,s57,v197
s_add_u32 m0,s57,0
s_nop 0
buffer_load_dwordx4 v195,s[12:15],s31 offen lds
s_add_u32 m0,s57,1024
s_nop 0
buffer_load_dwordx4 v195,s[12:15],s56 offen lds
s_add_u32 m0,s57,1984
s_nop 0
buffer_load_dwordx4 v195,s[12:15],s31 offen offset:64 lds
s_add_u32 m0,s57,3008
s_nop 0
buffer_load_dwordx4 v195,s[12:15],s56 offen offset:64 lds
s_add_u32 m0,s57,3968
s_nop 0
buffer_load_dwordx4 v195,s[12:15],s31 offen offset:128 lds
s_add_u32 m0,s57,4992
s_nop 0
buffer_load_dwordx4 v195,s[12:15],s56 offen offset:128 lds
s_add_u32 m0,s57,5952
s_nop 0
buffer_load_dwordx4 v195,s[12:15],s31 offen offset:192 lds
s_add_u32 m0,s57,6976
s_nop 0
buffer_load_dwordx4 v195,s[12:15],s56 offen offset:192 lds
s_add_u32 m0,s57,7936
s_nop 0
buffer_load_dwordx4 v195,s[12:15],s31 offen offset:256 lds
s_add_u32 m0,s57,8960
s_nop 0
buffer_load_dwordx4 v195,s[12:15],s56 offen offset:256 lds
s_add_u32 m0,s57,9920
s_nop 0
buffer_load_dwordx4 v195,s[12:15],s31 offen offset:320 lds
s_add_u32 m0,s57,10944
s_nop 0
buffer_load_dwordx4 v195,s[12:15],s56 offen offset:320 lds
s_add_u32 m0,s57,11904
s_nop 0
buffer_load_dwordx4 v195,s[12:15],s31 offen offset:384 lds
s_add_u32 m0,s57,12928
s_nop 0
buffer_load_dwordx4 v195,s[12:15],s56 offen offset:384 lds
s_add_u32 m0,s57,13888
s_nop 0
buffer_load_dwordx4 v195,s[12:15],s31 offen offset:448 lds
s_add_u32 m0,s57,14912
s_nop 0
buffer_load_dwordx4 v195,s[12:15],s56 offen offset:448 lds
s_add_u32 m0,s57,15872
s_nop 0
buffer_load_dwordx4 v195,s[12:15],s31 offen offset:512 lds
s_add_u32 m0,s57,16896
s_nop 0
buffer_load_dwordx4 v195,s[12:15],s56 offen offset:512 lds
s_add_u32 m0,s57,17856
s_nop 0
buffer_load_dwordx4 v195,s[12:15],s31 offen offset:576 lds
s_add_u32 m0,s57,18880
s_nop 0
buffer_load_dwordx4 v195,s[12:15],s56 offen offset:576 lds
s_add_u32 m0,s57,19840
s_nop 0
buffer_load_dwordx4 v195,s[12:15],s31 offen offset:640 lds
s_add_u32 m0,s57,20864
s_nop 0
buffer_load_dwordx4 v195,s[12:15],s56 offen offset:640 lds
s_add_u32 m0,s57,21824
s_nop 0
buffer_load_dwordx4 v195,s[12:15],s31 offen offset:704 lds
s_add_u32 m0,s57,22848
s_nop 0
buffer_load_dwordx4 v195,s[12:15],s56 offen offset:704 lds
s_add_u32 m0,s57,23808
s_nop 0
buffer_load_dwordx4 v195,s[12:15],s31 offen offset:768 lds
s_add_u32 m0,s57,24832
s_nop 0
buffer_load_dwordx4 v195,s[12:15],s56 offen offset:768 lds
s_add_u32 m0,s57,25792
s_nop 0
buffer_load_dwordx4 v195,s[12:15],s31 offen offset:832 lds
s_add_u32 m0,s57,26816
s_nop 0
buffer_load_dwordx4 v195,s[12:15],s56 offen offset:832 lds
s_waitcnt vmcnt(26)
ds_read_b128 v[0:3],v208 offset:0
ds_read_b128 v[4:7],v209 offset:0
s_waitcnt vmcnt(24)
ds_read_b128 v[8:11],v208 offset:2048
ds_read_b128 v[12:15],v209 offset:2048
s_waitcnt vmcnt(22)
ds_read_b128 v[16:19],v208 offset:4096
ds_read_b128 v[20:23],v209 offset:4096
s_waitcnt vmcnt(20)
ds_read_b128 v[24:27],v208 offset:6144
ds_read_b128 v[28:31],v209 offset:6144
s_waitcnt vmcnt(18)
ds_read_b128 v[32:35],v208 offset:8192
ds_read_b128 v[36:39],v209 offset:8192
s_waitcnt vmcnt(16)
ds_read_b128 v[40:43],v208 offset:10240
ds_read_b128 v[44:47],v209 offset:10240
s_waitcnt vmcnt(14)
ds_read_b128 v[48:51],v208 offset:12288
ds_read_b128 v[52:55],v209 offset:12288
s_waitcnt vmcnt(12)
ds_read_b128 v[56:59],v208 offset:14336
ds_read_b128 v[60:63],v209 offset:14336
s_waitcnt vmcnt(10)
ds_read_b128 v[64:67],v208 offset:16384
ds_read_b128 v[68:71],v209 offset:16384
s_waitcnt vmcnt(8)
ds_read_b128 v[72:75],v208 offset:18432
ds_read_b128 v[76:79],v209 offset:18432
s_waitcnt vmcnt(6)
ds_read_b128 v[80:83],v208 offset:20480
ds_read_b128 v[84:87],v209 offset:20480
s_waitcnt vmcnt(4)
ds_read_b128 v[88:91],v208 offset:22528
ds_read_b128 v[92:95],v209 offset:22528
s_waitcnt vmcnt(2)
ds_read_b128 v[96:99],v208 offset:24576
ds_read_b128 v[100:103],v209 offset:24576
s_waitcnt vmcnt(0)
ds_read_b128 v[104:107],v208 offset:26624
ds_read_b128 v[108:111],v209 offset:26624
s_waitcnt lgkmcnt(15)
v_permlane32_swap_b32 v0,v2
v_permlane32_swap_b32 v1,v3
s_waitcnt lgkmcnt(15)
v_permlane32_swap_b32 v4,v6
v_permlane32_swap_b32 v5,v7
s_waitcnt lgkmcnt(15)
v_permlane32_swap_b32 v8,v10
v_permlane32_swap_b32 v9,v11
s_waitcnt lgkmcnt(15)
v_permlane32_swap_b32 v12,v14
v_permlane32_swap_b32 v13,v15
s_waitcnt lgkmcnt(15)
v_permlane32_swap_b32 v16,v18
v_permlane32_swap_b32 v17,v19
s_waitcnt lgkmcnt(15)
v_permlane32_swap_b32 v20,v22
v_permlane32_swap_b32 v21,v23
s_waitcnt lgkmcnt(15)
v_permlane32_swap_b32 v24,v26
v_permlane32_swap_b32 v25,v27
s_waitcnt lgkmcnt(15)
v_permlane32_swap_b32 v28,v30
v_permlane32_swap_b32 v29,v31
s_waitcnt lgkmcnt(15)
v_permlane32_swap_b32 v32,v34
v_permlane32_swap_b32 v33,v35
s_waitcnt lgkmcnt(15)
v_permlane32_swap_b32 v36,v38
v_permlane32_swap_b32 v37,v39
s_waitcnt lgkmcnt(15)
v_permlane32_swap_b32 v40,v42
v_permlane32_swap_b32 v41,v43
s_waitcnt lgkmcnt(15)
v_permlane32_swap_b32 v44,v46
v_permlane32_swap_b32 v45,v47
s_waitcnt lgkmcnt(15)
v_permlane32_swap_b32 v48,v50
v_permlane32_swap_b32 v49,v51
s_waitcnt lgkmcnt(14)
v_permlane32_swap_b32 v52,v54
v_permlane32_swap_b32 v53,v55
s_waitcnt lgkmcnt(13)
v_permlane32_swap_b32 v56,v58
v_permlane32_swap_b32 v57,v59
s_waitcnt lgkmcnt(12)
v_permlane32_swap_b32 v60,v62
v_permlane32_swap_b32 v61,v63
s_waitcnt lgkmcnt(11)
v_permlane32_swap_b32 v64,v66
v_permlane32_swap_b32 v65,v67
s_waitcnt lgkmcnt(10)
v_permlane32_swap_b32 v68,v70
v_permlane32_swap_b32 v69,v71
s_waitcnt lgkmcnt(9)
v_permlane32_swap_b32 v72,v74
v_permlane32_swap_b32 v73,v75
s_waitcnt lgkmcnt(8)
v_permlane32_swap_b32 v76,v78
v_permlane32_swap_b32 v77,v79
s_waitcnt lgkmcnt(7)
v_permlane32_swap_b32 v80,v82
v_permlane32_swap_b32 v81,v83
s_waitcnt lgkmcnt(6)
v_permlane32_swap_b32 v84,v86
v_permlane32_swap_b32 v85,v87
s_waitcnt lgkmcnt(5)
v_permlane32_swap_b32 v88,v90
v_permlane32_swap_b32 v89,v91
s_waitcnt lgkmcnt(4)
v_permlane32_swap_b32 v92,v94
v_permlane32_swap_b32 v93,v95
s_waitcnt lgkmcnt(3)
v_permlane32_swap_b32 v96,v98
v_permlane32_swap_b32 v97,v99
s_waitcnt lgkmcnt(2)
v_permlane32_swap_b32 v100,v102
v_permlane32_swap_b32 v101,v103
s_waitcnt lgkmcnt(1)
v_permlane32_swap_b32 v104,v106
v_permlane32_swap_b32 v105,v107
s_waitcnt lgkmcnt(0)
v_permlane32_swap_b32 v108,v110
v_permlane32_swap_b32 v109,v111
v_accvgpr_write_b32 a0,v0
v_accvgpr_write_b32 a1,v2
v_accvgpr_write_b32 a2,v1
v_accvgpr_write_b32 a3,v3
v_accvgpr_write_b32 a4,v4
v_accvgpr_write_b32 a5,v6
v_accvgpr_write_b32 a6,v5
v_accvgpr_write_b32 a7,v7
v_accvgpr_write_b32 a8,v8
v_accvgpr_write_b32 a9,v10
v_accvgpr_write_b32 a10,v9
v_accvgpr_write_b32 a11,v11
v_accvgpr_write_b32 a12,v12
v_accvgpr_write_b32 a13,v14
v_accvgpr_write_b32 a14,v13
v_accvgpr_write_b32 a15,v15
v_accvgpr_write_b32 a16,v16
v_accvgpr_write_b32 a17,v18
v_accvgpr_write_b32 a18,v17
v_accvgpr_write_b32 a19,v19
v_accvgpr_write_b32 a20,v20
v_accvgpr_write_b32 a21,v22
v_accvgpr_write_b32 a22,v21
v_accvgpr_write_b32 a23,v23
v_accvgpr_write_b32 a24,v24
v_accvgpr_write_b32 a25,v26
v_accvgpr_write_b32 a26,v25
v_accvgpr_write_b32 a27,v27
v_accvgpr_write_b32 a28,v28
v_accvgpr_write_b32 a29,v30
v_accvgpr_write_b32 a30,v29
v_accvgpr_write_b32 a31,v31
v_accvgpr_write_b32 a32,v32
v_accvgpr_write_b32 a33,v34
v_accvgpr_write_b32 a34,v33
v_accvgpr_write_b32 a35,v35
v_accvgpr_write_b32 a36,v36
v_accvgpr_write_b32 a37,v38
v_accvgpr_write_b32 a38,v37
v_accvgpr_write_b32 a39,v39
v_accvgpr_write_b32 a40,v40
v_accvgpr_write_b32 a41,v42
v_accvgpr_write_b32 a42,v41
v_accvgpr_write_b32 a43,v43
v_accvgpr_write_b32 a44,v44
v_accvgpr_write_b32 a45,v46
v_accvgpr_write_b32 a46,v45
v_accvgpr_write_b32 a47,v47
v_accvgpr_write_b32 a48,v48
v_accvgpr_write_b32 a49,v50
v_accvgpr_write_b32 a50,v49
v_accvgpr_write_b32 a51,v51
v_accvgpr_write_b32 a52,v52
v_accvgpr_write_b32 a53,v54
v_accvgpr_write_b32 a54,v53
v_accvgpr_write_b32 a55,v55
v_accvgpr_write_b32 a56,v56
v_accvgpr_write_b32 a57,v58
v_accvgpr_write_b32 a58,v57
v_accvgpr_write_b32 a59,v59
v_accvgpr_write_b32 a60,v60
v_accvgpr_write_b32 a61,v62
v_accvgpr_write_b32 a62,v61
v_accvgpr_write_b32 a63,v63
v_accvgpr_write_b32 a64,v64
v_accvgpr_write_b32 a65,v66
v_accvgpr_write_b32 a66,v65
v_accvgpr_write_b32 a67,v67
v_accvgpr_write_b32 a68,v68
v_accvgpr_write_b32 a69,v70
v_accvgpr_write_b32 a70,v69
v_accvgpr_write_b32 a71,v71
v_accvgpr_write_b32 a72,v72
v_accvgpr_write_b32 a73,v74
v_accvgpr_write_b32 a74,v73
v_accvgpr_write_b32 a75,v75
v_accvgpr_write_b32 a76,v76
v_accvgpr_write_b32 a77,v78
v_accvgpr_write_b32 a78,v77
v_accvgpr_write_b32 a79,v79
v_accvgpr_write_b32 a80,v80
v_accvgpr_write_b32 a81,v82
v_accvgpr_write_b32 a82,v81
v_accvgpr_write_b32 a83,v83
v_accvgpr_write_b32 a84,v84
v_accvgpr_write_b32 a85,v86
v_accvgpr_write_b32 a86,v85
v_accvgpr_write_b32 a87,v87
v_accvgpr_write_b32 a88,v88
v_accvgpr_write_b32 a89,v90
v_accvgpr_write_b32 a90,v89
v_accvgpr_write_b32 a91,v91
v_accvgpr_write_b32 a92,v92
v_accvgpr_write_b32 a93,v94
v_accvgpr_write_b32 a94,v93
v_accvgpr_write_b32 a95,v95
v_accvgpr_write_b32 a96,v96
v_accvgpr_write_b32 a97,v98
v_accvgpr_write_b32 a98,v97
v_accvgpr_write_b32 a99,v99
v_accvgpr_write_b32 a100,v100
v_accvgpr_write_b32 a101,v102
v_accvgpr_write_b32 a102,v101
v_accvgpr_write_b32 a103,v103
v_accvgpr_write_b32 a104,v104
v_accvgpr_write_b32 a105,v106
v_accvgpr_write_b32 a106,v105
v_accvgpr_write_b32 a107,v107
v_accvgpr_write_b32 a108,v108
v_accvgpr_write_b32 a109,v110
v_accvgpr_write_b32 a110,v109
v_accvgpr_write_b32 a111,v111
s_barrier
s_mul_i32 s101,s99,458752
s_lshl_b32 s31,s98,11
s_add_u32 s101,s101,s31
s_add_u32 s101,s101,16777216
s_mul_i32 s31,s63,32768
s_add_u32 s101,s101,s31
s_add_u32 s30,s100,28672
s_add_u32 m0,s60,28672
s_nop 0
buffer_load_dwordx4 v194,s[8:11],s30 offen sc1 lds
buffer_load_dwordx4 v194,s[8:11],s30 offen offset:1024 sc1 lds
buffer_load_dwordx4 v194,s[8:11],s30 offen offset:2048 sc1 lds
buffer_load_dwordx4 v194,s[8:11],s30 offen offset:3072 sc1 lds
s_add_u32 s30,s100,32768
s_add_u32 m0,s60,32768
s_nop 0
buffer_load_dwordx4 v194,s[8:11],s30 offen sc1 lds
buffer_load_dwordx4 v194,s[8:11],s30 offen offset:1024 sc1 lds
buffer_load_dwordx4 v194,s[8:11],s30 offen offset:2048 sc1 lds
s_barrier
ds_read_b128 a[112:115],v192 offset:0
ds_read_b128 a[116:119],v192 offset:1024
ds_read_b128 a[120:123],v192 offset:2048
ds_read_b128 a[124:127],v192 offset:3072
ds_read_b128 a[128:131],v192 offset:4096
ds_read_b128 a[132:135],v192 offset:5120
ds_read_b128 a[136:139],v192 offset:6144
s_waitcnt lgkmcnt(6)
v_mfma_f32_32x32x16_bf16 v[112:127],a[0:3],a[112:115],0
ds_read_b128 a[140:143],v192 offset:7168
s_waitcnt lgkmcnt(6)
v_mfma_f32_32x32x16_bf16 v[112:127],a[4:7],a[116:119],v[112:127]
ds_read_b128 a[112:115],v192 offset:8192
s_waitcnt lgkmcnt(6)
v_mfma_f32_32x32x16_bf16 v[112:127],a[8:11],a[120:123],v[112:127]
ds_read_b128 a[116:119],v192 offset:9216
s_waitcnt lgkmcnt(6)
v_mfma_f32_32x32x16_bf16 v[112:127],a[12:15],a[124:127],v[112:127]
ds_read_b128 a[120:123],v192 offset:10240
s_waitcnt lgkmcnt(6)
v_mfma_f32_32x32x16_bf16 v[112:127],a[16:19],a[128:131],v[112:127]
ds_read_b128 a[124:127],v192 offset:11264
s_waitcnt lgkmcnt(6)
v_mfma_f32_32x32x16_bf16 v[112:127],a[20:23],a[132:135],v[112:127]
ds_read_b128 a[128:131],v192 offset:12288
s_waitcnt lgkmcnt(6)
v_mfma_f32_32x32x16_bf16 v[112:127],a[24:27],a[136:139],v[112:127]
ds_read_b128 a[132:135],v192 offset:13312
s_waitcnt lgkmcnt(6)
v_mfma_f32_32x32x16_bf16 v[112:127],a[28:31],a[140:143],v[112:127]
ds_read_b128 a[136:139],v192 offset:14336
s_waitcnt lgkmcnt(6)
v_mfma_f32_32x32x16_bf16 v[112:127],a[32:35],a[112:115],v[112:127]
ds_read_b128 a[140:143],v192 offset:15360
s_waitcnt lgkmcnt(6)
v_mfma_f32_32x32x16_bf16 v[112:127],a[36:39],a[116:119],v[112:127]
ds_read_b128 a[112:115],v192 offset:16384
s_waitcnt lgkmcnt(6)
v_mfma_f32_32x32x16_bf16 v[112:127],a[40:43],a[120:123],v[112:127]
ds_read_b128 a[116:119],v192 offset:17408
s_waitcnt lgkmcnt(6)
v_mfma_f32_32x32x16_bf16 v[112:127],a[44:47],a[124:127],v[112:127]
ds_read_b128 a[120:123],v192 offset:18432
s_waitcnt lgkmcnt(6)
v_mfma_f32_32x32x16_bf16 v[112:127],a[48:51],a[128:131],v[112:127]
ds_read_b128 a[124:127],v192 offset:19456
s_waitcnt lgkmcnt(6)
v_mfma_f32_32x32x16_bf16 v[112:127],a[52:55],a[132:135],v[112:127]
ds_read_b128 a[128:131],v192 offset:20480
s_waitcnt lgkmcnt(6)
v_mfma_f32_32x32x16_bf16 v[112:127],a[56:59],a[136:139],v[112:127]
ds_read_b128 a[132:135],v192 offset:21504
s_waitcnt lgkmcnt(6)
v_mfma_f32_32x32x16_bf16 v[112:127],a[60:63],a[140:143],v[112:127]
ds_read_b128 a[136:139],v192 offset:22528
s_waitcnt lgkmcnt(6)
v_mfma_f32_32x32x16_bf16 v[112:127],a[64:67],a[112:115],v[112:127]
ds_read_b128 a[140:143],v192 offset:23552
s_waitcnt lgkmcnt(6)
v_mfma_f32_32x32x16_bf16 v[112:127],a[68:71],a[116:119],v[112:127]
ds_read_b128 a[112:115],v192 offset:24576
s_waitcnt lgkmcnt(6)
v_mfma_f32_32x32x16_bf16 v[112:127],a[72:75],a[120:123],v[112:127]
ds_read_b128 a[116:119],v192 offset:25600
s_waitcnt lgkmcnt(6)
v_mfma_f32_32x32x16_bf16 v[112:127],a[76:79],a[124:127],v[112:127]
ds_read_b128 a[120:123],v192 offset:26624
s_waitcnt vmcnt(0)
s_barrier
s_waitcnt lgkmcnt(6)
v_mfma_f32_32x32x16_bf16 v[112:127],a[80:83],a[128:131],v[112:127]
ds_read_b128 a[124:127],v192 offset:27648
s_waitcnt lgkmcnt(6)
v_mfma_f32_32x32x16_bf16 v[112:127],a[84:87],a[132:135],v[112:127]
ds_read_b128 a[128:131],v192 offset:28672
s_waitcnt lgkmcnt(6)
v_mfma_f32_32x32x16_bf16 v[112:127],a[88:91],a[136:139],v[112:127]
ds_read_b128 a[132:135],v192 offset:29696
s_waitcnt lgkmcnt(6)
v_mfma_f32_32x32x16_bf16 v[112:127],a[92:95],a[140:143],v[112:127]
ds_read_b128 a[136:139],v192 offset:30720
s_waitcnt lgkmcnt(6)
v_mfma_f32_32x32x16_bf16 v[112:127],a[96:99],a[112:115],v[112:127]
ds_read_b128 a[140:143],v192 offset:31744
s_waitcnt lgkmcnt(6)
v_mfma_f32_32x32x16_bf16 v[112:127],a[100:103],a[116:119],v[112:127]
ds_read_b128 a[112:115],v192 offset:32768
s_waitcnt lgkmcnt(6)
v_mfma_f32_32x32x16_bf16 v[112:127],a[104:107],a[120:123],v[112:127]
ds_read_b128 a[116:119],v192 offset:33792
s_waitcnt lgkmcnt(6)
v_mfma_f32_32x32x16_bf16 v[112:127],a[108:111],a[124:127],v[112:127]
ds_read_b128 a[120:123],v192 offset:34816
s_waitcnt lgkmcnt(6)
v_mfma_f32_32x32x16_bf16 v[128:143],a[0:3],a[128:131],0
ds_read_b128 a[124:127],v192 offset:35840
s_waitcnt lgkmcnt(6)
v_mfma_f32_32x32x16_bf16 v[128:143],a[4:7],a[132:135],v[128:143]
ds_read_b128 a[128:131],v192 offset:36864
s_waitcnt lgkmcnt(6)
v_mfma_f32_32x32x16_bf16 v[128:143],a[8:11],a[136:139],v[128:143]
ds_read_b128 a[132:135],v192 offset:37888
v_cvt_pk_bf16_f32 v160,v112,v113
s_waitcnt lgkmcnt(6)
v_mfma_f32_32x32x16_bf16 v[128:143],a[12:15],a[140:143],v[128:143]
ds_read_b128 a[136:139],v192 offset:38912
v_cvt_pk_bf16_f32 v161,v114,v115
s_waitcnt lgkmcnt(6)
v_mfma_f32_32x32x16_bf16 v[128:143],a[16:19],a[112:115],v[128:143]
ds_read_b128 a[140:143],v192 offset:39936
v_cvt_pk_bf16_f32 v162,v116,v117
s_waitcnt lgkmcnt(6)
v_mfma_f32_32x32x16_bf16 v[128:143],a[20:23],a[116:119],v[128:143]
ds_read_b128 a[112:115],v192 offset:40960
v_cvt_pk_bf16_f32 v163,v118,v119
s_waitcnt lgkmcnt(6)
v_mfma_f32_32x32x16_bf16 v[128:143],a[24:27],a[120:123],v[128:143]
ds_read_b128 a[116:119],v192 offset:41984
v_cvt_pk_bf16_f32 v164,v120,v121
s_waitcnt lgkmcnt(6)
v_mfma_f32_32x32x16_bf16 v[128:143],a[28:31],a[124:127],v[128:143]
ds_read_b128 a[120:123],v192 offset:43008
v_cvt_pk_bf16_f32 v165,v122,v123
s_waitcnt lgkmcnt(6)
v_mfma_f32_32x32x16_bf16 v[128:143],a[32:35],a[128:131],v[128:143]
ds_read_b128 a[124:127],v192 offset:44032
v_cvt_pk_bf16_f32 v166,v124,v125
s_waitcnt lgkmcnt(6)
v_mfma_f32_32x32x16_bf16 v[128:143],a[36:39],a[132:135],v[128:143]
ds_read_b128 a[128:131],v192 offset:45056
v_cvt_pk_bf16_f32 v167,v126,v127
s_waitcnt lgkmcnt(6)
v_mfma_f32_32x32x16_bf16 v[128:143],a[40:43],a[136:139],v[128:143]
ds_read_b128 a[132:135],v192 offset:46080
s_add_u32 s31,s101,0
s_waitcnt lgkmcnt(6)
v_mfma_f32_32x32x16_bf16 v[128:143],a[44:47],a[140:143],v[128:143]
ds_read_b128 a[136:139],v192 offset:47104
buffer_store_dwordx4 v[160:163],v192,s[8:11],s31 offen sc1
s_waitcnt lgkmcnt(6)
v_mfma_f32_32x32x16_bf16 v[128:143],a[48:51],a[112:115],v[128:143]
ds_read_b128 a[140:143],v192 offset:48128
buffer_store_dwordx4 v[164:167],v192,s[8:11],s31 offen offset:1024 sc1
s_waitcnt lgkmcnt(6)
v_mfma_f32_32x32x16_bf16 v[128:143],a[52:55],a[116:119],v[128:143]
ds_read_b128 a[112:115],v192 offset:49152
s_waitcnt lgkmcnt(6)
v_mfma_f32_32x32x16_bf16 v[128:143],a[56:59],a[120:123],v[128:143]
ds_read_b128 a[116:119],v192 offset:50176
s_waitcnt lgkmcnt(6)
v_mfma_f32_32x32x16_bf16 v[128:143],a[60:63],a[124:127],v[128:143]
ds_read_b128 a[120:123],v192 offset:51200
s_waitcnt lgkmcnt(6)
v_mfma_f32_32x32x16_bf16 v[128:143],a[64:67],a[128:131],v[128:143]
ds_read_b128 a[124:127],v192 offset:52224
s_waitcnt lgkmcnt(6)
v_mfma_f32_32x32x16_bf16 v[128:143],a[68:71],a[132:135],v[128:143]
ds_read_b128 a[128:131],v192 offset:53248
s_waitcnt lgkmcnt(6)
v_mfma_f32_32x32x16_bf16 v[128:143],a[72:75],a[136:139],v[128:143]
ds_read_b128 a[132:135],v192 offset:54272
s_waitcnt lgkmcnt(6)
v_mfma_f32_32x32x16_bf16 v[128:143],a[76:79],a[140:143],v[128:143]
ds_read_b128 a[136:139],v192 offset:55296
s_waitcnt lgkmcnt(6)
v_mfma_f32_32x32x16_bf16 v[128:143],a[80:83],a[112:115],v[128:143]
ds_read_b128 a[140:143],v192 offset:56320
s_waitcnt lgkmcnt(6)
v_mfma_f32_32x32x16_bf16 v[128:143],a[84:87],a[116:119],v[128:143]
s_waitcnt lgkmcnt(5)
v_mfma_f32_32x32x16_bf16 v[128:143],a[88:91],a[120:123],v[128:143]
s_waitcnt lgkmcnt(4)
v_mfma_f32_32x32x16_bf16 v[128:143],a[92:95],a[124:127],v[128:143]
s_waitcnt lgkmcnt(3)
v_mfma_f32_32x32x16_bf16 v[128:143],a[96:99],a[128:131],v[128:143]
s_waitcnt lgkmcnt(2)
v_mfma_f32_32x32x16_bf16 v[128:143],a[100:103],a[132:135],v[128:143]
s_waitcnt lgkmcnt(1)
v_mfma_f32_32x32x16_bf16 v[128:143],a[104:107],a[136:139],v[128:143]
s_waitcnt lgkmcnt(0)
v_mfma_f32_32x32x16_bf16 v[128:143],a[108:111],a[140:143],v[128:143]
s_nop 11
v_cvt_pk_bf16_f32 v160,v128,v129
v_cvt_pk_bf16_f32 v161,v130,v131
v_cvt_pk_bf16_f32 v162,v132,v133
v_cvt_pk_bf16_f32 v163,v134,v135
v_cvt_pk_bf16_f32 v164,v136,v137
v_cvt_pk_bf16_f32 v165,v138,v139
v_cvt_pk_bf16_f32 v166,v140,v141
v_cvt_pk_bf16_f32 v167,v142,v143
s_add_u32 s31,s101,32768
buffer_store_dwordx4 v[160:163],v192,s[8:11],s31 offen sc1
buffer_store_dwordx4 v[164:167],v192,s[8:11],s31 offen offset:1024 sc1
s_lshl_b32 s30,s97,7
s_lshl_b32 s31,s98,3
s_add_u32 s30,s30,s31
s_add_u32 s30,s30,50597888
s_waitcnt vmcnt(0)
s_barrier
s_cmp_lg_u32 s24,0
s_cbranch_scc1 sf_231
v_mov_b32 v248,0x01010101
s_add_u32 s30,s30,s62
v_lshrrev_b32 v249,2,v198
s_cmp_eq_u32 s62,6
s_cselect_b64 exec,3,1
buffer_store_byte v248,v249,s[8:11],s30 offen sc1
s_mov_b64 exec,-1
sf_231:
s_branch L_next
L_uX:
s_lshl_b32 s99,s97,2
s_add_u32 s99,s99,s24
v_mov_b32 v112,-1
v_mov_b32 v113,-1
v_mov_b32 v114,-1
v_mov_b32 v115,-1
s_add_u32 s30,s99,0
s_min_u32 s30,s30,31
s_lshl_b32 s30,s30,10
s_add_u32 s30,s30,51871744
buffer_store_dwordx4 v[112:115],v192,s[8:11],s30 offen sc1
s_add_u32 s30,s99,0
s_min_u32 s30,s30,159
s_lshl_b32 s30,s30,10
s_add_u32 s30,s30,63275008
buffer_store_dwordx4 v[112:115],v192,s[8:11],s30 offen sc1
s_add_u32 s30,s99,64
s_min_u32 s30,s30,159
s_lshl_b32 s30,s30,10
s_add_u32 s30,s30,63275008
buffer_store_dwordx4 v[112:115],v192,s[8:11],s30 offen sc1
s_add_u32 s30,s99,128
s_min_u32 s30,s30,159
s_lshl_b32 s30,s30,10
s_add_u32 s30,s30,63275008
buffer_store_dwordx4 v[112:115],v192,s[8:11],s30 offen sc1
s_add_u32 s30,s99,0
s_min_u32 s30,s30,447
s_lshl_b32 s30,s30,10
s_add_u32 s30,s30,59441152
buffer_store_dwordx4 v[112:115],v192,s[8:11],s30 offen sc1
s_add_u32 s30,s99,64
s_min_u32 s30,s30,447
s_lshl_b32 s30,s30,10
s_add_u32 s30,s30,59441152
buffer_store_dwordx4 v[112:115],v192,s[8:11],s30 offen sc1
s_add_u32 s30,s99,128
s_min_u32 s30,s30,447
s_lshl_b32 s30,s30,10
s_add_u32 s30,s30,59441152
buffer_store_dwordx4 v[112:115],v192,s[8:11],s30 offen sc1
s_add_u32 s30,s99,192
s_min_u32 s30,s30,447
s_lshl_b32 s30,s30,10
s_add_u32 s30,s30,59441152
buffer_store_dwordx4 v[112:115],v192,s[8:11],s30 offen sc1
s_add_u32 s30,s99,256
s_min_u32 s30,s30,447
s_lshl_b32 s30,s30,10
s_add_u32 s30,s30,59441152
buffer_store_dwordx4 v[112:115],v192,s[8:11],s30 offen sc1
s_add_u32 s30,s99,320
s_min_u32 s30,s30,447
s_lshl_b32 s30,s30,10
s_add_u32 s30,s30,59441152
buffer_store_dwordx4 v[112:115],v192,s[8:11],s30 offen sc1
s_add_u32 s30,s99,384
s_min_u32 s30,s30,447
s_lshl_b32 s30,s30,10
s_add_u32 s30,s30,59441152
buffer_store_dwordx4 v[112:115],v192,s[8:11],s30 offen sc1
s_mul_i32 s31,s99,28672
s_add_u32 s56,s31,14336
s_mul_i32 s57,s24,28672
s_add_u32 s57,s57,28672
v_add_u32 v208,s57,v196
v_add_u32 v209,s57,v197
s_add_u32 m0,s57,0
s_nop 0
buffer_load_dwordx4 v195,s[12:15],s31 offen lds
s_add_u32 m0,s57,1024
s_nop 0
buffer_load_dwordx4 v195,s[12:15],s56 offen lds
s_add_u32 m0,s57,1984
s_nop 0
buffer_load_dwordx4 v195,s[12:15],s31 offen offset:64 lds
s_add_u32 m0,s57,3008
s_nop 0
buffer_load_dwordx4 v195,s[12:15],s56 offen offset:64 lds
s_add_u32 m0,s57,3968
s_nop 0
buffer_load_dwordx4 v195,s[12:15],s31 offen offset:128 lds
s_add_u32 m0,s57,4992
s_nop 0
buffer_load_dwordx4 v195,s[12:15],s56 offen offset:128 lds
s_add_u32 m0,s57,5952
s_nop 0
buffer_load_dwordx4 v195,s[12:15],s31 offen offset:192 lds
s_add_u32 m0,s57,6976
s_nop 0
buffer_load_dwordx4 v195,s[12:15],s56 offen offset:192 lds
s_add_u32 m0,s57,7936
s_nop 0
buffer_load_dwordx4 v195,s[12:15],s31 offen offset:256 lds
s_add_u32 m0,s57,8960
s_nop 0
buffer_load_dwordx4 v195,s[12:15],s56 offen offset:256 lds
s_add_u32 m0,s57,9920
s_nop 0
buffer_load_dwordx4 v195,s[12:15],s31 offen offset:320 lds
s_add_u32 m0,s57,10944
s_nop 0
buffer_load_dwordx4 v195,s[12:15],s56 offen offset:320 lds
s_add_u32 m0,s57,11904
s_nop 0
buffer_load_dwordx4 v195,s[12:15],s31 offen offset:384 lds
s_add_u32 m0,s57,12928
s_nop 0
buffer_load_dwordx4 v195,s[12:15],s56 offen offset:384 lds
s_add_u32 m0,s57,13888
s_nop 0
buffer_load_dwordx4 v195,s[12:15],s31 offen offset:448 lds
s_add_u32 m0,s57,14912
s_nop 0
buffer_load_dwordx4 v195,s[12:15],s56 offen offset:448 lds
s_add_u32 m0,s57,15872
s_nop 0
buffer_load_dwordx4 v195,s[12:15],s31 offen offset:512 lds
s_add_u32 m0,s57,16896
s_nop 0
buffer_load_dwordx4 v195,s[12:15],s56 offen offset:512 lds
s_add_u32 m0,s57,17856
s_nop 0
buffer_load_dwordx4 v195,s[12:15],s31 offen offset:576 lds
s_add_u32 m0,s57,18880
s_nop 0
buffer_load_dwordx4 v195,s[12:15],s56 offen offset:576 lds
s_add_u32 m0,s57,19840
s_nop 0
buffer_load_dwordx4 v195,s[12:15],s31 offen offset:640 lds
s_add_u32 m0,s57,20864
s_nop 0
buffer_load_dwordx4 v195,s[12:15],s56 offen offset:640 lds
s_add_u32 m0,s57,21824
s_nop 0
buffer_load_dwordx4 v195,s[12:15],s31 offen offset:704 lds
s_add_u32 m0,s57,22848
s_nop 0
buffer_load_dwordx4 v195,s[12:15],s56 offen offset:704 lds
s_add_u32 m0,s57,23808
s_nop 0
buffer_load_dwordx4 v195,s[12:15],s31 offen offset:768 lds
s_add_u32 m0,s57,24832
s_nop 0
buffer_load_dwordx4 v195,s[12:15],s56 offen offset:768 lds
s_add_u32 m0,s57,25792
s_nop 0
buffer_load_dwordx4 v195,s[12:15],s31 offen offset:832 lds
s_add_u32 m0,s57,26816
s_nop 0
buffer_load_dwordx4 v195,s[12:15],s56 offen offset:832 lds
s_waitcnt vmcnt(0)
v_bfe_u32 v210,v192,4,1
v_bfe_u32 v211,v192,5,1
v_lshl_add_u32 v210,v210,1,v211
v_bfe_u32 v211,v192,8,1
v_lshlrev_b32 v211,1,v211
v_xor_b32 v211,v211,v210
v_lshlrev_b32 v211,4,v211
v_lshl_add_u32 v211,v210,8,v211
v_bfe_u32 v210,v192,6,1
v_lshl_add_u32 v211,v210,7,v211
v_bfe_u32 v210,v192,7,1
v_lshl_add_u32 v211,v210,10,v211
v_bfe_u32 v210,v192,9,1
v_lshl_add_u32 v211,v210,11,v211
v_add_u32 v210,s57,v211
v_xor_b32 v211,16,v210
s_lshl_b32 s56,s99,15
s_add_u32 s56,s56,63963136
ds_read_b128 v[0:3],v210 offset:0
ds_read_b128 v[4:7],v210 offset:4096
ds_read_b128 v[8:11],v210 offset:16384
ds_read_b128 v[12:15],v210 offset:20480
ds_read_b128 v[16:19],v210 offset:64
ds_read_b128 v[20:23],v210 offset:4160
ds_read_b128 v[24:27],v210 offset:16448
ds_read_b128 v[28:31],v210 offset:20544
ds_read_b128 v[32:35],v211 offset:0
ds_read_b128 v[36:39],v211 offset:4096
ds_read_b128 v[40:43],v211 offset:16384
ds_read_b128 v[44:47],v211 offset:20480
ds_read_b128 v[48:51],v211 offset:64
ds_read_b128 v[52:55],v211 offset:4160
ds_read_b128 v[56:59],v211 offset:16448
ds_read_b128 v[60:63],v211 offset:20544
ds_read_b128 a[144:147],v210 offset:8192
ds_read_b128 a[148:151],v210 offset:12288
ds_read_b128 a[152:155],v210 offset:20480
ds_read_b128 a[156:159],v210 offset:24576
ds_read_b128 a[160:163],v210 offset:8256
ds_read_b128 a[164:167],v210 offset:12352
ds_read_b128 a[168:171],v210 offset:20544
ds_read_b128 a[172:175],v210 offset:24640
ds_read_b128 a[176:179],v211 offset:8192
ds_read_b128 a[180:183],v211 offset:12288
ds_read_b128 a[184:187],v211 offset:20480
ds_read_b128 a[188:191],v211 offset:24576
ds_read_b128 a[192:195],v211 offset:8256
ds_read_b128 a[196:199],v211 offset:12352
ds_read_b128 a[200:203],v211 offset:20544
ds_read_b128 a[204:207],v211 offset:24640
s_waitcnt lgkmcnt(0)
s_add_u32 s31,s56,0
buffer_store_dwordx4 v[0:3],v192,s[8:11],s31 offen sc1
buffer_store_dwordx4 v[4:7],v192,s[8:11],s31 offen offset:1024 sc1
buffer_store_dwordx4 v[8:11],v192,s[8:11],s31 offen offset:2048 sc1
buffer_store_dwordx4 v[12:15],v192,s[8:11],s31 offen offset:3072 sc1
s_add_u32 s31,s56,4096
buffer_store_dwordx4 v[16:19],v192,s[8:11],s31 offen sc1
buffer_store_dwordx4 v[20:23],v192,s[8:11],s31 offen offset:1024 sc1
buffer_store_dwordx4 v[24:27],v192,s[8:11],s31 offen offset:2048 sc1
buffer_store_dwordx4 v[28:31],v192,s[8:11],s31 offen offset:3072 sc1
s_add_u32 s31,s56,8192
buffer_store_dwordx4 v[32:35],v192,s[8:11],s31 offen sc1
buffer_store_dwordx4 v[36:39],v192,s[8:11],s31 offen offset:1024 sc1
buffer_store_dwordx4 v[40:43],v192,s[8:11],s31 offen offset:2048 sc1
buffer_store_dwordx4 v[44:47],v192,s[8:11],s31 offen offset:3072 sc1
s_add_u32 s31,s56,12288
buffer_store_dwordx4 v[48:51],v192,s[8:11],s31 offen sc1
buffer_store_dwordx4 v[52:55],v192,s[8:11],s31 offen offset:1024 sc1
buffer_store_dwordx4 v[56:59],v192,s[8:11],s31 offen offset:2048 sc1
buffer_store_dwordx4 v[60:63],v192,s[8:11],s31 offen offset:3072 sc1
s_add_u32 s31,s56,16384
buffer_store_dwordx4 a[144:147],v192,s[8:11],s31 offen sc1
buffer_store_dwordx4 a[148:151],v192,s[8:11],s31 offen offset:1024 sc1
buffer_store_dwordx4 a[152:155],v192,s[8:11],s31 offen offset:2048 sc1
buffer_store_dwordx4 a[156:159],v192,s[8:11],s31 offen offset:3072 sc1
s_add_u32 s31,s56,20480
buffer_store_dwordx4 a[160:163],v192,s[8:11],s31 offen sc1
buffer_store_dwordx4 a[164:167],v192,s[8:11],s31 offen offset:1024 sc1
buffer_store_dwordx4 a[168:171],v192,s[8:11],s31 offen offset:2048 sc1
buffer_store_dwordx4 a[172:175],v192,s[8:11],s31 offen offset:3072 sc1
s_add_u32 s31,s56,24576
buffer_store_dwordx4 a[176:179],v192,s[8:11],s31 offen sc1
buffer_store_dwordx4 a[180:183],v192,s[8:11],s31 offen offset:1024 sc1
buffer_store_dwordx4 a[184:187],v192,s[8:11],s31 offen offset:2048 sc1
buffer_store_dwordx4 a[188:191],v192,s[8:11],s31 offen offset:3072 sc1
s_add_u32 s31,s56,28672
buffer_store_dwordx4 a[192:195],v192,s[8:11],s31 offen sc1
buffer_store_dwordx4 a[196:199],v192,s[8:11],s31 offen offset:1024 sc1
buffer_store_dwordx4 a[200:203],v192,s[8:11],s31 offen offset:2048 sc1
buffer_store_dwordx4 a[204:207],v192,s[8:11],s31 offen offset:3072 sc1
s_lshl_b32 s30,s97,7
s_add_u32 s30,s30,50599968
s_waitcnt vmcnt(0)
s_barrier
s_cmp_lg_u32 s24,0
s_cbranch_scc1 sf_232
v_mov_b32 v248,1
s_mov_b64 exec,1
buffer_store_dword v248,v199,s[8:11],s30 offen sc1
s_mov_b64 exec,-1
sf_232:
s_branch L_next
L_uQ:
s_lshl_b32 s99,s97,2
s_add_u32 s99,s99,s24
s_lshl_b32 s59,s98,7
s_add_u32 s59,s59,50593792
s_mul_i32 s100,s98,401408
s_add_u32 s100,s100,0
s_mul_i32 s60,s24,7168
s_mul_i32 s31,s99,28672
s_add_u32 s56,s31,14336
s_mul_i32 s57,s24,28672
s_add_u32 s57,s57,28672
v_add_u32 v208,s57,v196
v_add_u32 v209,s57,v197
s_add_u32 m0,s57,0
s_nop 0
buffer_load_dwordx4 v195,s[12:15],s31 offen lds
s_add_u32 m0,s57,1024
s_nop 0
buffer_load_dwordx4 v195,s[12:15],s56 offen lds
s_add_u32 m0,s57,1984
s_nop 0
buffer_load_dwordx4 v195,s[12:15],s31 offen offset:64 lds
s_add_u32 m0,s57,3008
s_nop 0
buffer_load_dwordx4 v195,s[12:15],s56 offen offset:64 lds
s_add_u32 m0,s57,3968
s_nop 0
buffer_load_dwordx4 v195,s[12:15],s31 offen offset:128 lds
s_add_u32 m0,s57,4992
s_nop 0
buffer_load_dwordx4 v195,s[12:15],s56 offen offset:128 lds
s_add_u32 m0,s57,5952
s_nop 0
buffer_load_dwordx4 v195,s[12:15],s31 offen offset:192 lds
s_add_u32 m0,s57,6976
s_nop 0
buffer_load_dwordx4 v195,s[12:15],s56 offen offset:192 lds
s_add_u32 m0,s57,7936
s_nop 0
buffer_load_dwordx4 v195,s[12:15],s31 offen offset:256 lds
s_add_u32 m0,s57,8960
s_nop 0
buffer_load_dwordx4 v195,s[12:15],s56 offen offset:256 lds
s_add_u32 m0,s57,9920
s_nop 0
buffer_load_dwordx4 v195,s[12:15],s31 offen offset:320 lds
s_add_u32 m0,s57,10944
s_nop 0
buffer_load_dwordx4 v195,s[12:15],s56 offen offset:320 lds
s_add_u32 m0,s57,11904
s_nop 0
buffer_load_dwordx4 v195,s[12:15],s31 offen offset:384 lds
s_add_u32 m0,s57,12928
s_nop 0
buffer_load_dwordx4 v195,s[12:15],s56 offen offset:384 lds
s_add_u32 m0,s57,13888
s_nop 0
buffer_load_dwordx4 v195,s[12:15],s31 offen offset:448 lds
s_add_u32 m0,s57,14912
s_nop 0
buffer_load_dwordx4 v195,s[12:15],s56 offen offset:448 lds
s_add_u32 m0,s57,15872
s_nop 0
buffer_load_dwordx4 v195,s[12:15],s31 offen offset:512 lds
s_add_u32 m0,s57,16896
s_nop 0
buffer_load_dwordx4 v195,s[12:15],s56 offen offset:512 lds
s_add_u32 m0,s57,17856
s_nop 0
buffer_load_dwordx4 v195,s[12:15],s31 offen offset:576 lds
s_add_u32 m0,s57,18880
s_nop 0
buffer_load_dwordx4 v195,s[12:15],s56 offen offset:576 lds
s_add_u32 m0,s57,19840
s_nop 0
buffer_load_dwordx4 v195,s[12:15],s31 offen offset:640 lds
s_add_u32 m0,s57,20864
s_nop 0
buffer_load_dwordx4 v195,s[12:15],s56 offen offset:640 lds
s_add_u32 m0,s57,21824
s_nop 0
buffer_load_dwordx4 v195,s[12:15],s31 offen offset:704 lds
s_add_u32 m0,s57,22848
s_nop 0
buffer_load_dwordx4 v195,s[12:15],s56 offen offset:704 lds
s_add_u32 m0,s57,23808
s_nop 0
buffer_load_dwordx4 v195,s[12:15],s31 offen offset:768 lds
s_add_u32 m0,s57,24832
s_nop 0
buffer_load_dwordx4 v195,s[12:15],s56 offen offset:768 lds
s_add_u32 m0,s57,25792
s_nop 0
buffer_load_dwordx4 v195,s[12:15],s31 offen offset:832 lds
s_add_u32 m0,s57,26816
s_nop 0
buffer_load_dwordx4 v195,s[12:15],s56 offen offset:832 lds
s_waitcnt vmcnt(26)
ds_read_b128 v[0:3],v208 offset:0
ds_read_b128 v[4:7],v209 offset:0
s_waitcnt vmcnt(24)
ds_read_b128 v[8:11],v208 offset:2048
ds_read_b128 v[12:15],v209 offset:2048
s_waitcnt vmcnt(22)
ds_read_b128 v[16:19],v208 offset:4096
ds_read_b128 v[20:23],v209 offset:4096
s_waitcnt vmcnt(20)
ds_read_b128 v[24:27],v208 offset:6144
ds_read_b128 v[28:31],v209 offset:6144
s_waitcnt vmcnt(18)
ds_read_b128 v[32:35],v208 offset:8192
ds_read_b128 v[36:39],v209 offset:8192
s_waitcnt vmcnt(16)
ds_read_b128 v[40:43],v208 offset:10240
ds_read_b128 v[44:47],v209 offset:10240
s_waitcnt vmcnt(14)
ds_read_b128 v[48:51],v208 offset:12288
ds_read_b128 v[52:55],v209 offset:12288
s_waitcnt vmcnt(12)
ds_read_b128 v[56:59],v208 offset:14336
ds_read_b128 v[60:63],v209 offset:14336
s_waitcnt vmcnt(10)
ds_read_b128 v[64:67],v208 offset:16384
ds_read_b128 v[68:71],v209 offset:16384
s_waitcnt vmcnt(8)
ds_read_b128 v[72:75],v208 offset:18432
ds_read_b128 v[76:79],v209 offset:18432
s_waitcnt vmcnt(6)
ds_read_b128 v[80:83],v208 offset:20480
ds_read_b128 v[84:87],v209 offset:20480
s_waitcnt vmcnt(4)
ds_read_b128 v[88:91],v208 offset:22528
ds_read_b128 v[92:95],v209 offset:22528
s_waitcnt vmcnt(2)
ds_read_b128 v[96:99],v208 offset:24576
ds_read_b128 v[100:103],v209 offset:24576
s_waitcnt vmcnt(0)
ds_read_b128 v[104:107],v208 offset:26624
ds_read_b128 v[108:111],v209 offset:26624
s_waitcnt lgkmcnt(15)
v_permlane32_swap_b32 v0,v2
v_permlane32_swap_b32 v1,v3
s_waitcnt lgkmcnt(15)
v_permlane32_swap_b32 v4,v6
v_permlane32_swap_b32 v5,v7
s_waitcnt lgkmcnt(15)
v_permlane32_swap_b32 v8,v10
v_permlane32_swap_b32 v9,v11
s_waitcnt lgkmcnt(15)
v_permlane32_swap_b32 v12,v14
v_permlane32_swap_b32 v13,v15
s_waitcnt lgkmcnt(15)
v_permlane32_swap_b32 v16,v18
v_permlane32_swap_b32 v17,v19
s_waitcnt lgkmcnt(15)
v_permlane32_swap_b32 v20,v22
v_permlane32_swap_b32 v21,v23
s_waitcnt lgkmcnt(15)
v_permlane32_swap_b32 v24,v26
v_permlane32_swap_b32 v25,v27
s_waitcnt lgkmcnt(15)
v_permlane32_swap_b32 v28,v30
v_permlane32_swap_b32 v29,v31
s_waitcnt lgkmcnt(15)
v_permlane32_swap_b32 v32,v34
v_permlane32_swap_b32 v33,v35
s_waitcnt lgkmcnt(15)
v_permlane32_swap_b32 v36,v38
v_permlane32_swap_b32 v37,v39
s_waitcnt lgkmcnt(15)
v_permlane32_swap_b32 v40,v42
v_permlane32_swap_b32 v41,v43
s_waitcnt lgkmcnt(15)
v_permlane32_swap_b32 v44,v46
v_permlane32_swap_b32 v45,v47
s_waitcnt lgkmcnt(15)
v_permlane32_swap_b32 v48,v50
v_permlane32_swap_b32 v49,v51
s_waitcnt lgkmcnt(14)
v_permlane32_swap_b32 v52,v54
v_permlane32_swap_b32 v53,v55
s_waitcnt lgkmcnt(13)
v_permlane32_swap_b32 v56,v58
v_permlane32_swap_b32 v57,v59
s_waitcnt lgkmcnt(12)
v_permlane32_swap_b32 v60,v62
v_permlane32_swap_b32 v61,v63
s_waitcnt lgkmcnt(11)
v_permlane32_swap_b32 v64,v66
v_permlane32_swap_b32 v65,v67
s_waitcnt lgkmcnt(10)
v_permlane32_swap_b32 v68,v70
v_permlane32_swap_b32 v69,v71
s_waitcnt lgkmcnt(9)
v_permlane32_swap_b32 v72,v74
v_permlane32_swap_b32 v73,v75
s_waitcnt lgkmcnt(8)
v_permlane32_swap_b32 v76,v78
v_permlane32_swap_b32 v77,v79
s_waitcnt lgkmcnt(7)
v_permlane32_swap_b32 v80,v82
v_permlane32_swap_b32 v81,v83
s_waitcnt lgkmcnt(6)
v_permlane32_swap_b32 v84,v86
v_permlane32_swap_b32 v85,v87
s_waitcnt lgkmcnt(5)
v_permlane32_swap_b32 v88,v90
v_permlane32_swap_b32 v89,v91
s_waitcnt lgkmcnt(4)
v_permlane32_swap_b32 v92,v94
v_permlane32_swap_b32 v93,v95
s_waitcnt lgkmcnt(3)
v_permlane32_swap_b32 v96,v98
v_permlane32_swap_b32 v97,v99
s_waitcnt lgkmcnt(2)
v_permlane32_swap_b32 v100,v102
v_permlane32_swap_b32 v101,v103
s_waitcnt lgkmcnt(1)
v_permlane32_swap_b32 v104,v106
v_permlane32_swap_b32 v105,v107
s_waitcnt lgkmcnt(0)
v_permlane32_swap_b32 v108,v110
v_permlane32_swap_b32 v109,v111
v_accvgpr_write_b32 a0,v0
v_accvgpr_write_b32 a1,v2
v_accvgpr_write_b32 a2,v1
v_accvgpr_write_b32 a3,v3
v_accvgpr_write_b32 a4,v4
v_accvgpr_write_b32 a5,v6
v_accvgpr_write_b32 a6,v5
v_accvgpr_write_b32 a7,v7
v_accvgpr_write_b32 a8,v8
v_accvgpr_write_b32 a9,v10
v_accvgpr_write_b32 a10,v9
v_accvgpr_write_b32 a11,v11
v_accvgpr_write_b32 a12,v12
v_accvgpr_write_b32 a13,v14
v_accvgpr_write_b32 a14,v13
v_accvgpr_write_b32 a15,v15
v_accvgpr_write_b32 a16,v16
v_accvgpr_write_b32 a17,v18
v_accvgpr_write_b32 a18,v17
v_accvgpr_write_b32 a19,v19
v_accvgpr_write_b32 a20,v20
v_accvgpr_write_b32 a21,v22
v_accvgpr_write_b32 a22,v21
v_accvgpr_write_b32 a23,v23
v_accvgpr_write_b32 a24,v24
v_accvgpr_write_b32 a25,v26
v_accvgpr_write_b32 a26,v25
v_accvgpr_write_b32 a27,v27
v_accvgpr_write_b32 a28,v28
v_accvgpr_write_b32 a29,v30
v_accvgpr_write_b32 a30,v29
v_accvgpr_write_b32 a31,v31
v_accvgpr_write_b32 a32,v32
v_accvgpr_write_b32 a33,v34
v_accvgpr_write_b32 a34,v33
v_accvgpr_write_b32 a35,v35
v_accvgpr_write_b32 a36,v36
v_accvgpr_write_b32 a37,v38
v_accvgpr_write_b32 a38,v37
v_accvgpr_write_b32 a39,v39
v_accvgpr_write_b32 a40,v40
v_accvgpr_write_b32 a41,v42
v_accvgpr_write_b32 a42,v41
v_accvgpr_write_b32 a43,v43
v_accvgpr_write_b32 a44,v44
v_accvgpr_write_b32 a45,v46
v_accvgpr_write_b32 a46,v45
v_accvgpr_write_b32 a47,v47
v_accvgpr_write_b32 a48,v48
v_accvgpr_write_b32 a49,v50
v_accvgpr_write_b32 a50,v49
v_accvgpr_write_b32 a51,v51
v_accvgpr_write_b32 a52,v52
v_accvgpr_write_b32 a53,v54
v_accvgpr_write_b32 a54,v53
v_accvgpr_write_b32 a55,v55
v_accvgpr_write_b32 a56,v56
v_accvgpr_write_b32 a57,v58
v_accvgpr_write_b32 a58,v57
v_accvgpr_write_b32 a59,v59
v_accvgpr_write_b32 a60,v60
v_accvgpr_write_b32 a61,v62
v_accvgpr_write_b32 a62,v61
v_accvgpr_write_b32 a63,v63
v_accvgpr_write_b32 a64,v64
v_accvgpr_write_b32 a65,v66
v_accvgpr_write_b32 a66,v65
v_accvgpr_write_b32 a67,v67
v_accvgpr_write_b32 a68,v68
v_accvgpr_write_b32 a69,v70
v_accvgpr_write_b32 a70,v69
v_accvgpr_write_b32 a71,v71
v_accvgpr_write_b32 a72,v72
v_accvgpr_write_b32 a73,v74
v_accvgpr_write_b32 a74,v73
v_accvgpr_write_b32 a75,v75
v_accvgpr_write_b32 a76,v76
v_accvgpr_write_b32 a77,v78
v_accvgpr_write_b32 a78,v77
v_accvgpr_write_b32 a79,v79
v_accvgpr_write_b32 a80,v80
v_accvgpr_write_b32 a81,v82
v_accvgpr_write_b32 a82,v81
v_accvgpr_write_b32 a83,v83
v_accvgpr_write_b32 a84,v84
v_accvgpr_write_b32 a85,v86
v_accvgpr_write_b32 a86,v85
v_accvgpr_write_b32 a87,v87
v_accvgpr_write_b32 a88,v88
v_accvgpr_write_b32 a89,v90
v_accvgpr_write_b32 a90,v89
v_accvgpr_write_b32 a91,v91
v_accvgpr_write_b32 a92,v92
v_accvgpr_write_b32 a93,v94
v_accvgpr_write_b32 a94,v93
v_accvgpr_write_b32 a95,v95
v_accvgpr_write_b32 a96,v96
v_accvgpr_write_b32 a97,v98
v_accvgpr_write_b32 a98,v97
v_accvgpr_write_b32 a99,v99
v_accvgpr_write_b32 a100,v100
v_accvgpr_write_b32 a101,v102
v_accvgpr_write_b32 a102,v101
v_accvgpr_write_b32 a103,v103
v_accvgpr_write_b32 a104,v104
v_accvgpr_write_b32 a105,v106
v_accvgpr_write_b32 a106,v105
v_accvgpr_write_b32 a107,v107
v_accvgpr_write_b32 a108,v108
v_accvgpr_write_b32 a109,v110
v_accvgpr_write_b32 a110,v109
v_accvgpr_write_b32 a111,v111
s_barrier
s_mov_b64 exec,0x7f
s_mov_b32 s27,0
wf_233:
buffer_load_dword v248,v198,s[8:11],s59 offen sc1
s_waitcnt vmcnt(0)
v_cmp_gt_u32 vcc,3,v248
s_cbranch_vccz wfd_234
s_sleep 1
s_add_u32 s27,s27,1
s_cmp_lt_u32 s27,32768
s_cbranch_scc1 wf_233
s_mov_b32 s38,9
wfd_234:
s_mov_b64 exec,-1
s_add_u32 s30,s100,0
s_add_u32 m0,s60,0
s_nop 0
buffer_load_dwordx4 v194,s[8:11],s30 offen sc1 lds
buffer_load_dwordx4 v194,s[8:11],s30 offen offset:1024 sc1 lds
buffer_load_dwordx4 v194,s[8:11],s30 offen offset:2048 sc1 lds
buffer_load_dwordx4 v194,s[8:11],s30 offen offset:3072 sc1 lds
s_add_u32 s30,s100,4096
s_add_u32 m0,s60,4096
s_nop 0
buffer_load_dwordx4 v194,s[8:11],s30 offen sc1 lds
buffer_load_dwordx4 v194,s[8:11],s30 offen offset:1024 sc1 lds
buffer_load_dwordx4 v194,s[8:11],s30 offen offset:2048 sc1 lds
s_add_u32 s30,s100,28672
s_add_u32 m0,s60,28672
s_nop 0
buffer_load_dwordx4 v194,s[8:11],s30 offen sc1 lds
buffer_load_dwordx4 v194,s[8:11],s30 offen offset:1024 sc1 lds
buffer_load_dwordx4 v194,s[8:11],s30 offen offset:2048 sc1 lds
buffer_load_dwordx4 v194,s[8:11],s30 offen offset:3072 sc1 lds
s_add_u32 s30,s100,32768
s_add_u32 m0,s60,32768
s_nop 0
buffer_load_dwordx4 v194,s[8:11],s30 offen sc1 lds
buffer_load_dwordx4 v194,s[8:11],s30 offen offset:1024 sc1 lds
buffer_load_dwordx4 v194,s[8:11],s30 offen offset:2048 sc1 lds
s_add_u32 s30,s100,57344
s_add_u32 m0,s60,57344
s_nop 0
buffer_load_dwordx4 v194,s[8:11],s30 offen sc1 lds
buffer_load_dwordx4 v194,s[8:11],s30 offen offset:1024 sc1 lds
buffer_load_dwordx4 v194,s[8:11],s30 offen offset:2048 sc1 lds
buffer_load_dwordx4 v194,s[8:11],s30 offen offset:3072 sc1 lds
s_add_u32 s30,s100,61440
s_add_u32 m0,s60,61440
s_nop 0
buffer_load_dwordx4 v194,s[8:11],s30 offen sc1 lds
buffer_load_dwordx4 v194,s[8:11],s30 offen offset:1024 sc1 lds
buffer_load_dwordx4 v194,s[8:11],s30 offen offset:2048 sc1 lds
s_waitcnt vmcnt(14)
s_barrier
ds_read_b128 a[112:115],v192 offset:0
ds_read_b128 a[116:119],v192 offset:1024
ds_read_b128 a[120:123],v192 offset:2048
ds_read_b128 a[124:127],v192 offset:3072
ds_read_b128 a[128:131],v192 offset:4096
ds_read_b128 a[132:135],v192 offset:5120
ds_read_b128 a[136:139],v192 offset:6144
s_waitcnt lgkmcnt(6)
v_mfma_f32_32x32x16_bf16 v[112:127],a[112:115],a[0:3],0
ds_read_b128 a[140:143],v192 offset:7168
s_waitcnt lgkmcnt(6)
v_mfma_f32_32x32x16_bf16 v[112:127],a[116:119],a[4:7],v[112:127]
ds_read_b128 a[112:115],v192 offset:8192
s_waitcnt lgkmcnt(6)
v_mfma_f32_32x32x16_bf16 v[112:127],a[120:123],a[8:11],v[112:127]
ds_read_b128 a[116:119],v192 offset:9216
s_waitcnt lgkmcnt(6)
v_mfma_f32_32x32x16_bf16 v[112:127],a[124:127],a[12:15],v[112:127]
ds_read_b128 a[120:123],v192 offset:10240
s_waitcnt lgkmcnt(6)
v_mfma_f32_32x32x16_bf16 v[112:127],a[128:131],a[16:19],v[112:127]
ds_read_b128 a[124:127],v192 offset:11264
s_waitcnt lgkmcnt(6)
v_mfma_f32_32x32x16_bf16 v[112:127],a[132:135],a[20:23],v[112:127]
ds_read_b128 a[128:131],v192 offset:12288
s_waitcnt lgkmcnt(6)
v_mfma_f32_32x32x16_bf16 v[112:127],a[136:139],a[24:27],v[112:127]
ds_read_b128 a[132:135],v192 offset:13312
s_waitcnt lgkmcnt(6)
v_mfma_f32_32x32x16_bf16 v[112:127],a[140:143],a[28:31],v[112:127]
ds_read_b128 a[136:139],v192 offset:14336
s_waitcnt lgkmcnt(6)
v_mfma_f32_32x32x16_bf16 v[112:127],a[112:115],a[32:35],v[112:127]
ds_read_b128 a[140:143],v192 offset:15360
s_waitcnt lgkmcnt(6)
v_mfma_f32_32x32x16_bf16 v[112:127],a[116:119],a[36:39],v[112:127]
ds_read_b128 a[112:115],v192 offset:16384
s_waitcnt lgkmcnt(6)
v_mfma_f32_32x32x16_bf16 v[112:127],a[120:123],a[40:43],v[112:127]
ds_read_b128 a[116:119],v192 offset:17408
s_waitcnt lgkmcnt(6)
v_mfma_f32_32x32x16_bf16 v[112:127],a[124:127],a[44:47],v[112:127]
ds_read_b128 a[120:123],v192 offset:18432
s_waitcnt lgkmcnt(6)
v_mfma_f32_32x32x16_bf16 v[112:127],a[128:131],a[48:51],v[112:127]
ds_read_b128 a[124:127],v192 offset:19456
s_waitcnt lgkmcnt(6)
v_mfma_f32_32x32x16_bf16 v[112:127],a[132:135],a[52:55],v[112:127]
ds_read_b128 a[128:131],v192 offset:20480
s_waitcnt lgkmcnt(6)
v_mfma_f32_32x32x16_bf16 v[112:127],a[136:139],a[56:59],v[112:127]
ds_read_b128 a[132:135],v192 offset:21504
s_waitcnt lgkmcnt(6)
v_mfma_f32_32x32x16_bf16 v[112:127],a[140:143],a[60:63],v[112:127]
ds_read_b128 a[136:139],v192 offset:22528
s_waitcnt lgkmcnt(6)
v_mfma_f32_32x32x16_bf16 v[112:127],a[112:115],a[64:67],v[112:127]
ds_read_b128 a[140:143],v192 offset:23552
s_waitcnt lgkmcnt(6)
v_mfma_f32_32x32x16_bf16 v[112:127],a[116:119],a[68:71],v[112:127]
ds_read_b128 a[112:115],v192 offset:24576
s_waitcnt lgkmcnt(6)
v_mfma_f32_32x32x16_bf16 v[112:127],a[120:123],a[72:75],v[112:127]
ds_read_b128 a[116:119],v192 offset:25600
s_waitcnt lgkmcnt(6)
v_mfma_f32_32x32x16_bf16 v[112:127],a[124:127],a[76:79],v[112:127]
ds_read_b128 a[120:123],v192 offset:26624
s_waitcnt vmcnt(7)
s_barrier
s_waitcnt lgkmcnt(6)
v_mfma_f32_32x32x16_bf16 v[112:127],a[128:131],a[80:83],v[112:127]
ds_read_b128 a[124:127],v192 offset:27648
s_add_u32 s30,s100,86016
s_add_u32 m0,s60,86016
s_nop 0
buffer_load_dwordx4 v194,s[8:11],s30 offen sc1 lds
s_waitcnt lgkmcnt(6)
v_mfma_f32_32x32x16_bf16 v[112:127],a[132:135],a[84:87],v[112:127]
ds_read_b128 a[128:131],v192 offset:28672
s_waitcnt lgkmcnt(6)
v_mfma_f32_32x32x16_bf16 v[112:127],a[136:139],a[88:91],v[112:127]
ds_read_b128 a[132:135],v192 offset:29696
s_waitcnt lgkmcnt(6)
v_mfma_f32_32x32x16_bf16 v[112:127],a[140:143],a[92:95],v[112:127]
ds_read_b128 a[136:139],v192 offset:30720
s_waitcnt lgkmcnt(6)
v_mfma_f32_32x32x16_bf16 v[112:127],a[112:115],a[96:99],v[112:127]
ds_read_b128 a[140:143],v192 offset:31744
buffer_load_dwordx4 v194,s[8:11],s30 offen offset:1024 sc1 lds
s_waitcnt lgkmcnt(6)
v_mfma_f32_32x32x16_bf16 v[112:127],a[116:119],a[100:103],v[112:127]
ds_read_b128 a[112:115],v192 offset:32768
s_waitcnt lgkmcnt(6)
v_mfma_f32_32x32x16_bf16 v[112:127],a[120:123],a[104:107],v[112:127]
ds_read_b128 a[116:119],v192 offset:33792
s_waitcnt lgkmcnt(6)
v_mfma_f32_32x32x16_bf16 v[112:127],a[124:127],a[108:111],v[112:127]
ds_read_b128 a[120:123],v192 offset:34816
s_waitcnt lgkmcnt(6)
v_mfma_f32_32x32x16_bf16 v[128:143],a[128:131],a[0:3],0
ds_read_b128 a[124:127],v192 offset:35840
buffer_load_dwordx4 v194,s[8:11],s30 offen offset:2048 sc1 lds
s_waitcnt lgkmcnt(6)
v_mfma_f32_32x32x16_bf16 v[128:143],a[132:135],a[4:7],v[128:143]
ds_read_b128 a[128:131],v192 offset:36864
s_waitcnt lgkmcnt(6)
v_mfma_f32_32x32x16_bf16 v[128:143],a[136:139],a[8:11],v[128:143]
ds_read_b128 a[132:135],v192 offset:37888
v_cvt_pk_bf16_f32 v0,v112,v116
s_waitcnt lgkmcnt(6)
v_mfma_f32_32x32x16_bf16 v[128:143],a[140:143],a[12:15],v[128:143]
ds_read_b128 a[136:139],v192 offset:38912
v_cvt_pk_bf16_f32 v1,v120,v124
s_waitcnt lgkmcnt(6)
v_mfma_f32_32x32x16_bf16 v[128:143],a[112:115],a[16:19],v[128:143]
ds_read_b128 a[140:143],v192 offset:39936
buffer_load_dwordx4 v194,s[8:11],s30 offen offset:3072 sc1 lds
v_cvt_pk_bf16_f32 v2,v113,v117
s_waitcnt lgkmcnt(6)
v_mfma_f32_32x32x16_bf16 v[128:143],a[116:119],a[20:23],v[128:143]
ds_read_b128 a[112:115],v192 offset:40960
v_cvt_pk_bf16_f32 v3,v121,v125
s_waitcnt lgkmcnt(6)
v_mfma_f32_32x32x16_bf16 v[128:143],a[120:123],a[24:27],v[128:143]
ds_read_b128 a[116:119],v192 offset:41984
v_cvt_pk_bf16_f32 v4,v114,v118
s_waitcnt lgkmcnt(6)
v_mfma_f32_32x32x16_bf16 v[128:143],a[124:127],a[28:31],v[128:143]
ds_read_b128 a[120:123],v192 offset:43008
v_cvt_pk_bf16_f32 v5,v122,v126
s_waitcnt lgkmcnt(6)
v_mfma_f32_32x32x16_bf16 v[128:143],a[128:131],a[32:35],v[128:143]
ds_read_b128 a[124:127],v192 offset:44032
s_add_u32 s30,s100,90112
s_add_u32 m0,s60,90112
s_nop 0
buffer_load_dwordx4 v194,s[8:11],s30 offen sc1 lds
v_cvt_pk_bf16_f32 v6,v115,v119
s_waitcnt lgkmcnt(6)
v_mfma_f32_32x32x16_bf16 v[128:143],a[132:135],a[36:39],v[128:143]
ds_read_b128 a[128:131],v192 offset:45056
v_cvt_pk_bf16_f32 v7,v123,v127
s_waitcnt lgkmcnt(6)
v_mfma_f32_32x32x16_bf16 v[128:143],a[136:139],a[40:43],v[128:143]
ds_read_b128 a[132:135],v192 offset:46080
v_permlane32_swap_b32 v0,v4
s_waitcnt lgkmcnt(6)
v_mfma_f32_32x32x16_bf16 v[128:143],a[140:143],a[44:47],v[128:143]
ds_read_b128 a[136:139],v192 offset:47104
v_permlane32_swap_b32 v1,v5
s_waitcnt lgkmcnt(6)
v_mfma_f32_32x32x16_bf16 v[128:143],a[112:115],a[48:51],v[128:143]
ds_read_b128 a[140:143],v192 offset:48128
buffer_load_dwordx4 v194,s[8:11],s30 offen offset:1024 sc1 lds
v_permlane32_swap_b32 v2,v6
s_waitcnt lgkmcnt(6)
v_mfma_f32_32x32x16_bf16 v[128:143],a[116:119],a[52:55],v[128:143]
ds_read_b128 a[112:115],v192 offset:49152
v_permlane32_swap_b32 v3,v7
s_waitcnt lgkmcnt(6)
v_mfma_f32_32x32x16_bf16 v[128:143],a[120:123],a[56:59],v[128:143]
ds_read_b128 a[116:119],v192 offset:50176
v_mfma_f32_32x32x16_bf16 v[144:159],a[0:3],v[0:3],0
s_waitcnt lgkmcnt(6)
v_mfma_f32_32x32x16_bf16 v[128:143],a[124:127],a[60:63],v[128:143]
ds_read_b128 a[120:123],v192 offset:51200
v_mfma_f32_32x32x16_bf16 v[144:159],a[4:7],v[4:7],v[144:159]
s_waitcnt lgkmcnt(6)
v_mfma_f32_32x32x16_bf16 v[128:143],a[128:131],a[64:67],v[128:143]
ds_read_b128 a[124:127],v192 offset:52224
buffer_load_dwordx4 v194,s[8:11],s30 offen offset:2048 sc1 lds
s_waitcnt lgkmcnt(6)
v_mfma_f32_32x32x16_bf16 v[128:143],a[132:135],a[68:71],v[128:143]
ds_read_b128 a[128:131],v192 offset:53248
s_waitcnt lgkmcnt(6)
v_mfma_f32_32x32x16_bf16 v[128:143],a[136:139],a[72:75],v[128:143]
ds_read_b128 a[132:135],v192 offset:54272
s_waitcnt lgkmcnt(6)
v_mfma_f32_32x32x16_bf16 v[128:143],a[140:143],a[76:79],v[128:143]
ds_read_b128 a[136:139],v192 offset:55296
s_waitcnt vmcnt(7)
s_barrier
s_waitcnt lgkmcnt(6)
v_mfma_f32_32x32x16_bf16 v[128:143],a[112:115],a[80:83],v[128:143]
ds_read_b128 a[140:143],v192 offset:56320
s_add_u32 s30,s100,114688
s_add_u32 m0,s60,0
s_nop 0
buffer_load_dwordx4 v194,s[8:11],s30 offen sc1 lds
s_waitcnt lgkmcnt(6)
v_mfma_f32_32x32x16_bf16 v[128:143],a[116:119],a[84:87],v[128:143]
ds_read_b128 a[112:115],v193 offset:0
s_waitcnt lgkmcnt(6)
v_mfma_f32_32x32x16_bf16 v[128:143],a[120:123],a[88:91],v[128:143]
ds_read_b128 a[116:119],v193 offset:1024
s_waitcnt lgkmcnt(6)
v_mfma_f32_32x32x16_bf16 v[128:143],a[124:127],a[92:95],v[128:143]
ds_read_b128 a[120:123],v193 offset:2048
s_waitcnt lgkmcnt(6)
v_mfma_f32_32x32x16_bf16 v[128:143],a[128:131],a[96:99],v[128:143]
ds_read_b128 a[124:127],v193 offset:3072
buffer_load_dwordx4 v194,s[8:11],s30 offen offset:1024 sc1 lds
s_waitcnt lgkmcnt(6)
v_mfma_f32_32x32x16_bf16 v[128:143],a[132:135],a[100:103],v[128:143]
ds_read_b128 a[128:131],v193 offset:4096
s_waitcnt lgkmcnt(6)
v_mfma_f32_32x32x16_bf16 v[128:143],a[136:139],a[104:107],v[128:143]
ds_read_b128 a[132:135],v193 offset:5120
s_waitcnt lgkmcnt(6)
v_mfma_f32_32x32x16_bf16 v[128:143],a[140:143],a[108:111],v[128:143]
ds_read_b128 a[136:139],v193 offset:6144
s_waitcnt lgkmcnt(6)
v_mfma_f32_32x32x16_bf16 v[112:127],a[112:115],a[0:3],0
ds_read_b128 a[140:143],v193 offset:7168
buffer_load_dwordx4 v194,s[8:11],s30 offen offset:2048 sc1 lds
s_waitcnt lgkmcnt(6)
v_mfma_f32_32x32x16_bf16 v[112:127],a[116:119],a[4:7],v[112:127]
ds_read_b128 a[112:115],v193 offset:8192
s_waitcnt lgkmcnt(6)
v_mfma_f32_32x32x16_bf16 v[112:127],a[120:123],a[8:11],v[112:127]
ds_read_b128 a[116:119],v193 offset:9216
v_cvt_pk_bf16_f32 v8,v128,v132
s_waitcnt lgkmcnt(6)
v_mfma_f32_32x32x16_bf16 v[112:127],a[124:127],a[12:15],v[112:127]
ds_read_b128 a[120:123],v193 offset:10240
v_cvt_pk_bf16_f32 v9,v136,v140
s_waitcnt lgkmcnt(6)
v_mfma_f32_32x32x16_bf16 v[112:127],a[128:131],a[16:19],v[112:127]
ds_read_b128 a[124:127],v193 offset:11264
buffer_load_dwordx4 v194,s[8:11],s30 offen offset:3072 sc1 lds
v_cvt_pk_bf16_f32 v10,v129,v133
s_waitcnt lgkmcnt(6)
v_mfma_f32_32x32x16_bf16 v[112:127],a[132:135],a[20:23],v[112:127]
ds_read_b128 a[128:131],v193 offset:12288
v_cvt_pk_bf16_f32 v11,v137,v141
s_waitcnt lgkmcnt(6)
v_mfma_f32_32x32x16_bf16 v[112:127],a[136:139],a[24:27],v[112:127]
ds_read_b128 a[132:135],v193 offset:13312
v_cvt_pk_bf16_f32 v12,v130,v134
s_waitcnt lgkmcnt(6)
v_mfma_f32_32x32x16_bf16 v[112:127],a[140:143],a[28:31],v[112:127]
ds_read_b128 a[136:139],v193 offset:14336
v_cvt_pk_bf16_f32 v13,v138,v142
s_waitcnt lgkmcnt(6)
v_mfma_f32_32x32x16_bf16 v[112:127],a[112:115],a[32:35],v[112:127]
ds_read_b128 a[140:143],v193 offset:15360
s_add_u32 s30,s100,118784
s_add_u32 m0,s60,4096
s_nop 0
buffer_load_dwordx4 v194,s[8:11],s30 offen sc1 lds
v_cvt_pk_bf16_f32 v14,v131,v135
s_waitcnt lgkmcnt(6)
v_mfma_f32_32x32x16_bf16 v[112:127],a[116:119],a[36:39],v[112:127]
ds_read_b128 a[112:115],v193 offset:16384
v_cvt_pk_bf16_f32 v15,v139,v143
s_waitcnt lgkmcnt(6)
v_mfma_f32_32x32x16_bf16 v[112:127],a[120:123],a[40:43],v[112:127]
ds_read_b128 a[116:119],v193 offset:17408
v_permlane32_swap_b32 v8,v12
s_waitcnt lgkmcnt(6)
v_mfma_f32_32x32x16_bf16 v[112:127],a[124:127],a[44:47],v[112:127]
ds_read_b128 a[120:123],v193 offset:18432
v_permlane32_swap_b32 v9,v13
s_waitcnt lgkmcnt(6)
v_mfma_f32_32x32x16_bf16 v[112:127],a[128:131],a[48:51],v[112:127]
ds_read_b128 a[124:127],v193 offset:19456
buffer_load_dwordx4 v194,s[8:11],s30 offen offset:1024 sc1 lds
v_permlane32_swap_b32 v10,v14
s_waitcnt lgkmcnt(6)
v_mfma_f32_32x32x16_bf16 v[112:127],a[132:135],a[52:55],v[112:127]
ds_read_b128 a[128:131],v193 offset:20480
v_permlane32_swap_b32 v11,v15
s_waitcnt lgkmcnt(6)
v_mfma_f32_32x32x16_bf16 v[112:127],a[136:139],a[56:59],v[112:127]
ds_read_b128 a[132:135],v193 offset:21504
v_mfma_f32_32x32x16_bf16 v[144:159],a[8:11],v[8:11],v[144:159]
s_waitcnt lgkmcnt(6)
v_mfma_f32_32x32x16_bf16 v[112:127],a[140:143],a[60:63],v[112:127]
ds_read_b128 a[136:139],v193 offset:22528
v_mfma_f32_32x32x16_bf16 v[144:159],a[12:15],v[12:15],v[144:159]
s_waitcnt lgkmcnt(6)
v_mfma_f32_32x32x16_bf16 v[112:127],a[112:115],a[64:67],v[112:127]
ds_read_b128 a[140:143],v193 offset:23552
buffer_load_dwordx4 v194,s[8:11],s30 offen offset:2048 sc1 lds
s_waitcnt lgkmcnt(6)
v_mfma_f32_32x32x16_bf16 v[112:127],a[116:119],a[68:71],v[112:127]
ds_read_b128 a[112:115],v193 offset:24576
s_waitcnt lgkmcnt(6)
v_mfma_f32_32x32x16_bf16 v[112:127],a[120:123],a[72:75],v[112:127]
ds_read_b128 a[116:119],v193 offset:25600
s_waitcnt lgkmcnt(6)
v_mfma_f32_32x32x16_bf16 v[112:127],a[124:127],a[76:79],v[112:127]
ds_read_b128 a[120:123],v193 offset:26624
s_waitcnt vmcnt(7)
s_barrier
s_waitcnt lgkmcnt(6)
v_mfma_f32_32x32x16_bf16 v[112:127],a[128:131],a[80:83],v[112:127]
ds_read_b128 a[124:127],v193 offset:27648
s_add_u32 s30,s100,143360
s_add_u32 m0,s60,28672
s_nop 0
buffer_load_dwordx4 v194,s[8:11],s30 offen sc1 lds
s_waitcnt lgkmcnt(6)
v_mfma_f32_32x32x16_bf16 v[112:127],a[132:135],a[84:87],v[112:127]
ds_read_b128 a[128:131],v193 offset:28672
s_waitcnt lgkmcnt(6)
v_mfma_f32_32x32x16_bf16 v[112:127],a[136:139],a[88:91],v[112:127]
ds_read_b128 a[132:135],v193 offset:29696
s_waitcnt lgkmcnt(6)
v_mfma_f32_32x32x16_bf16 v[112:127],a[140:143],a[92:95],v[112:127]
ds_read_b128 a[136:139],v193 offset:30720
s_waitcnt lgkmcnt(6)
v_mfma_f32_32x32x16_bf16 v[112:127],a[112:115],a[96:99],v[112:127]
ds_read_b128 a[140:143],v193 offset:31744
buffer_load_dwordx4 v194,s[8:11],s30 offen offset:1024 sc1 lds
s_waitcnt lgkmcnt(6)
v_mfma_f32_32x32x16_bf16 v[112:127],a[116:119],a[100:103],v[112:127]
ds_read_b128 a[112:115],v193 offset:32768
s_waitcnt lgkmcnt(6)
v_mfma_f32_32x32x16_bf16 v[112:127],a[120:123],a[104:107],v[112:127]
ds_read_b128 a[116:119],v193 offset:33792
s_waitcnt lgkmcnt(6)
v_mfma_f32_32x32x16_bf16 v[112:127],a[124:127],a[108:111],v[112:127]
ds_read_b128 a[120:123],v193 offset:34816
s_waitcnt lgkmcnt(6)
v_mfma_f32_32x32x16_bf16 v[128:143],a[128:131],a[0:3],0
ds_read_b128 a[124:127],v193 offset:35840
buffer_load_dwordx4 v194,s[8:11],s30 offen offset:2048 sc1 lds
s_waitcnt lgkmcnt(6)
v_mfma_f32_32x32x16_bf16 v[128:143],a[132:135],a[4:7],v[128:143]
ds_read_b128 a[128:131],v193 offset:36864
s_waitcnt lgkmcnt(6)
v_mfma_f32_32x32x16_bf16 v[128:143],a[136:139],a[8:11],v[128:143]
ds_read_b128 a[132:135],v193 offset:37888
v_cvt_pk_bf16_f32 v16,v112,v116
s_waitcnt lgkmcnt(6)
v_mfma_f32_32x32x16_bf16 v[128:143],a[140:143],a[12:15],v[128:143]
ds_read_b128 a[136:139],v193 offset:38912
v_cvt_pk_bf16_f32 v17,v120,v124
s_waitcnt lgkmcnt(6)
v_mfma_f32_32x32x16_bf16 v[128:143],a[112:115],a[16:19],v[128:143]
ds_read_b128 a[140:143],v193 offset:39936
buffer_load_dwordx4 v194,s[8:11],s30 offen offset:3072 sc1 lds
v_cvt_pk_bf16_f32 v18,v113,v117
s_waitcnt lgkmcnt(6)
v_mfma_f32_32x32x16_bf16 v[128:143],a[116:119],a[20:23],v[128:143]
ds_read_b128 a[112:115],v193 offset:40960
v_cvt_pk_bf16_f32 v19,v121,v125
s_waitcnt lgkmcnt(6)
v_mfma_f32_32x32x16_bf16 v[128:143],a[120:123],a[24:27],v[128:143]
ds_read_b128 a[116:119],v193 offset:41984
v_cvt_pk_bf16_f32 v20,v114,v118
s_waitcnt lgkmcnt(6)
v_mfma_f32_32x32x16_bf16 v[128:143],a[124:127],a[28:31],v[128:143]
ds_read_b128 a[120:123],v193 offset:43008
v_cvt_pk_bf16_f32 v21,v122,v126
s_waitcnt lgkmcnt(6)
v_mfma_f32_32x32x16_bf16 v[128:143],a[128:131],a[32:35],v[128:143]
ds_read_b128 a[124:127],v193 offset:44032
s_add_u32 s30,s100,147456
s_add_u32 m0,s60,32768
s_nop 0
buffer_load_dwordx4 v194,s[8:11],s30 offen sc1 lds
v_cvt_pk_bf16_f32 v22,v115,v119
s_waitcnt lgkmcnt(6)
v_mfma_f32_32x32x16_bf16 v[128:143],a[132:135],a[36:39],v[128:143]
ds_read_b128 a[128:131],v193 offset:45056
v_cvt_pk_bf16_f32 v23,v123,v127
s_waitcnt lgkmcnt(6)
v_mfma_f32_32x32x16_bf16 v[128:143],a[136:139],a[40:43],v[128:143]
ds_read_b128 a[132:135],v193 offset:46080
v_permlane32_swap_b32 v16,v20
s_waitcnt lgkmcnt(6)
v_mfma_f32_32x32x16_bf16 v[128:143],a[140:143],a[44:47],v[128:143]
ds_read_b128 a[136:139],v193 offset:47104
v_permlane32_swap_b32 v17,v21
s_waitcnt lgkmcnt(6)
v_mfma_f32_32x32x16_bf16 v[128:143],a[112:115],a[48:51],v[128:143]
ds_read_b128 a[140:143],v193 offset:48128
buffer_load_dwordx4 v194,s[8:11],s30 offen offset:1024 sc1 lds
v_permlane32_swap_b32 v18,v22
s_waitcnt lgkmcnt(6)
v_mfma_f32_32x32x16_bf16 v[128:143],a[116:119],a[52:55],v[128:143]
ds_read_b128 a[112:115],v193 offset:49152
v_permlane32_swap_b32 v19,v23
s_waitcnt lgkmcnt(6)
v_mfma_f32_32x32x16_bf16 v[128:143],a[120:123],a[56:59],v[128:143]
ds_read_b128 a[116:119],v193 offset:50176
v_mfma_f32_32x32x16_bf16 v[144:159],a[16:19],v[16:19],v[144:159]
s_waitcnt lgkmcnt(6)
v_mfma_f32_32x32x16_bf16 v[128:143],a[124:127],a[60:63],v[128:143]
ds_read_b128 a[120:123],v193 offset:51200
v_mfma_f32_32x32x16_bf16 v[144:159],a[20:23],v[20:23],v[144:159]
s_waitcnt lgkmcnt(6)
v_mfma_f32_32x32x16_bf16 v[128:143],a[128:131],a[64:67],v[128:143]
ds_read_b128 a[124:127],v193 offset:52224
buffer_load_dwordx4 v194,s[8:11],s30 offen offset:2048 sc1 lds
s_waitcnt lgkmcnt(6)
v_mfma_f32_32x32x16_bf16 v[128:143],a[132:135],a[68:71],v[128:143]
ds_read_b128 a[128:131],v193 offset:53248
s_waitcnt lgkmcnt(6)
v_mfma_f32_32x32x16_bf16 v[128:143],a[136:139],a[72:75],v[128:143]
ds_read_b128 a[132:135],v193 offset:54272
s_waitcnt lgkmcnt(6)
v_mfma_f32_32x32x16_bf16 v[128:143],a[140:143],a[76:79],v[128:143]
ds_read_b128 a[136:139],v193 offset:55296
s_waitcnt vmcnt(7)
s_barrier
s_waitcnt lgkmcnt(6)
v_mfma_f32_32x32x16_bf16 v[128:143],a[112:115],a[80:83],v[128:143]
ds_read_b128 a[140:143],v193 offset:56320
s_add_u32 s30,s100,172032
s_add_u32 m0,s60,57344
s_nop 0
buffer_load_dwordx4 v194,s[8:11],s30 offen sc1 lds
s_waitcnt lgkmcnt(6)
v_mfma_f32_32x32x16_bf16 v[128:143],a[116:119],a[84:87],v[128:143]
ds_read_b128 a[112:115],v192 offset:0
s_waitcnt lgkmcnt(6)
v_mfma_f32_32x32x16_bf16 v[128:143],a[120:123],a[88:91],v[128:143]
ds_read_b128 a[116:119],v192 offset:1024
s_waitcnt lgkmcnt(6)
v_mfma_f32_32x32x16_bf16 v[128:143],a[124:127],a[92:95],v[128:143]
ds_read_b128 a[120:123],v192 offset:2048
s_waitcnt lgkmcnt(6)
v_mfma_f32_32x32x16_bf16 v[128:143],a[128:131],a[96:99],v[128:143]
ds_read_b128 a[124:127],v192 offset:3072
buffer_load_dwordx4 v194,s[8:11],s30 offen offset:1024 sc1 lds
s_waitcnt lgkmcnt(6)
v_mfma_f32_32x32x16_bf16 v[128:143],a[132:135],a[100:103],v[128:143]
ds_read_b128 a[128:131],v192 offset:4096
s_waitcnt lgkmcnt(6)
v_mfma_f32_32x32x16_bf16 v[128:143],a[136:139],a[104:107],v[128:143]
ds_read_b128 a[132:135],v192 offset:5120
s_waitcnt lgkmcnt(6)
v_mfma_f32_32x32x16_bf16 v[128:143],a[140:143],a[108:111],v[128:143]
ds_read_b128 a[136:139],v192 offset:6144
s_waitcnt lgkmcnt(6)
v_mfma_f32_32x32x16_bf16 v[112:127],a[112:115],a[0:3],0
ds_read_b128 a[140:143],v192 offset:7168
buffer_load_dwordx4 v194,s[8:11],s30 offen offset:2048 sc1 lds
s_waitcnt lgkmcnt(6)
v_mfma_f32_32x32x16_bf16 v[112:127],a[116:119],a[4:7],v[112:127]
ds_read_b128 a[112:115],v192 offset:8192
s_waitcnt lgkmcnt(6)
v_mfma_f32_32x32x16_bf16 v[112:127],a[120:123],a[8:11],v[112:127]
ds_read_b128 a[116:119],v192 offset:9216
v_cvt_pk_bf16_f32 v24,v128,v132
s_waitcnt lgkmcnt(6)
v_mfma_f32_32x32x16_bf16 v[112:127],a[124:127],a[12:15],v[112:127]
ds_read_b128 a[120:123],v192 offset:10240
v_cvt_pk_bf16_f32 v25,v136,v140
s_waitcnt lgkmcnt(6)
v_mfma_f32_32x32x16_bf16 v[112:127],a[128:131],a[16:19],v[112:127]
ds_read_b128 a[124:127],v192 offset:11264
buffer_load_dwordx4 v194,s[8:11],s30 offen offset:3072 sc1 lds
v_cvt_pk_bf16_f32 v26,v129,v133
s_waitcnt lgkmcnt(6)
v_mfma_f32_32x32x16_bf16 v[112:127],a[132:135],a[20:23],v[112:127]
ds_read_b128 a[128:131],v192 offset:12288
v_cvt_pk_bf16_f32 v27,v137,v141
s_waitcnt lgkmcnt(6)
v_mfma_f32_32x32x16_bf16 v[112:127],a[136:139],a[24:27],v[112:127]
ds_read_b128 a[132:135],v192 offset:13312
v_cvt_pk_bf16_f32 v28,v130,v134
s_waitcnt lgkmcnt(6)
v_mfma_f32_32x32x16_bf16 v[112:127],a[140:143],a[28:31],v[112:127]
ds_read_b128 a[136:139],v192 offset:14336
v_cvt_pk_bf16_f32 v29,v138,v142
s_waitcnt lgkmcnt(6)
v_mfma_f32_32x32x16_bf16 v[112:127],a[112:115],a[32:35],v[112:127]
ds_read_b128 a[140:143],v192 offset:15360
s_add_u32 s30,s100,176128
s_add_u32 m0,s60,61440
s_nop 0
buffer_load_dwordx4 v194,s[8:11],s30 offen sc1 lds
v_cvt_pk_bf16_f32 v30,v131,v135
s_waitcnt lgkmcnt(6)
v_mfma_f32_32x32x16_bf16 v[112:127],a[116:119],a[36:39],v[112:127]
ds_read_b128 a[112:115],v192 offset:16384
v_cvt_pk_bf16_f32 v31,v139,v143
s_waitcnt lgkmcnt(6)
v_mfma_f32_32x32x16_bf16 v[112:127],a[120:123],a[40:43],v[112:127]
ds_read_b128 a[116:119],v192 offset:17408
v_permlane32_swap_b32 v24,v28
s_waitcnt lgkmcnt(6)
v_mfma_f32_32x32x16_bf16 v[112:127],a[124:127],a[44:47],v[112:127]
ds_read_b128 a[120:123],v192 offset:18432
v_permlane32_swap_b32 v25,v29
s_waitcnt lgkmcnt(6)
v_mfma_f32_32x32x16_bf16 v[112:127],a[128:131],a[48:51],v[112:127]
ds_read_b128 a[124:127],v192 offset:19456
buffer_load_dwordx4 v194,s[8:11],s30 offen offset:1024 sc1 lds
v_permlane32_swap_b32 v26,v30
s_waitcnt lgkmcnt(6)
v_mfma_f32_32x32x16_bf16 v[112:127],a[132:135],a[52:55],v[112:127]
ds_read_b128 a[128:131],v192 offset:20480
v_permlane32_swap_b32 v27,v31
s_waitcnt lgkmcnt(6)
v_mfma_f32_32x32x16_bf16 v[112:127],a[136:139],a[56:59],v[112:127]
ds_read_b128 a[132:135],v192 offset:21504
v_mfma_f32_32x32x16_bf16 v[144:159],a[24:27],v[24:27],v[144:159]
s_waitcnt lgkmcnt(6)
v_mfma_f32_32x32x16_bf16 v[112:127],a[140:143],a[60:63],v[112:127]
ds_read_b128 a[136:139],v192 offset:22528
v_mfma_f32_32x32x16_bf16 v[144:159],a[28:31],v[28:31],v[144:159]
s_waitcnt lgkmcnt(6)
v_mfma_f32_32x32x16_bf16 v[112:127],a[112:115],a[64:67],v[112:127]
ds_read_b128 a[140:143],v192 offset:23552
buffer_load_dwordx4 v194,s[8:11],s30 offen offset:2048 sc1 lds
s_waitcnt lgkmcnt(6)
v_mfma_f32_32x32x16_bf16 v[112:127],a[116:119],a[68:71],v[112:127]
ds_read_b128 a[112:115],v192 offset:24576
s_waitcnt lgkmcnt(6)
v_mfma_f32_32x32x16_bf16 v[112:127],a[120:123],a[72:75],v[112:127]
ds_read_b128 a[116:119],v192 offset:25600
s_waitcnt lgkmcnt(6)
v_mfma_f32_32x32x16_bf16 v[112:127],a[124:127],a[76:79],v[112:127]
ds_read_b128 a[120:123],v192 offset:26624
s_waitcnt vmcnt(7)
s_barrier
s_waitcnt lgkmcnt(6)
v_mfma_f32_32x32x16_bf16 v[112:127],a[128:131],a[80:83],v[112:127]
ds_read_b128 a[124:127],v192 offset:27648
s_add_u32 s30,s100,200704
s_add_u32 m0,s60,86016
s_nop 0
buffer_load_dwordx4 v194,s[8:11],s30 offen sc1 lds
s_waitcnt lgkmcnt(6)
v_mfma_f32_32x32x16_bf16 v[112:127],a[132:135],a[84:87],v[112:127]
ds_read_b128 a[128:131],v192 offset:28672
s_waitcnt lgkmcnt(6)
v_mfma_f32_32x32x16_bf16 v[112:127],a[136:139],a[88:91],v[112:127]
ds_read_b128 a[132:135],v192 offset:29696
s_waitcnt lgkmcnt(6)
v_mfma_f32_32x32x16_bf16 v[112:127],a[140:143],a[92:95],v[112:127]
ds_read_b128 a[136:139],v192 offset:30720
s_waitcnt lgkmcnt(6)
v_mfma_f32_32x32x16_bf16 v[112:127],a[112:115],a[96:99],v[112:127]
ds_read_b128 a[140:143],v192 offset:31744
buffer_load_dwordx4 v194,s[8:11],s30 offen offset:1024 sc1 lds
s_waitcnt lgkmcnt(6)
v_mfma_f32_32x32x16_bf16 v[112:127],a[116:119],a[100:103],v[112:127]
ds_read_b128 a[112:115],v192 offset:32768
s_waitcnt lgkmcnt(6)
v_mfma_f32_32x32x16_bf16 v[112:127],a[120:123],a[104:107],v[112:127]
ds_read_b128 a[116:119],v192 offset:33792
s_waitcnt lgkmcnt(6)
v_mfma_f32_32x32x16_bf16 v[112:127],a[124:127],a[108:111],v[112:127]
ds_read_b128 a[120:123],v192 offset:34816
s_waitcnt lgkmcnt(6)
v_mfma_f32_32x32x16_bf16 v[128:143],a[128:131],a[0:3],0
ds_read_b128 a[124:127],v192 offset:35840
buffer_load_dwordx4 v194,s[8:11],s30 offen offset:2048 sc1 lds
s_waitcnt lgkmcnt(6)
v_mfma_f32_32x32x16_bf16 v[128:143],a[132:135],a[4:7],v[128:143]
ds_read_b128 a[128:131],v192 offset:36864
s_waitcnt lgkmcnt(6)
v_mfma_f32_32x32x16_bf16 v[128:143],a[136:139],a[8:11],v[128:143]
ds_read_b128 a[132:135],v192 offset:37888
v_cvt_pk_bf16_f32 v32,v112,v116
s_waitcnt lgkmcnt(6)
v_mfma_f32_32x32x16_bf16 v[128:143],a[140:143],a[12:15],v[128:143]
ds_read_b128 a[136:139],v192 offset:38912
v_cvt_pk_bf16_f32 v33,v120,v124
s_waitcnt lgkmcnt(6)
v_mfma_f32_32x32x16_bf16 v[128:143],a[112:115],a[16:19],v[128:143]
ds_read_b128 a[140:143],v192 offset:39936
buffer_load_dwordx4 v194,s[8:11],s30 offen offset:3072 sc1 lds
v_cvt_pk_bf16_f32 v34,v113,v117
s_waitcnt lgkmcnt(6)
v_mfma_f32_32x32x16_bf16 v[128:143],a[116:119],a[20:23],v[128:143]
ds_read_b128 a[112:115],v192 offset:40960
v_cvt_pk_bf16_f32 v35,v121,v125
s_waitcnt lgkmcnt(6)
v_mfma_f32_32x32x16_bf16 v[128:143],a[120:123],a[24:27],v[128:143]
ds_read_b128 a[116:119],v192 offset:41984
v_cvt_pk_bf16_f32 v36,v114,v118
s_waitcnt lgkmcnt(6)
v_mfma_f32_32x32x16_bf16 v[128:143],a[124:127],a[28:31],v[128:143]
ds_read_b128 a[120:123],v192 offset:43008
v_cvt_pk_bf16_f32 v37,v122,v126
s_waitcnt lgkmcnt(6)
v_mfma_f32_32x32x16_bf16 v[128:143],a[128:131],a[32:35],v[128:143]
ds_read_b128 a[124:127],v192 offset:44032
s_add_u32 s30,s100,204800
s_add_u32 m0,s60,90112
s_nop 0
buffer_load_dwordx4 v194,s[8:11],s30 offen sc1 lds
v_cvt_pk_bf16_f32 v38,v115,v119
s_waitcnt lgkmcnt(6)
v_mfma_f32_32x32x16_bf16 v[128:143],a[132:135],a[36:39],v[128:143]
ds_read_b128 a[128:131],v192 offset:45056
v_cvt_pk_bf16_f32 v39,v123,v127
s_waitcnt lgkmcnt(6)
v_mfma_f32_32x32x16_bf16 v[128:143],a[136:139],a[40:43],v[128:143]
ds_read_b128 a[132:135],v192 offset:46080
v_permlane32_swap_b32 v32,v36
s_waitcnt lgkmcnt(6)
v_mfma_f32_32x32x16_bf16 v[128:143],a[140:143],a[44:47],v[128:143]
ds_read_b128 a[136:139],v192 offset:47104
v_permlane32_swap_b32 v33,v37
s_waitcnt lgkmcnt(6)
v_mfma_f32_32x32x16_bf16 v[128:143],a[112:115],a[48:51],v[128:143]
ds_read_b128 a[140:143],v192 offset:48128
buffer_load_dwordx4 v194,s[8:11],s30 offen offset:1024 sc1 lds
v_permlane32_swap_b32 v34,v38
s_waitcnt lgkmcnt(6)
v_mfma_f32_32x32x16_bf16 v[128:143],a[116:119],a[52:55],v[128:143]
ds_read_b128 a[112:115],v192 offset:49152
v_permlane32_swap_b32 v35,v39
s_waitcnt lgkmcnt(6)
v_mfma_f32_32x32x16_bf16 v[128:143],a[120:123],a[56:59],v[128:143]
ds_read_b128 a[116:119],v192 offset:50176
v_mfma_f32_32x32x16_bf16 v[144:159],a[32:35],v[32:35],v[144:159]
s_waitcnt lgkmcnt(6)
v_mfma_f32_32x32x16_bf16 v[128:143],a[124:127],a[60:63],v[128:143]
ds_read_b128 a[120:123],v192 offset:51200
v_mfma_f32_32x32x16_bf16 v[144:159],a[36:39],v[36:39],v[144:159]
s_waitcnt lgkmcnt(6)
v_mfma_f32_32x32x16_bf16 v[128:143],a[128:131],a[64:67],v[128:143]
ds_read_b128 a[124:127],v192 offset:52224
buffer_load_dwordx4 v194,s[8:11],s30 offen offset:2048 sc1 lds
s_waitcnt lgkmcnt(6)
v_mfma_f32_32x32x16_bf16 v[128:143],a[132:135],a[68:71],v[128:143]
ds_read_b128 a[128:131],v192 offset:53248
s_waitcnt lgkmcnt(6)
v_mfma_f32_32x32x16_bf16 v[128:143],a[136:139],a[72:75],v[128:143]
ds_read_b128 a[132:135],v192 offset:54272
s_waitcnt lgkmcnt(6)
v_mfma_f32_32x32x16_bf16 v[128:143],a[140:143],a[76:79],v[128:143]
ds_read_b128 a[136:139],v192 offset:55296
s_waitcnt vmcnt(7)
s_barrier
s_waitcnt lgkmcnt(6)
v_mfma_f32_32x32x16_bf16 v[128:143],a[112:115],a[80:83],v[128:143]
ds_read_b128 a[140:143],v192 offset:56320
s_add_u32 s30,s100,229376
s_add_u32 m0,s60,0
s_nop 0
buffer_load_dwordx4 v194,s[8:11],s30 offen sc1 lds
s_waitcnt lgkmcnt(6)
v_mfma_f32_32x32x16_bf16 v[128:143],a[116:119],a[84:87],v[128:143]
ds_read_b128 a[112:115],v193 offset:0
s_waitcnt lgkmcnt(6)
v_mfma_f32_32x32x16_bf16 v[128:143],a[120:123],a[88:91],v[128:143]
ds_read_b128 a[116:119],v193 offset:1024
s_waitcnt lgkmcnt(6)
v_mfma_f32_32x32x16_bf16 v[128:143],a[124:127],a[92:95],v[128:143]
ds_read_b128 a[120:123],v193 offset:2048
s_waitcnt lgkmcnt(6)
v_mfma_f32_32x32x16_bf16 v[128:143],a[128:131],a[96:99],v[128:143]
ds_read_b128 a[124:127],v193 offset:3072
buffer_load_dwordx4 v194,s[8:11],s30 offen offset:1024 sc1 lds
s_waitcnt lgkmcnt(6)
v_mfma_f32_32x32x16_bf16 v[128:143],a[132:135],a[100:103],v[128:143]
ds_read_b128 a[128:131],v193 offset:4096
s_waitcnt lgkmcnt(6)
v_mfma_f32_32x32x16_bf16 v[128:143],a[136:139],a[104:107],v[128:143]
ds_read_b128 a[132:135],v193 offset:5120
s_waitcnt lgkmcnt(6)
v_mfma_f32_32x32x16_bf16 v[128:143],a[140:143],a[108:111],v[128:143]
ds_read_b128 a[136:139],v193 offset:6144
s_waitcnt lgkmcnt(6)
v_mfma_f32_32x32x16_bf16 v[112:127],a[112:115],a[0:3],0
ds_read_b128 a[140:143],v193 offset:7168
buffer_load_dwordx4 v194,s[8:11],s30 offen offset:2048 sc1 lds
s_waitcnt lgkmcnt(6)
v_mfma_f32_32x32x16_bf16 v[112:127],a[116:119],a[4:7],v[112:127]
ds_read_b128 a[112:115],v193 offset:8192
s_waitcnt lgkmcnt(6)
v_mfma_f32_32x32x16_bf16 v[112:127],a[120:123],a[8:11],v[112:127]
ds_read_b128 a[116:119],v193 offset:9216
v_cvt_pk_bf16_f32 v40,v128,v132
s_waitcnt lgkmcnt(6)
v_mfma_f32_32x32x16_bf16 v[112:127],a[124:127],a[12:15],v[112:127]
ds_read_b128 a[120:123],v193 offset:10240
v_cvt_pk_bf16_f32 v41,v136,v140
s_waitcnt lgkmcnt(6)
v_mfma_f32_32x32x16_bf16 v[112:127],a[128:131],a[16:19],v[112:127]
ds_read_b128 a[124:127],v193 offset:11264
buffer_load_dwordx4 v194,s[8:11],s30 offen offset:3072 sc1 lds
v_cvt_pk_bf16_f32 v42,v129,v133
s_waitcnt lgkmcnt(6)
v_mfma_f32_32x32x16_bf16 v[112:127],a[132:135],a[20:23],v[112:127]
ds_read_b128 a[128:131],v193 offset:12288
v_cvt_pk_bf16_f32 v43,v137,v141
s_waitcnt lgkmcnt(6)
v_mfma_f32_32x32x16_bf16 v[112:127],a[136:139],a[24:27],v[112:127]
ds_read_b128 a[132:135],v193 offset:13312
v_cvt_pk_bf16_f32 v44,v130,v134
s_waitcnt lgkmcnt(6)
v_mfma_f32_32x32x16_bf16 v[112:127],a[140:143],a[28:31],v[112:127]
ds_read_b128 a[136:139],v193 offset:14336
v_cvt_pk_bf16_f32 v45,v138,v142
s_waitcnt lgkmcnt(6)
v_mfma_f32_32x32x16_bf16 v[112:127],a[112:115],a[32:35],v[112:127]
ds_read_b128 a[140:143],v193 offset:15360
s_add_u32 s30,s100,233472
s_add_u32 m0,s60,4096
s_nop 0
buffer_load_dwordx4 v194,s[8:11],s30 offen sc1 lds
v_cvt_pk_bf16_f32 v46,v131,v135
s_waitcnt lgkmcnt(6)
v_mfma_f32_32x32x16_bf16 v[112:127],a[116:119],a[36:39],v[112:127]
ds_read_b128 a[112:115],v193 offset:16384
v_cvt_pk_bf16_f32 v47,v139,v143
s_waitcnt lgkmcnt(6)
v_mfma_f32_32x32x16_bf16 v[112:127],a[120:123],a[40:43],v[112:127]
ds_read_b128 a[116:119],v193 offset:17408
v_permlane32_swap_b32 v40,v44
s_waitcnt lgkmcnt(6)
v_mfma_f32_32x32x16_bf16 v[112:127],a[124:127],a[44:47],v[112:127]
ds_read_b128 a[120:123],v193 offset:18432
v_permlane32_swap_b32 v41,v45
s_waitcnt lgkmcnt(6)
v_mfma_f32_32x32x16_bf16 v[112:127],a[128:131],a[48:51],v[112:127]
ds_read_b128 a[124:127],v193 offset:19456
buffer_load_dwordx4 v194,s[8:11],s30 offen offset:1024 sc1 lds
v_permlane32_swap_b32 v42,v46
s_waitcnt lgkmcnt(6)
v_mfma_f32_32x32x16_bf16 v[112:127],a[132:135],a[52:55],v[112:127]
ds_read_b128 a[128:131],v193 offset:20480
v_permlane32_swap_b32 v43,v47
s_waitcnt lgkmcnt(6)
v_mfma_f32_32x32x16_bf16 v[112:127],a[136:139],a[56:59],v[112:127]
ds_read_b128 a[132:135],v193 offset:21504
v_mfma_f32_32x32x16_bf16 v[144:159],a[40:43],v[40:43],v[144:159]
s_waitcnt lgkmcnt(6)
v_mfma_f32_32x32x16_bf16 v[112:127],a[140:143],a[60:63],v[112:127]
ds_read_b128 a[136:139],v193 offset:22528
v_mfma_f32_32x32x16_bf16 v[144:159],a[44:47],v[44:47],v[144:159]
s_waitcnt lgkmcnt(6)
v_mfma_f32_32x32x16_bf16 v[112:127],a[112:115],a[64:67],v[112:127]
ds_read_b128 a[140:143],v193 offset:23552
buffer_load_dwordx4 v194,s[8:11],s30 offen offset:2048 sc1 lds
s_waitcnt lgkmcnt(6)
v_mfma_f32_32x32x16_bf16 v[112:127],a[116:119],a[68:71],v[112:127]
ds_read_b128 a[112:115],v193 offset:24576
s_waitcnt lgkmcnt(6)
v_mfma_f32_32x32x16_bf16 v[112:127],a[120:123],a[72:75],v[112:127]
ds_read_b128 a[116:119],v193 offset:25600
s_waitcnt lgkmcnt(6)
v_mfma_f32_32x32x16_bf16 v[112:127],a[124:127],a[76:79],v[112:127]
ds_read_b128 a[120:123],v193 offset:26624
s_waitcnt vmcnt(7)
s_barrier
s_waitcnt lgkmcnt(6)
v_mfma_f32_32x32x16_bf16 v[112:127],a[128:131],a[80:83],v[112:127]
ds_read_b128 a[124:127],v193 offset:27648
s_add_u32 s30,s100,258048
s_add_u32 m0,s60,28672
s_nop 0
buffer_load_dwordx4 v194,s[8:11],s30 offen sc1 lds
s_waitcnt lgkmcnt(6)
v_mfma_f32_32x32x16_bf16 v[112:127],a[132:135],a[84:87],v[112:127]
ds_read_b128 a[128:131],v193 offset:28672
s_waitcnt lgkmcnt(6)
v_mfma_f32_32x32x16_bf16 v[112:127],a[136:139],a[88:91],v[112:127]
ds_read_b128 a[132:135],v193 offset:29696
s_waitcnt lgkmcnt(6)
v_mfma_f32_32x32x16_bf16 v[112:127],a[140:143],a[92:95],v[112:127]
ds_read_b128 a[136:139],v193 offset:30720
s_waitcnt lgkmcnt(6)
v_mfma_f32_32x32x16_bf16 v[112:127],a[112:115],a[96:99],v[112:127]
ds_read_b128 a[140:143],v193 offset:31744
buffer_load_dwordx4 v194,s[8:11],s30 offen offset:1024 sc1 lds
s_waitcnt lgkmcnt(6)
v_mfma_f32_32x32x16_bf16 v[112:127],a[116:119],a[100:103],v[112:127]
ds_read_b128 a[112:115],v193 offset:32768
s_waitcnt lgkmcnt(6)
v_mfma_f32_32x32x16_bf16 v[112:127],a[120:123],a[104:107],v[112:127]
ds_read_b128 a[116:119],v193 offset:33792
s_waitcnt lgkmcnt(6)
v_mfma_f32_32x32x16_bf16 v[112:127],a[124:127],a[108:111],v[112:127]
ds_read_b128 a[120:123],v193 offset:34816
s_waitcnt lgkmcnt(6)
v_mfma_f32_32x32x16_bf16 v[128:143],a[128:131],a[0:3],0
ds_read_b128 a[124:127],v193 offset:35840
buffer_load_dwordx4 v194,s[8:11],s30 offen offset:2048 sc1 lds
s_waitcnt lgkmcnt(6)
v_mfma_f32_32x32x16_bf16 v[128:143],a[132:135],a[4:7],v[128:143]
ds_read_b128 a[128:131],v193 offset:36864
s_waitcnt lgkmcnt(6)
v_mfma_f32_32x32x16_bf16 v[128:143],a[136:139],a[8:11],v[128:143]
ds_read_b128 a[132:135],v193 offset:37888
v_cvt_pk_bf16_f32 v48,v112,v116
s_waitcnt lgkmcnt(6)
v_mfma_f32_32x32x16_bf16 v[128:143],a[140:143],a[12:15],v[128:143]
ds_read_b128 a[136:139],v193 offset:38912
v_cvt_pk_bf16_f32 v49,v120,v124
s_waitcnt lgkmcnt(6)
v_mfma_f32_32x32x16_bf16 v[128:143],a[112:115],a[16:19],v[128:143]
ds_read_b128 a[140:143],v193 offset:39936
buffer_load_dwordx4 v194,s[8:11],s30 offen offset:3072 sc1 lds
v_cvt_pk_bf16_f32 v50,v113,v117
s_waitcnt lgkmcnt(6)
v_mfma_f32_32x32x16_bf16 v[128:143],a[116:119],a[20:23],v[128:143]
ds_read_b128 a[112:115],v193 offset:40960
v_cvt_pk_bf16_f32 v51,v121,v125
s_waitcnt lgkmcnt(6)
v_mfma_f32_32x32x16_bf16 v[128:143],a[120:123],a[24:27],v[128:143]
ds_read_b128 a[116:119],v193 offset:41984
v_cvt_pk_bf16_f32 v52,v114,v118
s_waitcnt lgkmcnt(6)
v_mfma_f32_32x32x16_bf16 v[128:143],a[124:127],a[28:31],v[128:143]
ds_read_b128 a[120:123],v193 offset:43008
v_cvt_pk_bf16_f32 v53,v122,v126
s_waitcnt lgkmcnt(6)
v_mfma_f32_32x32x16_bf16 v[128:143],a[128:131],a[32:35],v[128:143]
ds_read_b128 a[124:127],v193 offset:44032
s_add_u32 s30,s100,262144
s_add_u32 m0,s60,32768
s_nop 0
buffer_load_dwordx4 v194,s[8:11],s30 offen sc1 lds
v_cvt_pk_bf16_f32 v54,v115,v119
s_waitcnt lgkmcnt(6)
v_mfma_f32_32x32x16_bf16 v[128:143],a[132:135],a[36:39],v[128:143]
ds_read_b128 a[128:131],v193 offset:45056
v_cvt_pk_bf16_f32 v55,v123,v127
s_waitcnt lgkmcnt(6)
v_mfma_f32_32x32x16_bf16 v[128:143],a[136:139],a[40:43],v[128:143]
ds_read_b128 a[132:135],v193 offset:46080
v_permlane32_swap_b32 v48,v52
s_waitcnt lgkmcnt(6)
v_mfma_f32_32x32x16_bf16 v[128:143],a[140:143],a[44:47],v[128:143]
ds_read_b128 a[136:139],v193 offset:47104
v_permlane32_swap_b32 v49,v53
s_waitcnt lgkmcnt(6)
v_mfma_f32_32x32x16_bf16 v[128:143],a[112:115],a[48:51],v[128:143]
ds_read_b128 a[140:143],v193 offset:48128
buffer_load_dwordx4 v194,s[8:11],s30 offen offset:1024 sc1 lds
v_permlane32_swap_b32 v50,v54
s_waitcnt lgkmcnt(6)
v_mfma_f32_32x32x16_bf16 v[128:143],a[116:119],a[52:55],v[128:143]
ds_read_b128 a[112:115],v193 offset:49152
v_permlane32_swap_b32 v51,v55
s_waitcnt lgkmcnt(6)
v_mfma_f32_32x32x16_bf16 v[128:143],a[120:123],a[56:59],v[128:143]
ds_read_b128 a[116:119],v193 offset:50176
v_mfma_f32_32x32x16_bf16 v[144:159],a[48:51],v[48:51],v[144:159]
s_waitcnt lgkmcnt(6)
v_mfma_f32_32x32x16_bf16 v[128:143],a[124:127],a[60:63],v[128:143]
ds_read_b128 a[120:123],v193 offset:51200
v_mfma_f32_32x32x16_bf16 v[144:159],a[52:55],v[52:55],v[144:159]
s_waitcnt lgkmcnt(6)
v_mfma_f32_32x32x16_bf16 v[128:143],a[128:131],a[64:67],v[128:143]
ds_read_b128 a[124:127],v193 offset:52224
buffer_load_dwordx4 v194,s[8:11],s30 offen offset:2048 sc1 lds
s_waitcnt lgkmcnt(6)
v_mfma_f32_32x32x16_bf16 v[128:143],a[132:135],a[68:71],v[128:143]
ds_read_b128 a[128:131],v193 offset:53248
s_waitcnt lgkmcnt(6)
v_mfma_f32_32x32x16_bf16 v[128:143],a[136:139],a[72:75],v[128:143]
ds_read_b128 a[132:135],v193 offset:54272
s_waitcnt lgkmcnt(6)
v_mfma_f32_32x32x16_bf16 v[128:143],a[140:143],a[76:79],v[128:143]
ds_read_b128 a[136:139],v193 offset:55296
s_waitcnt vmcnt(7)
s_barrier
s_waitcnt lgkmcnt(6)
v_mfma_f32_32x32x16_bf16 v[128:143],a[112:115],a[80:83],v[128:143]
ds_read_b128 a[140:143],v193 offset:56320
s_add_u32 s30,s100,286720
s_add_u32 m0,s60,57344
s_nop 0
buffer_load_dwordx4 v194,s[8:11],s30 offen sc1 lds
s_waitcnt lgkmcnt(6)
v_mfma_f32_32x32x16_bf16 v[128:143],a[116:119],a[84:87],v[128:143]
ds_read_b128 a[112:115],v192 offset:0
s_waitcnt lgkmcnt(6)
v_mfma_f32_32x32x16_bf16 v[128:143],a[120:123],a[88:91],v[128:143]
ds_read_b128 a[116:119],v192 offset:1024
s_waitcnt lgkmcnt(6)
v_mfma_f32_32x32x16_bf16 v[128:143],a[124:127],a[92:95],v[128:143]
ds_read_b128 a[120:123],v192 offset:2048
s_waitcnt lgkmcnt(6)
v_mfma_f32_32x32x16_bf16 v[128:143],a[128:131],a[96:99],v[128:143]
ds_read_b128 a[124:127],v192 offset:3072
buffer_load_dwordx4 v194,s[8:11],s30 offen offset:1024 sc1 lds
s_waitcnt lgkmcnt(6)
v_mfma_f32_32x32x16_bf16 v[128:143],a[132:135],a[100:103],v[128:143]
ds_read_b128 a[128:131],v192 offset:4096
s_waitcnt lgkmcnt(6)
v_mfma_f32_32x32x16_bf16 v[128:143],a[136:139],a[104:107],v[128:143]
ds_read_b128 a[132:135],v192 offset:5120
s_waitcnt lgkmcnt(6)
v_mfma_f32_32x32x16_bf16 v[128:143],a[140:143],a[108:111],v[128:143]
ds_read_b128 a[136:139],v192 offset:6144
s_waitcnt lgkmcnt(6)
v_mfma_f32_32x32x16_bf16 v[112:127],a[112:115],a[0:3],0
ds_read_b128 a[140:143],v192 offset:7168
buffer_load_dwordx4 v194,s[8:11],s30 offen offset:2048 sc1 lds
s_waitcnt lgkmcnt(6)
v_mfma_f32_32x32x16_bf16 v[112:127],a[116:119],a[4:7],v[112:127]
ds_read_b128 a[112:115],v192 offset:8192
s_waitcnt lgkmcnt(6)
v_mfma_f32_32x32x16_bf16 v[112:127],a[120:123],a[8:11],v[112:127]
ds_read_b128 a[116:119],v192 offset:9216
v_cvt_pk_bf16_f32 v56,v128,v132
s_waitcnt lgkmcnt(6)
v_mfma_f32_32x32x16_bf16 v[112:127],a[124:127],a[12:15],v[112:127]
ds_read_b128 a[120:123],v192 offset:10240
v_cvt_pk_bf16_f32 v57,v136,v140
s_waitcnt lgkmcnt(6)
v_mfma_f32_32x32x16_bf16 v[112:127],a[128:131],a[16:19],v[112:127]
ds_read_b128 a[124:127],v192 offset:11264
buffer_load_dwordx4 v194,s[8:11],s30 offen offset:3072 sc1 lds
v_cvt_pk_bf16_f32 v58,v129,v133
s_waitcnt lgkmcnt(6)
v_mfma_f32_32x32x16_bf16 v[112:127],a[132:135],a[20:23],v[112:127]
ds_read_b128 a[128:131],v192 offset:12288
v_cvt_pk_bf16_f32 v59,v137,v141
s_waitcnt lgkmcnt(6)
v_mfma_f32_32x32x16_bf16 v[112:127],a[136:139],a[24:27],v[112:127]
ds_read_b128 a[132:135],v192 offset:13312
v_cvt_pk_bf16_f32 v60,v130,v134
s_waitcnt lgkmcnt(6)
v_mfma_f32_32x32x16_bf16 v[112:127],a[140:143],a[28:31],v[112:127]
ds_read_b128 a[136:139],v192 offset:14336
v_cvt_pk_bf16_f32 v61,v138,v142
s_waitcnt lgkmcnt(6)
v_mfma_f32_32x32x16_bf16 v[112:127],a[112:115],a[32:35],v[112:127]
ds_read_b128 a[140:143],v192 offset:15360
s_add_u32 s30,s100,290816
s_add_u32 m0,s60,61440
s_nop 0
buffer_load_dwordx4 v194,s[8:11],s30 offen sc1 lds
v_cvt_pk_bf16_f32 v62,v131,v135
s_waitcnt lgkmcnt(6)
v_mfma_f32_32x32x16_bf16 v[112:127],a[116:119],a[36:39],v[112:127]
ds_read_b128 a[112:115],v192 offset:16384
v_cvt_pk_bf16_f32 v63,v139,v143
s_waitcnt lgkmcnt(6)
v_mfma_f32_32x32x16_bf16 v[112:127],a[120:123],a[40:43],v[112:127]
ds_read_b128 a[116:119],v192 offset:17408
v_permlane32_swap_b32 v56,v60
s_waitcnt lgkmcnt(6)
v_mfma_f32_32x32x16_bf16 v[112:127],a[124:127],a[44:47],v[112:127]
ds_read_b128 a[120:123],v192 offset:18432
v_permlane32_swap_b32 v57,v61
s_waitcnt lgkmcnt(6)
v_mfma_f32_32x32x16_bf16 v[112:127],a[128:131],a[48:51],v[112:127]
ds_read_b128 a[124:127],v192 offset:19456
buffer_load_dwordx4 v194,s[8:11],s30 offen offset:1024 sc1 lds
v_permlane32_swap_b32 v58,v62
s_waitcnt lgkmcnt(6)
v_mfma_f32_32x32x16_bf16 v[112:127],a[132:135],a[52:55],v[112:127]
ds_read_b128 a[128:131],v192 offset:20480
v_permlane32_swap_b32 v59,v63
s_waitcnt lgkmcnt(6)
v_mfma_f32_32x32x16_bf16 v[112:127],a[136:139],a[56:59],v[112:127]
ds_read_b128 a[132:135],v192 offset:21504
v_mfma_f32_32x32x16_bf16 v[144:159],a[56:59],v[56:59],v[144:159]
s_waitcnt lgkmcnt(6)
v_mfma_f32_32x32x16_bf16 v[112:127],a[140:143],a[60:63],v[112:127]
ds_read_b128 a[136:139],v192 offset:22528
v_mfma_f32_32x32x16_bf16 v[144:159],a[60:63],v[60:63],v[144:159]
s_waitcnt lgkmcnt(6)
v_mfma_f32_32x32x16_bf16 v[112:127],a[112:115],a[64:67],v[112:127]
ds_read_b128 a[140:143],v192 offset:23552
buffer_load_dwordx4 v194,s[8:11],s30 offen offset:2048 sc1 lds
s_waitcnt lgkmcnt(6)
v_mfma_f32_32x32x16_bf16 v[112:127],a[116:119],a[68:71],v[112:127]
ds_read_b128 a[112:115],v192 offset:24576
s_waitcnt lgkmcnt(6)
v_mfma_f32_32x32x16_bf16 v[112:127],a[120:123],a[72:75],v[112:127]
ds_read_b128 a[116:119],v192 offset:25600
s_waitcnt lgkmcnt(6)
v_mfma_f32_32x32x16_bf16 v[112:127],a[124:127],a[76:79],v[112:127]
ds_read_b128 a[120:123],v192 offset:26624
s_waitcnt vmcnt(7)
s_barrier
s_waitcnt lgkmcnt(6)
v_mfma_f32_32x32x16_bf16 v[112:127],a[128:131],a[80:83],v[112:127]
ds_read_b128 a[124:127],v192 offset:27648
s_add_u32 s30,s100,315392
s_add_u32 m0,s60,86016
s_nop 0
buffer_load_dwordx4 v194,s[8:11],s30 offen sc1 lds
s_waitcnt lgkmcnt(6)
v_mfma_f32_32x32x16_bf16 v[112:127],a[132:135],a[84:87],v[112:127]
ds_read_b128 a[128:131],v192 offset:28672
s_waitcnt lgkmcnt(6)
v_mfma_f32_32x32x16_bf16 v[112:127],a[136:139],a[88:91],v[112:127]
ds_read_b128 a[132:135],v192 offset:29696
s_waitcnt lgkmcnt(6)
v_mfma_f32_32x32x16_bf16 v[112:127],a[140:143],a[92:95],v[112:127]
ds_read_b128 a[136:139],v192 offset:30720
s_waitcnt lgkmcnt(6)
v_mfma_f32_32x32x16_bf16 v[112:127],a[112:115],a[96:99],v[112:127]
ds_read_b128 a[140:143],v192 offset:31744
buffer_load_dwordx4 v194,s[8:11],s30 offen offset:1024 sc1 lds
s_waitcnt lgkmcnt(6)
v_mfma_f32_32x32x16_bf16 v[112:127],a[116:119],a[100:103],v[112:127]
ds_read_b128 a[112:115],v192 offset:32768
s_waitcnt lgkmcnt(6)
v_mfma_f32_32x32x16_bf16 v[112:127],a[120:123],a[104:107],v[112:127]
ds_read_b128 a[116:119],v192 offset:33792
s_waitcnt lgkmcnt(6)
v_mfma_f32_32x32x16_bf16 v[112:127],a[124:127],a[108:111],v[112:127]
ds_read_b128 a[120:123],v192 offset:34816
s_waitcnt lgkmcnt(6)
v_mfma_f32_32x32x16_bf16 v[128:143],a[128:131],a[0:3],0
ds_read_b128 a[124:127],v192 offset:35840
buffer_load_dwordx4 v194,s[8:11],s30 offen offset:2048 sc1 lds
s_waitcnt lgkmcnt(6)
v_mfma_f32_32x32x16_bf16 v[128:143],a[132:135],a[4:7],v[128:143]
ds_read_b128 a[128:131],v192 offset:36864
s_waitcnt lgkmcnt(6)
v_mfma_f32_32x32x16_bf16 v[128:143],a[136:139],a[8:11],v[128:143]
ds_read_b128 a[132:135],v192 offset:37888
v_cvt_pk_bf16_f32 v64,v112,v116
s_waitcnt lgkmcnt(6)
v_mfma_f32_32x32x16_bf16 v[128:143],a[140:143],a[12:15],v[128:143]
ds_read_b128 a[136:139],v192 offset:38912
v_cvt_pk_bf16_f32 v65,v120,v124
s_waitcnt lgkmcnt(6)
v_mfma_f32_32x32x16_bf16 v[128:143],a[112:115],a[16:19],v[128:143]
ds_read_b128 a[140:143],v192 offset:39936
buffer_load_dwordx4 v194,s[8:11],s30 offen offset:3072 sc1 lds
v_cvt_pk_bf16_f32 v66,v113,v117
s_waitcnt lgkmcnt(6)
v_mfma_f32_32x32x16_bf16 v[128:143],a[116:119],a[20:23],v[128:143]
ds_read_b128 a[112:115],v192 offset:40960
v_cvt_pk_bf16_f32 v67,v121,v125
s_waitcnt lgkmcnt(6)
v_mfma_f32_32x32x16_bf16 v[128:143],a[120:123],a[24:27],v[128:143]
ds_read_b128 a[116:119],v192 offset:41984
v_cvt_pk_bf16_f32 v68,v114,v118
s_waitcnt lgkmcnt(6)
v_mfma_f32_32x32x16_bf16 v[128:143],a[124:127],a[28:31],v[128:143]
ds_read_b128 a[120:123],v192 offset:43008
v_cvt_pk_bf16_f32 v69,v122,v126
s_waitcnt lgkmcnt(6)
v_mfma_f32_32x32x16_bf16 v[128:143],a[128:131],a[32:35],v[128:143]
ds_read_b128 a[124:127],v192 offset:44032
s_add_u32 s30,s100,319488
s_add_u32 m0,s60,90112
s_nop 0
buffer_load_dwordx4 v194,s[8:11],s30 offen sc1 lds
v_cvt_pk_bf16_f32 v70,v115,v119
s_waitcnt lgkmcnt(6)
v_mfma_f32_32x32x16_bf16 v[128:143],a[132:135],a[36:39],v[128:143]
ds_read_b128 a[128:131],v192 offset:45056
v_cvt_pk_bf16_f32 v71,v123,v127
s_waitcnt lgkmcnt(6)
v_mfma_f32_32x32x16_bf16 v[128:143],a[136:139],a[40:43],v[128:143]
ds_read_b128 a[132:135],v192 offset:46080
v_permlane32_swap_b32 v64,v68
s_waitcnt lgkmcnt(6)
v_mfma_f32_32x32x16_bf16 v[128:143],a[140:143],a[44:47],v[128:143]
ds_read_b128 a[136:139],v192 offset:47104
v_permlane32_swap_b32 v65,v69
s_waitcnt lgkmcnt(6)
v_mfma_f32_32x32x16_bf16 v[128:143],a[112:115],a[48:51],v[128:143]
ds_read_b128 a[140:143],v192 offset:48128
buffer_load_dwordx4 v194,s[8:11],s30 offen offset:1024 sc1 lds
v_permlane32_swap_b32 v66,v70
s_waitcnt lgkmcnt(6)
v_mfma_f32_32x32x16_bf16 v[128:143],a[116:119],a[52:55],v[128:143]
ds_read_b128 a[112:115],v192 offset:49152
v_permlane32_swap_b32 v67,v71
s_waitcnt lgkmcnt(6)
v_mfma_f32_32x32x16_bf16 v[128:143],a[120:123],a[56:59],v[128:143]
ds_read_b128 a[116:119],v192 offset:50176
v_mfma_f32_32x32x16_bf16 v[144:159],a[64:67],v[64:67],v[144:159]
s_waitcnt lgkmcnt(6)
v_mfma_f32_32x32x16_bf16 v[128:143],a[124:127],a[60:63],v[128:143]
ds_read_b128 a[120:123],v192 offset:51200
v_mfma_f32_32x32x16_bf16 v[144:159],a[68:71],v[68:71],v[144:159]
s_waitcnt lgkmcnt(6)
v_mfma_f32_32x32x16_bf16 v[128:143],a[128:131],a[64:67],v[128:143]
ds_read_b128 a[124:127],v192 offset:52224
buffer_load_dwordx4 v194,s[8:11],s30 offen offset:2048 sc1 lds
s_waitcnt lgkmcnt(6)
v_mfma_f32_32x32x16_bf16 v[128:143],a[132:135],a[68:71],v[128:143]
ds_read_b128 a[128:131],v192 offset:53248
s_waitcnt lgkmcnt(6)
v_mfma_f32_32x32x16_bf16 v[128:143],a[136:139],a[72:75],v[128:143]
ds_read_b128 a[132:135],v192 offset:54272
s_waitcnt lgkmcnt(6)
v_mfma_f32_32x32x16_bf16 v[128:143],a[140:143],a[76:79],v[128:143]
ds_read_b128 a[136:139],v192 offset:55296
s_waitcnt vmcnt(7)
s_barrier
s_waitcnt lgkmcnt(6)
v_mfma_f32_32x32x16_bf16 v[128:143],a[112:115],a[80:83],v[128:143]
ds_read_b128 a[140:143],v192 offset:56320
s_add_u32 s30,s100,344064
s_add_u32 m0,s60,0
s_nop 0
buffer_load_dwordx4 v194,s[8:11],s30 offen sc1 lds
s_waitcnt lgkmcnt(6)
v_mfma_f32_32x32x16_bf16 v[128:143],a[116:119],a[84:87],v[128:143]
ds_read_b128 a[112:115],v193 offset:0
s_waitcnt lgkmcnt(6)
v_mfma_f32_32x32x16_bf16 v[128:143],a[120:123],a[88:91],v[128:143]
ds_read_b128 a[116:119],v193 offset:1024
s_waitcnt lgkmcnt(6)
v_mfma_f32_32x32x16_bf16 v[128:143],a[124:127],a[92:95],v[128:143]
ds_read_b128 a[120:123],v193 offset:2048
s_waitcnt lgkmcnt(6)
v_mfma_f32_32x32x16_bf16 v[128:143],a[128:131],a[96:99],v[128:143]
ds_read_b128 a[124:127],v193 offset:3072
buffer_load_dwordx4 v194,s[8:11],s30 offen offset:1024 sc1 lds
s_waitcnt lgkmcnt(6)
v_mfma_f32_32x32x16_bf16 v[128:143],a[132:135],a[100:103],v[128:143]
ds_read_b128 a[128:131],v193 offset:4096
s_waitcnt lgkmcnt(6)
v_mfma_f32_32x32x16_bf16 v[128:143],a[136:139],a[104:107],v[128:143]
ds_read_b128 a[132:135],v193 offset:5120
s_waitcnt lgkmcnt(6)
v_mfma_f32_32x32x16_bf16 v[128:143],a[140:143],a[108:111],v[128:143]
ds_read_b128 a[136:139],v193 offset:6144
s_waitcnt lgkmcnt(6)
v_mfma_f32_32x32x16_bf16 v[112:127],a[112:115],a[0:3],0
ds_read_b128 a[140:143],v193 offset:7168
buffer_load_dwordx4 v194,s[8:11],s30 offen offset:2048 sc1 lds
s_waitcnt lgkmcnt(6)
v_mfma_f32_32x32x16_bf16 v[112:127],a[116:119],a[4:7],v[112:127]
ds_read_b128 a[112:115],v193 offset:8192
s_waitcnt lgkmcnt(6)
v_mfma_f32_32x32x16_bf16 v[112:127],a[120:123],a[8:11],v[112:127]
ds_read_b128 a[116:119],v193 offset:9216
v_cvt_pk_bf16_f32 v72,v128,v132
s_waitcnt lgkmcnt(6)
v_mfma_f32_32x32x16_bf16 v[112:127],a[124:127],a[12:15],v[112:127]
ds_read_b128 a[120:123],v193 offset:10240
v_cvt_pk_bf16_f32 v73,v136,v140
s_waitcnt lgkmcnt(6)
v_mfma_f32_32x32x16_bf16 v[112:127],a[128:131],a[16:19],v[112:127]
ds_read_b128 a[124:127],v193 offset:11264
buffer_load_dwordx4 v194,s[8:11],s30 offen offset:3072 sc1 lds
v_cvt_pk_bf16_f32 v74,v129,v133
s_waitcnt lgkmcnt(6)
v_mfma_f32_32x32x16_bf16 v[112:127],a[132:135],a[20:23],v[112:127]
ds_read_b128 a[128:131],v193 offset:12288
v_cvt_pk_bf16_f32 v75,v137,v141
s_waitcnt lgkmcnt(6)
v_mfma_f32_32x32x16_bf16 v[112:127],a[136:139],a[24:27],v[112:127]
ds_read_b128 a[132:135],v193 offset:13312
v_cvt_pk_bf16_f32 v76,v130,v134
s_waitcnt lgkmcnt(6)
v_mfma_f32_32x32x16_bf16 v[112:127],a[140:143],a[28:31],v[112:127]
ds_read_b128 a[136:139],v193 offset:14336
v_cvt_pk_bf16_f32 v77,v138,v142
s_waitcnt lgkmcnt(6)
v_mfma_f32_32x32x16_bf16 v[112:127],a[112:115],a[32:35],v[112:127]
ds_read_b128 a[140:143],v193 offset:15360
s_add_u32 s30,s100,348160
s_add_u32 m0,s60,4096
s_nop 0
buffer_load_dwordx4 v194,s[8:11],s30 offen sc1 lds
v_cvt_pk_bf16_f32 v78,v131,v135
s_waitcnt lgkmcnt(6)
v_mfma_f32_32x32x16_bf16 v[112:127],a[116:119],a[36:39],v[112:127]
ds_read_b128 a[112:115],v193 offset:16384
v_cvt_pk_bf16_f32 v79,v139,v143
s_waitcnt lgkmcnt(6)
v_mfma_f32_32x32x16_bf16 v[112:127],a[120:123],a[40:43],v[112:127]
ds_read_b128 a[116:119],v193 offset:17408
v_permlane32_swap_b32 v72,v76
s_waitcnt lgkmcnt(6)
v_mfma_f32_32x32x16_bf16 v[112:127],a[124:127],a[44:47],v[112:127]
ds_read_b128 a[120:123],v193 offset:18432
v_permlane32_swap_b32 v73,v77
s_waitcnt lgkmcnt(6)
v_mfma_f32_32x32x16_bf16 v[112:127],a[128:131],a[48:51],v[112:127]
ds_read_b128 a[124:127],v193 offset:19456
buffer_load_dwordx4 v194,s[8:11],s30 offen offset:1024 sc1 lds
v_permlane32_swap_b32 v74,v78
s_waitcnt lgkmcnt(6)
v_mfma_f32_32x32x16_bf16 v[112:127],a[132:135],a[52:55],v[112:127]
ds_read_b128 a[128:131],v193 offset:20480
v_permlane32_swap_b32 v75,v79
s_waitcnt lgkmcnt(6)
v_mfma_f32_32x32x16_bf16 v[112:127],a[136:139],a[56:59],v[112:127]
ds_read_b128 a[132:135],v193 offset:21504
v_mfma_f32_32x32x16_bf16 v[144:159],a[72:75],v[72:75],v[144:159]
s_waitcnt lgkmcnt(6)
v_mfma_f32_32x32x16_bf16 v[112:127],a[140:143],a[60:63],v[112:127]
ds_read_b128 a[136:139],v193 offset:22528
v_mfma_f32_32x32x16_bf16 v[144:159],a[76:79],v[76:79],v[144:159]
s_waitcnt lgkmcnt(6)
v_mfma_f32_32x32x16_bf16 v[112:127],a[112:115],a[64:67],v[112:127]
ds_read_b128 a[140:143],v193 offset:23552
buffer_load_dwordx4 v194,s[8:11],s30 offen offset:2048 sc1 lds
s_waitcnt lgkmcnt(6)
v_mfma_f32_32x32x16_bf16 v[112:127],a[116:119],a[68:71],v[112:127]
ds_read_b128 a[112:115],v193 offset:24576
s_waitcnt lgkmcnt(6)
v_mfma_f32_32x32x16_bf16 v[112:127],a[120:123],a[72:75],v[112:127]
ds_read_b128 a[116:119],v193 offset:25600
s_waitcnt lgkmcnt(6)
v_mfma_f32_32x32x16_bf16 v[112:127],a[124:127],a[76:79],v[112:127]
ds_read_b128 a[120:123],v193 offset:26624
s_waitcnt vmcnt(7)
s_barrier
s_waitcnt lgkmcnt(6)
v_mfma_f32_32x32x16_bf16 v[112:127],a[128:131],a[80:83],v[112:127]
ds_read_b128 a[124:127],v193 offset:27648
s_add_u32 s30,s100,372736
s_add_u32 m0,s60,28672
s_nop 0
buffer_load_dwordx4 v194,s[8:11],s30 offen sc1 lds
s_waitcnt lgkmcnt(6)
v_mfma_f32_32x32x16_bf16 v[112:127],a[132:135],a[84:87],v[112:127]
ds_read_b128 a[128:131],v193 offset:28672
s_waitcnt lgkmcnt(6)
v_mfma_f32_32x32x16_bf16 v[112:127],a[136:139],a[88:91],v[112:127]
ds_read_b128 a[132:135],v193 offset:29696
s_waitcnt lgkmcnt(6)
v_mfma_f32_32x32x16_bf16 v[112:127],a[140:143],a[92:95],v[112:127]
ds_read_b128 a[136:139],v193 offset:30720
s_waitcnt lgkmcnt(6)
v_mfma_f32_32x32x16_bf16 v[112:127],a[112:115],a[96:99],v[112:127]
ds_read_b128 a[140:143],v193 offset:31744
buffer_load_dwordx4 v194,s[8:11],s30 offen offset:1024 sc1 lds
s_waitcnt lgkmcnt(6)
v_mfma_f32_32x32x16_bf16 v[112:127],a[116:119],a[100:103],v[112:127]
ds_read_b128 a[112:115],v193 offset:32768
s_waitcnt lgkmcnt(6)
v_mfma_f32_32x32x16_bf16 v[112:127],a[120:123],a[104:107],v[112:127]
ds_read_b128 a[116:119],v193 offset:33792
s_waitcnt lgkmcnt(6)
v_mfma_f32_32x32x16_bf16 v[112:127],a[124:127],a[108:111],v[112:127]
ds_read_b128 a[120:123],v193 offset:34816
s_waitcnt lgkmcnt(6)
v_mfma_f32_32x32x16_bf16 v[128:143],a[128:131],a[0:3],0
ds_read_b128 a[124:127],v193 offset:35840
buffer_load_dwordx4 v194,s[8:11],s30 offen offset:2048 sc1 lds
s_waitcnt lgkmcnt(6)
v_mfma_f32_32x32x16_bf16 v[128:143],a[132:135],a[4:7],v[128:143]
ds_read_b128 a[128:131],v193 offset:36864
s_waitcnt lgkmcnt(6)
v_mfma_f32_32x32x16_bf16 v[128:143],a[136:139],a[8:11],v[128:143]
ds_read_b128 a[132:135],v193 offset:37888
v_cvt_pk_bf16_f32 v80,v112,v116
s_waitcnt lgkmcnt(6)
v_mfma_f32_32x32x16_bf16 v[128:143],a[140:143],a[12:15],v[128:143]
ds_read_b128 a[136:139],v193 offset:38912
v_cvt_pk_bf16_f32 v81,v120,v124
s_waitcnt lgkmcnt(6)
v_mfma_f32_32x32x16_bf16 v[128:143],a[112:115],a[16:19],v[128:143]
ds_read_b128 a[140:143],v193 offset:39936
buffer_load_dwordx4 v194,s[8:11],s30 offen offset:3072 sc1 lds
v_cvt_pk_bf16_f32 v82,v113,v117
s_waitcnt lgkmcnt(6)
v_mfma_f32_32x32x16_bf16 v[128:143],a[116:119],a[20:23],v[128:143]
ds_read_b128 a[112:115],v193 offset:40960
v_cvt_pk_bf16_f32 v83,v121,v125
s_waitcnt lgkmcnt(6)
v_mfma_f32_32x32x16_bf16 v[128:143],a[120:123],a[24:27],v[128:143]
ds_read_b128 a[116:119],v193 offset:41984
v_cvt_pk_bf16_f32 v84,v114,v118
s_waitcnt lgkmcnt(6)
v_mfma_f32_32x32x16_bf16 v[128:143],a[124:127],a[28:31],v[128:143]
ds_read_b128 a[120:123],v193 offset:43008
v_cvt_pk_bf16_f32 v85,v122,v126
s_waitcnt lgkmcnt(6)
v_mfma_f32_32x32x16_bf16 v[128:143],a[128:131],a[32:35],v[128:143]
ds_read_b128 a[124:127],v193 offset:44032
s_add_u32 s30,s100,376832
s_add_u32 m0,s60,32768
s_nop 0
buffer_load_dwordx4 v194,s[8:11],s30 offen sc1 lds
v_cvt_pk_bf16_f32 v86,v115,v119
s_waitcnt lgkmcnt(6)
v_mfma_f32_32x32x16_bf16 v[128:143],a[132:135],a[36:39],v[128:143]
ds_read_b128 a[128:131],v193 offset:45056
v_cvt_pk_bf16_f32 v87,v123,v127
s_waitcnt lgkmcnt(6)
v_mfma_f32_32x32x16_bf16 v[128:143],a[136:139],a[40:43],v[128:143]
ds_read_b128 a[132:135],v193 offset:46080
v_permlane32_swap_b32 v80,v84
s_waitcnt lgkmcnt(6)
v_mfma_f32_32x32x16_bf16 v[128:143],a[140:143],a[44:47],v[128:143]
ds_read_b128 a[136:139],v193 offset:47104
v_permlane32_swap_b32 v81,v85
s_waitcnt lgkmcnt(6)
v_mfma_f32_32x32x16_bf16 v[128:143],a[112:115],a[48:51],v[128:143]
ds_read_b128 a[140:143],v193 offset:48128
buffer_load_dwordx4 v194,s[8:11],s30 offen offset:1024 sc1 lds
v_permlane32_swap_b32 v82,v86
s_waitcnt lgkmcnt(6)
v_mfma_f32_32x32x16_bf16 v[128:143],a[116:119],a[52:55],v[128:143]
ds_read_b128 a[112:115],v193 offset:49152
v_permlane32_swap_b32 v83,v87
s_waitcnt lgkmcnt(6)
v_mfma_f32_32x32x16_bf16 v[128:143],a[120:123],a[56:59],v[128:143]
ds_read_b128 a[116:119],v193 offset:50176
v_mfma_f32_32x32x16_bf16 v[144:159],a[80:83],v[80:83],v[144:159]
s_waitcnt lgkmcnt(6)
v_mfma_f32_32x32x16_bf16 v[128:143],a[124:127],a[60:63],v[128:143]
ds_read_b128 a[120:123],v193 offset:51200
v_mfma_f32_32x32x16_bf16 v[144:159],a[84:87],v[84:87],v[144:159]
s_waitcnt lgkmcnt(6)
v_mfma_f32_32x32x16_bf16 v[128:143],a[128:131],a[64:67],v[128:143]
ds_read_b128 a[124:127],v193 offset:52224
buffer_load_dwordx4 v194,s[8:11],s30 offen offset:2048 sc1 lds
s_waitcnt lgkmcnt(6)
v_mfma_f32_32x32x16_bf16 v[128:143],a[132:135],a[68:71],v[128:143]
ds_read_b128 a[128:131],v193 offset:53248
s_waitcnt lgkmcnt(6)
v_mfma_f32_32x32x16_bf16 v[128:143],a[136:139],a[72:75],v[128:143]
ds_read_b128 a[132:135],v193 offset:54272
s_waitcnt lgkmcnt(6)
v_mfma_f32_32x32x16_bf16 v[128:143],a[140:143],a[76:79],v[128:143]
ds_read_b128 a[136:139],v193 offset:55296
s_waitcnt vmcnt(7)
s_barrier
s_waitcnt lgkmcnt(6)
v_mfma_f32_32x32x16_bf16 v[128:143],a[112:115],a[80:83],v[128:143]
ds_read_b128 a[140:143],v193 offset:56320
s_waitcnt lgkmcnt(6)
v_mfma_f32_32x32x16_bf16 v[128:143],a[116:119],a[84:87],v[128:143]
ds_read_b128 a[112:115],v192 offset:0
s_waitcnt lgkmcnt(6)
v_mfma_f32_32x32x16_bf16 v[128:143],a[120:123],a[88:91],v[128:143]
ds_read_b128 a[116:119],v192 offset:1024
s_waitcnt lgkmcnt(6)
v_mfma_f32_32x32x16_bf16 v[128:143],a[124:127],a[92:95],v[128:143]
ds_read_b128 a[120:123],v192 offset:2048
s_waitcnt lgkmcnt(6)
v_mfma_f32_32x32x16_bf16 v[128:143],a[128:131],a[96:99],v[128:143]
ds_read_b128 a[124:127],v192 offset:3072
s_waitcnt lgkmcnt(6)
v_mfma_f32_32x32x16_bf16 v[128:143],a[132:135],a[100:103],v[128:143]
ds_read_b128 a[128:131],v192 offset:4096
s_waitcnt lgkmcnt(6)
v_mfma_f32_32x32x16_bf16 v[128:143],a[136:139],a[104:107],v[128:143]
ds_read_b128 a[132:135],v192 offset:5120
s_waitcnt lgkmcnt(6)
v_mfma_f32_32x32x16_bf16 v[128:143],a[140:143],a[108:111],v[128:143]
ds_read_b128 a[136:139],v192 offset:6144
s_waitcnt lgkmcnt(6)
v_mfma_f32_32x32x16_bf16 v[112:127],a[112:115],a[0:3],0
ds_read_b128 a[140:143],v192 offset:7168
s_waitcnt lgkmcnt(6)
v_mfma_f32_32x32x16_bf16 v[112:127],a[116:119],a[4:7],v[112:127]
ds_read_b128 a[112:115],v192 offset:8192
s_waitcnt lgkmcnt(6)
v_mfma_f32_32x32x16_bf16 v[112:127],a[120:123],a[8:11],v[112:127]
ds_read_b128 a[116:119],v192 offset:9216
v_cvt_pk_bf16_f32 v88,v128,v132
s_waitcnt lgkmcnt(6)
v_mfma_f32_32x32x16_bf16 v[112:127],a[124:127],a[12:15],v[112:127]
ds_read_b128 a[120:123],v192 offset:10240
v_cvt_pk_bf16_f32 v89,v136,v140
s_waitcnt lgkmcnt(6)
v_mfma_f32_32x32x16_bf16 v[112:127],a[128:131],a[16:19],v[112:127]
ds_read_b128 a[124:127],v192 offset:11264
v_cvt_pk_bf16_f32 v90,v129,v133
s_waitcnt lgkmcnt(6)
v_mfma_f32_32x32x16_bf16 v[112:127],a[132:135],a[20:23],v[112:127]
ds_read_b128 a[128:131],v192 offset:12288
v_cvt_pk_bf16_f32 v91,v137,v141
s_waitcnt lgkmcnt(6)
v_mfma_f32_32x32x16_bf16 v[112:127],a[136:139],a[24:27],v[112:127]
ds_read_b128 a[132:135],v192 offset:13312
v_cvt_pk_bf16_f32 v92,v130,v134
s_waitcnt lgkmcnt(6)
v_mfma_f32_32x32x16_bf16 v[112:127],a[140:143],a[28:31],v[112:127]
ds_read_b128 a[136:139],v192 offset:14336
v_cvt_pk_bf16_f32 v93,v138,v142
s_waitcnt lgkmcnt(6)
v_mfma_f32_32x32x16_bf16 v[112:127],a[112:115],a[32:35],v[112:127]
ds_read_b128 a[140:143],v192 offset:15360
v_cvt_pk_bf16_f32 v94,v131,v135
s_waitcnt lgkmcnt(6)
v_mfma_f32_32x32x16_bf16 v[112:127],a[116:119],a[36:39],v[112:127]
ds_read_b128 a[112:115],v192 offset:16384
v_cvt_pk_bf16_f32 v95,v139,v143
s_waitcnt lgkmcnt(6)
v_mfma_f32_32x32x16_bf16 v[112:127],a[120:123],a[40:43],v[112:127]
ds_read_b128 a[116:119],v192 offset:17408
v_permlane32_swap_b32 v88,v92
s_waitcnt lgkmcnt(6)
v_mfma_f32_32x32x16_bf16 v[112:127],a[124:127],a[44:47],v[112:127]
ds_read_b128 a[120:123],v192 offset:18432
v_permlane32_swap_b32 v89,v93
s_waitcnt lgkmcnt(6)
v_mfma_f32_32x32x16_bf16 v[112:127],a[128:131],a[48:51],v[112:127]
ds_read_b128 a[124:127],v192 offset:19456
v_permlane32_swap_b32 v90,v94
s_waitcnt lgkmcnt(6)
v_mfma_f32_32x32x16_bf16 v[112:127],a[132:135],a[52:55],v[112:127]
ds_read_b128 a[128:131],v192 offset:20480
v_permlane32_swap_b32 v91,v95
s_waitcnt lgkmcnt(6)
v_mfma_f32_32x32x16_bf16 v[112:127],a[136:139],a[56:59],v[112:127]
ds_read_b128 a[132:135],v192 offset:21504
v_mfma_f32_32x32x16_bf16 v[144:159],a[88:91],v[88:91],v[144:159]
s_waitcnt lgkmcnt(6)
v_mfma_f32_32x32x16_bf16 v[112:127],a[140:143],a[60:63],v[112:127]
ds_read_b128 a[136:139],v192 offset:22528
v_mfma_f32_32x32x16_bf16 v[144:159],a[92:95],v[92:95],v[144:159]
s_waitcnt lgkmcnt(6)
v_mfma_f32_32x32x16_bf16 v[112:127],a[112:115],a[64:67],v[112:127]
ds_read_b128 a[140:143],v192 offset:23552
s_waitcnt lgkmcnt(6)
v_mfma_f32_32x32x16_bf16 v[112:127],a[116:119],a[68:71],v[112:127]
ds_read_b128 a[112:115],v192 offset:24576
s_waitcnt lgkmcnt(6)
v_mfma_f32_32x32x16_bf16 v[112:127],a[120:123],a[72:75],v[112:127]
ds_read_b128 a[116:119],v192 offset:25600
s_waitcnt lgkmcnt(6)
v_mfma_f32_32x32x16_bf16 v[112:127],a[124:127],a[76:79],v[112:127]
ds_read_b128 a[120:123],v192 offset:26624
s_waitcnt vmcnt(0)
s_barrier
s_waitcnt lgkmcnt(6)
v_mfma_f32_32x32x16_bf16 v[112:127],a[128:131],a[80:83],v[112:127]
ds_read_b128 a[124:127],v192 offset:27648
s_waitcnt lgkmcnt(6)
v_mfma_f32_32x32x16_bf16 v[112:127],a[132:135],a[84:87],v[112:127]
ds_read_b128 a[128:131],v192 offset:28672
s_waitcnt lgkmcnt(6)
v_mfma_f32_32x32x16_bf16 v[112:127],a[136:139],a[88:91],v[112:127]
ds_read_b128 a[132:135],v192 offset:29696
s_waitcnt lgkmcnt(6)
v_mfma_f32_32x32x16_bf16 v[112:127],a[140:143],a[92:95],v[112:127]
ds_read_b128 a[136:139],v192 offset:30720
s_waitcnt lgkmcnt(6)
v_mfma_f32_32x32x16_bf16 v[112:127],a[112:115],a[96:99],v[112:127]
ds_read_b128 a[140:143],v192 offset:31744
s_waitcnt lgkmcnt(6)
v_mfma_f32_32x32x16_bf16 v[112:127],a[116:119],a[100:103],v[112:127]
ds_read_b128 a[112:115],v192 offset:32768
s_waitcnt lgkmcnt(6)
v_mfma_f32_32x32x16_bf16 v[112:127],a[120:123],a[104:107],v[112:127]
ds_read_b128 a[116:119],v192 offset:33792
s_waitcnt lgkmcnt(6)
v_mfma_f32_32x32x16_bf16 v[112:127],a[124:127],a[108:111],v[112:127]
ds_read_b128 a[120:123],v192 offset:34816
s_waitcnt lgkmcnt(6)
v_mfma_f32_32x32x16_bf16 v[128:143],a[128:131],a[0:3],0
ds_read_b128 a[124:127],v192 offset:35840
s_waitcnt lgkmcnt(6)
v_mfma_f32_32x32x16_bf16 v[128:143],a[132:135],a[4:7],v[128:143]
ds_read_b128 a[128:131],v192 offset:36864
s_waitcnt lgkmcnt(6)
v_mfma_f32_32x32x16_bf16 v[128:143],a[136:139],a[8:11],v[128:143]
ds_read_b128 a[132:135],v192 offset:37888
v_cvt_pk_bf16_f32 v96,v112,v116
s_waitcnt lgkmcnt(6)
v_mfma_f32_32x32x16_bf16 v[128:143],a[140:143],a[12:15],v[128:143]
ds_read_b128 a[136:139],v192 offset:38912
v_cvt_pk_bf16_f32 v97,v120,v124
s_waitcnt lgkmcnt(6)
v_mfma_f32_32x32x16_bf16 v[128:143],a[112:115],a[16:19],v[128:143]
ds_read_b128 a[140:143],v192 offset:39936
v_cvt_pk_bf16_f32 v98,v113,v117
s_waitcnt lgkmcnt(6)
v_mfma_f32_32x32x16_bf16 v[128:143],a[116:119],a[20:23],v[128:143]
ds_read_b128 a[112:115],v192 offset:40960
v_cvt_pk_bf16_f32 v99,v121,v125
s_waitcnt lgkmcnt(6)
v_mfma_f32_32x32x16_bf16 v[128:143],a[120:123],a[24:27],v[128:143]
ds_read_b128 a[116:119],v192 offset:41984
v_cvt_pk_bf16_f32 v100,v114,v118
s_waitcnt lgkmcnt(6)
v_mfma_f32_32x32x16_bf16 v[128:143],a[124:127],a[28:31],v[128:143]
ds_read_b128 a[120:123],v192 offset:43008
v_cvt_pk_bf16_f32 v101,v122,v126
s_waitcnt lgkmcnt(6)
v_mfma_f32_32x32x16_bf16 v[128:143],a[128:131],a[32:35],v[128:143]
ds_read_b128 a[124:127],v192 offset:44032
v_cvt_pk_bf16_f32 v102,v115,v119
s_waitcnt lgkmcnt(6)
v_mfma_f32_32x32x16_bf16 v[128:143],a[132:135],a[36:39],v[128:143]
ds_read_b128 a[128:131],v192 offset:45056
v_cvt_pk_bf16_f32 v103,v123,v127
s_waitcnt lgkmcnt(6)
v_mfma_f32_32x32x16_bf16 v[128:143],a[136:139],a[40:43],v[128:143]
ds_read_b128 a[132:135],v192 offset:46080
v_permlane32_swap_b32 v96,v100
s_waitcnt lgkmcnt(6)
v_mfma_f32_32x32x16_bf16 v[128:143],a[140:143],a[44:47],v[128:143]
ds_read_b128 a[136:139],v192 offset:47104
v_permlane32_swap_b32 v97,v101
s_waitcnt lgkmcnt(6)
v_mfma_f32_32x32x16_bf16 v[128:143],a[112:115],a[48:51],v[128:143]
ds_read_b128 a[140:143],v192 offset:48128
v_permlane32_swap_b32 v98,v102
s_waitcnt lgkmcnt(6)
v_mfma_f32_32x32x16_bf16 v[128:143],a[116:119],a[52:55],v[128:143]
ds_read_b128 a[112:115],v192 offset:49152
v_permlane32_swap_b32 v99,v103
s_waitcnt lgkmcnt(6)
v_mfma_f32_32x32x16_bf16 v[128:143],a[120:123],a[56:59],v[128:143]
ds_read_b128 a[116:119],v192 offset:50176
v_mfma_f32_32x32x16_bf16 v[144:159],a[96:99],v[96:99],v[144:159]
s_waitcnt lgkmcnt(6)
v_mfma_f32_32x32x16_bf16 v[128:143],a[124:127],a[60:63],v[128:143]
ds_read_b128 a[120:123],v192 offset:51200
v_mfma_f32_32x32x16_bf16 v[144:159],a[100:103],v[100:103],v[144:159]
s_waitcnt lgkmcnt(6)
v_mfma_f32_32x32x16_bf16 v[128:143],a[128:131],a[64:67],v[128:143]
ds_read_b128 a[124:127],v192 offset:52224
s_waitcnt lgkmcnt(6)
v_mfma_f32_32x32x16_bf16 v[128:143],a[132:135],a[68:71],v[128:143]
ds_read_b128 a[128:131],v192 offset:53248
s_waitcnt lgkmcnt(6)
v_mfma_f32_32x32x16_bf16 v[128:143],a[136:139],a[72:75],v[128:143]
ds_read_b128 a[132:135],v192 offset:54272
s_waitcnt lgkmcnt(6)
v_mfma_f32_32x32x16_bf16 v[128:143],a[140:143],a[76:79],v[128:143]
ds_read_b128 a[136:139],v192 offset:55296
s_waitcnt lgkmcnt(6)
v_mfma_f32_32x32x16_bf16 v[128:143],a[112:115],a[80:83],v[128:143]
ds_read_b128 a[140:143],v192 offset:56320
s_waitcnt lgkmcnt(6)
v_mfma_f32_32x32x16_bf16 v[128:143],a[116:119],a[84:87],v[128:143]
s_waitcnt lgkmcnt(5)
v_mfma_f32_32x32x16_bf16 v[128:143],a[120:123],a[88:91],v[128:143]
s_waitcnt lgkmcnt(4)
v_mfma_f32_32x32x16_bf16 v[128:143],a[124:127],a[92:95],v[128:143]
s_waitcnt lgkmcnt(3)
v_mfma_f32_32x32x16_bf16 v[128:143],a[128:131],a[96:99],v[128:143]
s_waitcnt lgkmcnt(2)
v_mfma_f32_32x32x16_bf16 v[128:143],a[132:135],a[100:103],v[128:143]
s_waitcnt lgkmcnt(1)
v_mfma_f32_32x32x16_bf16 v[128:143],a[136:139],a[104:107],v[128:143]
s_waitcnt lgkmcnt(0)
v_mfma_f32_32x32x16_bf16 v[128:143],a[140:143],a[108:111],v[128:143]
s_nop 11
v_cvt_pk_bf16_f32 v104,v128,v132
v_cvt_pk_bf16_f32 v105,v136,v140
v_cvt_pk_bf16_f32 v106,v129,v133
v_cvt_pk_bf16_f32 v107,v137,v141
v_cvt_pk_bf16_f32 v108,v130,v134
v_cvt_pk_bf16_f32 v109,v138,v142
v_cvt_pk_bf16_f32 v110,v131,v135
v_cvt_pk_bf16_f32 v111,v139,v143
v_permlane32_swap_b32 v104,v108
v_permlane32_swap_b32 v105,v109
v_permlane32_swap_b32 v106,v110
v_permlane32_swap_b32 v107,v111
s_nop 1
v_mfma_f32_32x32x16_bf16 v[144:159],a[104:107],v[104:107],v[144:159]
v_mfma_f32_32x32x16_bf16 v[144:159],a[108:111],v[108:111],v[144:159]
v_bfe_u32 v208,v192,4,5
v_lshrrev_b32 v209,2,v206
v_sub_u32 v208,v208,v209
v_mov_b32 v209,0xceabfb8f
v_cmp_le_i32 vcc,0,v208
s_nop 6
v_cndmask_b32 v144,v209,v144,vcc
v_cmp_le_i32 vcc,1,v208
s_nop 1
v_cndmask_b32 v145,v209,v145,vcc
v_cmp_le_i32 vcc,2,v208
s_nop 1
v_cndmask_b32 v146,v209,v146,vcc
v_cmp_le_i32 vcc,3,v208
s_nop 1
v_cndmask_b32 v147,v209,v147,vcc
v_cmp_le_i32 vcc,8,v208
s_nop 1
v_cndmask_b32 v148,v209,v148,vcc
v_cmp_le_i32 vcc,9,v208
s_nop 1
v_cndmask_b32 v149,v209,v149,vcc
v_cmp_le_i32 vcc,10,v208
s_nop 1
v_cndmask_b32 v150,v209,v150,vcc
v_cmp_le_i32 vcc,11,v208
s_nop 1
v_cndmask_b32 v151,v209,v151,vcc
v_cmp_le_i32 vcc,16,v208
s_nop 1
v_cndmask_b32 v152,v209,v152,vcc
v_cmp_le_i32 vcc,17,v208
s_nop 1
v_cndmask_b32 v153,v209,v153,vcc
v_cmp_le_i32 vcc,18,v208
s_nop 1
v_cndmask_b32 v154,v209,v154,vcc
v_cmp_le_i32 vcc,19,v208
s_nop 1
v_cndmask_b32 v155,v209,v155,vcc
v_cmp_le_i32 vcc,24,v208
s_nop 1
v_cndmask_b32 v156,v209,v156,vcc
v_cmp_le_i32 vcc,25,v208
s_nop 1
v_cndmask_b32 v157,v209,v157,vcc
v_cmp_le_i32 vcc,26,v208
s_nop 1
v_cndmask_b32 v158,v209,v158,vcc
v_cmp_le_i32 vcc,27,v208
s_nop 1
v_cndmask_b32 v159,v209,v159,vcc
v_max3_f32 v210,v144,v145,v146
v_max3_f32 v210,v210,v147,v148
v_max3_f32 v210,v210,v149,v150
v_max3_f32 v210,v210,v151,v152
v_max3_f32 v210,v210,v153,v154
v_max3_f32 v210,v210,v155,v156
v_max3_f32 v210,v210,v157,v158
v_max_f32 v210,v210,v159
v_and_b32 v211,0x1f0,v192
v_and_b32 v212,0x30,v192
v_bfe_u32 v214,v192,7,1
v_lshl_add_u32 v212,v214,6,v212
v_bfe_u32 v214,v192,6,1
v_lshl_add_u32 v212,v214,7,v212
v_bfe_u32 v214,v192,8,1
v_lshl_add_u32 v212,v214,9,v212
v_lshl_add_u32 v212,v206,4,v212
v_bfe_u32 v214,v192,4,1
v_mul_u32_u24 v214,0xaaaa,v214
v_add_u32 v160,0x4444,v214
v_lshrrev_b32 v213,1,v206
v_add_u32 v213,v213,v211
v_mov_b64 v[112:113],0
v_mov_b64 v[114:115],0
v_mov_b64 v[116:117],0
v_mov_b64 v[118:119],0
v_mov_b64 v[120:121],0
v_mov_b64 v[122:123],0
v_mov_b64 v[124:125],0
v_mov_b64 v[126:127],0
v_mov_b64 v[128:129],0
v_mov_b64 v[130:131],0
v_mov_b64 v[132:133],0
v_mov_b64 v[134:135],0
v_mov_b64 v[136:137],0
v_mov_b64 v[138:139],0
v_mov_b64 v[140:141],0
v_mov_b64 v[142:143],0
s_cmp_ge_u32 s99,60
s_cselect_b32 s31,-1,1
s_add_u32 s31,s31,s99
s_and_b32 s30,s39,15
s_lshl_b32 s30,s30,7
s_add_u32 s30,s30,50610432
s_mov_b32 s27,0
s_mov_b64 exec,1
wp_235:
buffer_load_dword v248,v199,s[8:11],s30 offen sc1
s_waitcnt vmcnt(0)
v_readfirstlane_b32 s58,v248
s_cmp_ge_u32 s58,s31
s_cbranch_scc1 wpd_236
s_add_u32 s58,s58,2
s_cmp_gt_u32 s58,s31
s_cbranch_scc1 wps_237
s_sleep 24
wps_237:
s_sleep 2
s_add_u32 s27,s27,1
s_cmp_lt_u32 s27,32768
s_cbranch_scc1 wp_235
s_mov_b32 s38,10
wpd_236:
s_mov_b64 exec,-1
s_lshl_b32 s30,s99,13
s_add_u32 s30,s30,51380224
s_add_u32 s31,s30,4096
s_mov_b32 s27,0
uv_238:
buffer_load_dwordx4 v[224:227],v212,s[8:11],s30 offen sc1
buffer_load_dwordx4 v[228:231],v212,s[8:11],s30 offen offset:1024 sc1
buffer_load_dwordx4 v[232:235],v212,s[8:11],s30 offen offset:2048 sc1
buffer_load_dwordx4 v[236:239],v212,s[8:11],s30 offen offset:3072 sc1
buffer_load_dwordx4 v[240:243],v212,s[8:11],s31 offen sc1
buffer_load_dwordx4 v[244:247],v212,s[8:11],s31 offen offset:1024 sc1
buffer_load_dwordx4 v[248:251],v212,s[8:11],s31 offen offset:2048 sc1
s_waitcnt vmcnt(6)
v_max3_u32 v214,v224,v225,v226
v_max_u32 v214,v214,v227
s_waitcnt vmcnt(5)
v_max3_u32 v214,v228,v229,v214
v_max3_u32 v214,v230,v231,v214
s_waitcnt vmcnt(4)
v_max3_u32 v214,v232,v233,v214
v_max3_u32 v214,v234,v235,v214
s_waitcnt vmcnt(3)
v_max3_u32 v214,v236,v237,v214
v_max3_u32 v214,v238,v239,v214
s_waitcnt vmcnt(2)
v_max3_u32 v214,v240,v241,v214
v_max3_u32 v214,v242,v243,v214
s_waitcnt vmcnt(1)
v_max3_u32 v214,v244,v245,v214
v_max3_u32 v214,v246,v247,v214
s_waitcnt vmcnt(0)
v_max3_u32 v214,v248,v249,v214
v_max3_u32 v214,v250,v251,v214
v_cmp_eq_u32 vcc,-1,v214
s_cbranch_vccz uvd_239
s_add_u32 s27,s27,1
s_cmp_lt_u32 s27,32768
s_cbranch_scc1 uv_238
s_mov_b32 s38,11
uvd_239:
v_smfmac_f32_32x32x32_bf16 v[112:127],v[224:227],v[0:7],v160
v_smfmac_f32_32x32x32_bf16 v[128:143],v[224:227],v[8:15],v160
v_smfmac_f32_32x32x32_bf16 v[112:127],v[228:231],v[16:23],v160
v_smfmac_f32_32x32x32_bf16 v[128:143],v[228:231],v[24:31],v160
v_smfmac_f32_32x32x32_bf16 v[112:127],v[232:235],v[32:39],v160
v_smfmac_f32_32x32x32_bf16 v[128:143],v[232:235],v[40:47],v160
v_smfmac_f32_32x32x32_bf16 v[112:127],v[236:239],v[48:55],v160
v_smfmac_f32_32x32x32_bf16 v[128:143],v[236:239],v[56:63],v160
v_smfmac_f32_32x32x32_bf16 v[112:127],v[240:243],v[64:71],v160
v_smfmac_f32_32x32x32_bf16 v[128:143],v[240:243],v[72:79],v160
v_smfmac_f32_32x32x32_bf16 v[112:127],v[244:247],v[80:87],v160
v_smfmac_f32_32x32x32_bf16 v[128:143],v[244:247],v[88:95],v160
v_smfmac_f32_32x32x32_bf16 v[112:127],v[248:251],v[96:103],v160
v_smfmac_f32_32x32x32_bf16 v[128:143],v[248:251],v[104:111],v160
s_mul_i32 s30,s99,40960
s_lshr_b32 s31,s98,2
s_mul_i32 s31,s31,10240
s_add_u32 s30,s30,s31
s_add_u32 s30,s30,60817408
s_and_b32 s56,s98,3
s_lshl_b32 s31,s56,9
s_add_u32 s31,s31,s30
s_add_u32 s31,s31,8192
s_lshl_b32 s56,s56,11
s_add_u32 s30,s30,s56
s_lshl_b32 s57,s99,7
s_lshl_b32 s56,s98,2
s_add_u32 s57,s57,s56
s_add_u32 s57,s57,50601984
v_add_f32 v216,v112,v113
v_add_f32 v217,v114,v115
v_add_f32 v218,v116,v117
v_add_f32 v219,v118,v119
v_add_f32 v220,v136,v137
v_add_f32 v221,v138,v139
v_add_f32 v222,v140,v141
v_add_f32 v223,v142,v143
v_add_f32 v216,v216,v220
v_add_f32 v217,v217,v221
v_add_f32 v218,v218,v222
v_add_f32 v219,v219,v223
v_max3_f32 v210,v210,v216,v217
v_max3_f32 v210,v210,v218,v219
v_mov_b32 v214,v210
s_nop 1
v_permlane32_swap_b32 v210,v214
v_max_f32 v210,v210,v214
v_sub_f32 v144,v144,v210
v_sub_f32 v145,v145,v210
v_sub_f32 v146,v146,v210
v_sub_f32 v147,v147,v210
v_sub_f32 v148,v148,v210
v_sub_f32 v149,v149,v210
v_sub_f32 v150,v150,v210
v_sub_f32 v151,v151,v210
v_sub_f32 v152,v152,v210
v_sub_f32 v153,v153,v210
v_sub_f32 v154,v154,v210
v_sub_f32 v155,v155,v210
v_sub_f32 v156,v156,v210
v_sub_f32 v157,v157,v210
v_sub_f32 v158,v158,v210
v_sub_f32 v159,v159,v210
v_sub_f32 v216,v216,v210
v_sub_f32 v217,v217,v210
v_sub_f32 v218,v218,v210
v_sub_f32 v219,v219,v210
v_exp_f32 v144,v144
v_exp_f32 v145,v145
v_exp_f32 v146,v146
v_exp_f32 v147,v147
v_exp_f32 v148,v148
v_exp_f32 v149,v149
v_exp_f32 v150,v150
v_exp_f32 v151,v151
v_exp_f32 v152,v152
v_exp_f32 v153,v153
v_exp_f32 v154,v154
v_exp_f32 v155,v155
v_exp_f32 v156,v156
v_exp_f32 v157,v157
v_exp_f32 v158,v158
v_exp_f32 v159,v159
v_exp_f32 v216,v216
v_exp_f32 v217,v217
v_exp_f32 v218,v218
v_exp_f32 v219,v219
v_add_f32 v214,v144,v145
v_add_f32 v215,v146,v147
v_add_f32 v214,v214,v148
v_add_f32 v215,v215,v149
v_add_f32 v214,v214,v150
v_add_f32 v215,v215,v151
v_add_f32 v214,v214,v152
v_add_f32 v215,v215,v153
v_add_f32 v214,v214,v154
v_add_f32 v215,v215,v155
v_add_f32 v214,v214,v156
v_add_f32 v215,v215,v157
v_add_f32 v214,v214,v158
v_add_f32 v215,v215,v159
v_add_f32 v214,v214,v216
v_add_f32 v215,v215,v217
v_add_f32 v214,v214,v218
v_add_f32 v215,v215,v219
v_add_f32 v214,v214,v215
v_mov_b32 v215,v214
s_nop 1
v_permlane32_swap_b32 v214,v215
v_add_f32 v214,v214,v215
v_rcp_f32 v214,v214
s_nop 0
v_mul_f32 v144,v144,v214
v_mul_f32 v145,v145,v214
v_mul_f32 v146,v146,v214
v_mul_f32 v147,v147,v214
v_mul_f32 v148,v148,v214
v_mul_f32 v149,v149,v214
v_mul_f32 v150,v150,v214
v_mul_f32 v151,v151,v214
v_mul_f32 v152,v152,v214
v_mul_f32 v153,v153,v214
v_mul_f32 v154,v154,v214
v_mul_f32 v155,v155,v214
v_mul_f32 v156,v156,v214
v_mul_f32 v157,v157,v214
v_mul_f32 v158,v158,v214
v_mul_f32 v159,v159,v214
v_mul_f32 v216,v216,v214
v_mul_f32 v217,v217,v214
v_mul_f32 v218,v218,v214
v_mul_f32 v219,v219,v214
v_cvt_pk_bf16_f32 v112,|v144|,|v145|
v_cvt_pk_bf16_f32 v113,|v146|,|v147|
v_cvt_pk_bf16_f32 v114,|v148|,|v149|
v_cvt_pk_bf16_f32 v115,|v150|,|v151|
v_cvt_pk_bf16_f32 v116,|v152|,|v153|
v_cvt_pk_bf16_f32 v117,|v154|,|v155|
v_cvt_pk_bf16_f32 v118,|v156|,|v157|
v_cvt_pk_bf16_f32 v119,|v158|,|v159|
v_cvt_pk_bf16_f32 v120,|v216|,|v217|
v_cvt_pk_bf16_f32 v121,|v218|,|v219|
buffer_store_dwordx4 v[112:115],v192,s[8:11],s30 offen sc1
buffer_store_dwordx4 v[116:119],v192,s[8:11],s30 offen offset:1024 sc1
v_permlane32_swap_b32 v120,v122
v_permlane32_swap_b32 v121,v123
s_mov_b32 exec_hi,0
buffer_store_dwordx4 v[120:123],v192,s[8:11],s31 offen sc1
s_mov_b64 exec,-1
s_cmp_ge_u32 s99,60
s_cbranch_scc1 L_next
s_waitcnt vmcnt(0)
v_mov_b32 v248,1
s_mov_b64 exec,1
buffer_store_dword v248,v199,s[8:11],s57 offen sc1
s_mov_b64 exec,-1
s_branch L_next
L_uM:
s_mov_b32 s20,s80
s_mov_b32 s21,s81
s_mov_b32 s22,1605632
s_mov_b32 s23,0x20000
s_lshl_b32 s99,s97,2
s_add_u32 s99,s99,s24
s_mul_i32 s60,s24,7168
s_mul_i32 s100,s98,896
s_mul_i32 s101,s98,401408
s_add_u32 s30,s100,0
s_add_u32 m0,s60,0
s_nop 0
buffer_load_dwordx4 v204,s[20:23],s30 offen lds
s_add_u32 s30,s100,57344
s_add_u32 m0,s60,1024
s_nop 0
buffer_load_dwordx4 v204,s[20:23],s30 offen lds
s_add_u32 s30,s100,114688
s_add_u32 m0,s60,2048
s_nop 0
buffer_load_dwordx4 v204,s[20:23],s30 offen lds
s_add_u32 s30,s100,172032
s_add_u32 m0,s60,3072
s_nop 0
buffer_load_dwordx4 v204,s[20:23],s30 offen lds
s_add_u32 s30,s100,229376
s_add_u32 m0,s60,4096
s_nop 0
buffer_load_dwordx4 v204,s[20:23],s30 offen lds
s_add_u32 s30,s100,286720
s_add_u32 m0,s60,5120
s_nop 0
buffer_load_dwordx4 v204,s[20:23],s30 offen lds
s_add_u32 s30,s100,344064
s_add_u32 m0,s60,6144
s_nop 0
buffer_load_dwordx4 v204,s[20:23],s30 offen lds
s_lshl_b32 s30,s24,8
v_add_u32 v210,s30,v198
s_mov_b32 s4,s82
s_mov_b32 s5,s83
s_mov_b32 s6,3584
s_mov_b32 s7,0x20000
buffer_load_dword v211,v210,s[4:7],s100 offen
s_mov_b32 s4,s86
s_mov_b32 s5,s87
s_mov_b32 s6,896
s_mov_b32 s7,0x20000
s_lshl_b32 s30,s98,12
buffer_load_dword v212,v210,s[4:7],s30 offen
s_mov_b32 s4,s88
s_mov_b32 s5,s89
s_mov_b32 s6,896
s_mov_b32 s7,0x20000
buffer_load_dword v213,v210,s[4:7],0 offen
s_waitcnt vmcnt(0)
s_mov_b32 s4,s84
s_mov_b32 s5,s85
s_mov_b32 s6,1605632
s_mov_b32 s7,0x20000
v_lshlrev_b32 v214,16,v211
v_and_b32 v215,0xffff0000,v211
v_lshlrev_b32 v216,16,v212
v_and_b32 v217,0xffff0000,v212
v_lshlrev_b32 v218,1,v210
v_add_u32 v218,143360,v218
v_add_u32 v219,147456,v210
ds_write_b64 v218,v[214:215]
ds_write_b64 v218,v[216:217] offset:2048
ds_write_b32 v219,v213
v_add_u32 v220,143360,v206
s_mul_i32 s31,s99,28672
s_add_u32 s56,s31,14336
s_mul_i32 s57,s24,28672
s_add_u32 s57,s57,28672
v_add_u32 v208,s57,v196
v_add_u32 v209,s57,v197
s_add_u32 m0,s57,0
s_nop 0
buffer_load_dwordx4 v195,s[12:15],s31 offen lds
s_add_u32 m0,s57,1024
s_nop 0
buffer_load_dwordx4 v195,s[12:15],s56 offen lds
s_add_u32 m0,s57,1984
s_nop 0
buffer_load_dwordx4 v195,s[12:15],s31 offen offset:64 lds
s_add_u32 m0,s57,3008
s_nop 0
buffer_load_dwordx4 v195,s[12:15],s56 offen offset:64 lds
s_add_u32 m0,s57,3968
s_nop 0
buffer_load_dwordx4 v195,s[12:15],s31 offen offset:128 lds
s_add_u32 m0,s57,4992
s_nop 0
buffer_load_dwordx4 v195,s[12:15],s56 offen offset:128 lds
s_add_u32 m0,s57,5952
s_nop 0
buffer_load_dwordx4 v195,s[12:15],s31 offen offset:192 lds
s_add_u32 m0,s57,6976
s_nop 0
buffer_load_dwordx4 v195,s[12:15],s56 offen offset:192 lds
s_add_u32 m0,s57,7936
s_nop 0
buffer_load_dwordx4 v195,s[12:15],s31 offen offset:256 lds
s_add_u32 m0,s57,8960
s_nop 0
buffer_load_dwordx4 v195,s[12:15],s56 offen offset:256 lds
s_add_u32 m0,s57,9920
s_nop 0
buffer_load_dwordx4 v195,s[12:15],s31 offen offset:320 lds
s_add_u32 m0,s57,10944
s_nop 0
buffer_load_dwordx4 v195,s[12:15],s56 offen offset:320 lds
s_add_u32 m0,s57,11904
s_nop 0
buffer_load_dwordx4 v195,s[12:15],s31 offen offset:384 lds
s_add_u32 m0,s57,12928
s_nop 0
buffer_load_dwordx4 v195,s[12:15],s56 offen offset:384 lds
s_add_u32 m0,s57,13888
s_nop 0
buffer_load_dwordx4 v195,s[12:15],s31 offen offset:448 lds
s_add_u32 m0,s57,14912
s_nop 0
buffer_load_dwordx4 v195,s[12:15],s56 offen offset:448 lds
s_add_u32 m0,s57,15872
s_nop 0
buffer_load_dwordx4 v195,s[12:15],s31 offen offset:512 lds
s_add_u32 m0,s57,16896
s_nop 0
buffer_load_dwordx4 v195,s[12:15],s56 offen offset:512 lds
s_add_u32 m0,s57,17856
s_nop 0
buffer_load_dwordx4 v195,s[12:15],s31 offen offset:576 lds
s_add_u32 m0,s57,18880
s_nop 0
buffer_load_dwordx4 v195,s[12:15],s56 offen offset:576 lds
s_add_u32 m0,s57,19840
s_nop 0
buffer_load_dwordx4 v195,s[12:15],s31 offen offset:640 lds
s_add_u32 m0,s57,20864
s_nop 0
buffer_load_dwordx4 v195,s[12:15],s56 offen offset:640 lds
s_add_u32 m0,s57,21824
s_nop 0
buffer_load_dwordx4 v195,s[12:15],s31 offen offset:704 lds
s_add_u32 m0,s57,22848
s_nop 0
buffer_load_dwordx4 v195,s[12:15],s56 offen offset:704 lds
s_add_u32 m0,s57,23808
s_nop 0
buffer_load_dwordx4 v195,s[12:15],s31 offen offset:768 lds
s_add_u32 m0,s57,24832
s_nop 0
buffer_load_dwordx4 v195,s[12:15],s56 offen offset:768 lds
s_add_u32 m0,s57,25792
s_nop 0
buffer_load_dwordx4 v195,s[12:15],s31 offen offset:832 lds
s_add_u32 m0,s57,26816
s_nop 0
buffer_load_dwordx4 v195,s[12:15],s56 offen offset:832 lds
s_waitcnt vmcnt(26)
ds_read_b128 v[0:3],v208 offset:0
ds_read_b128 v[4:7],v209 offset:0
s_waitcnt vmcnt(24)
ds_read_b128 v[8:11],v208 offset:2048
ds_read_b128 v[12:15],v209 offset:2048
s_waitcnt vmcnt(22)
ds_read_b128 v[16:19],v208 offset:4096
ds_read_b128 v[20:23],v209 offset:4096
s_waitcnt vmcnt(20)
ds_read_b128 v[24:27],v208 offset:6144
ds_read_b128 v[28:31],v209 offset:6144
s_waitcnt vmcnt(18)
ds_read_b128 v[32:35],v208 offset:8192
ds_read_b128 v[36:39],v209 offset:8192
s_waitcnt vmcnt(16)
ds_read_b128 v[40:43],v208 offset:10240
ds_read_b128 v[44:47],v209 offset:10240
s_waitcnt vmcnt(14)
ds_read_b128 v[48:51],v208 offset:12288
ds_read_b128 v[52:55],v209 offset:12288
s_waitcnt vmcnt(12)
ds_read_b128 v[56:59],v208 offset:14336
ds_read_b128 v[60:63],v209 offset:14336
s_waitcnt vmcnt(10)
ds_read_b128 v[64:67],v208 offset:16384
ds_read_b128 v[68:71],v209 offset:16384
s_waitcnt vmcnt(8)
ds_read_b128 v[72:75],v208 offset:18432
ds_read_b128 v[76:79],v209 offset:18432
s_waitcnt vmcnt(6)
ds_read_b128 v[80:83],v208 offset:20480
ds_read_b128 v[84:87],v209 offset:20480
s_waitcnt vmcnt(4)
ds_read_b128 v[88:91],v208 offset:22528
ds_read_b128 v[92:95],v209 offset:22528
s_waitcnt vmcnt(2)
ds_read_b128 v[96:99],v208 offset:24576
ds_read_b128 v[100:103],v209 offset:24576
s_waitcnt vmcnt(0)
ds_read_b128 v[104:107],v208 offset:26624
ds_read_b128 v[108:111],v209 offset:26624
s_waitcnt lgkmcnt(0)
s_barrier
s_cmp_lg_u32 s98,0
s_cbranch_scc1 nog_240
v_mov_b32 v210,0
v_mov_b32 v211,0
ds_read_b128 v[112:115],v220 offset:4096
ds_read_b128 v[116:119],v220 offset:4128
ds_read_b128 v[120:123],v220 offset:4160
ds_read_b128 v[124:127],v220 offset:4192
ds_read_b128 v[128:131],v220 offset:4224
ds_read_b128 v[132:135],v220 offset:4256
ds_read_b128 v[136:139],v220 offset:4288
s_waitcnt lgkmcnt(6)
v_dot2_f32_bf16 v210,v0,v112,v210
v_dot2_f32_bf16 v211,v1,v113,v211
v_dot2_f32_bf16 v210,v2,v114,v210
v_dot2_f32_bf16 v211,v3,v115,v211
s_waitcnt lgkmcnt(5)
v_dot2_f32_bf16 v210,v4,v116,v210
v_dot2_f32_bf16 v211,v5,v117,v211
v_dot2_f32_bf16 v210,v6,v118,v210
v_dot2_f32_bf16 v211,v7,v119,v211
s_waitcnt lgkmcnt(4)
v_dot2_f32_bf16 v210,v8,v120,v210
v_dot2_f32_bf16 v211,v9,v121,v211
v_dot2_f32_bf16 v210,v10,v122,v210
v_dot2_f32_bf16 v211,v11,v123,v211
s_waitcnt lgkmcnt(3)
v_dot2_f32_bf16 v210,v12,v124,v210
v_dot2_f32_bf16 v211,v13,v125,v211
v_dot2_f32_bf16 v210,v14,v126,v210
v_dot2_f32_bf16 v211,v15,v127,v211
s_waitcnt lgkmcnt(2)
v_dot2_f32_bf16 v210,v16,v128,v210
v_dot2_f32_bf16 v211,v17,v129,v211
v_dot2_f32_bf16 v210,v18,v130,v210
v_dot2_f32_bf16 v211,v19,v131,v211
s_waitcnt lgkmcnt(1)
v_dot2_f32_bf16 v210,v20,v132,v210
v_dot2_f32_bf16 v211,v21,v133,v211
v_dot2_f32_bf16 v210,v22,v134,v210
v_dot2_f32_bf16 v211,v23,v135,v211
s_waitcnt lgkmcnt(0)
v_dot2_f32_bf16 v210,v24,v136,v210
v_dot2_f32_bf16 v211,v25,v137,v211
v_dot2_f32_bf16 v210,v26,v138,v210
v_dot2_f32_bf16 v211,v27,v139,v211
s_nop 2
ds_read_b128 v[112:115],v220 offset:4320
ds_read_b128 v[116:119],v220 offset:4352
ds_read_b128 v[120:123],v220 offset:4384
ds_read_b128 v[124:127],v220 offset:4416
ds_read_b128 v[128:131],v220 offset:4448
ds_read_b128 v[132:135],v220 offset:4480
ds_read_b128 v[136:139],v220 offset:4512
s_waitcnt lgkmcnt(6)
v_dot2_f32_bf16 v210,v28,v112,v210
v_dot2_f32_bf16 v211,v29,v113,v211
v_dot2_f32_bf16 v210,v30,v114,v210
v_dot2_f32_bf16 v211,v31,v115,v211
s_waitcnt lgkmcnt(5)
v_dot2_f32_bf16 v210,v32,v116,v210
v_dot2_f32_bf16 v211,v33,v117,v211
v_dot2_f32_bf16 v210,v34,v118,v210
v_dot2_f32_bf16 v211,v35,v119,v211
s_waitcnt lgkmcnt(4)
v_dot2_f32_bf16 v210,v36,v120,v210
v_dot2_f32_bf16 v211,v37,v121,v211
v_dot2_f32_bf16 v210,v38,v122,v210
v_dot2_f32_bf16 v211,v39,v123,v211
s_waitcnt lgkmcnt(3)
v_dot2_f32_bf16 v210,v40,v124,v210
v_dot2_f32_bf16 v211,v41,v125,v211
v_dot2_f32_bf16 v210,v42,v126,v210
v_dot2_f32_bf16 v211,v43,v127,v211
s_waitcnt lgkmcnt(2)
v_dot2_f32_bf16 v210,v44,v128,v210
v_dot2_f32_bf16 v211,v45,v129,v211
v_dot2_f32_bf16 v210,v46,v130,v210
v_dot2_f32_bf16 v211,v47,v131,v211
s_waitcnt lgkmcnt(1)
v_dot2_f32_bf16 v210,v48,v132,v210
v_dot2_f32_bf16 v211,v49,v133,v211
v_dot2_f32_bf16 v210,v50,v134,v210
v_dot2_f32_bf16 v211,v51,v135,v211
s_waitcnt lgkmcnt(0)
v_dot2_f32_bf16 v210,v52,v136,v210
v_dot2_f32_bf16 v211,v53,v137,v211
v_dot2_f32_bf16 v210,v54,v138,v210
v_dot2_f32_bf16 v211,v55,v139,v211
s_nop 2
ds_read_b128 v[112:115],v220 offset:4544
ds_read_b128 v[116:119],v220 offset:4576
ds_read_b128 v[120:123],v220 offset:4608
ds_read_b128 v[124:127],v220 offset:4640
ds_read_b128 v[128:131],v220 offset:4672
ds_read_b128 v[132:135],v220 offset:4704
ds_read_b128 v[136:139],v220 offset:4736
s_waitcnt lgkmcnt(6)
v_dot2_f32_bf16 v210,v56,v112,v210
v_dot2_f32_bf16 v211,v57,v113,v211
v_dot2_f32_bf16 v210,v58,v114,v210
v_dot2_f32_bf16 v211,v59,v115,v211
s_waitcnt lgkmcnt(5)
v_dot2_f32_bf16 v210,v60,v116,v210
v_dot2_f32_bf16 v211,v61,v117,v211
v_dot2_f32_bf16 v210,v62,v118,v210
v_dot2_f32_bf16 v211,v63,v119,v211
s_waitcnt lgkmcnt(4)
v_dot2_f32_bf16 v210,v64,v120,v210
v_dot2_f32_bf16 v211,v65,v121,v211
v_dot2_f32_bf16 v210,v66,v122,v210
v_dot2_f32_bf16 v211,v67,v123,v211
s_waitcnt lgkmcnt(3)
v_dot2_f32_bf16 v210,v68,v124,v210
v_dot2_f32_bf16 v211,v69,v125,v211
v_dot2_f32_bf16 v210,v70,v126,v210
v_dot2_f32_bf16 v211,v71,v127,v211
s_waitcnt lgkmcnt(2)
v_dot2_f32_bf16 v210,v72,v128,v210
v_dot2_f32_bf16 v211,v73,v129,v211
v_dot2_f32_bf16 v210,v74,v130,v210
v_dot2_f32_bf16 v211,v75,v131,v211
s_waitcnt lgkmcnt(1)
v_dot2_f32_bf16 v210,v76,v132,v210
v_dot2_f32_bf16 v211,v77,v133,v211
v_dot2_f32_bf16 v210,v78,v134,v210
v_dot2_f32_bf16 v211,v79,v135,v211
s_waitcnt lgkmcnt(0)
v_dot2_f32_bf16 v210,v80,v136,v210
v_dot2_f32_bf16 v211,v81,v137,v211
v_dot2_f32_bf16 v210,v82,v138,v210
v_dot2_f32_bf16 v211,v83,v139,v211
s_nop 2
ds_read_b128 v[112:115],v220 offset:4768
ds_read_b128 v[116:119],v220 offset:4800
ds_read_b128 v[120:123],v220 offset:4832
ds_read_b128 v[124:127],v220 offset:4864
ds_read_b128 v[128:131],v220 offset:4896
ds_read_b128 v[132:135],v220 offset:4928
ds_read_b128 v[136:139],v220 offset:4960
s_waitcnt lgkmcnt(6)
v_dot2_f32_bf16 v210,v84,v112,v210
v_dot2_f32_bf16 v211,v85,v113,v211
v_dot2_f32_bf16 v210,v86,v114,v210
v_dot2_f32_bf16 v211,v87,v115,v211
s_waitcnt lgkmcnt(5)
v_dot2_f32_bf16 v210,v88,v116,v210
v_dot2_f32_bf16 v211,v89,v117,v211
v_dot2_f32_bf16 v210,v90,v118,v210
v_dot2_f32_bf16 v211,v91,v119,v211
s_waitcnt lgkmcnt(4)
v_dot2_f32_bf16 v210,v92,v120,v210
v_dot2_f32_bf16 v211,v93,v121,v211
v_dot2_f32_bf16 v210,v94,v122,v210
v_dot2_f32_bf16 v211,v95,v123,v211
s_waitcnt lgkmcnt(3)
v_dot2_f32_bf16 v210,v96,v124,v210
v_dot2_f32_bf16 v211,v97,v125,v211
v_dot2_f32_bf16 v210,v98,v126,v210
v_dot2_f32_bf16 v211,v99,v127,v211
s_waitcnt lgkmcnt(2)
v_dot2_f32_bf16 v210,v100,v128,v210
v_dot2_f32_bf16 v211,v101,v129,v211
v_dot2_f32_bf16 v210,v102,v130,v210
v_dot2_f32_bf16 v211,v103,v131,v211
s_waitcnt lgkmcnt(1)
v_dot2_f32_bf16 v210,v104,v132,v210
v_dot2_f32_bf16 v211,v105,v133,v211
v_dot2_f32_bf16 v210,v106,v134,v210
v_dot2_f32_bf16 v211,v107,v135,v211
s_waitcnt lgkmcnt(0)
v_dot2_f32_bf16 v210,v108,v136,v210
v_dot2_f32_bf16 v211,v109,v137,v211
v_dot2_f32_bf16 v210,v110,v138,v210
v_dot2_f32_bf16 v211,v111,v139,v211
s_nop 2
v_add_f32 v210,v210,v211
v_mov_b32 v211,v210
s_nop 1
v_permlane32_swap_b32 v210,v211
v_add_f32 v210,v210,v211
v_mul_f32 v210,0xbfb8aa3b,v210
v_exp_f32 v210,v210
s_nop 0
v_add_f32 v210,1.0,v210
v_rcp_f32 v210,v210
v_and_b32 v211,127,v198
s_lshl_b32 s30,s99,7
s_add_u32 s30,s30,51970048
buffer_store_dword v210,v211,s[8:11],s30 offen sc1
nog_240:
v_mov_b32 v210,0
v_mov_b32 v211,0
v_mov_b32 v212,0x3f803f80
v_dot2_f32_bf16 v210,v0,v212,v210
v_dot2_f32_bf16 v211,v1,v212,v211
v_dot2_f32_bf16 v210,v2,v212,v210
v_dot2_f32_bf16 v211,v3,v212,v211
v_dot2_f32_bf16 v210,v4,v212,v210
v_dot2_f32_bf16 v211,v5,v212,v211
v_dot2_f32_bf16 v210,v6,v212,v210
v_dot2_f32_bf16 v211,v7,v212,v211
v_dot2_f32_bf16 v210,v8,v212,v210
v_dot2_f32_bf16 v211,v9,v212,v211
v_dot2_f32_bf16 v210,v10,v212,v210
v_dot2_f32_bf16 v211,v11,v212,v211
v_dot2_f32_bf16 v210,v12,v212,v210
v_dot2_f32_bf16 v211,v13,v212,v211
v_dot2_f32_bf16 v210,v14,v212,v210
v_dot2_f32_bf16 v211,v15,v212,v211
v_dot2_f32_bf16 v210,v16,v212,v210
v_dot2_f32_bf16 v211,v17,v212,v211
v_dot2_f32_bf16 v210,v18,v212,v210
v_dot2_f32_bf16 v211,v19,v212,v211
v_dot2_f32_bf16 v210,v20,v212,v210
v_dot2_f32_bf16 v211,v21,v212,v211
v_dot2_f32_bf16 v210,v22,v212,v210
v_dot2_f32_bf16 v211,v23,v212,v211
v_dot2_f32_bf16 v210,v24,v212,v210
v_dot2_f32_bf16 v211,v25,v212,v211
v_dot2_f32_bf16 v210,v26,v212,v210
v_dot2_f32_bf16 v211,v27,v212,v211
v_dot2_f32_bf16 v210,v28,v212,v210
v_dot2_f32_bf16 v211,v29,v212,v211
v_dot2_f32_bf16 v210,v30,v212,v210
v_dot2_f32_bf16 v211,v31,v212,v211
v_dot2_f32_bf16 v210,v32,v212,v210
v_dot2_f32_bf16 v211,v33,v212,v211
v_dot2_f32_bf16 v210,v34,v212,v210
v_dot2_f32_bf16 v211,v35,v212,v211
v_dot2_f32_bf16 v210,v36,v212,v210
v_dot2_f32_bf16 v211,v37,v212,v211
v_dot2_f32_bf16 v210,v38,v212,v210
v_dot2_f32_bf16 v211,v39,v212,v211
v_dot2_f32_bf16 v210,v40,v212,v210
v_dot2_f32_bf16 v211,v41,v212,v211
v_dot2_f32_bf16 v210,v42,v212,v210
v_dot2_f32_bf16 v211,v43,v212,v211
v_dot2_f32_bf16 v210,v44,v212,v210
v_dot2_f32_bf16 v211,v45,v212,v211
v_dot2_f32_bf16 v210,v46,v212,v210
v_dot2_f32_bf16 v211,v47,v212,v211
v_dot2_f32_bf16 v210,v48,v212,v210
v_dot2_f32_bf16 v211,v49,v212,v211
v_dot2_f32_bf16 v210,v50,v212,v210
v_dot2_f32_bf16 v211,v51,v212,v211
v_dot2_f32_bf16 v210,v52,v212,v210
v_dot2_f32_bf16 v211,v53,v212,v211
v_dot2_f32_bf16 v210,v54,v212,v210
v_dot2_f32_bf16 v211,v55,v212,v211
v_dot2_f32_bf16 v210,v56,v212,v210
v_dot2_f32_bf16 v211,v57,v212,v211
v_dot2_f32_bf16 v210,v58,v212,v210
v_dot2_f32_bf16 v211,v59,v212,v211
v_dot2_f32_bf16 v210,v60,v212,v210
v_dot2_f32_bf16 v211,v61,v212,v211
v_dot2_f32_bf16 v210,v62,v212,v210
v_dot2_f32_bf16 v211,v63,v212,v211
v_dot2_f32_bf16 v210,v64,v212,v210
v_dot2_f32_bf16 v211,v65,v212,v211
v_dot2_f32_bf16 v210,v66,v212,v210
v_dot2_f32_bf16 v211,v67,v212,v211
v_dot2_f32_bf16 v210,v68,v212,v210
v_dot2_f32_bf16 v211,v69,v212,v211
v_dot2_f32_bf16 v210,v70,v212,v210
v_dot2_f32_bf16 v211,v71,v212,v211
v_dot2_f32_bf16 v210,v72,v212,v210
v_dot2_f32_bf16 v211,v73,v212,v211
v_dot2_f32_bf16 v210,v74,v212,v210
v_dot2_f32_bf16 v211,v75,v212,v211
v_dot2_f32_bf16 v210,v76,v212,v210
v_dot2_f32_bf16 v211,v77,v212,v211
v_dot2_f32_bf16 v210,v78,v212,v210
v_dot2_f32_bf16 v211,v79,v212,v211
v_dot2_f32_bf16 v210,v80,v212,v210
v_dot2_f32_bf16 v211,v81,v212,v211
v_dot2_f32_bf16 v210,v82,v212,v210
v_dot2_f32_bf16 v211,v83,v212,v211
v_dot2_f32_bf16 v210,v84,v212,v210
v_dot2_f32_bf16 v211,v85,v212,v211
v_dot2_f32_bf16 v210,v86,v212,v210
v_dot2_f32_bf16 v211,v87,v212,v211
v_dot2_f32_bf16 v210,v88,v212,v210
v_dot2_f32_bf16 v211,v89,v212,v211
v_dot2_f32_bf16 v210,v90,v212,v210
v_dot2_f32_bf16 v211,v91,v212,v211
v_dot2_f32_bf16 v210,v92,v212,v210
v_dot2_f32_bf16 v211,v93,v212,v211
v_dot2_f32_bf16 v210,v94,v212,v210
v_dot2_f32_bf16 v211,v95,v212,v211
v_dot2_f32_bf16 v210,v96,v212,v210
v_dot2_f32_bf16 v211,v97,v212,v211
v_dot2_f32_bf16 v210,v98,v212,v210
v_dot2_f32_bf16 v211,v99,v212,v211
v_dot2_f32_bf16 v210,v100,v212,v210
v_dot2_f32_bf16 v211,v101,v212,v211
v_dot2_f32_bf16 v210,v102,v212,v210
v_dot2_f32_bf16 v211,v103,v212,v211
v_dot2_f32_bf16 v210,v104,v212,v210
v_dot2_f32_bf16 v211,v105,v212,v211
v_dot2_f32_bf16 v210,v106,v212,v210
v_dot2_f32_bf16 v211,v107,v212,v211
v_dot2_f32_bf16 v210,v108,v212,v210
v_dot2_f32_bf16 v211,v109,v212,v211
v_dot2_f32_bf16 v210,v110,v212,v210
v_dot2_f32_bf16 v211,v111,v212,v211
s_nop 2
v_add_f32 v210,v210,v211
v_mov_b32 v211,v210
s_nop 1
v_permlane32_swap_b32 v210,v211
v_add_f32 v210,v210,v211
v_mul_f32 v210,0x3b124925,v210
v_mov_b32 v211,0
v_mov_b32 v212,0
s_mov_b32 s30,0xffff0000
v_lshlrev_b32 v213,16,v0
v_and_b32 v214,s30,v0
v_sub_f32 v213,v213,v210
v_sub_f32 v214,v214,v210
v_fmac_f32 v211,v213,v213
v_fmac_f32 v212,v214,v214
v_lshlrev_b32 v213,16,v1
v_and_b32 v214,s30,v1
v_sub_f32 v213,v213,v210
v_sub_f32 v214,v214,v210
v_fmac_f32 v211,v213,v213
v_fmac_f32 v212,v214,v214
v_lshlrev_b32 v213,16,v2
v_and_b32 v214,s30,v2
v_sub_f32 v213,v213,v210
v_sub_f32 v214,v214,v210
v_fmac_f32 v211,v213,v213
v_fmac_f32 v212,v214,v214
v_lshlrev_b32 v213,16,v3
v_and_b32 v214,s30,v3
v_sub_f32 v213,v213,v210
v_sub_f32 v214,v214,v210
v_fmac_f32 v211,v213,v213
v_fmac_f32 v212,v214,v214
v_lshlrev_b32 v213,16,v4
v_and_b32 v214,s30,v4
v_sub_f32 v213,v213,v210
v_sub_f32 v214,v214,v210
v_fmac_f32 v211,v213,v213
v_fmac_f32 v212,v214,v214
v_lshlrev_b32 v213,16,v5
v_and_b32 v214,s30,v5
v_sub_f32 v213,v213,v210
v_sub_f32 v214,v214,v210
v_fmac_f32 v211,v213,v213
v_fmac_f32 v212,v214,v214
v_lshlrev_b32 v213,16,v6
v_and_b32 v214,s30,v6
v_sub_f32 v213,v213,v210
v_sub_f32 v214,v214,v210
v_fmac_f32 v211,v213,v213
v_fmac_f32 v212,v214,v214
v_lshlrev_b32 v213,16,v7
v_and_b32 v214,s30,v7
v_sub_f32 v213,v213,v210
v_sub_f32 v214,v214,v210
v_fmac_f32 v211,v213,v213
v_fmac_f32 v212,v214,v214
v_lshlrev_b32 v213,16,v8
v_and_b32 v214,s30,v8
v_sub_f32 v213,v213,v210
v_sub_f32 v214,v214,v210
v_fmac_f32 v211,v213,v213
v_fmac_f32 v212,v214,v214
v_lshlrev_b32 v213,16,v9
v_and_b32 v214,s30,v9
v_sub_f32 v213,v213,v210
v_sub_f32 v214,v214,v210
v_fmac_f32 v211,v213,v213
v_fmac_f32 v212,v214,v214
v_lshlrev_b32 v213,16,v10
v_and_b32 v214,s30,v10
v_sub_f32 v213,v213,v210
v_sub_f32 v214,v214,v210
v_fmac_f32 v211,v213,v213
v_fmac_f32 v212,v214,v214
v_lshlrev_b32 v213,16,v11
v_and_b32 v214,s30,v11
v_sub_f32 v213,v213,v210
v_sub_f32 v214,v214,v210
v_fmac_f32 v211,v213,v213
v_fmac_f32 v212,v214,v214
v_lshlrev_b32 v213,16,v12
v_and_b32 v214,s30,v12
v_sub_f32 v213,v213,v210
v_sub_f32 v214,v214,v210
v_fmac_f32 v211,v213,v213
v_fmac_f32 v212,v214,v214
v_lshlrev_b32 v213,16,v13
v_and_b32 v214,s30,v13
v_sub_f32 v213,v213,v210
v_sub_f32 v214,v214,v210
v_fmac_f32 v211,v213,v213
v_fmac_f32 v212,v214,v214
v_lshlrev_b32 v213,16,v14
v_and_b32 v214,s30,v14
v_sub_f32 v213,v213,v210
v_sub_f32 v214,v214,v210
v_fmac_f32 v211,v213,v213
v_fmac_f32 v212,v214,v214
v_lshlrev_b32 v213,16,v15
v_and_b32 v214,s30,v15
v_sub_f32 v213,v213,v210
v_sub_f32 v214,v214,v210
v_fmac_f32 v211,v213,v213
v_fmac_f32 v212,v214,v214
v_lshlrev_b32 v213,16,v16
v_and_b32 v214,s30,v16
v_sub_f32 v213,v213,v210
v_sub_f32 v214,v214,v210
v_fmac_f32 v211,v213,v213
v_fmac_f32 v212,v214,v214
v_lshlrev_b32 v213,16,v17
v_and_b32 v214,s30,v17
v_sub_f32 v213,v213,v210
v_sub_f32 v214,v214,v210
v_fmac_f32 v211,v213,v213
v_fmac_f32 v212,v214,v214
v_lshlrev_b32 v213,16,v18
v_and_b32 v214,s30,v18
v_sub_f32 v213,v213,v210
v_sub_f32 v214,v214,v210
v_fmac_f32 v211,v213,v213
v_fmac_f32 v212,v214,v214
v_lshlrev_b32 v213,16,v19
v_and_b32 v214,s30,v19
v_sub_f32 v213,v213,v210
v_sub_f32 v214,v214,v210
v_fmac_f32 v211,v213,v213
v_fmac_f32 v212,v214,v214
v_lshlrev_b32 v213,16,v20
v_and_b32 v214,s30,v20
v_sub_f32 v213,v213,v210
v_sub_f32 v214,v214,v210
v_fmac_f32 v211,v213,v213
v_fmac_f32 v212,v214,v214
v_lshlrev_b32 v213,16,v21
v_and_b32 v214,s30,v21
v_sub_f32 v213,v213,v210
v_sub_f32 v214,v214,v210
v_fmac_f32 v211,v213,v213
v_fmac_f32 v212,v214,v214
v_lshlrev_b32 v213,16,v22
v_and_b32 v214,s30,v22
v_sub_f32 v213,v213,v210
v_sub_f32 v214,v214,v210
v_fmac_f32 v211,v213,v213
v_fmac_f32 v212,v214,v214
v_lshlrev_b32 v213,16,v23
v_and_b32 v214,s30,v23
v_sub_f32 v213,v213,v210
v_sub_f32 v214,v214,v210
v_fmac_f32 v211,v213,v213
v_fmac_f32 v212,v214,v214
v_lshlrev_b32 v213,16,v24
v_and_b32 v214,s30,v24
v_sub_f32 v213,v213,v210
v_sub_f32 v214,v214,v210
v_fmac_f32 v211,v213,v213
v_fmac_f32 v212,v214,v214
v_lshlrev_b32 v213,16,v25
v_and_b32 v214,s30,v25
v_sub_f32 v213,v213,v210
v_sub_f32 v214,v214,v210
v_fmac_f32 v211,v213,v213
v_fmac_f32 v212,v214,v214
v_lshlrev_b32 v213,16,v26
v_and_b32 v214,s30,v26
v_sub_f32 v213,v213,v210
v_sub_f32 v214,v214,v210
v_fmac_f32 v211,v213,v213
v_fmac_f32 v212,v214,v214
v_lshlrev_b32 v213,16,v27
v_and_b32 v214,s30,v27
v_sub_f32 v213,v213,v210
v_sub_f32 v214,v214,v210
v_fmac_f32 v211,v213,v213
v_fmac_f32 v212,v214,v214
v_lshlrev_b32 v213,16,v28
v_and_b32 v214,s30,v28
v_sub_f32 v213,v213,v210
v_sub_f32 v214,v214,v210
v_fmac_f32 v211,v213,v213
v_fmac_f32 v212,v214,v214
v_lshlrev_b32 v213,16,v29
v_and_b32 v214,s30,v29
v_sub_f32 v213,v213,v210
v_sub_f32 v214,v214,v210
v_fmac_f32 v211,v213,v213
v_fmac_f32 v212,v214,v214
v_lshlrev_b32 v213,16,v30
v_and_b32 v214,s30,v30
v_sub_f32 v213,v213,v210
v_sub_f32 v214,v214,v210
v_fmac_f32 v211,v213,v213
v_fmac_f32 v212,v214,v214
v_lshlrev_b32 v213,16,v31
v_and_b32 v214,s30,v31
v_sub_f32 v213,v213,v210
v_sub_f32 v214,v214,v210
v_fmac_f32 v211,v213,v213
v_fmac_f32 v212,v214,v214
v_lshlrev_b32 v213,16,v32
v_and_b32 v214,s30,v32
v_sub_f32 v213,v213,v210
v_sub_f32 v214,v214,v210
v_fmac_f32 v211,v213,v213
v_fmac_f32 v212,v214,v214
v_lshlrev_b32 v213,16,v33
v_and_b32 v214,s30,v33
v_sub_f32 v213,v213,v210
v_sub_f32 v214,v214,v210
v_fmac_f32 v211,v213,v213
v_fmac_f32 v212,v214,v214
v_lshlrev_b32 v213,16,v34
v_and_b32 v214,s30,v34
v_sub_f32 v213,v213,v210
v_sub_f32 v214,v214,v210
v_fmac_f32 v211,v213,v213
v_fmac_f32 v212,v214,v214
v_lshlrev_b32 v213,16,v35
v_and_b32 v214,s30,v35
v_sub_f32 v213,v213,v210
v_sub_f32 v214,v214,v210
v_fmac_f32 v211,v213,v213
v_fmac_f32 v212,v214,v214
v_lshlrev_b32 v213,16,v36
v_and_b32 v214,s30,v36
v_sub_f32 v213,v213,v210
v_sub_f32 v214,v214,v210
v_fmac_f32 v211,v213,v213
v_fmac_f32 v212,v214,v214
v_lshlrev_b32 v213,16,v37
v_and_b32 v214,s30,v37
v_sub_f32 v213,v213,v210
v_sub_f32 v214,v214,v210
v_fmac_f32 v211,v213,v213
v_fmac_f32 v212,v214,v214
v_lshlrev_b32 v213,16,v38
v_and_b32 v214,s30,v38
v_sub_f32 v213,v213,v210
v_sub_f32 v214,v214,v210
v_fmac_f32 v211,v213,v213
v_fmac_f32 v212,v214,v214
v_lshlrev_b32 v213,16,v39
v_and_b32 v214,s30,v39
v_sub_f32 v213,v213,v210
v_sub_f32 v214,v214,v210
v_fmac_f32 v211,v213,v213
v_fmac_f32 v212,v214,v214
v_lshlrev_b32 v213,16,v40
v_and_b32 v214,s30,v40
v_sub_f32 v213,v213,v210
v_sub_f32 v214,v214,v210
v_fmac_f32 v211,v213,v213
v_fmac_f32 v212,v214,v214
v_lshlrev_b32 v213,16,v41
v_and_b32 v214,s30,v41
v_sub_f32 v213,v213,v210
v_sub_f32 v214,v214,v210
v_fmac_f32 v211,v213,v213
v_fmac_f32 v212,v214,v214
v_lshlrev_b32 v213,16,v42
v_and_b32 v214,s30,v42
v_sub_f32 v213,v213,v210
v_sub_f32 v214,v214,v210
v_fmac_f32 v211,v213,v213
v_fmac_f32 v212,v214,v214
v_lshlrev_b32 v213,16,v43
v_and_b32 v214,s30,v43
v_sub_f32 v213,v213,v210
v_sub_f32 v214,v214,v210
v_fmac_f32 v211,v213,v213
v_fmac_f32 v212,v214,v214
v_lshlrev_b32 v213,16,v44
v_and_b32 v214,s30,v44
v_sub_f32 v213,v213,v210
v_sub_f32 v214,v214,v210
v_fmac_f32 v211,v213,v213
v_fmac_f32 v212,v214,v214
v_lshlrev_b32 v213,16,v45
v_and_b32 v214,s30,v45
v_sub_f32 v213,v213,v210
v_sub_f32 v214,v214,v210
v_fmac_f32 v211,v213,v213
v_fmac_f32 v212,v214,v214
v_lshlrev_b32 v213,16,v46
v_and_b32 v214,s30,v46
v_sub_f32 v213,v213,v210
v_sub_f32 v214,v214,v210
v_fmac_f32 v211,v213,v213
v_fmac_f32 v212,v214,v214
v_lshlrev_b32 v213,16,v47
v_and_b32 v214,s30,v47
v_sub_f32 v213,v213,v210
v_sub_f32 v214,v214,v210
v_fmac_f32 v211,v213,v213
v_fmac_f32 v212,v214,v214
v_lshlrev_b32 v213,16,v48
v_and_b32 v214,s30,v48
v_sub_f32 v213,v213,v210
v_sub_f32 v214,v214,v210
v_fmac_f32 v211,v213,v213
v_fmac_f32 v212,v214,v214
v_lshlrev_b32 v213,16,v49
v_and_b32 v214,s30,v49
v_sub_f32 v213,v213,v210
v_sub_f32 v214,v214,v210
v_fmac_f32 v211,v213,v213
v_fmac_f32 v212,v214,v214
v_lshlrev_b32 v213,16,v50
v_and_b32 v214,s30,v50
v_sub_f32 v213,v213,v210
v_sub_f32 v214,v214,v210
v_fmac_f32 v211,v213,v213
v_fmac_f32 v212,v214,v214
v_lshlrev_b32 v213,16,v51
v_and_b32 v214,s30,v51
v_sub_f32 v213,v213,v210
v_sub_f32 v214,v214,v210
v_fmac_f32 v211,v213,v213
v_fmac_f32 v212,v214,v214
v_lshlrev_b32 v213,16,v52
v_and_b32 v214,s30,v52
v_sub_f32 v213,v213,v210
v_sub_f32 v214,v214,v210
v_fmac_f32 v211,v213,v213
v_fmac_f32 v212,v214,v214
v_lshlrev_b32 v213,16,v53
v_and_b32 v214,s30,v53
v_sub_f32 v213,v213,v210
v_sub_f32 v214,v214,v210
v_fmac_f32 v211,v213,v213
v_fmac_f32 v212,v214,v214
v_lshlrev_b32 v213,16,v54
v_and_b32 v214,s30,v54
v_sub_f32 v213,v213,v210
v_sub_f32 v214,v214,v210
v_fmac_f32 v211,v213,v213
v_fmac_f32 v212,v214,v214
v_lshlrev_b32 v213,16,v55
v_and_b32 v214,s30,v55
v_sub_f32 v213,v213,v210
v_sub_f32 v214,v214,v210
v_fmac_f32 v211,v213,v213
v_fmac_f32 v212,v214,v214
v_lshlrev_b32 v213,16,v56
v_and_b32 v214,s30,v56
v_sub_f32 v213,v213,v210
v_sub_f32 v214,v214,v210
v_fmac_f32 v211,v213,v213
v_fmac_f32 v212,v214,v214
v_lshlrev_b32 v213,16,v57
v_and_b32 v214,s30,v57
v_sub_f32 v213,v213,v210
v_sub_f32 v214,v214,v210
v_fmac_f32 v211,v213,v213
v_fmac_f32 v212,v214,v214
v_lshlrev_b32 v213,16,v58
v_and_b32 v214,s30,v58
v_sub_f32 v213,v213,v210
v_sub_f32 v214,v214,v210
v_fmac_f32 v211,v213,v213
v_fmac_f32 v212,v214,v214
v_lshlrev_b32 v213,16,v59
v_and_b32 v214,s30,v59
v_sub_f32 v213,v213,v210
v_sub_f32 v214,v214,v210
v_fmac_f32 v211,v213,v213
v_fmac_f32 v212,v214,v214
v_lshlrev_b32 v213,16,v60
v_and_b32 v214,s30,v60
v_sub_f32 v213,v213,v210
v_sub_f32 v214,v214,v210
v_fmac_f32 v211,v213,v213
v_fmac_f32 v212,v214,v214
v_lshlrev_b32 v213,16,v61
v_and_b32 v214,s30,v61
v_sub_f32 v213,v213,v210
v_sub_f32 v214,v214,v210
v_fmac_f32 v211,v213,v213
v_fmac_f32 v212,v214,v214
v_lshlrev_b32 v213,16,v62
v_and_b32 v214,s30,v62
v_sub_f32 v213,v213,v210
v_sub_f32 v214,v214,v210
v_fmac_f32 v211,v213,v213
v_fmac_f32 v212,v214,v214
v_lshlrev_b32 v213,16,v63
v_and_b32 v214,s30,v63
v_sub_f32 v213,v213,v210
v_sub_f32 v214,v214,v210
v_fmac_f32 v211,v213,v213
v_fmac_f32 v212,v214,v214
v_lshlrev_b32 v213,16,v64
v_and_b32 v214,s30,v64
v_sub_f32 v213,v213,v210
v_sub_f32 v214,v214,v210
v_fmac_f32 v211,v213,v213
v_fmac_f32 v212,v214,v214
v_lshlrev_b32 v213,16,v65
v_and_b32 v214,s30,v65
v_sub_f32 v213,v213,v210
v_sub_f32 v214,v214,v210
v_fmac_f32 v211,v213,v213
v_fmac_f32 v212,v214,v214
v_lshlrev_b32 v213,16,v66
v_and_b32 v214,s30,v66
v_sub_f32 v213,v213,v210
v_sub_f32 v214,v214,v210
v_fmac_f32 v211,v213,v213
v_fmac_f32 v212,v214,v214
v_lshlrev_b32 v213,16,v67
v_and_b32 v214,s30,v67
v_sub_f32 v213,v213,v210
v_sub_f32 v214,v214,v210
v_fmac_f32 v211,v213,v213
v_fmac_f32 v212,v214,v214
v_lshlrev_b32 v213,16,v68
v_and_b32 v214,s30,v68
v_sub_f32 v213,v213,v210
v_sub_f32 v214,v214,v210
v_fmac_f32 v211,v213,v213
v_fmac_f32 v212,v214,v214
v_lshlrev_b32 v213,16,v69
v_and_b32 v214,s30,v69
v_sub_f32 v213,v213,v210
v_sub_f32 v214,v214,v210
v_fmac_f32 v211,v213,v213
v_fmac_f32 v212,v214,v214
v_lshlrev_b32 v213,16,v70
v_and_b32 v214,s30,v70
v_sub_f32 v213,v213,v210
v_sub_f32 v214,v214,v210
v_fmac_f32 v211,v213,v213
v_fmac_f32 v212,v214,v214
v_lshlrev_b32 v213,16,v71
v_and_b32 v214,s30,v71
v_sub_f32 v213,v213,v210
v_sub_f32 v214,v214,v210
v_fmac_f32 v211,v213,v213
v_fmac_f32 v212,v214,v214
v_lshlrev_b32 v213,16,v72
v_and_b32 v214,s30,v72
v_sub_f32 v213,v213,v210
v_sub_f32 v214,v214,v210
v_fmac_f32 v211,v213,v213
v_fmac_f32 v212,v214,v214
v_lshlrev_b32 v213,16,v73
v_and_b32 v214,s30,v73
v_sub_f32 v213,v213,v210
v_sub_f32 v214,v214,v210
v_fmac_f32 v211,v213,v213
v_fmac_f32 v212,v214,v214
v_lshlrev_b32 v213,16,v74
v_and_b32 v214,s30,v74
v_sub_f32 v213,v213,v210
v_sub_f32 v214,v214,v210
v_fmac_f32 v211,v213,v213
v_fmac_f32 v212,v214,v214
v_lshlrev_b32 v213,16,v75
v_and_b32 v214,s30,v75
v_sub_f32 v213,v213,v210
v_sub_f32 v214,v214,v210
v_fmac_f32 v211,v213,v213
v_fmac_f32 v212,v214,v214
v_lshlrev_b32 v213,16,v76
v_and_b32 v214,s30,v76
v_sub_f32 v213,v213,v210
v_sub_f32 v214,v214,v210
v_fmac_f32 v211,v213,v213
v_fmac_f32 v212,v214,v214
v_lshlrev_b32 v213,16,v77
v_and_b32 v214,s30,v77
v_sub_f32 v213,v213,v210
v_sub_f32 v214,v214,v210
v_fmac_f32 v211,v213,v213
v_fmac_f32 v212,v214,v214
v_lshlrev_b32 v213,16,v78
v_and_b32 v214,s30,v78
v_sub_f32 v213,v213,v210
v_sub_f32 v214,v214,v210
v_fmac_f32 v211,v213,v213
v_fmac_f32 v212,v214,v214
v_lshlrev_b32 v213,16,v79
v_and_b32 v214,s30,v79
v_sub_f32 v213,v213,v210
v_sub_f32 v214,v214,v210
v_fmac_f32 v211,v213,v213
v_fmac_f32 v212,v214,v214
v_lshlrev_b32 v213,16,v80
v_and_b32 v214,s30,v80
v_sub_f32 v213,v213,v210
v_sub_f32 v214,v214,v210
v_fmac_f32 v211,v213,v213
v_fmac_f32 v212,v214,v214
v_lshlrev_b32 v213,16,v81
v_and_b32 v214,s30,v81
v_sub_f32 v213,v213,v210
v_sub_f32 v214,v214,v210
v_fmac_f32 v211,v213,v213
v_fmac_f32 v212,v214,v214
v_lshlrev_b32 v213,16,v82
v_and_b32 v214,s30,v82
v_sub_f32 v213,v213,v210
v_sub_f32 v214,v214,v210
v_fmac_f32 v211,v213,v213
v_fmac_f32 v212,v214,v214
v_lshlrev_b32 v213,16,v83
v_and_b32 v214,s30,v83
v_sub_f32 v213,v213,v210
v_sub_f32 v214,v214,v210
v_fmac_f32 v211,v213,v213
v_fmac_f32 v212,v214,v214
v_lshlrev_b32 v213,16,v84
v_and_b32 v214,s30,v84
v_sub_f32 v213,v213,v210
v_sub_f32 v214,v214,v210
v_fmac_f32 v211,v213,v213
v_fmac_f32 v212,v214,v214
v_lshlrev_b32 v213,16,v85
v_and_b32 v214,s30,v85
v_sub_f32 v213,v213,v210
v_sub_f32 v214,v214,v210
v_fmac_f32 v211,v213,v213
v_fmac_f32 v212,v214,v214
v_lshlrev_b32 v213,16,v86
v_and_b32 v214,s30,v86
v_sub_f32 v213,v213,v210
v_sub_f32 v214,v214,v210
v_fmac_f32 v211,v213,v213
v_fmac_f32 v212,v214,v214
v_lshlrev_b32 v213,16,v87
v_and_b32 v214,s30,v87
v_sub_f32 v213,v213,v210
v_sub_f32 v214,v214,v210
v_fmac_f32 v211,v213,v213
v_fmac_f32 v212,v214,v214
v_lshlrev_b32 v213,16,v88
v_and_b32 v214,s30,v88
v_sub_f32 v213,v213,v210
v_sub_f32 v214,v214,v210
v_fmac_f32 v211,v213,v213
v_fmac_f32 v212,v214,v214
v_lshlrev_b32 v213,16,v89
v_and_b32 v214,s30,v89
v_sub_f32 v213,v213,v210
v_sub_f32 v214,v214,v210
v_fmac_f32 v211,v213,v213
v_fmac_f32 v212,v214,v214
v_lshlrev_b32 v213,16,v90
v_and_b32 v214,s30,v90
v_sub_f32 v213,v213,v210
v_sub_f32 v214,v214,v210
v_fmac_f32 v211,v213,v213
v_fmac_f32 v212,v214,v214
v_lshlrev_b32 v213,16,v91
v_and_b32 v214,s30,v91
v_sub_f32 v213,v213,v210
v_sub_f32 v214,v214,v210
v_fmac_f32 v211,v213,v213
v_fmac_f32 v212,v214,v214
v_lshlrev_b32 v213,16,v92
v_and_b32 v214,s30,v92
v_sub_f32 v213,v213,v210
v_sub_f32 v214,v214,v210
v_fmac_f32 v211,v213,v213
v_fmac_f32 v212,v214,v214
v_lshlrev_b32 v213,16,v93
v_and_b32 v214,s30,v93
v_sub_f32 v213,v213,v210
v_sub_f32 v214,v214,v210
v_fmac_f32 v211,v213,v213
v_fmac_f32 v212,v214,v214
v_lshlrev_b32 v213,16,v94
v_and_b32 v214,s30,v94
v_sub_f32 v213,v213,v210
v_sub_f32 v214,v214,v210
v_fmac_f32 v211,v213,v213
v_fmac_f32 v212,v214,v214
v_lshlrev_b32 v213,16,v95
v_and_b32 v214,s30,v95
v_sub_f32 v213,v213,v210
v_sub_f32 v214,v214,v210
v_fmac_f32 v211,v213,v213
v_fmac_f32 v212,v214,v214
v_lshlrev_b32 v213,16,v96
v_and_b32 v214,s30,v96
v_sub_f32 v213,v213,v210
v_sub_f32 v214,v214,v210
v_fmac_f32 v211,v213,v213
v_fmac_f32 v212,v214,v214
v_lshlrev_b32 v213,16,v97
v_and_b32 v214,s30,v97
v_sub_f32 v213,v213,v210
v_sub_f32 v214,v214,v210
v_fmac_f32 v211,v213,v213
v_fmac_f32 v212,v214,v214
v_lshlrev_b32 v213,16,v98
v_and_b32 v214,s30,v98
v_sub_f32 v213,v213,v210
v_sub_f32 v214,v214,v210
v_fmac_f32 v211,v213,v213
v_fmac_f32 v212,v214,v214
v_lshlrev_b32 v213,16,v99
v_and_b32 v214,s30,v99
v_sub_f32 v213,v213,v210
v_sub_f32 v214,v214,v210
v_fmac_f32 v211,v213,v213
v_fmac_f32 v212,v214,v214
v_lshlrev_b32 v213,16,v100
v_and_b32 v214,s30,v100
v_sub_f32 v213,v213,v210
v_sub_f32 v214,v214,v210
v_fmac_f32 v211,v213,v213
v_fmac_f32 v212,v214,v214
v_lshlrev_b32 v213,16,v101
v_and_b32 v214,s30,v101
v_sub_f32 v213,v213,v210
v_sub_f32 v214,v214,v210
v_fmac_f32 v211,v213,v213
v_fmac_f32 v212,v214,v214
v_lshlrev_b32 v213,16,v102
v_and_b32 v214,s30,v102
v_sub_f32 v213,v213,v210
v_sub_f32 v214,v214,v210
v_fmac_f32 v211,v213,v213
v_fmac_f32 v212,v214,v214
v_lshlrev_b32 v213,16,v103
v_and_b32 v214,s30,v103
v_sub_f32 v213,v213,v210
v_sub_f32 v214,v214,v210
v_fmac_f32 v211,v213,v213
v_fmac_f32 v212,v214,v214
v_lshlrev_b32 v213,16,v104
v_and_b32 v214,s30,v104
v_sub_f32 v213,v213,v210
v_sub_f32 v214,v214,v210
v_fmac_f32 v211,v213,v213
v_fmac_f32 v212,v214,v214
v_lshlrev_b32 v213,16,v105
v_and_b32 v214,s30,v105
v_sub_f32 v213,v213,v210
v_sub_f32 v214,v214,v210
v_fmac_f32 v211,v213,v213
v_fmac_f32 v212,v214,v214
v_lshlrev_b32 v213,16,v106
v_and_b32 v214,s30,v106
v_sub_f32 v213,v213,v210
v_sub_f32 v214,v214,v210
v_fmac_f32 v211,v213,v213
v_fmac_f32 v212,v214,v214
v_lshlrev_b32 v213,16,v107
v_and_b32 v214,s30,v107
v_sub_f32 v213,v213,v210
v_sub_f32 v214,v214,v210
v_fmac_f32 v211,v213,v213
v_fmac_f32 v212,v214,v214
v_lshlrev_b32 v213,16,v108
v_and_b32 v214,s30,v108
v_sub_f32 v213,v213,v210
v_sub_f32 v214,v214,v210
v_fmac_f32 v211,v213,v213
v_fmac_f32 v212,v214,v214
v_lshlrev_b32 v213,16,v109
v_and_b32 v214,s30,v109
v_sub_f32 v213,v213,v210
v_sub_f32 v214,v214,v210
v_fmac_f32 v211,v213,v213
v_fmac_f32 v212,v214,v214
v_lshlrev_b32 v213,16,v110
v_and_b32 v214,s30,v110
v_sub_f32 v213,v213,v210
v_sub_f32 v214,v214,v210
v_fmac_f32 v211,v213,v213
v_fmac_f32 v212,v214,v214
v_lshlrev_b32 v213,16,v111
v_and_b32 v214,s30,v111
v_sub_f32 v213,v213,v210
v_sub_f32 v214,v214,v210
v_fmac_f32 v211,v213,v213
v_fmac_f32 v212,v214,v214
v_add_f32 v211,v211,v212
v_mov_b32 v212,v211
s_nop 1
v_permlane32_swap_b32 v211,v212
v_add_f32 v211,v211,v212
v_mov_b32 v212,0x3727c5ac
v_fmac_f32 v212,0x3b124925,v211
v_rsq_f32 v211,v212
v_lshlrev_b32 v213,16,v0
v_and_b32 v214,s30,v0
v_sub_f32 v213,v213,v210
v_sub_f32 v214,v214,v210
v_mul_f32 v213,v213,v211
v_mul_f32 v214,v214,v211
v_cvt_pk_bf16_f32 v213,v213,v214
v_accvgpr_write_b32 a0,v213
v_lshlrev_b32 v213,16,v1
v_and_b32 v214,s30,v1
v_sub_f32 v213,v213,v210
v_sub_f32 v214,v214,v210
v_mul_f32 v213,v213,v211
v_mul_f32 v214,v214,v211
v_cvt_pk_bf16_f32 v213,v213,v214
v_accvgpr_write_b32 a1,v213
v_lshlrev_b32 v213,16,v2
v_and_b32 v214,s30,v2
v_sub_f32 v213,v213,v210
v_sub_f32 v214,v214,v210
v_mul_f32 v213,v213,v211
v_mul_f32 v214,v214,v211
v_cvt_pk_bf16_f32 v213,v213,v214
v_accvgpr_write_b32 a2,v213
v_lshlrev_b32 v213,16,v3
v_and_b32 v214,s30,v3
v_sub_f32 v213,v213,v210
v_sub_f32 v214,v214,v210
v_mul_f32 v213,v213,v211
v_mul_f32 v214,v214,v211
v_cvt_pk_bf16_f32 v213,v213,v214
v_accvgpr_write_b32 a3,v213
v_lshlrev_b32 v213,16,v4
v_and_b32 v214,s30,v4
v_sub_f32 v213,v213,v210
v_sub_f32 v214,v214,v210
v_mul_f32 v213,v213,v211
v_mul_f32 v214,v214,v211
v_cvt_pk_bf16_f32 v213,v213,v214
v_accvgpr_write_b32 a4,v213
v_lshlrev_b32 v213,16,v5
v_and_b32 v214,s30,v5
v_sub_f32 v213,v213,v210
v_sub_f32 v214,v214,v210
v_mul_f32 v213,v213,v211
v_mul_f32 v214,v214,v211
v_cvt_pk_bf16_f32 v213,v213,v214
v_accvgpr_write_b32 a5,v213
v_lshlrev_b32 v213,16,v6
v_and_b32 v214,s30,v6
v_sub_f32 v213,v213,v210
v_sub_f32 v214,v214,v210
v_mul_f32 v213,v213,v211
v_mul_f32 v214,v214,v211
v_cvt_pk_bf16_f32 v213,v213,v214
v_accvgpr_write_b32 a6,v213
v_lshlrev_b32 v213,16,v7
v_and_b32 v214,s30,v7
v_sub_f32 v213,v213,v210
v_sub_f32 v214,v214,v210
v_mul_f32 v213,v213,v211
v_mul_f32 v214,v214,v211
v_cvt_pk_bf16_f32 v213,v213,v214
v_accvgpr_write_b32 a7,v213
v_lshlrev_b32 v213,16,v8
v_and_b32 v214,s30,v8
v_sub_f32 v213,v213,v210
v_sub_f32 v214,v214,v210
v_mul_f32 v213,v213,v211
v_mul_f32 v214,v214,v211
v_cvt_pk_bf16_f32 v213,v213,v214
v_accvgpr_write_b32 a8,v213
v_lshlrev_b32 v213,16,v9
v_and_b32 v214,s30,v9
v_sub_f32 v213,v213,v210
v_sub_f32 v214,v214,v210
v_mul_f32 v213,v213,v211
v_mul_f32 v214,v214,v211
v_cvt_pk_bf16_f32 v213,v213,v214
v_accvgpr_write_b32 a9,v213
v_lshlrev_b32 v213,16,v10
v_and_b32 v214,s30,v10
v_sub_f32 v213,v213,v210
v_sub_f32 v214,v214,v210
v_mul_f32 v213,v213,v211
v_mul_f32 v214,v214,v211
v_cvt_pk_bf16_f32 v213,v213,v214
v_accvgpr_write_b32 a10,v213
v_lshlrev_b32 v213,16,v11
v_and_b32 v214,s30,v11
v_sub_f32 v213,v213,v210
v_sub_f32 v214,v214,v210
v_mul_f32 v213,v213,v211
v_mul_f32 v214,v214,v211
v_cvt_pk_bf16_f32 v213,v213,v214
v_accvgpr_write_b32 a11,v213
v_lshlrev_b32 v213,16,v12
v_and_b32 v214,s30,v12
v_sub_f32 v213,v213,v210
v_sub_f32 v214,v214,v210
v_mul_f32 v213,v213,v211
v_mul_f32 v214,v214,v211
v_cvt_pk_bf16_f32 v213,v213,v214
v_accvgpr_write_b32 a12,v213
v_lshlrev_b32 v213,16,v13
v_and_b32 v214,s30,v13
v_sub_f32 v213,v213,v210
v_sub_f32 v214,v214,v210
v_mul_f32 v213,v213,v211
v_mul_f32 v214,v214,v211
v_cvt_pk_bf16_f32 v213,v213,v214
v_accvgpr_write_b32 a13,v213
v_lshlrev_b32 v213,16,v14
v_and_b32 v214,s30,v14
v_sub_f32 v213,v213,v210
v_sub_f32 v214,v214,v210
v_mul_f32 v213,v213,v211
v_mul_f32 v214,v214,v211
v_cvt_pk_bf16_f32 v213,v213,v214
v_accvgpr_write_b32 a14,v213
v_lshlrev_b32 v213,16,v15
v_and_b32 v214,s30,v15
v_sub_f32 v213,v213,v210
v_sub_f32 v214,v214,v210
v_mul_f32 v213,v213,v211
v_mul_f32 v214,v214,v211
v_cvt_pk_bf16_f32 v213,v213,v214
v_accvgpr_write_b32 a15,v213
v_lshlrev_b32 v213,16,v16
v_and_b32 v214,s30,v16
v_sub_f32 v213,v213,v210
v_sub_f32 v214,v214,v210
v_mul_f32 v213,v213,v211
v_mul_f32 v214,v214,v211
v_cvt_pk_bf16_f32 v213,v213,v214
v_accvgpr_write_b32 a16,v213
v_lshlrev_b32 v213,16,v17
v_and_b32 v214,s30,v17
v_sub_f32 v213,v213,v210
v_sub_f32 v214,v214,v210
v_mul_f32 v213,v213,v211
v_mul_f32 v214,v214,v211
v_cvt_pk_bf16_f32 v213,v213,v214
v_accvgpr_write_b32 a17,v213
v_lshlrev_b32 v213,16,v18
v_and_b32 v214,s30,v18
v_sub_f32 v213,v213,v210
v_sub_f32 v214,v214,v210
v_mul_f32 v213,v213,v211
v_mul_f32 v214,v214,v211
v_cvt_pk_bf16_f32 v213,v213,v214
v_accvgpr_write_b32 a18,v213
v_lshlrev_b32 v213,16,v19
v_and_b32 v214,s30,v19
v_sub_f32 v213,v213,v210
v_sub_f32 v214,v214,v210
v_mul_f32 v213,v213,v211
v_mul_f32 v214,v214,v211
v_cvt_pk_bf16_f32 v213,v213,v214
v_accvgpr_write_b32 a19,v213
v_lshlrev_b32 v213,16,v20
v_and_b32 v214,s30,v20
v_sub_f32 v213,v213,v210
v_sub_f32 v214,v214,v210
v_mul_f32 v213,v213,v211
v_mul_f32 v214,v214,v211
v_cvt_pk_bf16_f32 v213,v213,v214
v_accvgpr_write_b32 a20,v213
v_lshlrev_b32 v213,16,v21
v_and_b32 v214,s30,v21
v_sub_f32 v213,v213,v210
v_sub_f32 v214,v214,v210
v_mul_f32 v213,v213,v211
v_mul_f32 v214,v214,v211
v_cvt_pk_bf16_f32 v213,v213,v214
v_accvgpr_write_b32 a21,v213
v_lshlrev_b32 v213,16,v22
v_and_b32 v214,s30,v22
v_sub_f32 v213,v213,v210
v_sub_f32 v214,v214,v210
v_mul_f32 v213,v213,v211
v_mul_f32 v214,v214,v211
v_cvt_pk_bf16_f32 v213,v213,v214
v_accvgpr_write_b32 a22,v213
v_lshlrev_b32 v213,16,v23
v_and_b32 v214,s30,v23
v_sub_f32 v213,v213,v210
v_sub_f32 v214,v214,v210
v_mul_f32 v213,v213,v211
v_mul_f32 v214,v214,v211
v_cvt_pk_bf16_f32 v213,v213,v214
v_accvgpr_write_b32 a23,v213
v_lshlrev_b32 v213,16,v24
v_and_b32 v214,s30,v24
v_sub_f32 v213,v213,v210
v_sub_f32 v214,v214,v210
v_mul_f32 v213,v213,v211
v_mul_f32 v214,v214,v211
v_cvt_pk_bf16_f32 v213,v213,v214
v_accvgpr_write_b32 a24,v213
v_lshlrev_b32 v213,16,v25
v_and_b32 v214,s30,v25
v_sub_f32 v213,v213,v210
v_sub_f32 v214,v214,v210
v_mul_f32 v213,v213,v211
v_mul_f32 v214,v214,v211
v_cvt_pk_bf16_f32 v213,v213,v214
v_accvgpr_write_b32 a25,v213
v_lshlrev_b32 v213,16,v26
v_and_b32 v214,s30,v26
v_sub_f32 v213,v213,v210
v_sub_f32 v214,v214,v210
v_mul_f32 v213,v213,v211
v_mul_f32 v214,v214,v211
v_cvt_pk_bf16_f32 v213,v213,v214
v_accvgpr_write_b32 a26,v213
v_lshlrev_b32 v213,16,v27
v_and_b32 v214,s30,v27
v_sub_f32 v213,v213,v210
v_sub_f32 v214,v214,v210
v_mul_f32 v213,v213,v211
v_mul_f32 v214,v214,v211
v_cvt_pk_bf16_f32 v213,v213,v214
v_accvgpr_write_b32 a27,v213
v_lshlrev_b32 v213,16,v28
v_and_b32 v214,s30,v28
v_sub_f32 v213,v213,v210
v_sub_f32 v214,v214,v210
v_mul_f32 v213,v213,v211
v_mul_f32 v214,v214,v211
v_cvt_pk_bf16_f32 v213,v213,v214
v_accvgpr_write_b32 a28,v213
v_lshlrev_b32 v213,16,v29
v_and_b32 v214,s30,v29
v_sub_f32 v213,v213,v210
v_sub_f32 v214,v214,v210
v_mul_f32 v213,v213,v211
v_mul_f32 v214,v214,v211
v_cvt_pk_bf16_f32 v213,v213,v214
v_accvgpr_write_b32 a29,v213
v_lshlrev_b32 v213,16,v30
v_and_b32 v214,s30,v30
v_sub_f32 v213,v213,v210
v_sub_f32 v214,v214,v210
v_mul_f32 v213,v213,v211
v_mul_f32 v214,v214,v211
v_cvt_pk_bf16_f32 v213,v213,v214
v_accvgpr_write_b32 a30,v213
v_lshlrev_b32 v213,16,v31
v_and_b32 v214,s30,v31
v_sub_f32 v213,v213,v210
v_sub_f32 v214,v214,v210
v_mul_f32 v213,v213,v211
v_mul_f32 v214,v214,v211
v_cvt_pk_bf16_f32 v213,v213,v214
v_accvgpr_write_b32 a31,v213
v_lshlrev_b32 v213,16,v32
v_and_b32 v214,s30,v32
v_sub_f32 v213,v213,v210
v_sub_f32 v214,v214,v210
v_mul_f32 v213,v213,v211
v_mul_f32 v214,v214,v211
v_cvt_pk_bf16_f32 v213,v213,v214
v_accvgpr_write_b32 a32,v213
v_lshlrev_b32 v213,16,v33
v_and_b32 v214,s30,v33
v_sub_f32 v213,v213,v210
v_sub_f32 v214,v214,v210
v_mul_f32 v213,v213,v211
v_mul_f32 v214,v214,v211
v_cvt_pk_bf16_f32 v213,v213,v214
v_accvgpr_write_b32 a33,v213
v_lshlrev_b32 v213,16,v34
v_and_b32 v214,s30,v34
v_sub_f32 v213,v213,v210
v_sub_f32 v214,v214,v210
v_mul_f32 v213,v213,v211
v_mul_f32 v214,v214,v211
v_cvt_pk_bf16_f32 v213,v213,v214
v_accvgpr_write_b32 a34,v213
v_lshlrev_b32 v213,16,v35
v_and_b32 v214,s30,v35
v_sub_f32 v213,v213,v210
v_sub_f32 v214,v214,v210
v_mul_f32 v213,v213,v211
v_mul_f32 v214,v214,v211
v_cvt_pk_bf16_f32 v213,v213,v214
v_accvgpr_write_b32 a35,v213
v_lshlrev_b32 v213,16,v36
v_and_b32 v214,s30,v36
v_sub_f32 v213,v213,v210
v_sub_f32 v214,v214,v210
v_mul_f32 v213,v213,v211
v_mul_f32 v214,v214,v211
v_cvt_pk_bf16_f32 v213,v213,v214
v_accvgpr_write_b32 a36,v213
v_lshlrev_b32 v213,16,v37
v_and_b32 v214,s30,v37
v_sub_f32 v213,v213,v210
v_sub_f32 v214,v214,v210
v_mul_f32 v213,v213,v211
v_mul_f32 v214,v214,v211
v_cvt_pk_bf16_f32 v213,v213,v214
v_accvgpr_write_b32 a37,v213
v_lshlrev_b32 v213,16,v38
v_and_b32 v214,s30,v38
v_sub_f32 v213,v213,v210
v_sub_f32 v214,v214,v210
v_mul_f32 v213,v213,v211
v_mul_f32 v214,v214,v211
v_cvt_pk_bf16_f32 v213,v213,v214
v_accvgpr_write_b32 a38,v213
v_lshlrev_b32 v213,16,v39
v_and_b32 v214,s30,v39
v_sub_f32 v213,v213,v210
v_sub_f32 v214,v214,v210
v_mul_f32 v213,v213,v211
v_mul_f32 v214,v214,v211
v_cvt_pk_bf16_f32 v213,v213,v214
v_accvgpr_write_b32 a39,v213
v_lshlrev_b32 v213,16,v40
v_and_b32 v214,s30,v40
v_sub_f32 v213,v213,v210
v_sub_f32 v214,v214,v210
v_mul_f32 v213,v213,v211
v_mul_f32 v214,v214,v211
v_cvt_pk_bf16_f32 v213,v213,v214
v_accvgpr_write_b32 a40,v213
v_lshlrev_b32 v213,16,v41
v_and_b32 v214,s30,v41
v_sub_f32 v213,v213,v210
v_sub_f32 v214,v214,v210
v_mul_f32 v213,v213,v211
v_mul_f32 v214,v214,v211
v_cvt_pk_bf16_f32 v213,v213,v214
v_accvgpr_write_b32 a41,v213
v_lshlrev_b32 v213,16,v42
v_and_b32 v214,s30,v42
v_sub_f32 v213,v213,v210
v_sub_f32 v214,v214,v210
v_mul_f32 v213,v213,v211
v_mul_f32 v214,v214,v211
v_cvt_pk_bf16_f32 v213,v213,v214
v_accvgpr_write_b32 a42,v213
v_lshlrev_b32 v213,16,v43
v_and_b32 v214,s30,v43
v_sub_f32 v213,v213,v210
v_sub_f32 v214,v214,v210
v_mul_f32 v213,v213,v211
v_mul_f32 v214,v214,v211
v_cvt_pk_bf16_f32 v213,v213,v214
v_accvgpr_write_b32 a43,v213
v_lshlrev_b32 v213,16,v44
v_and_b32 v214,s30,v44
v_sub_f32 v213,v213,v210
v_sub_f32 v214,v214,v210
v_mul_f32 v213,v213,v211
v_mul_f32 v214,v214,v211
v_cvt_pk_bf16_f32 v213,v213,v214
v_accvgpr_write_b32 a44,v213
v_lshlrev_b32 v213,16,v45
v_and_b32 v214,s30,v45
v_sub_f32 v213,v213,v210
v_sub_f32 v214,v214,v210
v_mul_f32 v213,v213,v211
v_mul_f32 v214,v214,v211
v_cvt_pk_bf16_f32 v213,v213,v214
v_accvgpr_write_b32 a45,v213
v_lshlrev_b32 v213,16,v46
v_and_b32 v214,s30,v46
v_sub_f32 v213,v213,v210
v_sub_f32 v214,v214,v210
v_mul_f32 v213,v213,v211
v_mul_f32 v214,v214,v211
v_cvt_pk_bf16_f32 v213,v213,v214
v_accvgpr_write_b32 a46,v213
v_lshlrev_b32 v213,16,v47
v_and_b32 v214,s30,v47
v_sub_f32 v213,v213,v210
v_sub_f32 v214,v214,v210
v_mul_f32 v213,v213,v211
v_mul_f32 v214,v214,v211
v_cvt_pk_bf16_f32 v213,v213,v214
v_accvgpr_write_b32 a47,v213
v_lshlrev_b32 v213,16,v48
v_and_b32 v214,s30,v48
v_sub_f32 v213,v213,v210
v_sub_f32 v214,v214,v210
v_mul_f32 v213,v213,v211
v_mul_f32 v214,v214,v211
v_cvt_pk_bf16_f32 v213,v213,v214
v_accvgpr_write_b32 a48,v213
v_lshlrev_b32 v213,16,v49
v_and_b32 v214,s30,v49
v_sub_f32 v213,v213,v210
v_sub_f32 v214,v214,v210
v_mul_f32 v213,v213,v211
v_mul_f32 v214,v214,v211
v_cvt_pk_bf16_f32 v213,v213,v214
v_accvgpr_write_b32 a49,v213
v_lshlrev_b32 v213,16,v50
v_and_b32 v214,s30,v50
v_sub_f32 v213,v213,v210
v_sub_f32 v214,v214,v210
v_mul_f32 v213,v213,v211
v_mul_f32 v214,v214,v211
v_cvt_pk_bf16_f32 v213,v213,v214
v_accvgpr_write_b32 a50,v213
v_lshlrev_b32 v213,16,v51
v_and_b32 v214,s30,v51
v_sub_f32 v213,v213,v210
v_sub_f32 v214,v214,v210
v_mul_f32 v213,v213,v211
v_mul_f32 v214,v214,v211
v_cvt_pk_bf16_f32 v213,v213,v214
v_accvgpr_write_b32 a51,v213
v_lshlrev_b32 v213,16,v52
v_and_b32 v214,s30,v52
v_sub_f32 v213,v213,v210
v_sub_f32 v214,v214,v210
v_mul_f32 v213,v213,v211
v_mul_f32 v214,v214,v211
v_cvt_pk_bf16_f32 v213,v213,v214
v_accvgpr_write_b32 a52,v213
v_lshlrev_b32 v213,16,v53
v_and_b32 v214,s30,v53
v_sub_f32 v213,v213,v210
v_sub_f32 v214,v214,v210
v_mul_f32 v213,v213,v211
v_mul_f32 v214,v214,v211
v_cvt_pk_bf16_f32 v213,v213,v214
v_accvgpr_write_b32 a53,v213
v_lshlrev_b32 v213,16,v54
v_and_b32 v214,s30,v54
v_sub_f32 v213,v213,v210
v_sub_f32 v214,v214,v210
v_mul_f32 v213,v213,v211
v_mul_f32 v214,v214,v211
v_cvt_pk_bf16_f32 v213,v213,v214
v_accvgpr_write_b32 a54,v213
v_lshlrev_b32 v213,16,v55
v_and_b32 v214,s30,v55
v_sub_f32 v213,v213,v210
v_sub_f32 v214,v214,v210
v_mul_f32 v213,v213,v211
v_mul_f32 v214,v214,v211
v_cvt_pk_bf16_f32 v213,v213,v214
v_accvgpr_write_b32 a55,v213
v_lshlrev_b32 v213,16,v56
v_and_b32 v214,s30,v56
v_sub_f32 v213,v213,v210
v_sub_f32 v214,v214,v210
v_mul_f32 v213,v213,v211
v_mul_f32 v214,v214,v211
v_cvt_pk_bf16_f32 v213,v213,v214
v_accvgpr_write_b32 a56,v213
v_lshlrev_b32 v213,16,v57
v_and_b32 v214,s30,v57
v_sub_f32 v213,v213,v210
v_sub_f32 v214,v214,v210
v_mul_f32 v213,v213,v211
v_mul_f32 v214,v214,v211
v_cvt_pk_bf16_f32 v213,v213,v214
v_accvgpr_write_b32 a57,v213
v_lshlrev_b32 v213,16,v58
v_and_b32 v214,s30,v58
v_sub_f32 v213,v213,v210
v_sub_f32 v214,v214,v210
v_mul_f32 v213,v213,v211
v_mul_f32 v214,v214,v211
v_cvt_pk_bf16_f32 v213,v213,v214
v_accvgpr_write_b32 a58,v213
v_lshlrev_b32 v213,16,v59
v_and_b32 v214,s30,v59
v_sub_f32 v213,v213,v210
v_sub_f32 v214,v214,v210
v_mul_f32 v213,v213,v211
v_mul_f32 v214,v214,v211
v_cvt_pk_bf16_f32 v213,v213,v214
v_accvgpr_write_b32 a59,v213
v_lshlrev_b32 v213,16,v60
v_and_b32 v214,s30,v60
v_sub_f32 v213,v213,v210
v_sub_f32 v214,v214,v210
v_mul_f32 v213,v213,v211
v_mul_f32 v214,v214,v211
v_cvt_pk_bf16_f32 v213,v213,v214
v_accvgpr_write_b32 a60,v213
v_lshlrev_b32 v213,16,v61
v_and_b32 v214,s30,v61
v_sub_f32 v213,v213,v210
v_sub_f32 v214,v214,v210
v_mul_f32 v213,v213,v211
v_mul_f32 v214,v214,v211
v_cvt_pk_bf16_f32 v213,v213,v214
v_accvgpr_write_b32 a61,v213
v_lshlrev_b32 v213,16,v62
v_and_b32 v214,s30,v62
v_sub_f32 v213,v213,v210
v_sub_f32 v214,v214,v210
v_mul_f32 v213,v213,v211
v_mul_f32 v214,v214,v211
v_cvt_pk_bf16_f32 v213,v213,v214
v_accvgpr_write_b32 a62,v213
v_lshlrev_b32 v213,16,v63
v_and_b32 v214,s30,v63
v_sub_f32 v213,v213,v210
v_sub_f32 v214,v214,v210
v_mul_f32 v213,v213,v211
v_mul_f32 v214,v214,v211
v_cvt_pk_bf16_f32 v213,v213,v214
v_accvgpr_write_b32 a63,v213
v_lshlrev_b32 v213,16,v64
v_and_b32 v214,s30,v64
v_sub_f32 v213,v213,v210
v_sub_f32 v214,v214,v210
v_mul_f32 v213,v213,v211
v_mul_f32 v214,v214,v211
v_cvt_pk_bf16_f32 v213,v213,v214
v_accvgpr_write_b32 a64,v213
v_lshlrev_b32 v213,16,v65
v_and_b32 v214,s30,v65
v_sub_f32 v213,v213,v210
v_sub_f32 v214,v214,v210
v_mul_f32 v213,v213,v211
v_mul_f32 v214,v214,v211
v_cvt_pk_bf16_f32 v213,v213,v214
v_accvgpr_write_b32 a65,v213
v_lshlrev_b32 v213,16,v66
v_and_b32 v214,s30,v66
v_sub_f32 v213,v213,v210
v_sub_f32 v214,v214,v210
v_mul_f32 v213,v213,v211
v_mul_f32 v214,v214,v211
v_cvt_pk_bf16_f32 v213,v213,v214
v_accvgpr_write_b32 a66,v213
v_lshlrev_b32 v213,16,v67
v_and_b32 v214,s30,v67
v_sub_f32 v213,v213,v210
v_sub_f32 v214,v214,v210
v_mul_f32 v213,v213,v211
v_mul_f32 v214,v214,v211
v_cvt_pk_bf16_f32 v213,v213,v214
v_accvgpr_write_b32 a67,v213
v_lshlrev_b32 v213,16,v68
v_and_b32 v214,s30,v68
v_sub_f32 v213,v213,v210
v_sub_f32 v214,v214,v210
v_mul_f32 v213,v213,v211
v_mul_f32 v214,v214,v211
v_cvt_pk_bf16_f32 v213,v213,v214
v_accvgpr_write_b32 a68,v213
v_lshlrev_b32 v213,16,v69
v_and_b32 v214,s30,v69
v_sub_f32 v213,v213,v210
v_sub_f32 v214,v214,v210
v_mul_f32 v213,v213,v211
v_mul_f32 v214,v214,v211
v_cvt_pk_bf16_f32 v213,v213,v214
v_accvgpr_write_b32 a69,v213
v_lshlrev_b32 v213,16,v70
v_and_b32 v214,s30,v70
v_sub_f32 v213,v213,v210
v_sub_f32 v214,v214,v210
v_mul_f32 v213,v213,v211
v_mul_f32 v214,v214,v211
v_cvt_pk_bf16_f32 v213,v213,v214
v_accvgpr_write_b32 a70,v213
v_lshlrev_b32 v213,16,v71
v_and_b32 v214,s30,v71
v_sub_f32 v213,v213,v210
v_sub_f32 v214,v214,v210
v_mul_f32 v213,v213,v211
v_mul_f32 v214,v214,v211
v_cvt_pk_bf16_f32 v213,v213,v214
v_accvgpr_write_b32 a71,v213
v_lshlrev_b32 v213,16,v72
v_and_b32 v214,s30,v72
v_sub_f32 v213,v213,v210
v_sub_f32 v214,v214,v210
v_mul_f32 v213,v213,v211
v_mul_f32 v214,v214,v211
v_cvt_pk_bf16_f32 v213,v213,v214
v_accvgpr_write_b32 a72,v213
v_lshlrev_b32 v213,16,v73
v_and_b32 v214,s30,v73
v_sub_f32 v213,v213,v210
v_sub_f32 v214,v214,v210
v_mul_f32 v213,v213,v211
v_mul_f32 v214,v214,v211
v_cvt_pk_bf16_f32 v213,v213,v214
v_accvgpr_write_b32 a73,v213
v_lshlrev_b32 v213,16,v74
v_and_b32 v214,s30,v74
v_sub_f32 v213,v213,v210
v_sub_f32 v214,v214,v210
v_mul_f32 v213,v213,v211
v_mul_f32 v214,v214,v211
v_cvt_pk_bf16_f32 v213,v213,v214
v_accvgpr_write_b32 a74,v213
v_lshlrev_b32 v213,16,v75
v_and_b32 v214,s30,v75
v_sub_f32 v213,v213,v210
v_sub_f32 v214,v214,v210
v_mul_f32 v213,v213,v211
v_mul_f32 v214,v214,v211
v_cvt_pk_bf16_f32 v213,v213,v214
v_accvgpr_write_b32 a75,v213
v_lshlrev_b32 v213,16,v76
v_and_b32 v214,s30,v76
v_sub_f32 v213,v213,v210
v_sub_f32 v214,v214,v210
v_mul_f32 v213,v213,v211
v_mul_f32 v214,v214,v211
v_cvt_pk_bf16_f32 v213,v213,v214
v_accvgpr_write_b32 a76,v213
v_lshlrev_b32 v213,16,v77
v_and_b32 v214,s30,v77
v_sub_f32 v213,v213,v210
v_sub_f32 v214,v214,v210
v_mul_f32 v213,v213,v211
v_mul_f32 v214,v214,v211
v_cvt_pk_bf16_f32 v213,v213,v214
v_accvgpr_write_b32 a77,v213
v_lshlrev_b32 v213,16,v78
v_and_b32 v214,s30,v78
v_sub_f32 v213,v213,v210
v_sub_f32 v214,v214,v210
v_mul_f32 v213,v213,v211
v_mul_f32 v214,v214,v211
v_cvt_pk_bf16_f32 v213,v213,v214
v_accvgpr_write_b32 a78,v213
v_lshlrev_b32 v213,16,v79
v_and_b32 v214,s30,v79
v_sub_f32 v213,v213,v210
v_sub_f32 v214,v214,v210
v_mul_f32 v213,v213,v211
v_mul_f32 v214,v214,v211
v_cvt_pk_bf16_f32 v213,v213,v214
v_accvgpr_write_b32 a79,v213
v_lshlrev_b32 v213,16,v80
v_and_b32 v214,s30,v80
v_sub_f32 v213,v213,v210
v_sub_f32 v214,v214,v210
v_mul_f32 v213,v213,v211
v_mul_f32 v214,v214,v211
v_cvt_pk_bf16_f32 v213,v213,v214
v_accvgpr_write_b32 a80,v213
v_lshlrev_b32 v213,16,v81
v_and_b32 v214,s30,v81
v_sub_f32 v213,v213,v210
v_sub_f32 v214,v214,v210
v_mul_f32 v213,v213,v211
v_mul_f32 v214,v214,v211
v_cvt_pk_bf16_f32 v213,v213,v214
v_accvgpr_write_b32 a81,v213
v_lshlrev_b32 v213,16,v82
v_and_b32 v214,s30,v82
v_sub_f32 v213,v213,v210
v_sub_f32 v214,v214,v210
v_mul_f32 v213,v213,v211
v_mul_f32 v214,v214,v211
v_cvt_pk_bf16_f32 v213,v213,v214
v_accvgpr_write_b32 a82,v213
v_lshlrev_b32 v213,16,v83
v_and_b32 v214,s30,v83
v_sub_f32 v213,v213,v210
v_sub_f32 v214,v214,v210
v_mul_f32 v213,v213,v211
v_mul_f32 v214,v214,v211
v_cvt_pk_bf16_f32 v213,v213,v214
v_accvgpr_write_b32 a83,v213
v_lshlrev_b32 v213,16,v84
v_and_b32 v214,s30,v84
v_sub_f32 v213,v213,v210
v_sub_f32 v214,v214,v210
v_mul_f32 v213,v213,v211
v_mul_f32 v214,v214,v211
v_cvt_pk_bf16_f32 v213,v213,v214
v_accvgpr_write_b32 a84,v213
v_lshlrev_b32 v213,16,v85
v_and_b32 v214,s30,v85
v_sub_f32 v213,v213,v210
v_sub_f32 v214,v214,v210
v_mul_f32 v213,v213,v211
v_mul_f32 v214,v214,v211
v_cvt_pk_bf16_f32 v213,v213,v214
v_accvgpr_write_b32 a85,v213
v_lshlrev_b32 v213,16,v86
v_and_b32 v214,s30,v86
v_sub_f32 v213,v213,v210
v_sub_f32 v214,v214,v210
v_mul_f32 v213,v213,v211
v_mul_f32 v214,v214,v211
v_cvt_pk_bf16_f32 v213,v213,v214
v_accvgpr_write_b32 a86,v213
v_lshlrev_b32 v213,16,v87
v_and_b32 v214,s30,v87
v_sub_f32 v213,v213,v210
v_sub_f32 v214,v214,v210
v_mul_f32 v213,v213,v211
v_mul_f32 v214,v214,v211
v_cvt_pk_bf16_f32 v213,v213,v214
v_accvgpr_write_b32 a87,v213
v_lshlrev_b32 v213,16,v88
v_and_b32 v214,s30,v88
v_sub_f32 v213,v213,v210
v_sub_f32 v214,v214,v210
v_mul_f32 v213,v213,v211
v_mul_f32 v214,v214,v211
v_cvt_pk_bf16_f32 v213,v213,v214
v_accvgpr_write_b32 a88,v213
v_lshlrev_b32 v213,16,v89
v_and_b32 v214,s30,v89
v_sub_f32 v213,v213,v210
v_sub_f32 v214,v214,v210
v_mul_f32 v213,v213,v211
v_mul_f32 v214,v214,v211
v_cvt_pk_bf16_f32 v213,v213,v214
v_accvgpr_write_b32 a89,v213
v_lshlrev_b32 v213,16,v90
v_and_b32 v214,s30,v90
v_sub_f32 v213,v213,v210
v_sub_f32 v214,v214,v210
v_mul_f32 v213,v213,v211
v_mul_f32 v214,v214,v211
v_cvt_pk_bf16_f32 v213,v213,v214
v_accvgpr_write_b32 a90,v213
v_lshlrev_b32 v213,16,v91
v_and_b32 v214,s30,v91
v_sub_f32 v213,v213,v210
v_sub_f32 v214,v214,v210
v_mul_f32 v213,v213,v211
v_mul_f32 v214,v214,v211
v_cvt_pk_bf16_f32 v213,v213,v214
v_accvgpr_write_b32 a91,v213
v_lshlrev_b32 v213,16,v92
v_and_b32 v214,s30,v92
v_sub_f32 v213,v213,v210
v_sub_f32 v214,v214,v210
v_mul_f32 v213,v213,v211
v_mul_f32 v214,v214,v211
v_cvt_pk_bf16_f32 v213,v213,v214
v_accvgpr_write_b32 a92,v213
v_lshlrev_b32 v213,16,v93
v_and_b32 v214,s30,v93
v_sub_f32 v213,v213,v210
v_sub_f32 v214,v214,v210
v_mul_f32 v213,v213,v211
v_mul_f32 v214,v214,v211
v_cvt_pk_bf16_f32 v213,v213,v214
v_accvgpr_write_b32 a93,v213
v_lshlrev_b32 v213,16,v94
v_and_b32 v214,s30,v94
v_sub_f32 v213,v213,v210
v_sub_f32 v214,v214,v210
v_mul_f32 v213,v213,v211
v_mul_f32 v214,v214,v211
v_cvt_pk_bf16_f32 v213,v213,v214
v_accvgpr_write_b32 a94,v213
v_lshlrev_b32 v213,16,v95
v_and_b32 v214,s30,v95
v_sub_f32 v213,v213,v210
v_sub_f32 v214,v214,v210
v_mul_f32 v213,v213,v211
v_mul_f32 v214,v214,v211
v_cvt_pk_bf16_f32 v213,v213,v214
v_accvgpr_write_b32 a95,v213
v_lshlrev_b32 v213,16,v96
v_and_b32 v214,s30,v96
v_sub_f32 v213,v213,v210
v_sub_f32 v214,v214,v210
v_mul_f32 v213,v213,v211
v_mul_f32 v214,v214,v211
v_cvt_pk_bf16_f32 v213,v213,v214
v_accvgpr_write_b32 a96,v213
v_lshlrev_b32 v213,16,v97
v_and_b32 v214,s30,v97
v_sub_f32 v213,v213,v210
v_sub_f32 v214,v214,v210
v_mul_f32 v213,v213,v211
v_mul_f32 v214,v214,v211
v_cvt_pk_bf16_f32 v213,v213,v214
v_accvgpr_write_b32 a97,v213
v_lshlrev_b32 v213,16,v98
v_and_b32 v214,s30,v98
v_sub_f32 v213,v213,v210
v_sub_f32 v214,v214,v210
v_mul_f32 v213,v213,v211
v_mul_f32 v214,v214,v211
v_cvt_pk_bf16_f32 v213,v213,v214
v_accvgpr_write_b32 a98,v213
v_lshlrev_b32 v213,16,v99
v_and_b32 v214,s30,v99
v_sub_f32 v213,v213,v210
v_sub_f32 v214,v214,v210
v_mul_f32 v213,v213,v211
v_mul_f32 v214,v214,v211
v_cvt_pk_bf16_f32 v213,v213,v214
v_accvgpr_write_b32 a99,v213
v_lshlrev_b32 v213,16,v100
v_and_b32 v214,s30,v100
v_sub_f32 v213,v213,v210
v_sub_f32 v214,v214,v210
v_mul_f32 v213,v213,v211
v_mul_f32 v214,v214,v211
v_cvt_pk_bf16_f32 v213,v213,v214
v_accvgpr_write_b32 a100,v213
v_lshlrev_b32 v213,16,v101
v_and_b32 v214,s30,v101
v_sub_f32 v213,v213,v210
v_sub_f32 v214,v214,v210
v_mul_f32 v213,v213,v211
v_mul_f32 v214,v214,v211
v_cvt_pk_bf16_f32 v213,v213,v214
v_accvgpr_write_b32 a101,v213
v_lshlrev_b32 v213,16,v102
v_and_b32 v214,s30,v102
v_sub_f32 v213,v213,v210
v_sub_f32 v214,v214,v210
v_mul_f32 v213,v213,v211
v_mul_f32 v214,v214,v211
v_cvt_pk_bf16_f32 v213,v213,v214
v_accvgpr_write_b32 a102,v213
v_lshlrev_b32 v213,16,v103
v_and_b32 v214,s30,v103
v_sub_f32 v213,v213,v210
v_sub_f32 v214,v214,v210
v_mul_f32 v213,v213,v211
v_mul_f32 v214,v214,v211
v_cvt_pk_bf16_f32 v213,v213,v214
v_accvgpr_write_b32 a103,v213
v_lshlrev_b32 v213,16,v104
v_and_b32 v214,s30,v104
v_sub_f32 v213,v213,v210
v_sub_f32 v214,v214,v210
v_mul_f32 v213,v213,v211
v_mul_f32 v214,v214,v211
v_cvt_pk_bf16_f32 v213,v213,v214
v_accvgpr_write_b32 a104,v213
v_lshlrev_b32 v213,16,v105
v_and_b32 v214,s30,v105
v_sub_f32 v213,v213,v210
v_sub_f32 v214,v214,v210
v_mul_f32 v213,v213,v211
v_mul_f32 v214,v214,v211
v_cvt_pk_bf16_f32 v213,v213,v214
v_accvgpr_write_b32 a105,v213
v_lshlrev_b32 v213,16,v106
v_and_b32 v214,s30,v106
v_sub_f32 v213,v213,v210
v_sub_f32 v214,v214,v210
v_mul_f32 v213,v213,v211
v_mul_f32 v214,v214,v211
v_cvt_pk_bf16_f32 v213,v213,v214
v_accvgpr_write_b32 a106,v213
v_lshlrev_b32 v213,16,v107
v_and_b32 v214,s30,v107
v_sub_f32 v213,v213,v210
v_sub_f32 v214,v214,v210
v_mul_f32 v213,v213,v211
v_mul_f32 v214,v214,v211
v_cvt_pk_bf16_f32 v213,v213,v214
v_accvgpr_write_b32 a107,v213
v_lshlrev_b32 v213,16,v108
v_and_b32 v214,s30,v108
v_sub_f32 v213,v213,v210
v_sub_f32 v214,v214,v210
v_mul_f32 v213,v213,v211
v_mul_f32 v214,v214,v211
v_cvt_pk_bf16_f32 v213,v213,v214
v_accvgpr_write_b32 a108,v213
v_lshlrev_b32 v213,16,v109
v_and_b32 v214,s30,v109
v_sub_f32 v213,v213,v210
v_sub_f32 v214,v214,v210
v_mul_f32 v213,v213,v211
v_mul_f32 v214,v214,v211
v_cvt_pk_bf16_f32 v213,v213,v214
v_accvgpr_write_b32 a109,v213
v_lshlrev_b32 v213,16,v110
v_and_b32 v214,s30,v110
v_sub_f32 v213,v213,v210
v_sub_f32 v214,v214,v210
v_mul_f32 v213,v213,v211
v_mul_f32 v214,v214,v211
v_cvt_pk_bf16_f32 v213,v213,v214
v_accvgpr_write_b32 a110,v213
v_lshlrev_b32 v213,16,v111
v_and_b32 v214,s30,v111
v_sub_f32 v213,v213,v210
v_sub_f32 v214,v214,v210
v_mul_f32 v213,v213,v211
v_mul_f32 v214,v214,v211
v_cvt_pk_bf16_f32 v213,v213,v214
v_accvgpr_write_b32 a111,v213
s_mov_b32 s58,0xbdd2d3e8
v_mov_b32 v210,0xc0135761
v_and_b32 v211,0x1f0,v192
v_lshl_add_u32 v211,v211,1,v206
s_mul_i32 s59,s98,3670016
s_mul_i32 s31,s99,57344
s_add_u32 s59,s59,s31
s_add_u32 s59,s59,67108864
s_add_u32 s30,s100,64
s_add_u32 m0,s60,28672
s_nop 0
buffer_load_dwordx4 v204,s[20:23],s30 offen lds
s_add_u32 s30,s100,57408
s_add_u32 m0,s60,29696
s_nop 0
buffer_load_dwordx4 v204,s[20:23],s30 offen lds
s_add_u32 s30,s100,114752
s_add_u32 m0,s60,30720
s_nop 0
buffer_load_dwordx4 v204,s[20:23],s30 offen lds
s_add_u32 s30,s100,172096
s_add_u32 m0,s60,31744
s_nop 0
buffer_load_dwordx4 v204,s[20:23],s30 offen lds
s_add_u32 s30,s100,229440
s_add_u32 m0,s60,32768
s_nop 0
buffer_load_dwordx4 v204,s[20:23],s30 offen lds
s_add_u32 s30,s100,286784
s_add_u32 m0,s60,33792
s_nop 0
buffer_load_dwordx4 v204,s[20:23],s30 offen lds
s_add_u32 s30,s100,344128
s_add_u32 m0,s60,34816
s_nop 0
buffer_load_dwordx4 v204,s[20:23],s30 offen lds
s_add_u32 s30,s100,128
s_add_u32 m0,s60,57344
s_nop 0
buffer_load_dwordx4 v204,s[20:23],s30 offen lds
s_add_u32 s30,s100,57472
s_add_u32 m0,s60,58368
s_nop 0
buffer_load_dwordx4 v204,s[20:23],s30 offen lds
s_add_u32 s30,s100,114816
s_add_u32 m0,s60,59392
s_nop 0
buffer_load_dwordx4 v204,s[20:23],s30 offen lds
s_add_u32 s30,s100,172160
s_add_u32 m0,s60,60416
s_nop 0
buffer_load_dwordx4 v204,s[20:23],s30 offen lds
s_add_u32 s30,s100,229504
s_add_u32 m0,s60,61440
s_nop 0
buffer_load_dwordx4 v204,s[20:23],s30 offen lds
s_add_u32 s30,s100,286848
s_add_u32 m0,s60,62464
s_nop 0
buffer_load_dwordx4 v204,s[20:23],s30 offen lds
s_add_u32 s30,s100,344192
s_add_u32 m0,s60,63488
s_nop 0
buffer_load_dwordx4 v204,s[20:23],s30 offen lds
ds_read_b128 v[112:115],v220 offset:0
ds_read_b128 v[116:119],v220 offset:32
ds_read_b128 v[120:123],v220 offset:64
ds_read_b128 v[124:127],v220 offset:96
s_barrier
ds_read_b64_tr_b16 a[112:113],v200 offset:0
ds_read_b64_tr_b16 a[114:115],v200 offset:256
ds_read_b64_tr_b16 a[116:117],v200 offset:1024
ds_read_b64_tr_b16 a[118:119],v200 offset:1280
ds_read_b64_tr_b16 a[120:121],v200 offset:2048
ds_read_b64_tr_b16 a[122:123],v200 offset:2304
ds_read_b64_tr_b16 a[124:125],v200 offset:3072
ds_read_b64_tr_b16 a[126:127],v200 offset:3328
ds_read_b64_tr_b16 a[128:129],v200 offset:4096
ds_read_b64_tr_b16 a[130:131],v200 offset:4352
s_waitcnt lgkmcnt(10)
s_waitcnt lgkmcnt(8)
v_mfma_f32_32x32x16_bf16 v[112:127],a[112:115],a[0:3],v[112:127]
ds_read_b64_tr_b16 a[132:133],v200 offset:5120
ds_read_b64_tr_b16 a[134:135],v200 offset:5376
s_waitcnt lgkmcnt(8)
v_mfma_f32_32x32x16_bf16 v[112:127],a[116:119],a[4:7],v[112:127]
ds_read_b64_tr_b16 a[136:137],v200 offset:6144
ds_read_b64_tr_b16 a[138:139],v200 offset:6400
s_waitcnt lgkmcnt(8)
v_mfma_f32_32x32x16_bf16 v[112:127],a[120:123],a[8:11],v[112:127]
ds_read_b64_tr_b16 a[140:141],v200 offset:7168
ds_read_b64_tr_b16 a[142:143],v200 offset:7424
ds_read_b128 v[128:131],v220 offset:128
s_waitcnt lgkmcnt(9)
v_mfma_f32_32x32x16_bf16 v[112:127],a[124:127],a[12:15],v[112:127]
ds_read_b64_tr_b16 a[112:113],v200 offset:8192
ds_read_b64_tr_b16 a[114:115],v200 offset:8448
ds_read_b128 v[132:135],v220 offset:160
s_waitcnt lgkmcnt(10)
v_mfma_f32_32x32x16_bf16 v[112:127],a[128:131],a[16:19],v[112:127]
ds_read_b64_tr_b16 a[116:117],v200 offset:9216
ds_read_b64_tr_b16 a[118:119],v200 offset:9472
ds_read_b128 v[136:139],v220 offset:192
s_waitcnt lgkmcnt(11)
v_mfma_f32_32x32x16_bf16 v[112:127],a[132:135],a[20:23],v[112:127]
ds_read_b64_tr_b16 a[120:121],v200 offset:10240
ds_read_b64_tr_b16 a[122:123],v200 offset:10496
ds_read_b128 v[140:143],v220 offset:224
s_waitcnt lgkmcnt(12)
v_mfma_f32_32x32x16_bf16 v[112:127],a[136:139],a[24:27],v[112:127]
ds_read_b64_tr_b16 a[124:125],v200 offset:11264
ds_read_b64_tr_b16 a[126:127],v200 offset:11520
s_waitcnt lgkmcnt(12)
v_mfma_f32_32x32x16_bf16 v[112:127],a[140:143],a[28:31],v[112:127]
ds_read_b64_tr_b16 a[128:129],v200 offset:12288
ds_read_b64_tr_b16 a[130:131],v200 offset:12544
s_waitcnt lgkmcnt(11)
v_mfma_f32_32x32x16_bf16 v[112:127],a[112:115],a[32:35],v[112:127]
ds_read_b64_tr_b16 a[132:133],v200 offset:13312
ds_read_b64_tr_b16 a[134:135],v200 offset:13568
s_waitcnt lgkmcnt(10)
v_mfma_f32_32x32x16_bf16 v[112:127],a[116:119],a[36:39],v[112:127]
ds_read_b64_tr_b16 a[136:137],v200 offset:14336
ds_read_b64_tr_b16 a[138:139],v200 offset:14592
s_waitcnt lgkmcnt(9)
v_mfma_f32_32x32x16_bf16 v[112:127],a[120:123],a[40:43],v[112:127]
ds_read_b64_tr_b16 a[140:141],v200 offset:15360
ds_read_b64_tr_b16 a[142:143],v200 offset:15616
s_waitcnt lgkmcnt(8)
v_mfma_f32_32x32x16_bf16 v[112:127],a[124:127],a[44:47],v[112:127]
ds_read_b64_tr_b16 a[112:113],v200 offset:16384
ds_read_b64_tr_b16 a[114:115],v200 offset:16640
s_waitcnt lgkmcnt(8)
v_mfma_f32_32x32x16_bf16 v[112:127],a[128:131],a[48:51],v[112:127]
ds_read_b64_tr_b16 a[116:117],v200 offset:17408
ds_read_b64_tr_b16 a[118:119],v200 offset:17664
s_waitcnt lgkmcnt(8)
v_mfma_f32_32x32x16_bf16 v[112:127],a[132:135],a[52:55],v[112:127]
ds_read_b64_tr_b16 a[120:121],v200 offset:18432
ds_read_b64_tr_b16 a[122:123],v200 offset:18688
s_waitcnt lgkmcnt(8)
v_mfma_f32_32x32x16_bf16 v[112:127],a[136:139],a[56:59],v[112:127]
ds_read_b64_tr_b16 a[124:125],v200 offset:19456
ds_read_b64_tr_b16 a[126:127],v200 offset:19712
s_waitcnt lgkmcnt(8)
v_mfma_f32_32x32x16_bf16 v[112:127],a[140:143],a[60:63],v[112:127]
ds_read_b64_tr_b16 a[128:129],v200 offset:20480
ds_read_b64_tr_b16 a[130:131],v200 offset:20736
s_waitcnt lgkmcnt(8)
v_mfma_f32_32x32x16_bf16 v[112:127],a[112:115],a[64:67],v[112:127]
ds_read_b64_tr_b16 a[132:133],v200 offset:21504
ds_read_b64_tr_b16 a[134:135],v200 offset:21760
s_waitcnt lgkmcnt(8)
v_mfma_f32_32x32x16_bf16 v[112:127],a[116:119],a[68:71],v[112:127]
ds_read_b64_tr_b16 a[136:137],v200 offset:22528
ds_read_b64_tr_b16 a[138:139],v200 offset:22784
s_waitcnt lgkmcnt(8)
v_mfma_f32_32x32x16_bf16 v[112:127],a[120:123],a[72:75],v[112:127]
ds_read_b64_tr_b16 a[140:141],v200 offset:23552
ds_read_b64_tr_b16 a[142:143],v200 offset:23808
s_waitcnt lgkmcnt(8)
v_mfma_f32_32x32x16_bf16 v[112:127],a[124:127],a[76:79],v[112:127]
ds_read_b64_tr_b16 a[112:113],v200 offset:24576
ds_read_b64_tr_b16 a[114:115],v200 offset:24832
s_waitcnt lgkmcnt(8)
v_mfma_f32_32x32x16_bf16 v[112:127],a[128:131],a[80:83],v[112:127]
ds_read_b64_tr_b16 a[116:117],v200 offset:25600
ds_read_b64_tr_b16 a[118:119],v200 offset:25856
s_waitcnt lgkmcnt(8)
v_mfma_f32_32x32x16_bf16 v[112:127],a[132:135],a[84:87],v[112:127]
ds_read_b64_tr_b16 a[120:121],v200 offset:26624
ds_read_b64_tr_b16 a[122:123],v200 offset:26880
s_waitcnt vmcnt(7)
s_barrier
s_waitcnt lgkmcnt(8)
v_mfma_f32_32x32x16_bf16 v[112:127],a[136:139],a[88:91],v[112:127]
ds_read_b64_tr_b16 a[124:125],v200 offset:27648
ds_read_b64_tr_b16 a[126:127],v200 offset:27904
s_add_u32 s30,s100,192
s_add_u32 m0,s60,86016
s_nop 0
buffer_load_dwordx4 v204,s[20:23],s30 offen lds
s_waitcnt lgkmcnt(8)
v_mfma_f32_32x32x16_bf16 v[112:127],a[140:143],a[92:95],v[112:127]
ds_read_b64_tr_b16 a[128:129],v200 offset:28672
ds_read_b64_tr_b16 a[130:131],v200 offset:28928
s_waitcnt lgkmcnt(8)
v_mfma_f32_32x32x16_bf16 v[112:127],a[112:115],a[96:99],v[112:127]
ds_read_b64_tr_b16 a[132:133],v200 offset:29696
ds_read_b64_tr_b16 a[134:135],v200 offset:29952
s_waitcnt lgkmcnt(8)
v_mfma_f32_32x32x16_bf16 v[112:127],a[116:119],a[100:103],v[112:127]
ds_read_b64_tr_b16 a[136:137],v200 offset:30720
ds_read_b64_tr_b16 a[138:139],v200 offset:30976
s_waitcnt lgkmcnt(8)
v_mfma_f32_32x32x16_bf16 v[112:127],a[120:123],a[104:107],v[112:127]
ds_read_b64_tr_b16 a[140:141],v200 offset:31744
ds_read_b64_tr_b16 a[142:143],v200 offset:32000
s_add_u32 s30,s100,57536
s_add_u32 m0,s60,87040
s_nop 0
buffer_load_dwordx4 v204,s[20:23],s30 offen lds
s_waitcnt lgkmcnt(8)
v_mfma_f32_32x32x16_bf16 v[112:127],a[124:127],a[108:111],v[112:127]
ds_read_b64_tr_b16 a[112:113],v200 offset:32768
ds_read_b64_tr_b16 a[114:115],v200 offset:33024
s_waitcnt lgkmcnt(8)
v_mfma_f32_32x32x16_bf16 v[128:143],a[128:131],a[0:3],v[128:143]
ds_read_b64_tr_b16 a[116:117],v200 offset:33792
ds_read_b64_tr_b16 a[118:119],v200 offset:34048
s_waitcnt lgkmcnt(8)
v_mfma_f32_32x32x16_bf16 v[128:143],a[132:135],a[4:7],v[128:143]
ds_read_b64_tr_b16 a[120:121],v200 offset:34816
ds_read_b64_tr_b16 a[122:123],v200 offset:35072
s_waitcnt lgkmcnt(8)
v_mfma_f32_32x32x16_bf16 v[128:143],a[136:139],a[8:11],v[128:143]
ds_read_b64_tr_b16 a[124:125],v200 offset:35840
ds_read_b64_tr_b16 a[126:127],v200 offset:36096
s_add_u32 s30,s100,114880
s_add_u32 m0,s60,88064
s_nop 0
buffer_load_dwordx4 v204,s[20:23],s30 offen lds
v_mul_f32 v144,v112,v112
v_mul_f32 v145,v113,v113
v_mul_f32 v146,v114,v114
v_mul_f32 v147,v115,v115
v_mul_f32 v148,v116,v116
v_mul_f32 v149,v117,v117
s_waitcnt lgkmcnt(8)
v_mfma_f32_32x32x16_bf16 v[128:143],a[140:143],a[12:15],v[128:143]
ds_read_b64_tr_b16 a[128:129],v200 offset:36864
ds_read_b64_tr_b16 a[130:131],v200 offset:37120
v_mul_f32 v150,v118,v118
v_mul_f32 v151,v119,v119
v_fma_f32 v144,v144,s58,v210
v_fma_f32 v145,v145,s58,v210
v_fma_f32 v146,v146,s58,v210
v_fma_f32 v147,v147,s58,v210
s_waitcnt lgkmcnt(8)
v_mfma_f32_32x32x16_bf16 v[128:143],a[112:115],a[16:19],v[128:143]
ds_read_b64_tr_b16 a[132:133],v200 offset:37888
ds_read_b64_tr_b16 a[134:135],v200 offset:38144
v_fma_f32 v148,v148,s58,v210
v_fma_f32 v149,v149,s58,v210
v_fma_f32 v150,v150,s58,v210
v_fma_f32 v151,v151,s58,v210
v_mul_f32 v144,v144,v112
v_mul_f32 v145,v145,v113
s_waitcnt lgkmcnt(8)
v_mfma_f32_32x32x16_bf16 v[128:143],a[116:119],a[20:23],v[128:143]
ds_read_b64_tr_b16 a[136:137],v200 offset:38912
ds_read_b64_tr_b16 a[138:139],v200 offset:39168
v_mul_f32 v146,v146,v114
v_mul_f32 v147,v147,v115
v_mul_f32 v148,v148,v116
v_mul_f32 v149,v149,v117
v_mul_f32 v150,v150,v118
v_mul_f32 v151,v151,v119
s_waitcnt lgkmcnt(8)
v_mfma_f32_32x32x16_bf16 v[128:143],a[120:123],a[24:27],v[128:143]
ds_read_b64_tr_b16 a[140:141],v200 offset:39936
ds_read_b64_tr_b16 a[142:143],v200 offset:40192
s_add_u32 s30,s100,172224
s_add_u32 m0,s60,89088
s_nop 0
buffer_load_dwordx4 v204,s[20:23],s30 offen lds
v_exp_f32 v144,v144
v_exp_f32 v145,v145
v_exp_f32 v146,v146
v_exp_f32 v147,v147
v_exp_f32 v148,v148
s_waitcnt lgkmcnt(8)
v_mfma_f32_32x32x16_bf16 v[128:143],a[124:127],a[28:31],v[128:143]
ds_read_b64_tr_b16 a[112:113],v200 offset:40960
ds_read_b64_tr_b16 a[114:115],v200 offset:41216
v_exp_f32 v149,v149
v_exp_f32 v150,v150
v_exp_f32 v151,v151
v_add_f32 v144,1.0,v144
v_add_f32 v145,1.0,v145
s_waitcnt lgkmcnt(8)
v_mfma_f32_32x32x16_bf16 v[128:143],a[128:131],a[32:35],v[128:143]
ds_read_b64_tr_b16 a[116:117],v200 offset:41984
ds_read_b64_tr_b16 a[118:119],v200 offset:42240
v_add_f32 v146,1.0,v146
v_add_f32 v147,1.0,v147
v_add_f32 v148,1.0,v148
v_add_f32 v149,1.0,v149
v_add_f32 v150,1.0,v150
s_waitcnt lgkmcnt(8)
v_mfma_f32_32x32x16_bf16 v[128:143],a[132:135],a[36:39],v[128:143]
ds_read_b64_tr_b16 a[120:121],v200 offset:43008
ds_read_b64_tr_b16 a[122:123],v200 offset:43264
v_add_f32 v151,1.0,v151
v_rcp_f32 v144,v144
v_rcp_f32 v145,v145
v_rcp_f32 v146,v146
v_rcp_f32 v147,v147
s_waitcnt lgkmcnt(8)
v_mfma_f32_32x32x16_bf16 v[128:143],a[136:139],a[40:43],v[128:143]
ds_read_b64_tr_b16 a[124:125],v200 offset:44032
ds_read_b64_tr_b16 a[126:127],v200 offset:44288
s_add_u32 s30,s100,229568
s_add_u32 m0,s60,90112
s_nop 0
buffer_load_dwordx4 v204,s[20:23],s30 offen lds
v_rcp_f32 v148,v148
v_rcp_f32 v149,v149
v_rcp_f32 v150,v150
v_rcp_f32 v151,v151
v_mul_f32 v144,v144,v112
s_waitcnt lgkmcnt(8)
v_mfma_f32_32x32x16_bf16 v[128:143],a[140:143],a[44:47],v[128:143]
ds_read_b64_tr_b16 a[128:129],v200 offset:45056
ds_read_b64_tr_b16 a[130:131],v200 offset:45312
v_mul_f32 v145,v145,v113
v_mul_f32 v146,v146,v114
v_mul_f32 v147,v147,v115
v_mul_f32 v148,v148,v116
v_mul_f32 v149,v149,v117
s_waitcnt lgkmcnt(8)
v_mfma_f32_32x32x16_bf16 v[128:143],a[112:115],a[48:51],v[128:143]
ds_read_b64_tr_b16 a[132:133],v200 offset:46080
ds_read_b64_tr_b16 a[134:135],v200 offset:46336
v_mul_f32 v150,v150,v118
v_mul_f32 v151,v151,v119
v_cvt_pk_bf16_f32 v0,v144,v145
v_cvt_pk_bf16_f32 v1,v146,v147
v_cvt_pk_bf16_f32 v2,v148,v149
s_waitcnt lgkmcnt(8)
v_mfma_f32_32x32x16_bf16 v[128:143],a[116:119],a[52:55],v[128:143]
ds_read_b64_tr_b16 a[136:137],v200 offset:47104
ds_read_b64_tr_b16 a[138:139],v200 offset:47360
v_cvt_pk_bf16_f32 v3,v150,v151
v_mul_f32 v144,v120,v120
v_mul_f32 v145,v121,v121
v_mul_f32 v146,v122,v122
v_mul_f32 v147,v123,v123
s_waitcnt lgkmcnt(8)
v_mfma_f32_32x32x16_bf16 v[128:143],a[120:123],a[56:59],v[128:143]
ds_read_b64_tr_b16 a[140:141],v200 offset:48128
ds_read_b64_tr_b16 a[142:143],v200 offset:48384
s_add_u32 s30,s100,286912
s_add_u32 m0,s60,91136
s_nop 0
buffer_load_dwordx4 v204,s[20:23],s30 offen lds
v_mul_f32 v148,v124,v124
v_mul_f32 v149,v125,v125
v_mul_f32 v150,v126,v126
v_mul_f32 v151,v127,v127
v_fma_f32 v144,v144,s58,v210
s_waitcnt lgkmcnt(8)
v_mfma_f32_32x32x16_bf16 v[128:143],a[124:127],a[60:63],v[128:143]
ds_read_b64_tr_b16 a[112:113],v200 offset:49152
ds_read_b64_tr_b16 a[114:115],v200 offset:49408
v_fma_f32 v145,v145,s58,v210
v_fma_f32 v146,v146,s58,v210
v_fma_f32 v147,v147,s58,v210
v_fma_f32 v148,v148,s58,v210
v_fma_f32 v149,v149,s58,v210
s_waitcnt lgkmcnt(8)
v_mfma_f32_32x32x16_bf16 v[128:143],a[128:131],a[64:67],v[128:143]
ds_read_b64_tr_b16 a[116:117],v200 offset:50176
ds_read_b64_tr_b16 a[118:119],v200 offset:50432
v_fma_f32 v150,v150,s58,v210
v_fma_f32 v151,v151,s58,v210
v_mul_f32 v144,v144,v120
v_mul_f32 v145,v145,v121
v_mul_f32 v146,v146,v122
s_waitcnt lgkmcnt(8)
v_mfma_f32_32x32x16_bf16 v[128:143],a[132:135],a[68:71],v[128:143]
ds_read_b64_tr_b16 a[120:121],v200 offset:51200
ds_read_b64_tr_b16 a[122:123],v200 offset:51456
v_mul_f32 v147,v147,v123
v_mul_f32 v148,v148,v124
v_mul_f32 v149,v149,v125
v_mul_f32 v150,v150,v126
v_mul_f32 v151,v151,v127
s_waitcnt lgkmcnt(8)
v_mfma_f32_32x32x16_bf16 v[128:143],a[136:139],a[72:75],v[128:143]
ds_read_b64_tr_b16 a[124:125],v200 offset:52224
ds_read_b64_tr_b16 a[126:127],v200 offset:52480
s_add_u32 s30,s100,344256
s_add_u32 m0,s60,92160
s_nop 0
buffer_load_dwordx4 v204,s[20:23],s30 offen lds
v_exp_f32 v144,v144
v_exp_f32 v145,v145
v_exp_f32 v146,v146
v_exp_f32 v147,v147
v_exp_f32 v148,v148
s_waitcnt lgkmcnt(8)
v_mfma_f32_32x32x16_bf16 v[128:143],a[140:143],a[76:79],v[128:143]
ds_read_b64_tr_b16 a[128:129],v200 offset:53248
ds_read_b64_tr_b16 a[130:131],v200 offset:53504
v_exp_f32 v149,v149
v_exp_f32 v150,v150
v_exp_f32 v151,v151
v_add_f32 v144,1.0,v144
v_add_f32 v145,1.0,v145
s_waitcnt lgkmcnt(8)
v_mfma_f32_32x32x16_bf16 v[128:143],a[112:115],a[80:83],v[128:143]
ds_read_b64_tr_b16 a[132:133],v200 offset:54272
ds_read_b64_tr_b16 a[134:135],v200 offset:54528
v_add_f32 v146,1.0,v146
v_add_f32 v147,1.0,v147
v_add_f32 v148,1.0,v148
v_add_f32 v149,1.0,v149
v_add_f32 v150,1.0,v150
s_waitcnt lgkmcnt(8)
v_mfma_f32_32x32x16_bf16 v[128:143],a[116:119],a[84:87],v[128:143]
ds_read_b64_tr_b16 a[136:137],v200 offset:55296
ds_read_b64_tr_b16 a[138:139],v200 offset:55552
v_add_f32 v151,1.0,v151
v_rcp_f32 v144,v144
v_rcp_f32 v145,v145
v_rcp_f32 v146,v146
v_rcp_f32 v147,v147
s_waitcnt vmcnt(7)
s_barrier
s_waitcnt lgkmcnt(8)
v_mfma_f32_32x32x16_bf16 v[128:143],a[120:123],a[88:91],v[128:143]
ds_read_b64_tr_b16 a[140:141],v200 offset:56320
ds_read_b64_tr_b16 a[142:143],v200 offset:56576
s_add_u32 s30,s100,256
s_add_u32 m0,s60,0
s_nop 0
buffer_load_dwordx4 v204,s[20:23],s30 offen lds
v_rcp_f32 v148,v148
v_rcp_f32 v149,v149
v_rcp_f32 v150,v150
v_rcp_f32 v151,v151
v_mul_f32 v144,v144,v120
s_waitcnt lgkmcnt(8)
v_mfma_f32_32x32x16_bf16 v[128:143],a[124:127],a[92:95],v[128:143]
ds_read_b64_tr_b16 a[112:113],v201 offset:0
ds_read_b64_tr_b16 a[114:115],v201 offset:256
v_mul_f32 v145,v145,v121
v_mul_f32 v146,v146,v122
v_mul_f32 v147,v147,v123
v_mul_f32 v148,v148,v124
v_mul_f32 v149,v149,v125
s_waitcnt lgkmcnt(8)
v_mfma_f32_32x32x16_bf16 v[128:143],a[128:131],a[96:99],v[128:143]
ds_read_b64_tr_b16 a[116:117],v201 offset:1024
ds_read_b64_tr_b16 a[118:119],v201 offset:1280
v_mul_f32 v150,v150,v126
v_mul_f32 v151,v151,v127
v_cvt_pk_bf16_f32 v4,v144,v145
v_cvt_pk_bf16_f32 v5,v146,v147
v_cvt_pk_bf16_f32 v6,v148,v149
s_waitcnt lgkmcnt(8)
v_mfma_f32_32x32x16_bf16 v[128:143],a[132:135],a[100:103],v[128:143]
ds_read_b64_tr_b16 a[120:121],v201 offset:2048
ds_read_b64_tr_b16 a[122:123],v201 offset:2304
v_cvt_pk_bf16_f32 v7,v150,v151
ds_read_b128 v[112:115],v220 offset:256
ds_read_b128 v[116:119],v220 offset:288
ds_read_b128 v[120:123],v220 offset:320
ds_read_b128 v[124:127],v220 offset:352
s_waitcnt lgkmcnt(12)
v_mfma_f32_32x32x16_bf16 v[128:143],a[136:139],a[104:107],v[128:143]
ds_read_b64_tr_b16 a[124:125],v201 offset:3072
ds_read_b64_tr_b16 a[126:127],v201 offset:3328
s_add_u32 s30,s100,57600
s_add_u32 m0,s60,1024
s_nop 0
buffer_load_dwordx4 v204,s[20:23],s30 offen lds
s_waitcnt lgkmcnt(12)
v_mfma_f32_32x32x16_bf16 v[128:143],a[140:143],a[108:111],v[128:143]
ds_read_b64_tr_b16 a[128:129],v201 offset:4096
ds_read_b64_tr_b16 a[130:131],v201 offset:4352
s_waitcnt lgkmcnt(4)
v_mfma_f32_32x32x16_bf16 v[112:127],a[112:115],a[0:3],v[112:127]
ds_read_b64_tr_b16 a[132:133],v201 offset:5120
ds_read_b64_tr_b16 a[134:135],v201 offset:5376
v_mfma_f32_32x32x16_bf16 v[112:127],a[116:119],a[4:7],v[112:127]
ds_read_b64_tr_b16 a[136:137],v201 offset:6144
ds_read_b64_tr_b16 a[138:139],v201 offset:6400
v_mfma_f32_32x32x16_bf16 v[112:127],a[120:123],a[8:11],v[112:127]
ds_read_b64_tr_b16 a[140:141],v201 offset:7168
ds_read_b64_tr_b16 a[142:143],v201 offset:7424
s_add_u32 s30,s100,114944
s_add_u32 m0,s60,2048
s_nop 0
buffer_load_dwordx4 v204,s[20:23],s30 offen lds
v_mul_f32 v144,v128,v128
v_mul_f32 v145,v129,v129
v_mul_f32 v146,v130,v130
v_mul_f32 v147,v131,v131
v_mul_f32 v148,v132,v132
v_mul_f32 v149,v133,v133
s_waitcnt lgkmcnt(8)
v_mfma_f32_32x32x16_bf16 v[112:127],a[124:127],a[12:15],v[112:127]
ds_read_b64_tr_b16 a[112:113],v201 offset:8192
ds_read_b64_tr_b16 a[114:115],v201 offset:8448
v_mul_f32 v150,v134,v134
v_mul_f32 v151,v135,v135
v_fma_f32 v144,v144,s58,v210
v_fma_f32 v145,v145,s58,v210
v_fma_f32 v146,v146,s58,v210
v_fma_f32 v147,v147,s58,v210
s_waitcnt lgkmcnt(8)
v_mfma_f32_32x32x16_bf16 v[112:127],a[128:131],a[16:19],v[112:127]
ds_read_b64_tr_b16 a[116:117],v201 offset:9216
ds_read_b64_tr_b16 a[118:119],v201 offset:9472
v_fma_f32 v148,v148,s58,v210
v_fma_f32 v149,v149,s58,v210
v_fma_f32 v150,v150,s58,v210
v_fma_f32 v151,v151,s58,v210
v_mul_f32 v144,v144,v128
v_mul_f32 v145,v145,v129
s_waitcnt lgkmcnt(8)
v_mfma_f32_32x32x16_bf16 v[112:127],a[132:135],a[20:23],v[112:127]
ds_read_b64_tr_b16 a[120:121],v201 offset:10240
ds_read_b64_tr_b16 a[122:123],v201 offset:10496
v_mul_f32 v146,v146,v130
v_mul_f32 v147,v147,v131
v_mul_f32 v148,v148,v132
v_mul_f32 v149,v149,v133
v_mul_f32 v150,v150,v134
v_mul_f32 v151,v151,v135
s_waitcnt lgkmcnt(8)
v_mfma_f32_32x32x16_bf16 v[112:127],a[136:139],a[24:27],v[112:127]
ds_read_b64_tr_b16 a[124:125],v201 offset:11264
ds_read_b64_tr_b16 a[126:127],v201 offset:11520
s_add_u32 s30,s100,172288
s_add_u32 m0,s60,3072
s_nop 0
buffer_load_dwordx4 v204,s[20:23],s30 offen lds
v_exp_f32 v144,v144
v_exp_f32 v145,v145
v_exp_f32 v146,v146
v_exp_f32 v147,v147
v_exp_f32 v148,v148
s_waitcnt lgkmcnt(8)
v_mfma_f32_32x32x16_bf16 v[112:127],a[140:143],a[28:31],v[112:127]
ds_read_b64_tr_b16 a[128:129],v201 offset:12288
ds_read_b64_tr_b16 a[130:131],v201 offset:12544
v_exp_f32 v149,v149
v_exp_f32 v150,v150
v_exp_f32 v151,v151
v_add_f32 v144,1.0,v144
v_add_f32 v145,1.0,v145
s_waitcnt lgkmcnt(8)
v_mfma_f32_32x32x16_bf16 v[112:127],a[112:115],a[32:35],v[112:127]
ds_read_b64_tr_b16 a[132:133],v201 offset:13312
ds_read_b64_tr_b16 a[134:135],v201 offset:13568
v_add_f32 v146,1.0,v146
v_add_f32 v147,1.0,v147
v_add_f32 v148,1.0,v148
v_add_f32 v149,1.0,v149
v_add_f32 v150,1.0,v150
s_waitcnt lgkmcnt(8)
v_mfma_f32_32x32x16_bf16 v[112:127],a[116:119],a[36:39],v[112:127]
ds_read_b64_tr_b16 a[136:137],v201 offset:14336
ds_read_b64_tr_b16 a[138:139],v201 offset:14592
v_add_f32 v151,1.0,v151
v_rcp_f32 v144,v144
v_rcp_f32 v145,v145
v_rcp_f32 v146,v146
v_rcp_f32 v147,v147
s_waitcnt lgkmcnt(8)
v_mfma_f32_32x32x16_bf16 v[112:127],a[120:123],a[40:43],v[112:127]
ds_read_b64_tr_b16 a[140:141],v201 offset:15360
ds_read_b64_tr_b16 a[142:143],v201 offset:15616
s_add_u32 s30,s100,229632
s_add_u32 m0,s60,4096
s_nop 0
buffer_load_dwordx4 v204,s[20:23],s30 offen lds
v_rcp_f32 v148,v148
v_rcp_f32 v149,v149
v_rcp_f32 v150,v150
v_rcp_f32 v151,v151
v_mul_f32 v144,v144,v128
s_waitcnt lgkmcnt(8)
v_mfma_f32_32x32x16_bf16 v[112:127],a[124:127],a[44:47],v[112:127]
ds_read_b64_tr_b16 a[112:113],v201 offset:16384
ds_read_b64_tr_b16 a[114:115],v201 offset:16640
v_mul_f32 v145,v145,v129
v_mul_f32 v146,v146,v130
v_mul_f32 v147,v147,v131
v_mul_f32 v148,v148,v132
v_mul_f32 v149,v149,v133
s_waitcnt lgkmcnt(8)
v_mfma_f32_32x32x16_bf16 v[112:127],a[128:131],a[48:51],v[112:127]
ds_read_b64_tr_b16 a[116:117],v201 offset:17408
ds_read_b64_tr_b16 a[118:119],v201 offset:17664
v_mul_f32 v150,v150,v134
v_mul_f32 v151,v151,v135
v_cvt_pk_bf16_f32 v8,v144,v145
v_cvt_pk_bf16_f32 v9,v146,v147
v_cvt_pk_bf16_f32 v10,v148,v149
s_waitcnt lgkmcnt(8)
v_mfma_f32_32x32x16_bf16 v[112:127],a[132:135],a[52:55],v[112:127]
ds_read_b64_tr_b16 a[120:121],v201 offset:18432
ds_read_b64_tr_b16 a[122:123],v201 offset:18688
v_cvt_pk_bf16_f32 v11,v150,v151
v_mul_f32 v144,v136,v136
v_mul_f32 v145,v137,v137
v_mul_f32 v146,v138,v138
v_mul_f32 v147,v139,v139
s_waitcnt lgkmcnt(8)
v_mfma_f32_32x32x16_bf16 v[112:127],a[136:139],a[56:59],v[112:127]
ds_read_b64_tr_b16 a[124:125],v201 offset:19456
ds_read_b64_tr_b16 a[126:127],v201 offset:19712
s_add_u32 s30,s100,286976
s_add_u32 m0,s60,5120
s_nop 0
buffer_load_dwordx4 v204,s[20:23],s30 offen lds
v_mul_f32 v148,v140,v140
v_mul_f32 v149,v141,v141
v_mul_f32 v150,v142,v142
v_mul_f32 v151,v143,v143
v_fma_f32 v144,v144,s58,v210
s_waitcnt lgkmcnt(8)
v_mfma_f32_32x32x16_bf16 v[112:127],a[140:143],a[60:63],v[112:127]
ds_read_b64_tr_b16 a[128:129],v201 offset:20480
ds_read_b64_tr_b16 a[130:131],v201 offset:20736
v_fma_f32 v145,v145,s58,v210
v_fma_f32 v146,v146,s58,v210
v_fma_f32 v147,v147,s58,v210
v_fma_f32 v148,v148,s58,v210
v_fma_f32 v149,v149,s58,v210
s_waitcnt lgkmcnt(8)
v_mfma_f32_32x32x16_bf16 v[112:127],a[112:115],a[64:67],v[112:127]
ds_read_b64_tr_b16 a[132:133],v201 offset:21504
ds_read_b64_tr_b16 a[134:135],v201 offset:21760
v_fma_f32 v150,v150,s58,v210
v_fma_f32 v151,v151,s58,v210
v_mul_f32 v144,v144,v136
v_mul_f32 v145,v145,v137
v_mul_f32 v146,v146,v138
s_waitcnt lgkmcnt(8)
v_mfma_f32_32x32x16_bf16 v[112:127],a[116:119],a[68:71],v[112:127]
ds_read_b64_tr_b16 a[136:137],v201 offset:22528
ds_read_b64_tr_b16 a[138:139],v201 offset:22784
v_mul_f32 v147,v147,v139
v_mul_f32 v148,v148,v140
v_mul_f32 v149,v149,v141
v_mul_f32 v150,v150,v142
v_mul_f32 v151,v151,v143
s_waitcnt lgkmcnt(8)
v_mfma_f32_32x32x16_bf16 v[112:127],a[120:123],a[72:75],v[112:127]
ds_read_b64_tr_b16 a[140:141],v201 offset:23552
ds_read_b64_tr_b16 a[142:143],v201 offset:23808
s_add_u32 s30,s100,344320
s_add_u32 m0,s60,6144
s_nop 0
buffer_load_dwordx4 v204,s[20:23],s30 offen lds
v_exp_f32 v144,v144
v_exp_f32 v145,v145
v_exp_f32 v146,v146
v_exp_f32 v147,v147
v_exp_f32 v148,v148
s_waitcnt lgkmcnt(8)
v_mfma_f32_32x32x16_bf16 v[112:127],a[124:127],a[76:79],v[112:127]
ds_read_b64_tr_b16 a[112:113],v201 offset:24576
ds_read_b64_tr_b16 a[114:115],v201 offset:24832
v_exp_f32 v149,v149
v_exp_f32 v150,v150
v_exp_f32 v151,v151
v_add_f32 v144,1.0,v144
v_add_f32 v145,1.0,v145
s_waitcnt lgkmcnt(8)
v_mfma_f32_32x32x16_bf16 v[112:127],a[128:131],a[80:83],v[112:127]
ds_read_b64_tr_b16 a[116:117],v201 offset:25600
ds_read_b64_tr_b16 a[118:119],v201 offset:25856
v_add_f32 v146,1.0,v146
v_add_f32 v147,1.0,v147
v_add_f32 v148,1.0,v148
v_add_f32 v149,1.0,v149
v_add_f32 v150,1.0,v150
s_waitcnt lgkmcnt(8)
v_mfma_f32_32x32x16_bf16 v[112:127],a[132:135],a[84:87],v[112:127]
ds_read_b64_tr_b16 a[120:121],v201 offset:26624
ds_read_b64_tr_b16 a[122:123],v201 offset:26880
v_add_f32 v151,1.0,v151
v_rcp_f32 v144,v144
v_rcp_f32 v145,v145
v_rcp_f32 v146,v146
v_rcp_f32 v147,v147
s_waitcnt vmcnt(7)
s_barrier
s_waitcnt lgkmcnt(8)
v_mfma_f32_32x32x16_bf16 v[112:127],a[136:139],a[88:91],v[112:127]
ds_read_b64_tr_b16 a[124:125],v201 offset:27648
ds_read_b64_tr_b16 a[126:127],v201 offset:27904
s_add_u32 s30,s100,320
s_add_u32 m0,s60,28672
s_nop 0
buffer_load_dwordx4 v204,s[20:23],s30 offen lds
v_rcp_f32 v148,v148
v_rcp_f32 v149,v149
v_rcp_f32 v150,v150
v_rcp_f32 v151,v151
v_mul_f32 v144,v144,v136
s_waitcnt lgkmcnt(8)
v_mfma_f32_32x32x16_bf16 v[112:127],a[140:143],a[92:95],v[112:127]
ds_read_b64_tr_b16 a[128:129],v201 offset:28672
ds_read_b64_tr_b16 a[130:131],v201 offset:28928
v_mul_f32 v145,v145,v137
v_mul_f32 v146,v146,v138
v_mul_f32 v147,v147,v139
v_mul_f32 v148,v148,v140
v_mul_f32 v149,v149,v141
s_waitcnt lgkmcnt(8)
v_mfma_f32_32x32x16_bf16 v[112:127],a[112:115],a[96:99],v[112:127]
ds_read_b64_tr_b16 a[132:133],v201 offset:29696
ds_read_b64_tr_b16 a[134:135],v201 offset:29952
v_mul_f32 v150,v150,v142
v_mul_f32 v151,v151,v143
v_cvt_pk_bf16_f32 v12,v144,v145
v_cvt_pk_bf16_f32 v13,v146,v147
v_cvt_pk_bf16_f32 v14,v148,v149
s_waitcnt lgkmcnt(8)
v_mfma_f32_32x32x16_bf16 v[112:127],a[116:119],a[100:103],v[112:127]
ds_read_b64_tr_b16 a[136:137],v201 offset:30720
ds_read_b64_tr_b16 a[138:139],v201 offset:30976
v_cvt_pk_bf16_f32 v15,v150,v151
ds_read_b128 v[128:131],v220 offset:384
ds_read_b128 v[132:135],v220 offset:416
ds_read_b128 v[136:139],v220 offset:448
ds_read_b128 v[140:143],v220 offset:480
s_waitcnt lgkmcnt(12)
v_mfma_f32_32x32x16_bf16 v[112:127],a[120:123],a[104:107],v[112:127]
ds_read_b64_tr_b16 a[140:141],v201 offset:31744
ds_read_b64_tr_b16 a[142:143],v201 offset:32000
s_add_u32 s30,s100,57664
s_add_u32 m0,s60,29696
s_nop 0
buffer_load_dwordx4 v204,s[20:23],s30 offen lds
s_waitcnt lgkmcnt(12)
v_mfma_f32_32x32x16_bf16 v[112:127],a[124:127],a[108:111],v[112:127]
ds_read_b64_tr_b16 a[112:113],v201 offset:32768
ds_read_b64_tr_b16 a[114:115],v201 offset:33024
s_waitcnt lgkmcnt(4)
v_mfma_f32_32x32x16_bf16 v[128:143],a[128:131],a[0:3],v[128:143]
ds_read_b64_tr_b16 a[116:117],v201 offset:33792
ds_read_b64_tr_b16 a[118:119],v201 offset:34048
v_mfma_f32_32x32x16_bf16 v[128:143],a[132:135],a[4:7],v[128:143]
ds_read_b64_tr_b16 a[120:121],v201 offset:34816
ds_read_b64_tr_b16 a[122:123],v201 offset:35072
v_mfma_f32_32x32x16_bf16 v[128:143],a[136:139],a[8:11],v[128:143]
ds_read_b64_tr_b16 a[124:125],v201 offset:35840
ds_read_b64_tr_b16 a[126:127],v201 offset:36096
s_add_u32 s30,s100,115008
s_add_u32 m0,s60,30720
s_nop 0
buffer_load_dwordx4 v204,s[20:23],s30 offen lds
v_mul_f32 v144,v112,v112
v_mul_f32 v145,v113,v113
v_mul_f32 v146,v114,v114
v_mul_f32 v147,v115,v115
v_mul_f32 v148,v116,v116
v_mul_f32 v149,v117,v117
s_waitcnt lgkmcnt(8)
v_mfma_f32_32x32x16_bf16 v[128:143],a[140:143],a[12:15],v[128:143]
ds_read_b64_tr_b16 a[128:129],v201 offset:36864
ds_read_b64_tr_b16 a[130:131],v201 offset:37120
v_mul_f32 v150,v118,v118
v_mul_f32 v151,v119,v119
v_fma_f32 v144,v144,s58,v210
v_fma_f32 v145,v145,s58,v210
v_fma_f32 v146,v146,s58,v210
v_fma_f32 v147,v147,s58,v210
s_waitcnt lgkmcnt(8)
v_mfma_f32_32x32x16_bf16 v[128:143],a[112:115],a[16:19],v[128:143]
ds_read_b64_tr_b16 a[132:133],v201 offset:37888
ds_read_b64_tr_b16 a[134:135],v201 offset:38144
v_fma_f32 v148,v148,s58,v210
v_fma_f32 v149,v149,s58,v210
v_fma_f32 v150,v150,s58,v210
v_fma_f32 v151,v151,s58,v210
v_mul_f32 v144,v144,v112
v_mul_f32 v145,v145,v113
s_waitcnt lgkmcnt(8)
v_mfma_f32_32x32x16_bf16 v[128:143],a[116:119],a[20:23],v[128:143]
ds_read_b64_tr_b16 a[136:137],v201 offset:38912
ds_read_b64_tr_b16 a[138:139],v201 offset:39168
v_mul_f32 v146,v146,v114
v_mul_f32 v147,v147,v115
v_mul_f32 v148,v148,v116
v_mul_f32 v149,v149,v117
v_mul_f32 v150,v150,v118
v_mul_f32 v151,v151,v119
s_waitcnt lgkmcnt(8)
v_mfma_f32_32x32x16_bf16 v[128:143],a[120:123],a[24:27],v[128:143]
ds_read_b64_tr_b16 a[140:141],v201 offset:39936
ds_read_b64_tr_b16 a[142:143],v201 offset:40192
s_add_u32 s30,s100,172352
s_add_u32 m0,s60,31744
s_nop 0
buffer_load_dwordx4 v204,s[20:23],s30 offen lds
v_exp_f32 v144,v144
v_exp_f32 v145,v145
v_exp_f32 v146,v146
v_exp_f32 v147,v147
v_exp_f32 v148,v148
s_waitcnt lgkmcnt(8)
v_mfma_f32_32x32x16_bf16 v[128:143],a[124:127],a[28:31],v[128:143]
ds_read_b64_tr_b16 a[112:113],v201 offset:40960
ds_read_b64_tr_b16 a[114:115],v201 offset:41216
v_exp_f32 v149,v149
v_exp_f32 v150,v150
v_exp_f32 v151,v151
v_add_f32 v144,1.0,v144
v_add_f32 v145,1.0,v145
s_waitcnt lgkmcnt(8)
v_mfma_f32_32x32x16_bf16 v[128:143],a[128:131],a[32:35],v[128:143]
ds_read_b64_tr_b16 a[116:117],v201 offset:41984
ds_read_b64_tr_b16 a[118:119],v201 offset:42240
v_add_f32 v146,1.0,v146
v_add_f32 v147,1.0,v147
v_add_f32 v148,1.0,v148
v_add_f32 v149,1.0,v149
v_add_f32 v150,1.0,v150
s_waitcnt lgkmcnt(8)
v_mfma_f32_32x32x16_bf16 v[128:143],a[132:135],a[36:39],v[128:143]
ds_read_b64_tr_b16 a[120:121],v201 offset:43008
ds_read_b64_tr_b16 a[122:123],v201 offset:43264
v_add_f32 v151,1.0,v151
v_rcp_f32 v144,v144
v_rcp_f32 v145,v145
v_rcp_f32 v146,v146
v_rcp_f32 v147,v147
s_waitcnt lgkmcnt(8)
v_mfma_f32_32x32x16_bf16 v[128:143],a[136:139],a[40:43],v[128:143]
ds_read_b64_tr_b16 a[124:125],v201 offset:44032
ds_read_b64_tr_b16 a[126:127],v201 offset:44288
s_add_u32 s30,s100,229696
s_add_u32 m0,s60,32768
s_nop 0
buffer_load_dwordx4 v204,s[20:23],s30 offen lds
v_rcp_f32 v148,v148
v_rcp_f32 v149,v149
v_rcp_f32 v150,v150
v_rcp_f32 v151,v151
v_mul_f32 v144,v144,v112
s_waitcnt lgkmcnt(8)
v_mfma_f32_32x32x16_bf16 v[128:143],a[140:143],a[44:47],v[128:143]
ds_read_b64_tr_b16 a[128:129],v201 offset:45056
ds_read_b64_tr_b16 a[130:131],v201 offset:45312
v_mul_f32 v145,v145,v113
v_mul_f32 v146,v146,v114
v_mul_f32 v147,v147,v115
v_mul_f32 v148,v148,v116
v_mul_f32 v149,v149,v117
s_waitcnt lgkmcnt(8)
v_mfma_f32_32x32x16_bf16 v[128:143],a[112:115],a[48:51],v[128:143]
ds_read_b64_tr_b16 a[132:133],v201 offset:46080
ds_read_b64_tr_b16 a[134:135],v201 offset:46336
v_mul_f32 v150,v150,v118
v_mul_f32 v151,v151,v119
v_cvt_pk_bf16_f32 v16,v144,v145
v_cvt_pk_bf16_f32 v17,v146,v147
v_cvt_pk_bf16_f32 v18,v148,v149
s_waitcnt lgkmcnt(8)
v_mfma_f32_32x32x16_bf16 v[128:143],a[116:119],a[52:55],v[128:143]
ds_read_b64_tr_b16 a[136:137],v201 offset:47104
ds_read_b64_tr_b16 a[138:139],v201 offset:47360
v_cvt_pk_bf16_f32 v19,v150,v151
v_mul_f32 v144,v120,v120
v_mul_f32 v145,v121,v121
v_mul_f32 v146,v122,v122
v_mul_f32 v147,v123,v123
s_waitcnt lgkmcnt(8)
v_mfma_f32_32x32x16_bf16 v[128:143],a[120:123],a[56:59],v[128:143]
ds_read_b64_tr_b16 a[140:141],v201 offset:48128
ds_read_b64_tr_b16 a[142:143],v201 offset:48384
s_add_u32 s30,s100,287040
s_add_u32 m0,s60,33792
s_nop 0
buffer_load_dwordx4 v204,s[20:23],s30 offen lds
v_mul_f32 v148,v124,v124
v_mul_f32 v149,v125,v125
v_mul_f32 v150,v126,v126
v_mul_f32 v151,v127,v127
v_fma_f32 v144,v144,s58,v210
s_waitcnt lgkmcnt(8)
v_mfma_f32_32x32x16_bf16 v[128:143],a[124:127],a[60:63],v[128:143]
ds_read_b64_tr_b16 a[112:113],v201 offset:49152
ds_read_b64_tr_b16 a[114:115],v201 offset:49408
v_fma_f32 v145,v145,s58,v210
v_fma_f32 v146,v146,s58,v210
v_fma_f32 v147,v147,s58,v210
v_fma_f32 v148,v148,s58,v210
v_fma_f32 v149,v149,s58,v210
s_waitcnt lgkmcnt(8)
v_mfma_f32_32x32x16_bf16 v[128:143],a[128:131],a[64:67],v[128:143]
ds_read_b64_tr_b16 a[116:117],v201 offset:50176
ds_read_b64_tr_b16 a[118:119],v201 offset:50432
v_fma_f32 v150,v150,s58,v210
v_fma_f32 v151,v151,s58,v210
v_mul_f32 v144,v144,v120
v_mul_f32 v145,v145,v121
v_mul_f32 v146,v146,v122
s_waitcnt lgkmcnt(8)
v_mfma_f32_32x32x16_bf16 v[128:143],a[132:135],a[68:71],v[128:143]
ds_read_b64_tr_b16 a[120:121],v201 offset:51200
ds_read_b64_tr_b16 a[122:123],v201 offset:51456
v_mul_f32 v147,v147,v123
v_mul_f32 v148,v148,v124
v_mul_f32 v149,v149,v125
v_mul_f32 v150,v150,v126
v_mul_f32 v151,v151,v127
s_waitcnt lgkmcnt(8)
v_mfma_f32_32x32x16_bf16 v[128:143],a[136:139],a[72:75],v[128:143]
ds_read_b64_tr_b16 a[124:125],v201 offset:52224
ds_read_b64_tr_b16 a[126:127],v201 offset:52480
s_add_u32 s30,s100,344384
s_add_u32 m0,s60,34816
s_nop 0
buffer_load_dwordx4 v204,s[20:23],s30 offen lds
v_exp_f32 v144,v144
v_exp_f32 v145,v145
v_exp_f32 v146,v146
v_exp_f32 v147,v147
v_exp_f32 v148,v148
s_waitcnt lgkmcnt(8)
v_mfma_f32_32x32x16_bf16 v[128:143],a[140:143],a[76:79],v[128:143]
ds_read_b64_tr_b16 a[128:129],v201 offset:53248
ds_read_b64_tr_b16 a[130:131],v201 offset:53504
v_exp_f32 v149,v149
v_exp_f32 v150,v150
v_exp_f32 v151,v151
v_add_f32 v144,1.0,v144
v_add_f32 v145,1.0,v145
s_waitcnt lgkmcnt(8)
v_mfma_f32_32x32x16_bf16 v[128:143],a[112:115],a[80:83],v[128:143]
ds_read_b64_tr_b16 a[132:133],v201 offset:54272
ds_read_b64_tr_b16 a[134:135],v201 offset:54528
v_add_f32 v146,1.0,v146
v_add_f32 v147,1.0,v147
v_add_f32 v148,1.0,v148
v_add_f32 v149,1.0,v149
v_add_f32 v150,1.0,v150
s_waitcnt lgkmcnt(8)
v_mfma_f32_32x32x16_bf16 v[128:143],a[116:119],a[84:87],v[128:143]
ds_read_b64_tr_b16 a[136:137],v201 offset:55296
ds_read_b64_tr_b16 a[138:139],v201 offset:55552
v_add_f32 v151,1.0,v151
v_rcp_f32 v144,v144
v_rcp_f32 v145,v145
v_rcp_f32 v146,v146
v_rcp_f32 v147,v147
s_waitcnt vmcnt(7)
s_barrier
s_waitcnt lgkmcnt(8)
v_mfma_f32_32x32x16_bf16 v[128:143],a[120:123],a[88:91],v[128:143]
ds_read_b64_tr_b16 a[140:141],v201 offset:56320
ds_read_b64_tr_b16 a[142:143],v201 offset:56576
s_add_u32 s30,s100,384
s_add_u32 m0,s60,57344
s_nop 0
buffer_load_dwordx4 v204,s[20:23],s30 offen lds
v_rcp_f32 v148,v148
v_rcp_f32 v149,v149
v_rcp_f32 v150,v150
v_rcp_f32 v151,v151
v_mul_f32 v144,v144,v120
s_waitcnt lgkmcnt(8)
v_mfma_f32_32x32x16_bf16 v[128:143],a[124:127],a[92:95],v[128:143]
ds_read_b64_tr_b16 a[112:113],v200 offset:0
ds_read_b64_tr_b16 a[114:115],v200 offset:256
v_mul_f32 v145,v145,v121
v_mul_f32 v146,v146,v122
v_mul_f32 v147,v147,v123
v_mul_f32 v148,v148,v124
v_mul_f32 v149,v149,v125
s_waitcnt lgkmcnt(8)
v_mfma_f32_32x32x16_bf16 v[128:143],a[128:131],a[96:99],v[128:143]
ds_read_b64_tr_b16 a[116:117],v200 offset:1024
ds_read_b64_tr_b16 a[118:119],v200 offset:1280
v_mul_f32 v150,v150,v126
v_mul_f32 v151,v151,v127
v_cvt_pk_bf16_f32 v20,v144,v145
v_cvt_pk_bf16_f32 v21,v146,v147
v_cvt_pk_bf16_f32 v22,v148,v149
s_waitcnt lgkmcnt(8)
v_mfma_f32_32x32x16_bf16 v[128:143],a[132:135],a[100:103],v[128:143]
ds_read_b64_tr_b16 a[120:121],v200 offset:2048
ds_read_b64_tr_b16 a[122:123],v200 offset:2304
v_cvt_pk_bf16_f32 v23,v150,v151
ds_read_b128 v[112:115],v220 offset:512
ds_read_b128 v[116:119],v220 offset:544
ds_read_b128 v[120:123],v220 offset:576
ds_read_b128 v[124:127],v220 offset:608
s_waitcnt lgkmcnt(12)
v_mfma_f32_32x32x16_bf16 v[128:143],a[136:139],a[104:107],v[128:143]
ds_read_b64_tr_b16 a[124:125],v200 offset:3072
ds_read_b64_tr_b16 a[126:127],v200 offset:3328
s_add_u32 s30,s100,57728
s_add_u32 m0,s60,58368
s_nop 0
buffer_load_dwordx4 v204,s[20:23],s30 offen lds
s_waitcnt lgkmcnt(12)
v_mfma_f32_32x32x16_bf16 v[128:143],a[140:143],a[108:111],v[128:143]
ds_read_b64_tr_b16 a[128:129],v200 offset:4096
ds_read_b64_tr_b16 a[130:131],v200 offset:4352
s_waitcnt lgkmcnt(4)
v_mfma_f32_32x32x16_bf16 v[112:127],a[112:115],a[0:3],v[112:127]
ds_read_b64_tr_b16 a[132:133],v200 offset:5120
ds_read_b64_tr_b16 a[134:135],v200 offset:5376
v_mfma_f32_32x32x16_bf16 v[112:127],a[116:119],a[4:7],v[112:127]
ds_read_b64_tr_b16 a[136:137],v200 offset:6144
ds_read_b64_tr_b16 a[138:139],v200 offset:6400
v_mfma_f32_32x32x16_bf16 v[112:127],a[120:123],a[8:11],v[112:127]
ds_read_b64_tr_b16 a[140:141],v200 offset:7168
ds_read_b64_tr_b16 a[142:143],v200 offset:7424
s_add_u32 s30,s100,115072
s_add_u32 m0,s60,59392
s_nop 0
buffer_load_dwordx4 v204,s[20:23],s30 offen lds
v_mul_f32 v144,v128,v128
v_mul_f32 v145,v129,v129
v_mul_f32 v146,v130,v130
v_mul_f32 v147,v131,v131
v_mul_f32 v148,v132,v132
v_mul_f32 v149,v133,v133
s_waitcnt lgkmcnt(8)
v_mfma_f32_32x32x16_bf16 v[112:127],a[124:127],a[12:15],v[112:127]
ds_read_b64_tr_b16 a[112:113],v200 offset:8192
ds_read_b64_tr_b16 a[114:115],v200 offset:8448
v_mul_f32 v150,v134,v134
v_mul_f32 v151,v135,v135
v_fma_f32 v144,v144,s58,v210
v_fma_f32 v145,v145,s58,v210
v_fma_f32 v146,v146,s58,v210
v_fma_f32 v147,v147,s58,v210
s_waitcnt lgkmcnt(8)
v_mfma_f32_32x32x16_bf16 v[112:127],a[128:131],a[16:19],v[112:127]
ds_read_b64_tr_b16 a[116:117],v200 offset:9216
ds_read_b64_tr_b16 a[118:119],v200 offset:9472
v_fma_f32 v148,v148,s58,v210
v_fma_f32 v149,v149,s58,v210
v_fma_f32 v150,v150,s58,v210
v_fma_f32 v151,v151,s58,v210
v_mul_f32 v144,v144,v128
v_mul_f32 v145,v145,v129
s_waitcnt lgkmcnt(8)
v_mfma_f32_32x32x16_bf16 v[112:127],a[132:135],a[20:23],v[112:127]
ds_read_b64_tr_b16 a[120:121],v200 offset:10240
ds_read_b64_tr_b16 a[122:123],v200 offset:10496
v_mul_f32 v146,v146,v130
v_mul_f32 v147,v147,v131
v_mul_f32 v148,v148,v132
v_mul_f32 v149,v149,v133
v_mul_f32 v150,v150,v134
v_mul_f32 v151,v151,v135
s_waitcnt lgkmcnt(8)
v_mfma_f32_32x32x16_bf16 v[112:127],a[136:139],a[24:27],v[112:127]
ds_read_b64_tr_b16 a[124:125],v200 offset:11264
ds_read_b64_tr_b16 a[126:127],v200 offset:11520
s_add_u32 s30,s100,172416
s_add_u32 m0,s60,60416
s_nop 0
buffer_load_dwordx4 v204,s[20:23],s30 offen lds
v_exp_f32 v144,v144
v_exp_f32 v145,v145
v_exp_f32 v146,v146
v_exp_f32 v147,v147
v_exp_f32 v148,v148
s_waitcnt lgkmcnt(8)
v_mfma_f32_32x32x16_bf16 v[112:127],a[140:143],a[28:31],v[112:127]
ds_read_b64_tr_b16 a[128:129],v200 offset:12288
ds_read_b64_tr_b16 a[130:131],v200 offset:12544
v_exp_f32 v149,v149
v_exp_f32 v150,v150
v_exp_f32 v151,v151
v_add_f32 v144,1.0,v144
v_add_f32 v145,1.0,v145
s_waitcnt lgkmcnt(8)
v_mfma_f32_32x32x16_bf16 v[112:127],a[112:115],a[32:35],v[112:127]
ds_read_b64_tr_b16 a[132:133],v200 offset:13312
ds_read_b64_tr_b16 a[134:135],v200 offset:13568
v_add_f32 v146,1.0,v146
v_add_f32 v147,1.0,v147
v_add_f32 v148,1.0,v148
v_add_f32 v149,1.0,v149
v_add_f32 v150,1.0,v150
s_waitcnt lgkmcnt(8)
v_mfma_f32_32x32x16_bf16 v[112:127],a[116:119],a[36:39],v[112:127]
ds_read_b64_tr_b16 a[136:137],v200 offset:14336
ds_read_b64_tr_b16 a[138:139],v200 offset:14592
v_add_f32 v151,1.0,v151
v_rcp_f32 v144,v144
v_rcp_f32 v145,v145
v_rcp_f32 v146,v146
v_rcp_f32 v147,v147
s_waitcnt lgkmcnt(8)
v_mfma_f32_32x32x16_bf16 v[112:127],a[120:123],a[40:43],v[112:127]
ds_read_b64_tr_b16 a[140:141],v200 offset:15360
ds_read_b64_tr_b16 a[142:143],v200 offset:15616
s_add_u32 s30,s100,229760
s_add_u32 m0,s60,61440
s_nop 0
buffer_load_dwordx4 v204,s[20:23],s30 offen lds
v_rcp_f32 v148,v148
v_rcp_f32 v149,v149
v_rcp_f32 v150,v150
v_rcp_f32 v151,v151
v_mul_f32 v144,v144,v128
s_waitcnt lgkmcnt(8)
v_mfma_f32_32x32x16_bf16 v[112:127],a[124:127],a[44:47],v[112:127]
ds_read_b64_tr_b16 a[112:113],v200 offset:16384
ds_read_b64_tr_b16 a[114:115],v200 offset:16640
v_mul_f32 v145,v145,v129
v_mul_f32 v146,v146,v130
v_mul_f32 v147,v147,v131
v_mul_f32 v148,v148,v132
v_mul_f32 v149,v149,v133
s_waitcnt lgkmcnt(8)
v_mfma_f32_32x32x16_bf16 v[112:127],a[128:131],a[48:51],v[112:127]
ds_read_b64_tr_b16 a[116:117],v200 offset:17408
ds_read_b64_tr_b16 a[118:119],v200 offset:17664
v_mul_f32 v150,v150,v134
v_mul_f32 v151,v151,v135
v_cvt_pk_bf16_f32 v24,v144,v145
v_cvt_pk_bf16_f32 v25,v146,v147
v_cvt_pk_bf16_f32 v26,v148,v149
s_waitcnt lgkmcnt(8)
v_mfma_f32_32x32x16_bf16 v[112:127],a[132:135],a[52:55],v[112:127]
ds_read_b64_tr_b16 a[120:121],v200 offset:18432
ds_read_b64_tr_b16 a[122:123],v200 offset:18688
v_cvt_pk_bf16_f32 v27,v150,v151
v_mul_f32 v144,v136,v136
v_mul_f32 v145,v137,v137
v_mul_f32 v146,v138,v138
v_mul_f32 v147,v139,v139
s_waitcnt lgkmcnt(8)
v_mfma_f32_32x32x16_bf16 v[112:127],a[136:139],a[56:59],v[112:127]
ds_read_b64_tr_b16 a[124:125],v200 offset:19456
ds_read_b64_tr_b16 a[126:127],v200 offset:19712
s_add_u32 s30,s100,287104
s_add_u32 m0,s60,62464
s_nop 0
buffer_load_dwordx4 v204,s[20:23],s30 offen lds
v_mul_f32 v148,v140,v140
v_mul_f32 v149,v141,v141
v_mul_f32 v150,v142,v142
v_mul_f32 v151,v143,v143
v_fma_f32 v144,v144,s58,v210
s_waitcnt lgkmcnt(8)
v_mfma_f32_32x32x16_bf16 v[112:127],a[140:143],a[60:63],v[112:127]
ds_read_b64_tr_b16 a[128:129],v200 offset:20480
ds_read_b64_tr_b16 a[130:131],v200 offset:20736
v_fma_f32 v145,v145,s58,v210
v_fma_f32 v146,v146,s58,v210
v_fma_f32 v147,v147,s58,v210
v_fma_f32 v148,v148,s58,v210
v_fma_f32 v149,v149,s58,v210
s_waitcnt lgkmcnt(8)
v_mfma_f32_32x32x16_bf16 v[112:127],a[112:115],a[64:67],v[112:127]
ds_read_b64_tr_b16 a[132:133],v200 offset:21504
ds_read_b64_tr_b16 a[134:135],v200 offset:21760
v_fma_f32 v150,v150,s58,v210
v_fma_f32 v151,v151,s58,v210
v_mul_f32 v144,v144,v136
v_mul_f32 v145,v145,v137
v_mul_f32 v146,v146,v138
s_waitcnt lgkmcnt(8)
v_mfma_f32_32x32x16_bf16 v[112:127],a[116:119],a[68:71],v[112:127]
ds_read_b64_tr_b16 a[136:137],v200 offset:22528
ds_read_b64_tr_b16 a[138:139],v200 offset:22784
v_mul_f32 v147,v147,v139
v_mul_f32 v148,v148,v140
v_mul_f32 v149,v149,v141
v_mul_f32 v150,v150,v142
v_mul_f32 v151,v151,v143
s_waitcnt lgkmcnt(8)
v_mfma_f32_32x32x16_bf16 v[112:127],a[120:123],a[72:75],v[112:127]
ds_read_b64_tr_b16 a[140:141],v200 offset:23552
ds_read_b64_tr_b16 a[142:143],v200 offset:23808
s_add_u32 s30,s100,344448
s_add_u32 m0,s60,63488
s_nop 0
buffer_load_dwordx4 v204,s[20:23],s30 offen lds
v_exp_f32 v144,v144
v_exp_f32 v145,v145
v_exp_f32 v146,v146
v_exp_f32 v147,v147
v_exp_f32 v148,v148
s_waitcnt lgkmcnt(8)
v_mfma_f32_32x32x16_bf16 v[112:127],a[124:127],a[76:79],v[112:127]
ds_read_b64_tr_b16 a[112:113],v200 offset:24576
ds_read_b64_tr_b16 a[114:115],v200 offset:24832
v_exp_f32 v149,v149
v_exp_f32 v150,v150
v_exp_f32 v151,v151
v_add_f32 v144,1.0,v144
v_add_f32 v145,1.0,v145
s_waitcnt lgkmcnt(8)
v_mfma_f32_32x32x16_bf16 v[112:127],a[128:131],a[80:83],v[112:127]
ds_read_b64_tr_b16 a[116:117],v200 offset:25600
ds_read_b64_tr_b16 a[118:119],v200 offset:25856
v_add_f32 v146,1.0,v146
v_add_f32 v147,1.0,v147
v_add_f32 v148,1.0,v148
v_add_f32 v149,1.0,v149
v_add_f32 v150,1.0,v150
s_waitcnt lgkmcnt(8)
v_mfma_f32_32x32x16_bf16 v[112:127],a[132:135],a[84:87],v[112:127]
ds_read_b64_tr_b16 a[120:121],v200 offset:26624
ds_read_b64_tr_b16 a[122:123],v200 offset:26880
v_add_f32 v151,1.0,v151
v_rcp_f32 v144,v144
v_rcp_f32 v145,v145
v_rcp_f32 v146,v146
v_rcp_f32 v147,v147
s_waitcnt vmcnt(7)
s_barrier
s_waitcnt lgkmcnt(8)
v_mfma_f32_32x32x16_bf16 v[112:127],a[136:139],a[88:91],v[112:127]
ds_read_b64_tr_b16 a[124:125],v200 offset:27648
ds_read_b64_tr_b16 a[126:127],v200 offset:27904
s_add_u32 s30,s100,448
s_add_u32 m0,s60,86016
s_nop 0
buffer_load_dwordx4 v204,s[20:23],s30 offen lds
v_rcp_f32 v148,v148
v_rcp_f32 v149,v149
v_rcp_f32 v150,v150
v_rcp_f32 v151,v151
v_mul_f32 v144,v144,v136
s_waitcnt lgkmcnt(8)
v_mfma_f32_32x32x16_bf16 v[112:127],a[140:143],a[92:95],v[112:127]
ds_read_b64_tr_b16 a[128:129],v200 offset:28672
ds_read_b64_tr_b16 a[130:131],v200 offset:28928
v_mul_f32 v145,v145,v137
v_mul_f32 v146,v146,v138
v_mul_f32 v147,v147,v139
v_mul_f32 v148,v148,v140
v_mul_f32 v149,v149,v141
s_waitcnt lgkmcnt(8)
v_mfma_f32_32x32x16_bf16 v[112:127],a[112:115],a[96:99],v[112:127]
ds_read_b64_tr_b16 a[132:133],v200 offset:29696
ds_read_b64_tr_b16 a[134:135],v200 offset:29952
v_mul_f32 v150,v150,v142
v_mul_f32 v151,v151,v143
v_cvt_pk_bf16_f32 v28,v144,v145
v_cvt_pk_bf16_f32 v29,v146,v147
v_cvt_pk_bf16_f32 v30,v148,v149
s_waitcnt lgkmcnt(8)
v_mfma_f32_32x32x16_bf16 v[112:127],a[116:119],a[100:103],v[112:127]
ds_read_b64_tr_b16 a[136:137],v200 offset:30720
ds_read_b64_tr_b16 a[138:139],v200 offset:30976
v_cvt_pk_bf16_f32 v31,v150,v151
ds_read_b128 v[128:131],v220 offset:640
ds_read_b128 v[132:135],v220 offset:672
ds_read_b128 v[136:139],v220 offset:704
ds_read_b128 v[140:143],v220 offset:736
s_waitcnt lgkmcnt(12)
v_mfma_f32_32x32x16_bf16 v[112:127],a[120:123],a[104:107],v[112:127]
ds_read_b64_tr_b16 a[140:141],v200 offset:31744
ds_read_b64_tr_b16 a[142:143],v200 offset:32000
s_add_u32 s30,s100,57792
s_add_u32 m0,s60,87040
s_nop 0
buffer_load_dwordx4 v204,s[20:23],s30 offen lds
s_waitcnt lgkmcnt(12)
v_mfma_f32_32x32x16_bf16 v[112:127],a[124:127],a[108:111],v[112:127]
ds_read_b64_tr_b16 a[112:113],v200 offset:32768
ds_read_b64_tr_b16 a[114:115],v200 offset:33024
s_waitcnt lgkmcnt(4)
v_mfma_f32_32x32x16_bf16 v[128:143],a[128:131],a[0:3],v[128:143]
ds_read_b64_tr_b16 a[116:117],v200 offset:33792
ds_read_b64_tr_b16 a[118:119],v200 offset:34048
v_mfma_f32_32x32x16_bf16 v[128:143],a[132:135],a[4:7],v[128:143]
ds_read_b64_tr_b16 a[120:121],v200 offset:34816
ds_read_b64_tr_b16 a[122:123],v200 offset:35072
v_mfma_f32_32x32x16_bf16 v[128:143],a[136:139],a[8:11],v[128:143]
ds_read_b64_tr_b16 a[124:125],v200 offset:35840
ds_read_b64_tr_b16 a[126:127],v200 offset:36096
s_add_u32 s30,s100,115136
s_add_u32 m0,s60,88064
s_nop 0
buffer_load_dwordx4 v204,s[20:23],s30 offen lds
v_mul_f32 v144,v112,v112
v_mul_f32 v145,v113,v113
v_mul_f32 v146,v114,v114
v_mul_f32 v147,v115,v115
v_mul_f32 v148,v116,v116
v_mul_f32 v149,v117,v117
s_waitcnt lgkmcnt(8)
v_mfma_f32_32x32x16_bf16 v[128:143],a[140:143],a[12:15],v[128:143]
ds_read_b64_tr_b16 a[128:129],v200 offset:36864
ds_read_b64_tr_b16 a[130:131],v200 offset:37120
v_mul_f32 v150,v118,v118
v_mul_f32 v151,v119,v119
v_fma_f32 v144,v144,s58,v210
v_fma_f32 v145,v145,s58,v210
v_fma_f32 v146,v146,s58,v210
v_fma_f32 v147,v147,s58,v210
s_waitcnt lgkmcnt(8)
v_mfma_f32_32x32x16_bf16 v[128:143],a[112:115],a[16:19],v[128:143]
ds_read_b64_tr_b16 a[132:133],v200 offset:37888
ds_read_b64_tr_b16 a[134:135],v200 offset:38144
v_fma_f32 v148,v148,s58,v210
v_fma_f32 v149,v149,s58,v210
v_fma_f32 v150,v150,s58,v210
v_fma_f32 v151,v151,s58,v210
v_mul_f32 v144,v144,v112
v_mul_f32 v145,v145,v113
s_waitcnt lgkmcnt(8)
v_mfma_f32_32x32x16_bf16 v[128:143],a[116:119],a[20:23],v[128:143]
ds_read_b64_tr_b16 a[136:137],v200 offset:38912
ds_read_b64_tr_b16 a[138:139],v200 offset:39168
v_mul_f32 v146,v146,v114
v_mul_f32 v147,v147,v115
v_mul_f32 v148,v148,v116
v_mul_f32 v149,v149,v117
v_mul_f32 v150,v150,v118
v_mul_f32 v151,v151,v119
s_waitcnt lgkmcnt(8)
v_mfma_f32_32x32x16_bf16 v[128:143],a[120:123],a[24:27],v[128:143]
ds_read_b64_tr_b16 a[140:141],v200 offset:39936
ds_read_b64_tr_b16 a[142:143],v200 offset:40192
s_add_u32 s30,s100,172480
s_add_u32 m0,s60,89088
s_nop 0
buffer_load_dwordx4 v204,s[20:23],s30 offen lds
v_exp_f32 v144,v144
v_exp_f32 v145,v145
v_exp_f32 v146,v146
v_exp_f32 v147,v147
v_exp_f32 v148,v148
s_waitcnt lgkmcnt(8)
v_mfma_f32_32x32x16_bf16 v[128:143],a[124:127],a[28:31],v[128:143]
ds_read_b64_tr_b16 a[112:113],v200 offset:40960
ds_read_b64_tr_b16 a[114:115],v200 offset:41216
v_exp_f32 v149,v149
v_exp_f32 v150,v150
v_exp_f32 v151,v151
v_add_f32 v144,1.0,v144
v_add_f32 v145,1.0,v145
s_waitcnt lgkmcnt(8)
v_mfma_f32_32x32x16_bf16 v[128:143],a[128:131],a[32:35],v[128:143]
ds_read_b64_tr_b16 a[116:117],v200 offset:41984
ds_read_b64_tr_b16 a[118:119],v200 offset:42240
v_add_f32 v146,1.0,v146
v_add_f32 v147,1.0,v147
v_add_f32 v148,1.0,v148
v_add_f32 v149,1.0,v149
v_add_f32 v150,1.0,v150
s_waitcnt lgkmcnt(8)
v_mfma_f32_32x32x16_bf16 v[128:143],a[132:135],a[36:39],v[128:143]
ds_read_b64_tr_b16 a[120:121],v200 offset:43008
ds_read_b64_tr_b16 a[122:123],v200 offset:43264
v_add_f32 v151,1.0,v151
v_rcp_f32 v144,v144
v_rcp_f32 v145,v145
v_rcp_f32 v146,v146
v_rcp_f32 v147,v147
s_waitcnt lgkmcnt(8)
v_mfma_f32_32x32x16_bf16 v[128:143],a[136:139],a[40:43],v[128:143]
ds_read_b64_tr_b16 a[124:125],v200 offset:44032
ds_read_b64_tr_b16 a[126:127],v200 offset:44288
s_add_u32 s30,s100,229824
s_add_u32 m0,s60,90112
s_nop 0
buffer_load_dwordx4 v204,s[20:23],s30 offen lds
v_rcp_f32 v148,v148
v_rcp_f32 v149,v149
v_rcp_f32 v150,v150
v_rcp_f32 v151,v151
v_mul_f32 v144,v144,v112
s_waitcnt lgkmcnt(8)
v_mfma_f32_32x32x16_bf16 v[128:143],a[140:143],a[44:47],v[128:143]
ds_read_b64_tr_b16 a[128:129],v200 offset:45056
ds_read_b64_tr_b16 a[130:131],v200 offset:45312
v_mul_f32 v145,v145,v113
v_mul_f32 v146,v146,v114
v_mul_f32 v147,v147,v115
v_mul_f32 v148,v148,v116
v_mul_f32 v149,v149,v117
s_waitcnt lgkmcnt(8)
v_mfma_f32_32x32x16_bf16 v[128:143],a[112:115],a[48:51],v[128:143]
ds_read_b64_tr_b16 a[132:133],v200 offset:46080
ds_read_b64_tr_b16 a[134:135],v200 offset:46336
v_mul_f32 v150,v150,v118
v_mul_f32 v151,v151,v119
v_cvt_pk_bf16_f32 v32,v144,v145
v_cvt_pk_bf16_f32 v33,v146,v147
v_cvt_pk_bf16_f32 v34,v148,v149
s_waitcnt lgkmcnt(8)
v_mfma_f32_32x32x16_bf16 v[128:143],a[116:119],a[52:55],v[128:143]
ds_read_b64_tr_b16 a[136:137],v200 offset:47104
ds_read_b64_tr_b16 a[138:139],v200 offset:47360
v_cvt_pk_bf16_f32 v35,v150,v151
v_mul_f32 v144,v120,v120
v_mul_f32 v145,v121,v121
v_mul_f32 v146,v122,v122
v_mul_f32 v147,v123,v123
s_waitcnt lgkmcnt(8)
v_mfma_f32_32x32x16_bf16 v[128:143],a[120:123],a[56:59],v[128:143]
ds_read_b64_tr_b16 a[140:141],v200 offset:48128
ds_read_b64_tr_b16 a[142:143],v200 offset:48384
s_add_u32 s30,s100,287168
s_add_u32 m0,s60,91136
s_nop 0
buffer_load_dwordx4 v204,s[20:23],s30 offen lds
v_mul_f32 v148,v124,v124
v_mul_f32 v149,v125,v125
v_mul_f32 v150,v126,v126
v_mul_f32 v151,v127,v127
v_fma_f32 v144,v144,s58,v210
s_waitcnt lgkmcnt(8)
v_mfma_f32_32x32x16_bf16 v[128:143],a[124:127],a[60:63],v[128:143]
ds_read_b64_tr_b16 a[112:113],v200 offset:49152
ds_read_b64_tr_b16 a[114:115],v200 offset:49408
v_fma_f32 v145,v145,s58,v210
v_fma_f32 v146,v146,s58,v210
v_fma_f32 v147,v147,s58,v210
v_fma_f32 v148,v148,s58,v210
v_fma_f32 v149,v149,s58,v210
s_waitcnt lgkmcnt(8)
v_mfma_f32_32x32x16_bf16 v[128:143],a[128:131],a[64:67],v[128:143]
ds_read_b64_tr_b16 a[116:117],v200 offset:50176
ds_read_b64_tr_b16 a[118:119],v200 offset:50432
v_fma_f32 v150,v150,s58,v210
v_fma_f32 v151,v151,s58,v210
v_mul_f32 v144,v144,v120
v_mul_f32 v145,v145,v121
v_mul_f32 v146,v146,v122
s_waitcnt lgkmcnt(8)
v_mfma_f32_32x32x16_bf16 v[128:143],a[132:135],a[68:71],v[128:143]
ds_read_b64_tr_b16 a[120:121],v200 offset:51200
ds_read_b64_tr_b16 a[122:123],v200 offset:51456
v_mul_f32 v147,v147,v123
v_mul_f32 v148,v148,v124
v_mul_f32 v149,v149,v125
v_mul_f32 v150,v150,v126
v_mul_f32 v151,v151,v127
s_waitcnt lgkmcnt(8)
v_mfma_f32_32x32x16_bf16 v[128:143],a[136:139],a[72:75],v[128:143]
ds_read_b64_tr_b16 a[124:125],v200 offset:52224
ds_read_b64_tr_b16 a[126:127],v200 offset:52480
s_add_u32 s30,s100,344512
s_add_u32 m0,s60,92160
s_nop 0
buffer_load_dwordx4 v204,s[20:23],s30 offen lds
v_exp_f32 v144,v144
v_exp_f32 v145,v145
v_exp_f32 v146,v146
v_exp_f32 v147,v147
v_exp_f32 v148,v148
s_waitcnt lgkmcnt(8)
v_mfma_f32_32x32x16_bf16 v[128:143],a[140:143],a[76:79],v[128:143]
ds_read_b64_tr_b16 a[128:129],v200 offset:53248
ds_read_b64_tr_b16 a[130:131],v200 offset:53504
v_exp_f32 v149,v149
v_exp_f32 v150,v150
v_exp_f32 v151,v151
v_add_f32 v144,1.0,v144
v_add_f32 v145,1.0,v145
s_waitcnt lgkmcnt(8)
v_mfma_f32_32x32x16_bf16 v[128:143],a[112:115],a[80:83],v[128:143]
ds_read_b64_tr_b16 a[132:133],v200 offset:54272
ds_read_b64_tr_b16 a[134:135],v200 offset:54528
v_add_f32 v146,1.0,v146
v_add_f32 v147,1.0,v147
v_add_f32 v148,1.0,v148
v_add_f32 v149,1.0,v149
v_add_f32 v150,1.0,v150
s_waitcnt lgkmcnt(8)
v_mfma_f32_32x32x16_bf16 v[128:143],a[116:119],a[84:87],v[128:143]
ds_read_b64_tr_b16 a[136:137],v200 offset:55296
ds_read_b64_tr_b16 a[138:139],v200 offset:55552
v_add_f32 v151,1.0,v151
v_rcp_f32 v144,v144
v_rcp_f32 v145,v145
v_rcp_f32 v146,v146
v_rcp_f32 v147,v147
s_waitcnt vmcnt(7)
s_barrier
s_waitcnt lgkmcnt(8)
v_mfma_f32_32x32x16_bf16 v[128:143],a[120:123],a[88:91],v[128:143]
ds_read_b64_tr_b16 a[140:141],v200 offset:56320
ds_read_b64_tr_b16 a[142:143],v200 offset:56576
s_add_u32 s30,s100,512
s_add_u32 m0,s60,0
s_nop 0
buffer_load_dwordx4 v204,s[20:23],s30 offen lds
v_rcp_f32 v148,v148
v_rcp_f32 v149,v149
v_rcp_f32 v150,v150
v_rcp_f32 v151,v151
v_mul_f32 v144,v144,v120
s_waitcnt lgkmcnt(8)
v_mfma_f32_32x32x16_bf16 v[128:143],a[124:127],a[92:95],v[128:143]
ds_read_b64_tr_b16 a[112:113],v201 offset:0
ds_read_b64_tr_b16 a[114:115],v201 offset:256
v_mul_f32 v145,v145,v121
v_mul_f32 v146,v146,v122
v_mul_f32 v147,v147,v123
v_mul_f32 v148,v148,v124
v_mul_f32 v149,v149,v125
s_waitcnt lgkmcnt(8)
v_mfma_f32_32x32x16_bf16 v[128:143],a[128:131],a[96:99],v[128:143]
ds_read_b64_tr_b16 a[116:117],v201 offset:1024
ds_read_b64_tr_b16 a[118:119],v201 offset:1280
v_mul_f32 v150,v150,v126
v_mul_f32 v151,v151,v127
v_cvt_pk_bf16_f32 v36,v144,v145
v_cvt_pk_bf16_f32 v37,v146,v147
v_cvt_pk_bf16_f32 v38,v148,v149
s_waitcnt lgkmcnt(8)
v_mfma_f32_32x32x16_bf16 v[128:143],a[132:135],a[100:103],v[128:143]
ds_read_b64_tr_b16 a[120:121],v201 offset:2048
ds_read_b64_tr_b16 a[122:123],v201 offset:2304
v_cvt_pk_bf16_f32 v39,v150,v151
ds_read_b128 v[112:115],v220 offset:768
ds_read_b128 v[116:119],v220 offset:800
ds_read_b128 v[120:123],v220 offset:832
ds_read_b128 v[124:127],v220 offset:864
s_waitcnt lgkmcnt(12)
v_mfma_f32_32x32x16_bf16 v[128:143],a[136:139],a[104:107],v[128:143]
ds_read_b64_tr_b16 a[124:125],v201 offset:3072
ds_read_b64_tr_b16 a[126:127],v201 offset:3328
s_add_u32 s30,s100,57856
s_add_u32 m0,s60,1024
s_nop 0
buffer_load_dwordx4 v204,s[20:23],s30 offen lds
s_waitcnt lgkmcnt(12)
v_mfma_f32_32x32x16_bf16 v[128:143],a[140:143],a[108:111],v[128:143]
ds_read_b64_tr_b16 a[128:129],v201 offset:4096
ds_read_b64_tr_b16 a[130:131],v201 offset:4352
s_waitcnt lgkmcnt(4)
v_mfma_f32_32x32x16_bf16 v[112:127],a[112:115],a[0:3],v[112:127]
ds_read_b64_tr_b16 a[132:133],v201 offset:5120
ds_read_b64_tr_b16 a[134:135],v201 offset:5376
v_mfma_f32_32x32x16_bf16 v[112:127],a[116:119],a[4:7],v[112:127]
ds_read_b64_tr_b16 a[136:137],v201 offset:6144
ds_read_b64_tr_b16 a[138:139],v201 offset:6400
v_mfma_f32_32x32x16_bf16 v[112:127],a[120:123],a[8:11],v[112:127]
ds_read_b64_tr_b16 a[140:141],v201 offset:7168
ds_read_b64_tr_b16 a[142:143],v201 offset:7424
s_add_u32 s30,s100,115200
s_add_u32 m0,s60,2048
s_nop 0
buffer_load_dwordx4 v204,s[20:23],s30 offen lds
v_mul_f32 v144,v128,v128
v_mul_f32 v145,v129,v129
v_mul_f32 v146,v130,v130
v_mul_f32 v147,v131,v131
v_mul_f32 v148,v132,v132
v_mul_f32 v149,v133,v133
s_waitcnt lgkmcnt(8)
v_mfma_f32_32x32x16_bf16 v[112:127],a[124:127],a[12:15],v[112:127]
ds_read_b64_tr_b16 a[112:113],v201 offset:8192
ds_read_b64_tr_b16 a[114:115],v201 offset:8448
v_mul_f32 v150,v134,v134
v_mul_f32 v151,v135,v135
v_fma_f32 v144,v144,s58,v210
v_fma_f32 v145,v145,s58,v210
v_fma_f32 v146,v146,s58,v210
v_fma_f32 v147,v147,s58,v210
s_waitcnt lgkmcnt(8)
v_mfma_f32_32x32x16_bf16 v[112:127],a[128:131],a[16:19],v[112:127]
ds_read_b64_tr_b16 a[116:117],v201 offset:9216
ds_read_b64_tr_b16 a[118:119],v201 offset:9472
v_fma_f32 v148,v148,s58,v210
v_fma_f32 v149,v149,s58,v210
v_fma_f32 v150,v150,s58,v210
v_fma_f32 v151,v151,s58,v210
v_mul_f32 v144,v144,v128
v_mul_f32 v145,v145,v129
s_waitcnt lgkmcnt(8)
v_mfma_f32_32x32x16_bf16 v[112:127],a[132:135],a[20:23],v[112:127]
ds_read_b64_tr_b16 a[120:121],v201 offset:10240
ds_read_b64_tr_b16 a[122:123],v201 offset:10496
v_mul_f32 v146,v146,v130
v_mul_f32 v147,v147,v131
v_mul_f32 v148,v148,v132
v_mul_f32 v149,v149,v133
v_mul_f32 v150,v150,v134
v_mul_f32 v151,v151,v135
s_waitcnt lgkmcnt(8)
v_mfma_f32_32x32x16_bf16 v[112:127],a[136:139],a[24:27],v[112:127]
ds_read_b64_tr_b16 a[124:125],v201 offset:11264
ds_read_b64_tr_b16 a[126:127],v201 offset:11520
s_add_u32 s30,s100,172544
s_add_u32 m0,s60,3072
s_nop 0
buffer_load_dwordx4 v204,s[20:23],s30 offen lds
v_exp_f32 v144,v144
v_exp_f32 v145,v145
v_exp_f32 v146,v146
v_exp_f32 v147,v147
v_exp_f32 v148,v148
s_waitcnt lgkmcnt(8)
v_mfma_f32_32x32x16_bf16 v[112:127],a[140:143],a[28:31],v[112:127]
ds_read_b64_tr_b16 a[128:129],v201 offset:12288
ds_read_b64_tr_b16 a[130:131],v201 offset:12544
v_exp_f32 v149,v149
v_exp_f32 v150,v150
v_exp_f32 v151,v151
v_add_f32 v144,1.0,v144
v_add_f32 v145,1.0,v145
s_waitcnt lgkmcnt(8)
v_mfma_f32_32x32x16_bf16 v[112:127],a[112:115],a[32:35],v[112:127]
ds_read_b64_tr_b16 a[132:133],v201 offset:13312
ds_read_b64_tr_b16 a[134:135],v201 offset:13568
v_add_f32 v146,1.0,v146
v_add_f32 v147,1.0,v147
v_add_f32 v148,1.0,v148
v_add_f32 v149,1.0,v149
v_add_f32 v150,1.0,v150
s_waitcnt lgkmcnt(8)
v_mfma_f32_32x32x16_bf16 v[112:127],a[116:119],a[36:39],v[112:127]
ds_read_b64_tr_b16 a[136:137],v201 offset:14336
ds_read_b64_tr_b16 a[138:139],v201 offset:14592
v_add_f32 v151,1.0,v151
v_rcp_f32 v144,v144
v_rcp_f32 v145,v145
v_rcp_f32 v146,v146
v_rcp_f32 v147,v147
s_waitcnt lgkmcnt(8)
v_mfma_f32_32x32x16_bf16 v[112:127],a[120:123],a[40:43],v[112:127]
ds_read_b64_tr_b16 a[140:141],v201 offset:15360
ds_read_b64_tr_b16 a[142:143],v201 offset:15616
s_add_u32 s30,s100,229888
s_add_u32 m0,s60,4096
s_nop 0
buffer_load_dwordx4 v204,s[20:23],s30 offen lds
v_rcp_f32 v148,v148
v_rcp_f32 v149,v149
v_rcp_f32 v150,v150
v_rcp_f32 v151,v151
v_mul_f32 v144,v144,v128
s_waitcnt lgkmcnt(8)
v_mfma_f32_32x32x16_bf16 v[112:127],a[124:127],a[44:47],v[112:127]
ds_read_b64_tr_b16 a[112:113],v201 offset:16384
ds_read_b64_tr_b16 a[114:115],v201 offset:16640
v_mul_f32 v145,v145,v129
v_mul_f32 v146,v146,v130
v_mul_f32 v147,v147,v131
v_mul_f32 v148,v148,v132
v_mul_f32 v149,v149,v133
s_waitcnt lgkmcnt(8)
v_mfma_f32_32x32x16_bf16 v[112:127],a[128:131],a[48:51],v[112:127]
ds_read_b64_tr_b16 a[116:117],v201 offset:17408
ds_read_b64_tr_b16 a[118:119],v201 offset:17664
v_mul_f32 v150,v150,v134
v_mul_f32 v151,v151,v135
v_cvt_pk_bf16_f32 v40,v144,v145
v_cvt_pk_bf16_f32 v41,v146,v147
v_cvt_pk_bf16_f32 v42,v148,v149
s_waitcnt lgkmcnt(8)
v_mfma_f32_32x32x16_bf16 v[112:127],a[132:135],a[52:55],v[112:127]
ds_read_b64_tr_b16 a[120:121],v201 offset:18432
ds_read_b64_tr_b16 a[122:123],v201 offset:18688
v_cvt_pk_bf16_f32 v43,v150,v151
v_mul_f32 v144,v136,v136
v_mul_f32 v145,v137,v137
v_mul_f32 v146,v138,v138
v_mul_f32 v147,v139,v139
s_waitcnt lgkmcnt(8)
v_mfma_f32_32x32x16_bf16 v[112:127],a[136:139],a[56:59],v[112:127]
ds_read_b64_tr_b16 a[124:125],v201 offset:19456
ds_read_b64_tr_b16 a[126:127],v201 offset:19712
s_add_u32 s30,s100,287232
s_add_u32 m0,s60,5120
s_nop 0
buffer_load_dwordx4 v204,s[20:23],s30 offen lds
v_mul_f32 v148,v140,v140
v_mul_f32 v149,v141,v141
v_mul_f32 v150,v142,v142
v_mul_f32 v151,v143,v143
v_fma_f32 v144,v144,s58,v210
s_waitcnt lgkmcnt(8)
v_mfma_f32_32x32x16_bf16 v[112:127],a[140:143],a[60:63],v[112:127]
ds_read_b64_tr_b16 a[128:129],v201 offset:20480
ds_read_b64_tr_b16 a[130:131],v201 offset:20736
v_fma_f32 v145,v145,s58,v210
v_fma_f32 v146,v146,s58,v210
v_fma_f32 v147,v147,s58,v210
v_fma_f32 v148,v148,s58,v210
v_fma_f32 v149,v149,s58,v210
s_waitcnt lgkmcnt(8)
v_mfma_f32_32x32x16_bf16 v[112:127],a[112:115],a[64:67],v[112:127]
ds_read_b64_tr_b16 a[132:133],v201 offset:21504
ds_read_b64_tr_b16 a[134:135],v201 offset:21760
v_fma_f32 v150,v150,s58,v210
v_fma_f32 v151,v151,s58,v210
v_mul_f32 v144,v144,v136
v_mul_f32 v145,v145,v137
v_mul_f32 v146,v146,v138
s_waitcnt lgkmcnt(8)
v_mfma_f32_32x32x16_bf16 v[112:127],a[116:119],a[68:71],v[112:127]
ds_read_b64_tr_b16 a[136:137],v201 offset:22528
ds_read_b64_tr_b16 a[138:139],v201 offset:22784
v_mul_f32 v147,v147,v139
v_mul_f32 v148,v148,v140
v_mul_f32 v149,v149,v141
v_mul_f32 v150,v150,v142
v_mul_f32 v151,v151,v143
s_waitcnt lgkmcnt(8)
v_mfma_f32_32x32x16_bf16 v[112:127],a[120:123],a[72:75],v[112:127]
ds_read_b64_tr_b16 a[140:141],v201 offset:23552
ds_read_b64_tr_b16 a[142:143],v201 offset:23808
s_add_u32 s30,s100,344576
s_add_u32 m0,s60,6144
s_nop 0
buffer_load_dwordx4 v204,s[20:23],s30 offen lds
v_exp_f32 v144,v144
v_exp_f32 v145,v145
v_exp_f32 v146,v146
v_exp_f32 v147,v147
v_exp_f32 v148,v148
s_waitcnt lgkmcnt(8)
v_mfma_f32_32x32x16_bf16 v[112:127],a[124:127],a[76:79],v[112:127]
ds_read_b64_tr_b16 a[112:113],v201 offset:24576
ds_read_b64_tr_b16 a[114:115],v201 offset:24832
v_exp_f32 v149,v149
v_exp_f32 v150,v150
v_exp_f32 v151,v151
v_add_f32 v144,1.0,v144
v_add_f32 v145,1.0,v145
s_waitcnt lgkmcnt(8)
v_mfma_f32_32x32x16_bf16 v[112:127],a[128:131],a[80:83],v[112:127]
ds_read_b64_tr_b16 a[116:117],v201 offset:25600
ds_read_b64_tr_b16 a[118:119],v201 offset:25856
v_add_f32 v146,1.0,v146
v_add_f32 v147,1.0,v147
v_add_f32 v148,1.0,v148
v_add_f32 v149,1.0,v149
v_add_f32 v150,1.0,v150
s_waitcnt lgkmcnt(8)
v_mfma_f32_32x32x16_bf16 v[112:127],a[132:135],a[84:87],v[112:127]
ds_read_b64_tr_b16 a[120:121],v201 offset:26624
ds_read_b64_tr_b16 a[122:123],v201 offset:26880
v_add_f32 v151,1.0,v151
v_rcp_f32 v144,v144
v_rcp_f32 v145,v145
v_rcp_f32 v146,v146
v_rcp_f32 v147,v147
s_waitcnt vmcnt(7)
s_barrier
s_waitcnt lgkmcnt(8)
v_mfma_f32_32x32x16_bf16 v[112:127],a[136:139],a[88:91],v[112:127]
ds_read_b64_tr_b16 a[124:125],v201 offset:27648
ds_read_b64_tr_b16 a[126:127],v201 offset:27904
s_add_u32 s30,s100,576
s_add_u32 m0,s60,28672
s_nop 0
buffer_load_dwordx4 v204,s[20:23],s30 offen lds
v_rcp_f32 v148,v148
v_rcp_f32 v149,v149
v_rcp_f32 v150,v150
v_rcp_f32 v151,v151
v_mul_f32 v144,v144,v136
s_waitcnt lgkmcnt(8)
v_mfma_f32_32x32x16_bf16 v[112:127],a[140:143],a[92:95],v[112:127]
ds_read_b64_tr_b16 a[128:129],v201 offset:28672
ds_read_b64_tr_b16 a[130:131],v201 offset:28928
v_mul_f32 v145,v145,v137
v_mul_f32 v146,v146,v138
v_mul_f32 v147,v147,v139
v_mul_f32 v148,v148,v140
v_mul_f32 v149,v149,v141
s_waitcnt lgkmcnt(8)
v_mfma_f32_32x32x16_bf16 v[112:127],a[112:115],a[96:99],v[112:127]
ds_read_b64_tr_b16 a[132:133],v201 offset:29696
ds_read_b64_tr_b16 a[134:135],v201 offset:29952
v_mul_f32 v150,v150,v142
v_mul_f32 v151,v151,v143
v_cvt_pk_bf16_f32 v44,v144,v145
v_cvt_pk_bf16_f32 v45,v146,v147
v_cvt_pk_bf16_f32 v46,v148,v149
s_waitcnt lgkmcnt(8)
v_mfma_f32_32x32x16_bf16 v[112:127],a[116:119],a[100:103],v[112:127]
ds_read_b64_tr_b16 a[136:137],v201 offset:30720
ds_read_b64_tr_b16 a[138:139],v201 offset:30976
v_cvt_pk_bf16_f32 v47,v150,v151
ds_read_b128 v[128:131],v220 offset:896
ds_read_b128 v[132:135],v220 offset:928
ds_read_b128 v[136:139],v220 offset:960
ds_read_b128 v[140:143],v220 offset:992
s_waitcnt lgkmcnt(12)
v_mfma_f32_32x32x16_bf16 v[112:127],a[120:123],a[104:107],v[112:127]
ds_read_b64_tr_b16 a[140:141],v201 offset:31744
ds_read_b64_tr_b16 a[142:143],v201 offset:32000
s_add_u32 s30,s100,57920
s_add_u32 m0,s60,29696
s_nop 0
buffer_load_dwordx4 v204,s[20:23],s30 offen lds
s_waitcnt lgkmcnt(12)
v_mfma_f32_32x32x16_bf16 v[112:127],a[124:127],a[108:111],v[112:127]
ds_read_b64_tr_b16 a[112:113],v201 offset:32768
ds_read_b64_tr_b16 a[114:115],v201 offset:33024
s_waitcnt lgkmcnt(4)
v_mfma_f32_32x32x16_bf16 v[128:143],a[128:131],a[0:3],v[128:143]
ds_read_b64_tr_b16 a[116:117],v201 offset:33792
ds_read_b64_tr_b16 a[118:119],v201 offset:34048
v_mfma_f32_32x32x16_bf16 v[128:143],a[132:135],a[4:7],v[128:143]
ds_read_b64_tr_b16 a[120:121],v201 offset:34816
ds_read_b64_tr_b16 a[122:123],v201 offset:35072
v_mfma_f32_32x32x16_bf16 v[128:143],a[136:139],a[8:11],v[128:143]
ds_read_b64_tr_b16 a[124:125],v201 offset:35840
ds_read_b64_tr_b16 a[126:127],v201 offset:36096
s_add_u32 s30,s100,115264
s_add_u32 m0,s60,30720
s_nop 0
buffer_load_dwordx4 v204,s[20:23],s30 offen lds
v_mul_f32 v144,v112,v112
v_mul_f32 v145,v113,v113
v_mul_f32 v146,v114,v114
v_mul_f32 v147,v115,v115
v_mul_f32 v148,v116,v116
v_mul_f32 v149,v117,v117
s_waitcnt lgkmcnt(8)
v_mfma_f32_32x32x16_bf16 v[128:143],a[140:143],a[12:15],v[128:143]
ds_read_b64_tr_b16 a[128:129],v201 offset:36864
ds_read_b64_tr_b16 a[130:131],v201 offset:37120
v_mul_f32 v150,v118,v118
v_mul_f32 v151,v119,v119
v_fma_f32 v144,v144,s58,v210
v_fma_f32 v145,v145,s58,v210
v_fma_f32 v146,v146,s58,v210
v_fma_f32 v147,v147,s58,v210
s_waitcnt lgkmcnt(8)
v_mfma_f32_32x32x16_bf16 v[128:143],a[112:115],a[16:19],v[128:143]
ds_read_b64_tr_b16 a[132:133],v201 offset:37888
ds_read_b64_tr_b16 a[134:135],v201 offset:38144
v_fma_f32 v148,v148,s58,v210
v_fma_f32 v149,v149,s58,v210
v_fma_f32 v150,v150,s58,v210
v_fma_f32 v151,v151,s58,v210
v_mul_f32 v144,v144,v112
v_mul_f32 v145,v145,v113
s_waitcnt lgkmcnt(8)
v_mfma_f32_32x32x16_bf16 v[128:143],a[116:119],a[20:23],v[128:143]
ds_read_b64_tr_b16 a[136:137],v201 offset:38912
ds_read_b64_tr_b16 a[138:139],v201 offset:39168
v_mul_f32 v146,v146,v114
v_mul_f32 v147,v147,v115
v_mul_f32 v148,v148,v116
v_mul_f32 v149,v149,v117
v_mul_f32 v150,v150,v118
v_mul_f32 v151,v151,v119
s_waitcnt lgkmcnt(8)
v_mfma_f32_32x32x16_bf16 v[128:143],a[120:123],a[24:27],v[128:143]
ds_read_b64_tr_b16 a[140:141],v201 offset:39936
ds_read_b64_tr_b16 a[142:143],v201 offset:40192
s_add_u32 s30,s100,172608
s_add_u32 m0,s60,31744
s_nop 0
buffer_load_dwordx4 v204,s[20:23],s30 offen lds
v_exp_f32 v144,v144
v_exp_f32 v145,v145
v_exp_f32 v146,v146
v_exp_f32 v147,v147
v_exp_f32 v148,v148
s_waitcnt lgkmcnt(8)
v_mfma_f32_32x32x16_bf16 v[128:143],a[124:127],a[28:31],v[128:143]
ds_read_b64_tr_b16 a[112:113],v201 offset:40960
ds_read_b64_tr_b16 a[114:115],v201 offset:41216
v_exp_f32 v149,v149
v_exp_f32 v150,v150
v_exp_f32 v151,v151
v_add_f32 v144,1.0,v144
v_add_f32 v145,1.0,v145
s_waitcnt lgkmcnt(8)
v_mfma_f32_32x32x16_bf16 v[128:143],a[128:131],a[32:35],v[128:143]
ds_read_b64_tr_b16 a[116:117],v201 offset:41984
ds_read_b64_tr_b16 a[118:119],v201 offset:42240
v_add_f32 v146,1.0,v146
v_add_f32 v147,1.0,v147
v_add_f32 v148,1.0,v148
v_add_f32 v149,1.0,v149
v_add_f32 v150,1.0,v150
s_waitcnt lgkmcnt(8)
v_mfma_f32_32x32x16_bf16 v[128:143],a[132:135],a[36:39],v[128:143]
ds_read_b64_tr_b16 a[120:121],v201 offset:43008
ds_read_b64_tr_b16 a[122:123],v201 offset:43264
v_add_f32 v151,1.0,v151
v_rcp_f32 v144,v144
v_rcp_f32 v145,v145
v_rcp_f32 v146,v146
v_rcp_f32 v147,v147
s_waitcnt lgkmcnt(8)
v_mfma_f32_32x32x16_bf16 v[128:143],a[136:139],a[40:43],v[128:143]
ds_read_b64_tr_b16 a[124:125],v201 offset:44032
ds_read_b64_tr_b16 a[126:127],v201 offset:44288
s_add_u32 s30,s100,229952
s_add_u32 m0,s60,32768
s_nop 0
buffer_load_dwordx4 v204,s[20:23],s30 offen lds
v_rcp_f32 v148,v148
v_rcp_f32 v149,v149
v_rcp_f32 v150,v150
v_rcp_f32 v151,v151
v_mul_f32 v144,v144,v112
s_waitcnt lgkmcnt(8)
v_mfma_f32_32x32x16_bf16 v[128:143],a[140:143],a[44:47],v[128:143]
ds_read_b64_tr_b16 a[128:129],v201 offset:45056
ds_read_b64_tr_b16 a[130:131],v201 offset:45312
v_mul_f32 v145,v145,v113
v_mul_f32 v146,v146,v114
v_mul_f32 v147,v147,v115
v_mul_f32 v148,v148,v116
v_mul_f32 v149,v149,v117
s_waitcnt lgkmcnt(8)
v_mfma_f32_32x32x16_bf16 v[128:143],a[112:115],a[48:51],v[128:143]
ds_read_b64_tr_b16 a[132:133],v201 offset:46080
ds_read_b64_tr_b16 a[134:135],v201 offset:46336
v_mul_f32 v150,v150,v118
v_mul_f32 v151,v151,v119
v_cvt_pk_bf16_f32 v48,v144,v145
v_cvt_pk_bf16_f32 v49,v146,v147
v_cvt_pk_bf16_f32 v50,v148,v149
s_waitcnt lgkmcnt(8)
v_mfma_f32_32x32x16_bf16 v[128:143],a[116:119],a[52:55],v[128:143]
ds_read_b64_tr_b16 a[136:137],v201 offset:47104
ds_read_b64_tr_b16 a[138:139],v201 offset:47360
v_cvt_pk_bf16_f32 v51,v150,v151
v_mul_f32 v144,v120,v120
v_mul_f32 v145,v121,v121
v_mul_f32 v146,v122,v122
v_mul_f32 v147,v123,v123
s_waitcnt lgkmcnt(8)
v_mfma_f32_32x32x16_bf16 v[128:143],a[120:123],a[56:59],v[128:143]
ds_read_b64_tr_b16 a[140:141],v201 offset:48128
ds_read_b64_tr_b16 a[142:143],v201 offset:48384
s_add_u32 s30,s100,287296
s_add_u32 m0,s60,33792
s_nop 0
buffer_load_dwordx4 v204,s[20:23],s30 offen lds
v_mul_f32 v148,v124,v124
v_mul_f32 v149,v125,v125
v_mul_f32 v150,v126,v126
v_mul_f32 v151,v127,v127
v_fma_f32 v144,v144,s58,v210
s_waitcnt lgkmcnt(8)
v_mfma_f32_32x32x16_bf16 v[128:143],a[124:127],a[60:63],v[128:143]
ds_read_b64_tr_b16 a[112:113],v201 offset:49152
ds_read_b64_tr_b16 a[114:115],v201 offset:49408
v_fma_f32 v145,v145,s58,v210
v_fma_f32 v146,v146,s58,v210
v_fma_f32 v147,v147,s58,v210
v_fma_f32 v148,v148,s58,v210
v_fma_f32 v149,v149,s58,v210
s_waitcnt lgkmcnt(8)
v_mfma_f32_32x32x16_bf16 v[128:143],a[128:131],a[64:67],v[128:143]
ds_read_b64_tr_b16 a[116:117],v201 offset:50176
ds_read_b64_tr_b16 a[118:119],v201 offset:50432
v_fma_f32 v150,v150,s58,v210
v_fma_f32 v151,v151,s58,v210
v_mul_f32 v144,v144,v120
v_mul_f32 v145,v145,v121
v_mul_f32 v146,v146,v122
s_waitcnt lgkmcnt(8)
v_mfma_f32_32x32x16_bf16 v[128:143],a[132:135],a[68:71],v[128:143]
ds_read_b64_tr_b16 a[120:121],v201 offset:51200
ds_read_b64_tr_b16 a[122:123],v201 offset:51456
v_mul_f32 v147,v147,v123
v_mul_f32 v148,v148,v124
v_mul_f32 v149,v149,v125
v_mul_f32 v150,v150,v126
v_mul_f32 v151,v151,v127
s_waitcnt lgkmcnt(8)
v_mfma_f32_32x32x16_bf16 v[128:143],a[136:139],a[72:75],v[128:143]
ds_read_b64_tr_b16 a[124:125],v201 offset:52224
ds_read_b64_tr_b16 a[126:127],v201 offset:52480
s_add_u32 s30,s100,344640
s_add_u32 m0,s60,34816
s_nop 0
buffer_load_dwordx4 v204,s[20:23],s30 offen lds
v_exp_f32 v144,v144
v_exp_f32 v145,v145
v_exp_f32 v146,v146
v_exp_f32 v147,v147
v_exp_f32 v148,v148
s_waitcnt lgkmcnt(8)
v_mfma_f32_32x32x16_bf16 v[128:143],a[140:143],a[76:79],v[128:143]
ds_read_b64_tr_b16 a[128:129],v201 offset:53248
ds_read_b64_tr_b16 a[130:131],v201 offset:53504
v_exp_f32 v149,v149
v_exp_f32 v150,v150
v_exp_f32 v151,v151
v_add_f32 v144,1.0,v144
v_add_f32 v145,1.0,v145
s_waitcnt lgkmcnt(8)
v_mfma_f32_32x32x16_bf16 v[128:143],a[112:115],a[80:83],v[128:143]
ds_read_b64_tr_b16 a[132:133],v201 offset:54272
ds_read_b64_tr_b16 a[134:135],v201 offset:54528
v_add_f32 v146,1.0,v146
v_add_f32 v147,1.0,v147
v_add_f32 v148,1.0,v148
v_add_f32 v149,1.0,v149
v_add_f32 v150,1.0,v150
s_waitcnt lgkmcnt(8)
v_mfma_f32_32x32x16_bf16 v[128:143],a[116:119],a[84:87],v[128:143]
ds_read_b64_tr_b16 a[136:137],v201 offset:55296
ds_read_b64_tr_b16 a[138:139],v201 offset:55552
v_add_f32 v151,1.0,v151
v_rcp_f32 v144,v144
v_rcp_f32 v145,v145
v_rcp_f32 v146,v146
v_rcp_f32 v147,v147
s_waitcnt vmcnt(7)
s_barrier
s_waitcnt lgkmcnt(8)
v_mfma_f32_32x32x16_bf16 v[128:143],a[120:123],a[88:91],v[128:143]
ds_read_b64_tr_b16 a[140:141],v201 offset:56320
ds_read_b64_tr_b16 a[142:143],v201 offset:56576
s_add_u32 s30,s100,640
s_add_u32 m0,s60,57344
s_nop 0
buffer_load_dwordx4 v204,s[20:23],s30 offen lds
v_rcp_f32 v148,v148
v_rcp_f32 v149,v149
v_rcp_f32 v150,v150
v_rcp_f32 v151,v151
v_mul_f32 v144,v144,v120
s_waitcnt lgkmcnt(8)
v_mfma_f32_32x32x16_bf16 v[128:143],a[124:127],a[92:95],v[128:143]
ds_read_b64_tr_b16 a[112:113],v200 offset:0
ds_read_b64_tr_b16 a[114:115],v200 offset:256
v_mul_f32 v145,v145,v121
v_mul_f32 v146,v146,v122
v_mul_f32 v147,v147,v123
v_mul_f32 v148,v148,v124
v_mul_f32 v149,v149,v125
s_waitcnt lgkmcnt(8)
v_mfma_f32_32x32x16_bf16 v[128:143],a[128:131],a[96:99],v[128:143]
ds_read_b64_tr_b16 a[116:117],v200 offset:1024
ds_read_b64_tr_b16 a[118:119],v200 offset:1280
v_mul_f32 v150,v150,v126
v_mul_f32 v151,v151,v127
v_cvt_pk_bf16_f32 v52,v144,v145
v_cvt_pk_bf16_f32 v53,v146,v147
v_cvt_pk_bf16_f32 v54,v148,v149
s_waitcnt lgkmcnt(8)
v_mfma_f32_32x32x16_bf16 v[128:143],a[132:135],a[100:103],v[128:143]
ds_read_b64_tr_b16 a[120:121],v200 offset:2048
ds_read_b64_tr_b16 a[122:123],v200 offset:2304
v_cvt_pk_bf16_f32 v55,v150,v151
ds_read_b128 v[112:115],v220 offset:1024
ds_read_b128 v[116:119],v220 offset:1056
ds_read_b128 v[120:123],v220 offset:1088
ds_read_b128 v[124:127],v220 offset:1120
s_waitcnt lgkmcnt(12)
v_mfma_f32_32x32x16_bf16 v[128:143],a[136:139],a[104:107],v[128:143]
ds_read_b64_tr_b16 a[124:125],v200 offset:3072
ds_read_b64_tr_b16 a[126:127],v200 offset:3328
s_add_u32 s30,s100,57984
s_add_u32 m0,s60,58368
s_nop 0
buffer_load_dwordx4 v204,s[20:23],s30 offen lds
s_waitcnt lgkmcnt(12)
v_mfma_f32_32x32x16_bf16 v[128:143],a[140:143],a[108:111],v[128:143]
ds_read_b64_tr_b16 a[128:129],v200 offset:4096
ds_read_b64_tr_b16 a[130:131],v200 offset:4352
s_waitcnt lgkmcnt(4)
v_mfma_f32_32x32x16_bf16 v[112:127],a[112:115],a[0:3],v[112:127]
ds_read_b64_tr_b16 a[132:133],v200 offset:5120
ds_read_b64_tr_b16 a[134:135],v200 offset:5376
v_mfma_f32_32x32x16_bf16 v[112:127],a[116:119],a[4:7],v[112:127]
ds_read_b64_tr_b16 a[136:137],v200 offset:6144
ds_read_b64_tr_b16 a[138:139],v200 offset:6400
v_mfma_f32_32x32x16_bf16 v[112:127],a[120:123],a[8:11],v[112:127]
ds_read_b64_tr_b16 a[140:141],v200 offset:7168
ds_read_b64_tr_b16 a[142:143],v200 offset:7424
s_add_u32 s30,s100,115328
s_add_u32 m0,s60,59392
s_nop 0
buffer_load_dwordx4 v204,s[20:23],s30 offen lds
v_mul_f32 v144,v128,v128
v_mul_f32 v145,v129,v129
v_mul_f32 v146,v130,v130
v_mul_f32 v147,v131,v131
v_mul_f32 v148,v132,v132
v_mul_f32 v149,v133,v133
s_waitcnt lgkmcnt(8)
v_mfma_f32_32x32x16_bf16 v[112:127],a[124:127],a[12:15],v[112:127]
ds_read_b64_tr_b16 a[112:113],v200 offset:8192
ds_read_b64_tr_b16 a[114:115],v200 offset:8448
v_mul_f32 v150,v134,v134
v_mul_f32 v151,v135,v135
v_fma_f32 v144,v144,s58,v210
v_fma_f32 v145,v145,s58,v210
v_fma_f32 v146,v146,s58,v210
v_fma_f32 v147,v147,s58,v210
s_waitcnt lgkmcnt(8)
v_mfma_f32_32x32x16_bf16 v[112:127],a[128:131],a[16:19],v[112:127]
ds_read_b64_tr_b16 a[116:117],v200 offset:9216
ds_read_b64_tr_b16 a[118:119],v200 offset:9472
v_fma_f32 v148,v148,s58,v210
v_fma_f32 v149,v149,s58,v210
v_fma_f32 v150,v150,s58,v210
v_fma_f32 v151,v151,s58,v210
v_mul_f32 v144,v144,v128
v_mul_f32 v145,v145,v129
s_waitcnt lgkmcnt(8)
v_mfma_f32_32x32x16_bf16 v[112:127],a[132:135],a[20:23],v[112:127]
ds_read_b64_tr_b16 a[120:121],v200 offset:10240
ds_read_b64_tr_b16 a[122:123],v200 offset:10496
v_mul_f32 v146,v146,v130
v_mul_f32 v147,v147,v131
v_mul_f32 v148,v148,v132
v_mul_f32 v149,v149,v133
v_mul_f32 v150,v150,v134
v_mul_f32 v151,v151,v135
s_waitcnt lgkmcnt(8)
v_mfma_f32_32x32x16_bf16 v[112:127],a[136:139],a[24:27],v[112:127]
ds_read_b64_tr_b16 a[124:125],v200 offset:11264
ds_read_b64_tr_b16 a[126:127],v200 offset:11520
s_add_u32 s30,s100,172672
s_add_u32 m0,s60,60416
s_nop 0
buffer_load_dwordx4 v204,s[20:23],s30 offen lds
v_exp_f32 v144,v144
v_exp_f32 v145,v145
v_exp_f32 v146,v146
v_exp_f32 v147,v147
v_exp_f32 v148,v148
s_waitcnt lgkmcnt(8)
v_mfma_f32_32x32x16_bf16 v[112:127],a[140:143],a[28:31],v[112:127]
ds_read_b64_tr_b16 a[128:129],v200 offset:12288
ds_read_b64_tr_b16 a[130:131],v200 offset:12544
v_exp_f32 v149,v149
v_exp_f32 v150,v150
v_exp_f32 v151,v151
v_add_f32 v144,1.0,v144
v_add_f32 v145,1.0,v145
s_waitcnt lgkmcnt(8)
v_mfma_f32_32x32x16_bf16 v[112:127],a[112:115],a[32:35],v[112:127]
ds_read_b64_tr_b16 a[132:133],v200 offset:13312
ds_read_b64_tr_b16 a[134:135],v200 offset:13568
v_add_f32 v146,1.0,v146
v_add_f32 v147,1.0,v147
v_add_f32 v148,1.0,v148
v_add_f32 v149,1.0,v149
v_add_f32 v150,1.0,v150
s_waitcnt lgkmcnt(8)
v_mfma_f32_32x32x16_bf16 v[112:127],a[116:119],a[36:39],v[112:127]
ds_read_b64_tr_b16 a[136:137],v200 offset:14336
ds_read_b64_tr_b16 a[138:139],v200 offset:14592
v_add_f32 v151,1.0,v151
v_rcp_f32 v144,v144
v_rcp_f32 v145,v145
v_rcp_f32 v146,v146
v_rcp_f32 v147,v147
s_waitcnt lgkmcnt(8)
v_mfma_f32_32x32x16_bf16 v[112:127],a[120:123],a[40:43],v[112:127]
ds_read_b64_tr_b16 a[140:141],v200 offset:15360
ds_read_b64_tr_b16 a[142:143],v200 offset:15616
s_add_u32 s30,s100,230016
s_add_u32 m0,s60,61440
s_nop 0
buffer_load_dwordx4 v204,s[20:23],s30 offen lds
v_rcp_f32 v148,v148
v_rcp_f32 v149,v149
v_rcp_f32 v150,v150
v_rcp_f32 v151,v151
v_mul_f32 v144,v144,v128
s_waitcnt lgkmcnt(8)
v_mfma_f32_32x32x16_bf16 v[112:127],a[124:127],a[44:47],v[112:127]
ds_read_b64_tr_b16 a[112:113],v200 offset:16384
ds_read_b64_tr_b16 a[114:115],v200 offset:16640
v_mul_f32 v145,v145,v129
v_mul_f32 v146,v146,v130
v_mul_f32 v147,v147,v131
v_mul_f32 v148,v148,v132
v_mul_f32 v149,v149,v133
s_waitcnt lgkmcnt(8)
v_mfma_f32_32x32x16_bf16 v[112:127],a[128:131],a[48:51],v[112:127]
ds_read_b64_tr_b16 a[116:117],v200 offset:17408
ds_read_b64_tr_b16 a[118:119],v200 offset:17664
v_mul_f32 v150,v150,v134
v_mul_f32 v151,v151,v135
v_cvt_pk_bf16_f32 v56,v144,v145
v_cvt_pk_bf16_f32 v57,v146,v147
v_cvt_pk_bf16_f32 v58,v148,v149
s_waitcnt lgkmcnt(8)
v_mfma_f32_32x32x16_bf16 v[112:127],a[132:135],a[52:55],v[112:127]
ds_read_b64_tr_b16 a[120:121],v200 offset:18432
ds_read_b64_tr_b16 a[122:123],v200 offset:18688
v_cvt_pk_bf16_f32 v59,v150,v151
v_mul_f32 v144,v136,v136
v_mul_f32 v145,v137,v137
v_mul_f32 v146,v138,v138
v_mul_f32 v147,v139,v139
s_waitcnt lgkmcnt(8)
v_mfma_f32_32x32x16_bf16 v[112:127],a[136:139],a[56:59],v[112:127]
ds_read_b64_tr_b16 a[124:125],v200 offset:19456
ds_read_b64_tr_b16 a[126:127],v200 offset:19712
s_add_u32 s30,s100,287360
s_add_u32 m0,s60,62464
s_nop 0
buffer_load_dwordx4 v204,s[20:23],s30 offen lds
v_mul_f32 v148,v140,v140
v_mul_f32 v149,v141,v141
v_mul_f32 v150,v142,v142
v_mul_f32 v151,v143,v143
v_fma_f32 v144,v144,s58,v210
s_waitcnt lgkmcnt(8)
v_mfma_f32_32x32x16_bf16 v[112:127],a[140:143],a[60:63],v[112:127]
ds_read_b64_tr_b16 a[128:129],v200 offset:20480
ds_read_b64_tr_b16 a[130:131],v200 offset:20736
v_fma_f32 v145,v145,s58,v210
v_fma_f32 v146,v146,s58,v210
v_fma_f32 v147,v147,s58,v210
v_fma_f32 v148,v148,s58,v210
v_fma_f32 v149,v149,s58,v210
s_waitcnt lgkmcnt(8)
v_mfma_f32_32x32x16_bf16 v[112:127],a[112:115],a[64:67],v[112:127]
ds_read_b64_tr_b16 a[132:133],v200 offset:21504
ds_read_b64_tr_b16 a[134:135],v200 offset:21760
v_fma_f32 v150,v150,s58,v210
v_fma_f32 v151,v151,s58,v210
v_mul_f32 v144,v144,v136
v_mul_f32 v145,v145,v137
v_mul_f32 v146,v146,v138
s_waitcnt lgkmcnt(8)
v_mfma_f32_32x32x16_bf16 v[112:127],a[116:119],a[68:71],v[112:127]
ds_read_b64_tr_b16 a[136:137],v200 offset:22528
ds_read_b64_tr_b16 a[138:139],v200 offset:22784
v_mul_f32 v147,v147,v139
v_mul_f32 v148,v148,v140
v_mul_f32 v149,v149,v141
v_mul_f32 v150,v150,v142
v_mul_f32 v151,v151,v143
s_waitcnt lgkmcnt(8)
v_mfma_f32_32x32x16_bf16 v[112:127],a[120:123],a[72:75],v[112:127]
ds_read_b64_tr_b16 a[140:141],v200 offset:23552
ds_read_b64_tr_b16 a[142:143],v200 offset:23808
s_add_u32 s30,s100,344704
s_add_u32 m0,s60,63488
s_nop 0
buffer_load_dwordx4 v204,s[20:23],s30 offen lds
v_exp_f32 v144,v144
v_exp_f32 v145,v145
v_exp_f32 v146,v146
v_exp_f32 v147,v147
v_exp_f32 v148,v148
s_waitcnt lgkmcnt(8)
v_mfma_f32_32x32x16_bf16 v[112:127],a[124:127],a[76:79],v[112:127]
ds_read_b64_tr_b16 a[112:113],v200 offset:24576
ds_read_b64_tr_b16 a[114:115],v200 offset:24832
v_exp_f32 v149,v149
v_exp_f32 v150,v150
v_exp_f32 v151,v151
v_add_f32 v144,1.0,v144
v_add_f32 v145,1.0,v145
s_waitcnt lgkmcnt(8)
v_mfma_f32_32x32x16_bf16 v[112:127],a[128:131],a[80:83],v[112:127]
ds_read_b64_tr_b16 a[116:117],v200 offset:25600
ds_read_b64_tr_b16 a[118:119],v200 offset:25856
v_add_f32 v146,1.0,v146
v_add_f32 v147,1.0,v147
v_add_f32 v148,1.0,v148
v_add_f32 v149,1.0,v149
v_add_f32 v150,1.0,v150
s_waitcnt lgkmcnt(8)
v_mfma_f32_32x32x16_bf16 v[112:127],a[132:135],a[84:87],v[112:127]
ds_read_b64_tr_b16 a[120:121],v200 offset:26624
ds_read_b64_tr_b16 a[122:123],v200 offset:26880
v_add_f32 v151,1.0,v151
v_rcp_f32 v144,v144
v_rcp_f32 v145,v145
v_rcp_f32 v146,v146
v_rcp_f32 v147,v147
s_waitcnt vmcnt(7)
s_barrier
s_waitcnt lgkmcnt(8)
v_mfma_f32_32x32x16_bf16 v[112:127],a[136:139],a[88:91],v[112:127]
ds_read_b64_tr_b16 a[124:125],v200 offset:27648
ds_read_b64_tr_b16 a[126:127],v200 offset:27904
s_add_u32 s30,s100,704
s_add_u32 m0,s60,86016
s_nop 0
buffer_load_dwordx4 v204,s[20:23],s30 offen lds
v_rcp_f32 v148,v148
v_rcp_f32 v149,v149
v_rcp_f32 v150,v150
v_rcp_f32 v151,v151
v_mul_f32 v144,v144,v136
s_waitcnt lgkmcnt(8)
v_mfma_f32_32x32x16_bf16 v[112:127],a[140:143],a[92:95],v[112:127]
ds_read_b64_tr_b16 a[128:129],v200 offset:28672
ds_read_b64_tr_b16 a[130:131],v200 offset:28928
v_mul_f32 v145,v145,v137
v_mul_f32 v146,v146,v138
v_mul_f32 v147,v147,v139
v_mul_f32 v148,v148,v140
v_mul_f32 v149,v149,v141
s_waitcnt lgkmcnt(8)
v_mfma_f32_32x32x16_bf16 v[112:127],a[112:115],a[96:99],v[112:127]
ds_read_b64_tr_b16 a[132:133],v200 offset:29696
ds_read_b64_tr_b16 a[134:135],v200 offset:29952
v_mul_f32 v150,v150,v142
v_mul_f32 v151,v151,v143
v_cvt_pk_bf16_f32 v60,v144,v145
v_cvt_pk_bf16_f32 v61,v146,v147
v_cvt_pk_bf16_f32 v62,v148,v149
s_waitcnt lgkmcnt(8)
v_mfma_f32_32x32x16_bf16 v[112:127],a[116:119],a[100:103],v[112:127]
ds_read_b64_tr_b16 a[136:137],v200 offset:30720
ds_read_b64_tr_b16 a[138:139],v200 offset:30976
v_cvt_pk_bf16_f32 v63,v150,v151
ds_read_b128 v[128:131],v220 offset:1152
ds_read_b128 v[132:135],v220 offset:1184
ds_read_b128 v[136:139],v220 offset:1216
ds_read_b128 v[140:143],v220 offset:1248
s_waitcnt lgkmcnt(12)
v_mfma_f32_32x32x16_bf16 v[112:127],a[120:123],a[104:107],v[112:127]
ds_read_b64_tr_b16 a[140:141],v200 offset:31744
ds_read_b64_tr_b16 a[142:143],v200 offset:32000
s_add_u32 s30,s100,58048
s_add_u32 m0,s60,87040
s_nop 0
buffer_load_dwordx4 v204,s[20:23],s30 offen lds
s_waitcnt lgkmcnt(12)
v_mfma_f32_32x32x16_bf16 v[112:127],a[124:127],a[108:111],v[112:127]
ds_read_b64_tr_b16 a[112:113],v200 offset:32768
ds_read_b64_tr_b16 a[114:115],v200 offset:33024
s_waitcnt lgkmcnt(4)
v_mfma_f32_32x32x16_bf16 v[128:143],a[128:131],a[0:3],v[128:143]
ds_read_b64_tr_b16 a[116:117],v200 offset:33792
ds_read_b64_tr_b16 a[118:119],v200 offset:34048
v_mfma_f32_32x32x16_bf16 v[128:143],a[132:135],a[4:7],v[128:143]
ds_read_b64_tr_b16 a[120:121],v200 offset:34816
ds_read_b64_tr_b16 a[122:123],v200 offset:35072
v_mfma_f32_32x32x16_bf16 v[128:143],a[136:139],a[8:11],v[128:143]
ds_read_b64_tr_b16 a[124:125],v200 offset:35840
ds_read_b64_tr_b16 a[126:127],v200 offset:36096
s_add_u32 s30,s100,115392
s_add_u32 m0,s60,88064
s_nop 0
buffer_load_dwordx4 v204,s[20:23],s30 offen lds
v_mul_f32 v144,v112,v112
v_mul_f32 v145,v113,v113
v_mul_f32 v146,v114,v114
v_mul_f32 v147,v115,v115
v_mul_f32 v148,v116,v116
v_mul_f32 v149,v117,v117
s_waitcnt lgkmcnt(8)
v_mfma_f32_32x32x16_bf16 v[128:143],a[140:143],a[12:15],v[128:143]
ds_read_b64_tr_b16 a[128:129],v200 offset:36864
ds_read_b64_tr_b16 a[130:131],v200 offset:37120
v_mul_f32 v150,v118,v118
v_mul_f32 v151,v119,v119
v_fma_f32 v144,v144,s58,v210
v_fma_f32 v145,v145,s58,v210
v_fma_f32 v146,v146,s58,v210
v_fma_f32 v147,v147,s58,v210
s_waitcnt lgkmcnt(8)
v_mfma_f32_32x32x16_bf16 v[128:143],a[112:115],a[16:19],v[128:143]
ds_read_b64_tr_b16 a[132:133],v200 offset:37888
ds_read_b64_tr_b16 a[134:135],v200 offset:38144
v_fma_f32 v148,v148,s58,v210
v_fma_f32 v149,v149,s58,v210
v_fma_f32 v150,v150,s58,v210
v_fma_f32 v151,v151,s58,v210
v_mul_f32 v144,v144,v112
v_mul_f32 v145,v145,v113
s_waitcnt lgkmcnt(8)
v_mfma_f32_32x32x16_bf16 v[128:143],a[116:119],a[20:23],v[128:143]
ds_read_b64_tr_b16 a[136:137],v200 offset:38912
ds_read_b64_tr_b16 a[138:139],v200 offset:39168
v_mul_f32 v146,v146,v114
v_mul_f32 v147,v147,v115
v_mul_f32 v148,v148,v116
v_mul_f32 v149,v149,v117
v_mul_f32 v150,v150,v118
v_mul_f32 v151,v151,v119
s_waitcnt lgkmcnt(8)
v_mfma_f32_32x32x16_bf16 v[128:143],a[120:123],a[24:27],v[128:143]
ds_read_b64_tr_b16 a[140:141],v200 offset:39936
ds_read_b64_tr_b16 a[142:143],v200 offset:40192
s_add_u32 s30,s100,172736
s_add_u32 m0,s60,89088
s_nop 0
buffer_load_dwordx4 v204,s[20:23],s30 offen lds
v_exp_f32 v144,v144
v_exp_f32 v145,v145
v_exp_f32 v146,v146
v_exp_f32 v147,v147
v_exp_f32 v148,v148
s_waitcnt lgkmcnt(8)
v_mfma_f32_32x32x16_bf16 v[128:143],a[124:127],a[28:31],v[128:143]
ds_read_b64_tr_b16 a[112:113],v200 offset:40960
ds_read_b64_tr_b16 a[114:115],v200 offset:41216
v_exp_f32 v149,v149
v_exp_f32 v150,v150
v_exp_f32 v151,v151
v_add_f32 v144,1.0,v144
v_add_f32 v145,1.0,v145
s_waitcnt lgkmcnt(8)
v_mfma_f32_32x32x16_bf16 v[128:143],a[128:131],a[32:35],v[128:143]
ds_read_b64_tr_b16 a[116:117],v200 offset:41984
ds_read_b64_tr_b16 a[118:119],v200 offset:42240
v_add_f32 v146,1.0,v146
v_add_f32 v147,1.0,v147
v_add_f32 v148,1.0,v148
v_add_f32 v149,1.0,v149
v_add_f32 v150,1.0,v150
s_waitcnt lgkmcnt(8)
v_mfma_f32_32x32x16_bf16 v[128:143],a[132:135],a[36:39],v[128:143]
ds_read_b64_tr_b16 a[120:121],v200 offset:43008
ds_read_b64_tr_b16 a[122:123],v200 offset:43264
v_add_f32 v151,1.0,v151
v_rcp_f32 v144,v144
v_rcp_f32 v145,v145
v_rcp_f32 v146,v146
v_rcp_f32 v147,v147
s_waitcnt lgkmcnt(8)
v_mfma_f32_32x32x16_bf16 v[128:143],a[136:139],a[40:43],v[128:143]
ds_read_b64_tr_b16 a[124:125],v200 offset:44032
ds_read_b64_tr_b16 a[126:127],v200 offset:44288
s_add_u32 s30,s100,230080
s_add_u32 m0,s60,90112
s_nop 0
buffer_load_dwordx4 v204,s[20:23],s30 offen lds
v_rcp_f32 v148,v148
v_rcp_f32 v149,v149
v_rcp_f32 v150,v150
v_rcp_f32 v151,v151
v_mul_f32 v144,v144,v112
s_waitcnt lgkmcnt(8)
v_mfma_f32_32x32x16_bf16 v[128:143],a[140:143],a[44:47],v[128:143]
ds_read_b64_tr_b16 a[128:129],v200 offset:45056
ds_read_b64_tr_b16 a[130:131],v200 offset:45312
v_mul_f32 v145,v145,v113
v_mul_f32 v146,v146,v114
v_mul_f32 v147,v147,v115
v_mul_f32 v148,v148,v116
v_mul_f32 v149,v149,v117
s_waitcnt lgkmcnt(8)
v_mfma_f32_32x32x16_bf16 v[128:143],a[112:115],a[48:51],v[128:143]
ds_read_b64_tr_b16 a[132:133],v200 offset:46080
ds_read_b64_tr_b16 a[134:135],v200 offset:46336
v_mul_f32 v150,v150,v118
v_mul_f32 v151,v151,v119
v_cvt_pk_bf16_f32 v64,v144,v145
v_cvt_pk_bf16_f32 v65,v146,v147
v_cvt_pk_bf16_f32 v66,v148,v149
s_waitcnt lgkmcnt(8)
v_mfma_f32_32x32x16_bf16 v[128:143],a[116:119],a[52:55],v[128:143]
ds_read_b64_tr_b16 a[136:137],v200 offset:47104
ds_read_b64_tr_b16 a[138:139],v200 offset:47360
v_cvt_pk_bf16_f32 v67,v150,v151
v_mul_f32 v144,v120,v120
v_mul_f32 v145,v121,v121
v_mul_f32 v146,v122,v122
v_mul_f32 v147,v123,v123
s_waitcnt lgkmcnt(8)
v_mfma_f32_32x32x16_bf16 v[128:143],a[120:123],a[56:59],v[128:143]
ds_read_b64_tr_b16 a[140:141],v200 offset:48128
ds_read_b64_tr_b16 a[142:143],v200 offset:48384
s_add_u32 s30,s100,287424
s_add_u32 m0,s60,91136
s_nop 0
buffer_load_dwordx4 v204,s[20:23],s30 offen lds
v_mul_f32 v148,v124,v124
v_mul_f32 v149,v125,v125
v_mul_f32 v150,v126,v126
v_mul_f32 v151,v127,v127
v_fma_f32 v144,v144,s58,v210
s_waitcnt lgkmcnt(8)
v_mfma_f32_32x32x16_bf16 v[128:143],a[124:127],a[60:63],v[128:143]
ds_read_b64_tr_b16 a[112:113],v200 offset:49152
ds_read_b64_tr_b16 a[114:115],v200 offset:49408
v_fma_f32 v145,v145,s58,v210
v_fma_f32 v146,v146,s58,v210
v_fma_f32 v147,v147,s58,v210
v_fma_f32 v148,v148,s58,v210
v_fma_f32 v149,v149,s58,v210
s_waitcnt lgkmcnt(8)
v_mfma_f32_32x32x16_bf16 v[128:143],a[128:131],a[64:67],v[128:143]
ds_read_b64_tr_b16 a[116:117],v200 offset:50176
ds_read_b64_tr_b16 a[118:119],v200 offset:50432
v_fma_f32 v150,v150,s58,v210
v_fma_f32 v151,v151,s58,v210
v_mul_f32 v144,v144,v120
v_mul_f32 v145,v145,v121
v_mul_f32 v146,v146,v122
s_waitcnt lgkmcnt(8)
v_mfma_f32_32x32x16_bf16 v[128:143],a[132:135],a[68:71],v[128:143]
ds_read_b64_tr_b16 a[120:121],v200 offset:51200
ds_read_b64_tr_b16 a[122:123],v200 offset:51456
v_mul_f32 v147,v147,v123
v_mul_f32 v148,v148,v124
v_mul_f32 v149,v149,v125
v_mul_f32 v150,v150,v126
v_mul_f32 v151,v151,v127
s_waitcnt lgkmcnt(8)
v_mfma_f32_32x32x16_bf16 v[128:143],a[136:139],a[72:75],v[128:143]
ds_read_b64_tr_b16 a[124:125],v200 offset:52224
ds_read_b64_tr_b16 a[126:127],v200 offset:52480
s_add_u32 s30,s100,344768
s_add_u32 m0,s60,92160
s_nop 0
buffer_load_dwordx4 v204,s[20:23],s30 offen lds
v_exp_f32 v144,v144
v_exp_f32 v145,v145
v_exp_f32 v146,v146
v_exp_f32 v147,v147
v_exp_f32 v148,v148
s_waitcnt lgkmcnt(8)
v_mfma_f32_32x32x16_bf16 v[128:143],a[140:143],a[76:79],v[128:143]
ds_read_b64_tr_b16 a[128:129],v200 offset:53248
ds_read_b64_tr_b16 a[130:131],v200 offset:53504
v_exp_f32 v149,v149
v_exp_f32 v150,v150
v_exp_f32 v151,v151
v_add_f32 v144,1.0,v144
v_add_f32 v145,1.0,v145
s_waitcnt lgkmcnt(8)
v_mfma_f32_32x32x16_bf16 v[128:143],a[112:115],a[80:83],v[128:143]
ds_read_b64_tr_b16 a[132:133],v200 offset:54272
ds_read_b64_tr_b16 a[134:135],v200 offset:54528
v_add_f32 v146,1.0,v146
v_add_f32 v147,1.0,v147
v_add_f32 v148,1.0,v148
v_add_f32 v149,1.0,v149
v_add_f32 v150,1.0,v150
s_waitcnt lgkmcnt(8)
v_mfma_f32_32x32x16_bf16 v[128:143],a[116:119],a[84:87],v[128:143]
ds_read_b64_tr_b16 a[136:137],v200 offset:55296
ds_read_b64_tr_b16 a[138:139],v200 offset:55552
v_add_f32 v151,1.0,v151
v_rcp_f32 v144,v144
v_rcp_f32 v145,v145
v_rcp_f32 v146,v146
v_rcp_f32 v147,v147
s_waitcnt vmcnt(7)
s_barrier
s_waitcnt lgkmcnt(8)
v_mfma_f32_32x32x16_bf16 v[128:143],a[120:123],a[88:91],v[128:143]
ds_read_b64_tr_b16 a[140:141],v200 offset:56320
ds_read_b64_tr_b16 a[142:143],v200 offset:56576
s_add_u32 s30,s100,768
s_add_u32 m0,s60,0
s_nop 0
buffer_load_dwordx4 v204,s[20:23],s30 offen lds
v_rcp_f32 v148,v148
v_rcp_f32 v149,v149
v_rcp_f32 v150,v150
v_rcp_f32 v151,v151
v_mul_f32 v144,v144,v120
s_waitcnt lgkmcnt(8)
v_mfma_f32_32x32x16_bf16 v[128:143],a[124:127],a[92:95],v[128:143]
ds_read_b64_tr_b16 a[112:113],v201 offset:0
ds_read_b64_tr_b16 a[114:115],v201 offset:256
v_mul_f32 v145,v145,v121
v_mul_f32 v146,v146,v122
v_mul_f32 v147,v147,v123
v_mul_f32 v148,v148,v124
v_mul_f32 v149,v149,v125
s_waitcnt lgkmcnt(8)
v_mfma_f32_32x32x16_bf16 v[128:143],a[128:131],a[96:99],v[128:143]
ds_read_b64_tr_b16 a[116:117],v201 offset:1024
ds_read_b64_tr_b16 a[118:119],v201 offset:1280
v_mul_f32 v150,v150,v126
v_mul_f32 v151,v151,v127
v_cvt_pk_bf16_f32 v68,v144,v145
v_cvt_pk_bf16_f32 v69,v146,v147
v_cvt_pk_bf16_f32 v70,v148,v149
s_waitcnt lgkmcnt(8)
v_mfma_f32_32x32x16_bf16 v[128:143],a[132:135],a[100:103],v[128:143]
ds_read_b64_tr_b16 a[120:121],v201 offset:2048
ds_read_b64_tr_b16 a[122:123],v201 offset:2304
v_cvt_pk_bf16_f32 v71,v150,v151
ds_read_b128 v[112:115],v220 offset:1280
ds_read_b128 v[116:119],v220 offset:1312
ds_read_b128 v[120:123],v220 offset:1344
ds_read_b128 v[124:127],v220 offset:1376
s_waitcnt lgkmcnt(12)
v_mfma_f32_32x32x16_bf16 v[128:143],a[136:139],a[104:107],v[128:143]
ds_read_b64_tr_b16 a[124:125],v201 offset:3072
ds_read_b64_tr_b16 a[126:127],v201 offset:3328
s_add_u32 s30,s100,58112
s_add_u32 m0,s60,1024
s_nop 0
buffer_load_dwordx4 v204,s[20:23],s30 offen lds
s_waitcnt lgkmcnt(12)
v_mfma_f32_32x32x16_bf16 v[128:143],a[140:143],a[108:111],v[128:143]
ds_read_b64_tr_b16 a[128:129],v201 offset:4096
ds_read_b64_tr_b16 a[130:131],v201 offset:4352
s_waitcnt lgkmcnt(4)
v_mfma_f32_32x32x16_bf16 v[112:127],a[112:115],a[0:3],v[112:127]
ds_read_b64_tr_b16 a[132:133],v201 offset:5120
ds_read_b64_tr_b16 a[134:135],v201 offset:5376
v_mfma_f32_32x32x16_bf16 v[112:127],a[116:119],a[4:7],v[112:127]
ds_read_b64_tr_b16 a[136:137],v201 offset:6144
ds_read_b64_tr_b16 a[138:139],v201 offset:6400
v_mfma_f32_32x32x16_bf16 v[112:127],a[120:123],a[8:11],v[112:127]
ds_read_b64_tr_b16 a[140:141],v201 offset:7168
ds_read_b64_tr_b16 a[142:143],v201 offset:7424
s_add_u32 s30,s100,115456
s_add_u32 m0,s60,2048
s_nop 0
buffer_load_dwordx4 v204,s[20:23],s30 offen lds
v_mul_f32 v144,v128,v128
v_mul_f32 v145,v129,v129
v_mul_f32 v146,v130,v130
v_mul_f32 v147,v131,v131
v_mul_f32 v148,v132,v132
v_mul_f32 v149,v133,v133
s_waitcnt lgkmcnt(8)
v_mfma_f32_32x32x16_bf16 v[112:127],a[124:127],a[12:15],v[112:127]
ds_read_b64_tr_b16 a[112:113],v201 offset:8192
ds_read_b64_tr_b16 a[114:115],v201 offset:8448
v_mul_f32 v150,v134,v134
v_mul_f32 v151,v135,v135
v_fma_f32 v144,v144,s58,v210
v_fma_f32 v145,v145,s58,v210
v_fma_f32 v146,v146,s58,v210
v_fma_f32 v147,v147,s58,v210
s_waitcnt lgkmcnt(8)
v_mfma_f32_32x32x16_bf16 v[112:127],a[128:131],a[16:19],v[112:127]
ds_read_b64_tr_b16 a[116:117],v201 offset:9216
ds_read_b64_tr_b16 a[118:119],v201 offset:9472
v_fma_f32 v148,v148,s58,v210
v_fma_f32 v149,v149,s58,v210
v_fma_f32 v150,v150,s58,v210
v_fma_f32 v151,v151,s58,v210
v_mul_f32 v144,v144,v128
v_mul_f32 v145,v145,v129
s_waitcnt lgkmcnt(8)
v_mfma_f32_32x32x16_bf16 v[112:127],a[132:135],a[20:23],v[112:127]
ds_read_b64_tr_b16 a[120:121],v201 offset:10240
ds_read_b64_tr_b16 a[122:123],v201 offset:10496
v_mul_f32 v146,v146,v130
v_mul_f32 v147,v147,v131
v_mul_f32 v148,v148,v132
v_mul_f32 v149,v149,v133
v_mul_f32 v150,v150,v134
v_mul_f32 v151,v151,v135
s_waitcnt lgkmcnt(8)
v_mfma_f32_32x32x16_bf16 v[112:127],a[136:139],a[24:27],v[112:127]
ds_read_b64_tr_b16 a[124:125],v201 offset:11264
ds_read_b64_tr_b16 a[126:127],v201 offset:11520
s_add_u32 s30,s100,172800
s_add_u32 m0,s60,3072
s_nop 0
buffer_load_dwordx4 v204,s[20:23],s30 offen lds
v_exp_f32 v144,v144
v_exp_f32 v145,v145
v_exp_f32 v146,v146
v_exp_f32 v147,v147
v_exp_f32 v148,v148
s_waitcnt lgkmcnt(8)
v_mfma_f32_32x32x16_bf16 v[112:127],a[140:143],a[28:31],v[112:127]
ds_read_b64_tr_b16 a[128:129],v201 offset:12288
ds_read_b64_tr_b16 a[130:131],v201 offset:12544
v_exp_f32 v149,v149
v_exp_f32 v150,v150
v_exp_f32 v151,v151
v_add_f32 v144,1.0,v144
v_add_f32 v145,1.0,v145
s_waitcnt lgkmcnt(8)
v_mfma_f32_32x32x16_bf16 v[112:127],a[112:115],a[32:35],v[112:127]
ds_read_b64_tr_b16 a[132:133],v201 offset:13312
ds_read_b64_tr_b16 a[134:135],v201 offset:13568
v_add_f32 v146,1.0,v146
v_add_f32 v147,1.0,v147
v_add_f32 v148,1.0,v148
v_add_f32 v149,1.0,v149
v_add_f32 v150,1.0,v150
s_waitcnt lgkmcnt(8)
v_mfma_f32_32x32x16_bf16 v[112:127],a[116:119],a[36:39],v[112:127]
ds_read_b64_tr_b16 a[136:137],v201 offset:14336
ds_read_b64_tr_b16 a[138:139],v201 offset:14592
v_add_f32 v151,1.0,v151
v_rcp_f32 v144,v144
v_rcp_f32 v145,v145
v_rcp_f32 v146,v146
v_rcp_f32 v147,v147
s_waitcnt lgkmcnt(8)
v_mfma_f32_32x32x16_bf16 v[112:127],a[120:123],a[40:43],v[112:127]
ds_read_b64_tr_b16 a[140:141],v201 offset:15360
ds_read_b64_tr_b16 a[142:143],v201 offset:15616
s_add_u32 s30,s100,230144
s_add_u32 m0,s60,4096
s_nop 0
buffer_load_dwordx4 v204,s[20:23],s30 offen lds
v_rcp_f32 v148,v148
v_rcp_f32 v149,v149
v_rcp_f32 v150,v150
v_rcp_f32 v151,v151
v_mul_f32 v144,v144,v128
s_waitcnt lgkmcnt(8)
v_mfma_f32_32x32x16_bf16 v[112:127],a[124:127],a[44:47],v[112:127]
ds_read_b64_tr_b16 a[112:113],v201 offset:16384
ds_read_b64_tr_b16 a[114:115],v201 offset:16640
v_mul_f32 v145,v145,v129
v_mul_f32 v146,v146,v130
v_mul_f32 v147,v147,v131
v_mul_f32 v148,v148,v132
v_mul_f32 v149,v149,v133
s_waitcnt lgkmcnt(8)
v_mfma_f32_32x32x16_bf16 v[112:127],a[128:131],a[48:51],v[112:127]
ds_read_b64_tr_b16 a[116:117],v201 offset:17408
ds_read_b64_tr_b16 a[118:119],v201 offset:17664
v_mul_f32 v150,v150,v134
v_mul_f32 v151,v151,v135
v_cvt_pk_bf16_f32 v72,v144,v145
v_cvt_pk_bf16_f32 v73,v146,v147
v_cvt_pk_bf16_f32 v74,v148,v149
s_waitcnt lgkmcnt(8)
v_mfma_f32_32x32x16_bf16 v[112:127],a[132:135],a[52:55],v[112:127]
ds_read_b64_tr_b16 a[120:121],v201 offset:18432
ds_read_b64_tr_b16 a[122:123],v201 offset:18688
v_cvt_pk_bf16_f32 v75,v150,v151
v_mul_f32 v144,v136,v136
v_mul_f32 v145,v137,v137
v_mul_f32 v146,v138,v138
v_mul_f32 v147,v139,v139
s_waitcnt lgkmcnt(8)
v_mfma_f32_32x32x16_bf16 v[112:127],a[136:139],a[56:59],v[112:127]
ds_read_b64_tr_b16 a[124:125],v201 offset:19456
ds_read_b64_tr_b16 a[126:127],v201 offset:19712
s_add_u32 s30,s100,287488
s_add_u32 m0,s60,5120
s_nop 0
buffer_load_dwordx4 v204,s[20:23],s30 offen lds
v_mul_f32 v148,v140,v140
v_mul_f32 v149,v141,v141
v_mul_f32 v150,v142,v142
v_mul_f32 v151,v143,v143
v_fma_f32 v144,v144,s58,v210
s_waitcnt lgkmcnt(8)
v_mfma_f32_32x32x16_bf16 v[112:127],a[140:143],a[60:63],v[112:127]
ds_read_b64_tr_b16 a[128:129],v201 offset:20480
ds_read_b64_tr_b16 a[130:131],v201 offset:20736
v_fma_f32 v145,v145,s58,v210
v_fma_f32 v146,v146,s58,v210
v_fma_f32 v147,v147,s58,v210
v_fma_f32 v148,v148,s58,v210
v_fma_f32 v149,v149,s58,v210
s_waitcnt lgkmcnt(8)
v_mfma_f32_32x32x16_bf16 v[112:127],a[112:115],a[64:67],v[112:127]
ds_read_b64_tr_b16 a[132:133],v201 offset:21504
ds_read_b64_tr_b16 a[134:135],v201 offset:21760
v_fma_f32 v150,v150,s58,v210
v_fma_f32 v151,v151,s58,v210
v_mul_f32 v144,v144,v136
v_mul_f32 v145,v145,v137
v_mul_f32 v146,v146,v138
s_waitcnt lgkmcnt(8)
v_mfma_f32_32x32x16_bf16 v[112:127],a[116:119],a[68:71],v[112:127]
ds_read_b64_tr_b16 a[136:137],v201 offset:22528
ds_read_b64_tr_b16 a[138:139],v201 offset:22784
v_mul_f32 v147,v147,v139
v_mul_f32 v148,v148,v140
v_mul_f32 v149,v149,v141
v_mul_f32 v150,v150,v142
v_mul_f32 v151,v151,v143
s_waitcnt lgkmcnt(8)
v_mfma_f32_32x32x16_bf16 v[112:127],a[120:123],a[72:75],v[112:127]
ds_read_b64_tr_b16 a[140:141],v201 offset:23552
ds_read_b64_tr_b16 a[142:143],v201 offset:23808
s_add_u32 s30,s100,344832
s_add_u32 m0,s60,6144
s_nop 0
buffer_load_dwordx4 v204,s[20:23],s30 offen lds
v_exp_f32 v144,v144
v_exp_f32 v145,v145
v_exp_f32 v146,v146
v_exp_f32 v147,v147
v_exp_f32 v148,v148
s_waitcnt lgkmcnt(8)
v_mfma_f32_32x32x16_bf16 v[112:127],a[124:127],a[76:79],v[112:127]
ds_read_b64_tr_b16 a[112:113],v201 offset:24576
ds_read_b64_tr_b16 a[114:115],v201 offset:24832
v_exp_f32 v149,v149
v_exp_f32 v150,v150
v_exp_f32 v151,v151
v_add_f32 v144,1.0,v144
v_add_f32 v145,1.0,v145
s_waitcnt lgkmcnt(8)
v_mfma_f32_32x32x16_bf16 v[112:127],a[128:131],a[80:83],v[112:127]
ds_read_b64_tr_b16 a[116:117],v201 offset:25600
ds_read_b64_tr_b16 a[118:119],v201 offset:25856
v_add_f32 v146,1.0,v146
v_add_f32 v147,1.0,v147
v_add_f32 v148,1.0,v148
v_add_f32 v149,1.0,v149
v_add_f32 v150,1.0,v150
s_waitcnt lgkmcnt(8)
v_mfma_f32_32x32x16_bf16 v[112:127],a[132:135],a[84:87],v[112:127]
ds_read_b64_tr_b16 a[120:121],v201 offset:26624
ds_read_b64_tr_b16 a[122:123],v201 offset:26880
v_add_f32 v151,1.0,v151
v_rcp_f32 v144,v144
v_rcp_f32 v145,v145
v_rcp_f32 v146,v146
v_rcp_f32 v147,v147
s_waitcnt vmcnt(7)
s_barrier
s_waitcnt lgkmcnt(8)
v_mfma_f32_32x32x16_bf16 v[112:127],a[136:139],a[88:91],v[112:127]
ds_read_b64_tr_b16 a[124:125],v201 offset:27648
ds_read_b64_tr_b16 a[126:127],v201 offset:27904
s_add_u32 s30,s100,832
s_add_u32 m0,s60,28672
s_nop 0
buffer_load_dwordx4 v204,s[20:23],s30 offen lds
v_rcp_f32 v148,v148
v_rcp_f32 v149,v149
v_rcp_f32 v150,v150
v_rcp_f32 v151,v151
v_mul_f32 v144,v144,v136
s_waitcnt lgkmcnt(8)
v_mfma_f32_32x32x16_bf16 v[112:127],a[140:143],a[92:95],v[112:127]
ds_read_b64_tr_b16 a[128:129],v201 offset:28672
ds_read_b64_tr_b16 a[130:131],v201 offset:28928
v_mul_f32 v145,v145,v137
v_mul_f32 v146,v146,v138
v_mul_f32 v147,v147,v139
v_mul_f32 v148,v148,v140
v_mul_f32 v149,v149,v141
s_waitcnt lgkmcnt(8)
v_mfma_f32_32x32x16_bf16 v[112:127],a[112:115],a[96:99],v[112:127]
ds_read_b64_tr_b16 a[132:133],v201 offset:29696
ds_read_b64_tr_b16 a[134:135],v201 offset:29952
v_mul_f32 v150,v150,v142
v_mul_f32 v151,v151,v143
v_cvt_pk_bf16_f32 v76,v144,v145
v_cvt_pk_bf16_f32 v77,v146,v147
v_cvt_pk_bf16_f32 v78,v148,v149
s_waitcnt lgkmcnt(8)
v_mfma_f32_32x32x16_bf16 v[112:127],a[116:119],a[100:103],v[112:127]
ds_read_b64_tr_b16 a[136:137],v201 offset:30720
ds_read_b64_tr_b16 a[138:139],v201 offset:30976
v_cvt_pk_bf16_f32 v79,v150,v151
ds_read_b128 v[128:131],v220 offset:1408
ds_read_b128 v[132:135],v220 offset:1440
ds_read_b128 v[136:139],v220 offset:1472
ds_read_b128 v[140:143],v220 offset:1504
s_waitcnt lgkmcnt(12)
v_mfma_f32_32x32x16_bf16 v[112:127],a[120:123],a[104:107],v[112:127]
ds_read_b64_tr_b16 a[140:141],v201 offset:31744
ds_read_b64_tr_b16 a[142:143],v201 offset:32000
s_add_u32 s30,s100,58176
s_add_u32 m0,s60,29696
s_nop 0
buffer_load_dwordx4 v204,s[20:23],s30 offen lds
s_waitcnt lgkmcnt(12)
v_mfma_f32_32x32x16_bf16 v[112:127],a[124:127],a[108:111],v[112:127]
ds_read_b64_tr_b16 a[112:113],v201 offset:32768
ds_read_b64_tr_b16 a[114:115],v201 offset:33024
s_waitcnt lgkmcnt(4)
v_mfma_f32_32x32x16_bf16 v[128:143],a[128:131],a[0:3],v[128:143]
ds_read_b64_tr_b16 a[116:117],v201 offset:33792
ds_read_b64_tr_b16 a[118:119],v201 offset:34048
v_mfma_f32_32x32x16_bf16 v[128:143],a[132:135],a[4:7],v[128:143]
ds_read_b64_tr_b16 a[120:121],v201 offset:34816
ds_read_b64_tr_b16 a[122:123],v201 offset:35072
v_mfma_f32_32x32x16_bf16 v[128:143],a[136:139],a[8:11],v[128:143]
ds_read_b64_tr_b16 a[124:125],v201 offset:35840
ds_read_b64_tr_b16 a[126:127],v201 offset:36096
s_add_u32 s30,s100,115520
s_add_u32 m0,s60,30720
s_nop 0
buffer_load_dwordx4 v204,s[20:23],s30 offen lds
v_mul_f32 v144,v112,v112
v_mul_f32 v145,v113,v113
v_mul_f32 v146,v114,v114
v_mul_f32 v147,v115,v115
v_mul_f32 v148,v116,v116
v_mul_f32 v149,v117,v117
s_waitcnt lgkmcnt(8)
v_mfma_f32_32x32x16_bf16 v[128:143],a[140:143],a[12:15],v[128:143]
ds_read_b64_tr_b16 a[128:129],v201 offset:36864
ds_read_b64_tr_b16 a[130:131],v201 offset:37120
v_mul_f32 v150,v118,v118
v_mul_f32 v151,v119,v119
v_fma_f32 v144,v144,s58,v210
v_fma_f32 v145,v145,s58,v210
v_fma_f32 v146,v146,s58,v210
v_fma_f32 v147,v147,s58,v210
s_waitcnt lgkmcnt(8)
v_mfma_f32_32x32x16_bf16 v[128:143],a[112:115],a[16:19],v[128:143]
ds_read_b64_tr_b16 a[132:133],v201 offset:37888
ds_read_b64_tr_b16 a[134:135],v201 offset:38144
v_fma_f32 v148,v148,s58,v210
v_fma_f32 v149,v149,s58,v210
v_fma_f32 v150,v150,s58,v210
v_fma_f32 v151,v151,s58,v210
v_mul_f32 v144,v144,v112
v_mul_f32 v145,v145,v113
s_waitcnt lgkmcnt(8)
v_mfma_f32_32x32x16_bf16 v[128:143],a[116:119],a[20:23],v[128:143]
ds_read_b64_tr_b16 a[136:137],v201 offset:38912
ds_read_b64_tr_b16 a[138:139],v201 offset:39168
v_mul_f32 v146,v146,v114
v_mul_f32 v147,v147,v115
v_mul_f32 v148,v148,v116
v_mul_f32 v149,v149,v117
v_mul_f32 v150,v150,v118
v_mul_f32 v151,v151,v119
s_waitcnt lgkmcnt(8)
v_mfma_f32_32x32x16_bf16 v[128:143],a[120:123],a[24:27],v[128:143]
ds_read_b64_tr_b16 a[140:141],v201 offset:39936
ds_read_b64_tr_b16 a[142:143],v201 offset:40192
s_add_u32 s30,s100,172864
s_add_u32 m0,s60,31744
s_nop 0
buffer_load_dwordx4 v204,s[20:23],s30 offen lds
v_exp_f32 v144,v144
v_exp_f32 v145,v145
v_exp_f32 v146,v146
v_exp_f32 v147,v147
v_exp_f32 v148,v148
s_waitcnt lgkmcnt(8)
v_mfma_f32_32x32x16_bf16 v[128:143],a[124:127],a[28:31],v[128:143]
ds_read_b64_tr_b16 a[112:113],v201 offset:40960
ds_read_b64_tr_b16 a[114:115],v201 offset:41216
v_exp_f32 v149,v149
v_exp_f32 v150,v150
v_exp_f32 v151,v151
v_add_f32 v144,1.0,v144
v_add_f32 v145,1.0,v145
s_waitcnt lgkmcnt(8)
v_mfma_f32_32x32x16_bf16 v[128:143],a[128:131],a[32:35],v[128:143]
ds_read_b64_tr_b16 a[116:117],v201 offset:41984
ds_read_b64_tr_b16 a[118:119],v201 offset:42240
v_add_f32 v146,1.0,v146
v_add_f32 v147,1.0,v147
v_add_f32 v148,1.0,v148
v_add_f32 v149,1.0,v149
v_add_f32 v150,1.0,v150
s_waitcnt lgkmcnt(8)
v_mfma_f32_32x32x16_bf16 v[128:143],a[132:135],a[36:39],v[128:143]
ds_read_b64_tr_b16 a[120:121],v201 offset:43008
ds_read_b64_tr_b16 a[122:123],v201 offset:43264
v_add_f32 v151,1.0,v151
v_rcp_f32 v144,v144
v_rcp_f32 v145,v145
v_rcp_f32 v146,v146
v_rcp_f32 v147,v147
s_waitcnt lgkmcnt(8)
v_mfma_f32_32x32x16_bf16 v[128:143],a[136:139],a[40:43],v[128:143]
ds_read_b64_tr_b16 a[124:125],v201 offset:44032
ds_read_b64_tr_b16 a[126:127],v201 offset:44288
s_add_u32 s30,s100,230208
s_add_u32 m0,s60,32768
s_nop 0
buffer_load_dwordx4 v204,s[20:23],s30 offen lds
v_rcp_f32 v148,v148
v_rcp_f32 v149,v149
v_rcp_f32 v150,v150
v_rcp_f32 v151,v151
v_mul_f32 v144,v144,v112
s_waitcnt lgkmcnt(8)
v_mfma_f32_32x32x16_bf16 v[128:143],a[140:143],a[44:47],v[128:143]
ds_read_b64_tr_b16 a[128:129],v201 offset:45056
ds_read_b64_tr_b16 a[130:131],v201 offset:45312
v_mul_f32 v145,v145,v113
v_mul_f32 v146,v146,v114
v_mul_f32 v147,v147,v115
v_mul_f32 v148,v148,v116
v_mul_f32 v149,v149,v117
s_waitcnt lgkmcnt(8)
v_mfma_f32_32x32x16_bf16 v[128:143],a[112:115],a[48:51],v[128:143]
ds_read_b64_tr_b16 a[132:133],v201 offset:46080
ds_read_b64_tr_b16 a[134:135],v201 offset:46336
v_mul_f32 v150,v150,v118
v_mul_f32 v151,v151,v119
v_cvt_pk_bf16_f32 v80,v144,v145
v_cvt_pk_bf16_f32 v81,v146,v147
v_cvt_pk_bf16_f32 v82,v148,v149
s_waitcnt lgkmcnt(8)
v_mfma_f32_32x32x16_bf16 v[128:143],a[116:119],a[52:55],v[128:143]
ds_read_b64_tr_b16 a[136:137],v201 offset:47104
ds_read_b64_tr_b16 a[138:139],v201 offset:47360
v_cvt_pk_bf16_f32 v83,v150,v151
v_mul_f32 v144,v120,v120
v_mul_f32 v145,v121,v121
v_mul_f32 v146,v122,v122
v_mul_f32 v147,v123,v123
s_waitcnt lgkmcnt(8)
v_mfma_f32_32x32x16_bf16 v[128:143],a[120:123],a[56:59],v[128:143]
ds_read_b64_tr_b16 a[140:141],v201 offset:48128
ds_read_b64_tr_b16 a[142:143],v201 offset:48384
s_add_u32 s30,s100,287552
s_add_u32 m0,s60,33792
s_nop 0
buffer_load_dwordx4 v204,s[20:23],s30 offen lds
v_mul_f32 v148,v124,v124
v_mul_f32 v149,v125,v125
v_mul_f32 v150,v126,v126
v_mul_f32 v151,v127,v127
v_fma_f32 v144,v144,s58,v210
s_waitcnt lgkmcnt(8)
v_mfma_f32_32x32x16_bf16 v[128:143],a[124:127],a[60:63],v[128:143]
ds_read_b64_tr_b16 a[112:113],v201 offset:49152
ds_read_b64_tr_b16 a[114:115],v201 offset:49408
v_fma_f32 v145,v145,s58,v210
v_fma_f32 v146,v146,s58,v210
v_fma_f32 v147,v147,s58,v210
v_fma_f32 v148,v148,s58,v210
v_fma_f32 v149,v149,s58,v210
s_waitcnt lgkmcnt(8)
v_mfma_f32_32x32x16_bf16 v[128:143],a[128:131],a[64:67],v[128:143]
ds_read_b64_tr_b16 a[116:117],v201 offset:50176
ds_read_b64_tr_b16 a[118:119],v201 offset:50432
v_fma_f32 v150,v150,s58,v210
v_fma_f32 v151,v151,s58,v210
v_mul_f32 v144,v144,v120
v_mul_f32 v145,v145,v121
v_mul_f32 v146,v146,v122
s_waitcnt lgkmcnt(8)
v_mfma_f32_32x32x16_bf16 v[128:143],a[132:135],a[68:71],v[128:143]
ds_read_b64_tr_b16 a[120:121],v201 offset:51200
ds_read_b64_tr_b16 a[122:123],v201 offset:51456
v_mul_f32 v147,v147,v123
v_mul_f32 v148,v148,v124
v_mul_f32 v149,v149,v125
v_mul_f32 v150,v150,v126
v_mul_f32 v151,v151,v127
s_waitcnt lgkmcnt(8)
v_mfma_f32_32x32x16_bf16 v[128:143],a[136:139],a[72:75],v[128:143]
ds_read_b64_tr_b16 a[124:125],v201 offset:52224
ds_read_b64_tr_b16 a[126:127],v201 offset:52480
s_add_u32 s30,s100,344896
s_add_u32 m0,s60,34816
s_nop 0
buffer_load_dwordx4 v204,s[20:23],s30 offen lds
v_exp_f32 v144,v144
v_exp_f32 v145,v145
v_exp_f32 v146,v146
v_exp_f32 v147,v147
v_exp_f32 v148,v148
s_waitcnt lgkmcnt(8)
v_mfma_f32_32x32x16_bf16 v[128:143],a[140:143],a[76:79],v[128:143]
ds_read_b64_tr_b16 a[128:129],v201 offset:53248
ds_read_b64_tr_b16 a[130:131],v201 offset:53504
v_exp_f32 v149,v149
v_exp_f32 v150,v150
v_exp_f32 v151,v151
v_add_f32 v144,1.0,v144
v_add_f32 v145,1.0,v145
s_waitcnt lgkmcnt(8)
v_mfma_f32_32x32x16_bf16 v[128:143],a[112:115],a[80:83],v[128:143]
ds_read_b64_tr_b16 a[132:133],v201 offset:54272
ds_read_b64_tr_b16 a[134:135],v201 offset:54528
v_add_f32 v146,1.0,v146
v_add_f32 v147,1.0,v147
v_add_f32 v148,1.0,v148
v_add_f32 v149,1.0,v149
v_add_f32 v150,1.0,v150
s_waitcnt lgkmcnt(8)
v_mfma_f32_32x32x16_bf16 v[128:143],a[116:119],a[84:87],v[128:143]
ds_read_b64_tr_b16 a[136:137],v201 offset:55296
ds_read_b64_tr_b16 a[138:139],v201 offset:55552
v_add_f32 v151,1.0,v151
v_rcp_f32 v144,v144
v_rcp_f32 v145,v145
v_rcp_f32 v146,v146
v_rcp_f32 v147,v147
s_waitcnt vmcnt(7)
s_barrier
s_waitcnt lgkmcnt(8)
v_mfma_f32_32x32x16_bf16 v[128:143],a[120:123],a[88:91],v[128:143]
ds_read_b64_tr_b16 a[140:141],v201 offset:56320
ds_read_b64_tr_b16 a[142:143],v201 offset:56576
s_add_u32 s30,s101,0
s_add_u32 m0,s60,57344
s_nop 0
buffer_load_dwordx4 v205,s[4:7],s30 offen lds
v_rcp_f32 v148,v148
v_rcp_f32 v149,v149
v_rcp_f32 v150,v150
v_rcp_f32 v151,v151
v_mul_f32 v144,v144,v120
s_waitcnt lgkmcnt(8)
v_mfma_f32_32x32x16_bf16 v[128:143],a[124:127],a[92:95],v[128:143]
ds_read_b64_tr_b16 a[112:113],v200 offset:0
ds_read_b64_tr_b16 a[114:115],v200 offset:256
v_mul_f32 v145,v145,v121
v_mul_f32 v146,v146,v122
v_mul_f32 v147,v147,v123
v_mul_f32 v148,v148,v124
v_mul_f32 v149,v149,v125
s_waitcnt lgkmcnt(8)
v_mfma_f32_32x32x16_bf16 v[128:143],a[128:131],a[96:99],v[128:143]
ds_read_b64_tr_b16 a[116:117],v200 offset:1024
ds_read_b64_tr_b16 a[118:119],v200 offset:1280
v_mul_f32 v150,v150,v126
v_mul_f32 v151,v151,v127
v_cvt_pk_bf16_f32 v84,v144,v145
v_cvt_pk_bf16_f32 v85,v146,v147
v_cvt_pk_bf16_f32 v86,v148,v149
s_waitcnt lgkmcnt(8)
v_mfma_f32_32x32x16_bf16 v[128:143],a[132:135],a[100:103],v[128:143]
ds_read_b64_tr_b16 a[120:121],v200 offset:2048
ds_read_b64_tr_b16 a[122:123],v200 offset:2304
v_cvt_pk_bf16_f32 v87,v150,v151
ds_read_b128 v[112:115],v220 offset:1536
ds_read_b128 v[116:119],v220 offset:1568
ds_read_b128 v[120:123],v220 offset:1600
ds_read_b128 v[124:127],v220 offset:1632
s_waitcnt lgkmcnt(12)
v_mfma_f32_32x32x16_bf16 v[128:143],a[136:139],a[104:107],v[128:143]
ds_read_b64_tr_b16 a[124:125],v200 offset:3072
ds_read_b64_tr_b16 a[126:127],v200 offset:3328
s_add_u32 s30,s101,14336
s_add_u32 m0,s60,58368
s_nop 0
buffer_load_dwordx4 v205,s[4:7],s30 offen lds
s_waitcnt lgkmcnt(12)
v_mfma_f32_32x32x16_bf16 v[128:143],a[140:143],a[108:111],v[128:143]
ds_read_b64_tr_b16 a[128:129],v200 offset:4096
ds_read_b64_tr_b16 a[130:131],v200 offset:4352
s_waitcnt lgkmcnt(4)
v_mfma_f32_32x32x16_bf16 v[112:127],a[112:115],a[0:3],v[112:127]
ds_read_b64_tr_b16 a[132:133],v200 offset:5120
ds_read_b64_tr_b16 a[134:135],v200 offset:5376
v_mfma_f32_32x32x16_bf16 v[112:127],a[116:119],a[4:7],v[112:127]
ds_read_b64_tr_b16 a[136:137],v200 offset:6144
ds_read_b64_tr_b16 a[138:139],v200 offset:6400
v_mfma_f32_32x32x16_bf16 v[112:127],a[120:123],a[8:11],v[112:127]
ds_read_b64_tr_b16 a[140:141],v200 offset:7168
ds_read_b64_tr_b16 a[142:143],v200 offset:7424
s_add_u32 s30,s101,28672
s_add_u32 m0,s60,59392
s_nop 0
buffer_load_dwordx4 v205,s[4:7],s30 offen lds
v_mul_f32 v144,v128,v128
v_mul_f32 v145,v129,v129
v_mul_f32 v146,v130,v130
v_mul_f32 v147,v131,v131
v_mul_f32 v148,v132,v132
v_mul_f32 v149,v133,v133
s_waitcnt lgkmcnt(8)
v_mfma_f32_32x32x16_bf16 v[112:127],a[124:127],a[12:15],v[112:127]
ds_read_b64_tr_b16 a[112:113],v200 offset:8192
ds_read_b64_tr_b16 a[114:115],v200 offset:8448
v_mul_f32 v150,v134,v134
v_mul_f32 v151,v135,v135
v_fma_f32 v144,v144,s58,v210
v_fma_f32 v145,v145,s58,v210
v_fma_f32 v146,v146,s58,v210
v_fma_f32 v147,v147,s58,v210
s_waitcnt lgkmcnt(8)
v_mfma_f32_32x32x16_bf16 v[112:127],a[128:131],a[16:19],v[112:127]
ds_read_b64_tr_b16 a[116:117],v200 offset:9216
ds_read_b64_tr_b16 a[118:119],v200 offset:9472
v_fma_f32 v148,v148,s58,v210
v_fma_f32 v149,v149,s58,v210
v_fma_f32 v150,v150,s58,v210
v_fma_f32 v151,v151,s58,v210
v_mul_f32 v144,v144,v128
v_mul_f32 v145,v145,v129
s_waitcnt lgkmcnt(8)
v_mfma_f32_32x32x16_bf16 v[112:127],a[132:135],a[20:23],v[112:127]
ds_read_b64_tr_b16 a[120:121],v200 offset:10240
ds_read_b64_tr_b16 a[122:123],v200 offset:10496
v_mul_f32 v146,v146,v130
v_mul_f32 v147,v147,v131
v_mul_f32 v148,v148,v132
v_mul_f32 v149,v149,v133
v_mul_f32 v150,v150,v134
v_mul_f32 v151,v151,v135
s_waitcnt lgkmcnt(8)
v_mfma_f32_32x32x16_bf16 v[112:127],a[136:139],a[24:27],v[112:127]
ds_read_b64_tr_b16 a[124:125],v200 offset:11264
ds_read_b64_tr_b16 a[126:127],v200 offset:11520
s_add_u32 s30,s101,43008
s_add_u32 m0,s60,60416
s_nop 0
buffer_load_dwordx4 v205,s[4:7],s30 offen lds
v_exp_f32 v144,v144
v_exp_f32 v145,v145
v_exp_f32 v146,v146
v_exp_f32 v147,v147
v_exp_f32 v148,v148
s_waitcnt lgkmcnt(8)
v_mfma_f32_32x32x16_bf16 v[112:127],a[140:143],a[28:31],v[112:127]
ds_read_b64_tr_b16 a[128:129],v200 offset:12288
ds_read_b64_tr_b16 a[130:131],v200 offset:12544
v_exp_f32 v149,v149
v_exp_f32 v150,v150
v_exp_f32 v151,v151
v_add_f32 v144,1.0,v144
v_add_f32 v145,1.0,v145
s_waitcnt lgkmcnt(8)
v_mfma_f32_32x32x16_bf16 v[112:127],a[112:115],a[32:35],v[112:127]
ds_read_b64_tr_b16 a[132:133],v200 offset:13312
ds_read_b64_tr_b16 a[134:135],v200 offset:13568
v_add_f32 v146,1.0,v146
v_add_f32 v147,1.0,v147
v_add_f32 v148,1.0,v148
v_add_f32 v149,1.0,v149
v_add_f32 v150,1.0,v150
s_waitcnt lgkmcnt(8)
v_mfma_f32_32x32x16_bf16 v[112:127],a[116:119],a[36:39],v[112:127]
ds_read_b64_tr_b16 a[136:137],v200 offset:14336
ds_read_b64_tr_b16 a[138:139],v200 offset:14592
v_add_f32 v151,1.0,v151
v_rcp_f32 v144,v144
v_rcp_f32 v145,v145
v_rcp_f32 v146,v146
v_rcp_f32 v147,v147
s_waitcnt lgkmcnt(8)
v_mfma_f32_32x32x16_bf16 v[112:127],a[120:123],a[40:43],v[112:127]
ds_read_b64_tr_b16 a[140:141],v200 offset:15360
ds_read_b64_tr_b16 a[142:143],v200 offset:15616
s_add_u32 s30,s101,57344
s_add_u32 m0,s60,61440
s_nop 0
buffer_load_dwordx4 v205,s[4:7],s30 offen lds
v_rcp_f32 v148,v148
v_rcp_f32 v149,v149
v_rcp_f32 v150,v150
v_rcp_f32 v151,v151
v_mul_f32 v144,v144,v128
s_waitcnt lgkmcnt(8)
v_mfma_f32_32x32x16_bf16 v[112:127],a[124:127],a[44:47],v[112:127]
ds_read_b64_tr_b16 a[112:113],v200 offset:16384
ds_read_b64_tr_b16 a[114:115],v200 offset:16640
v_mul_f32 v145,v145,v129
v_mul_f32 v146,v146,v130
v_mul_f32 v147,v147,v131
v_mul_f32 v148,v148,v132
v_mul_f32 v149,v149,v133
s_waitcnt lgkmcnt(8)
v_mfma_f32_32x32x16_bf16 v[112:127],a[128:131],a[48:51],v[112:127]
ds_read_b64_tr_b16 a[116:117],v200 offset:17408
ds_read_b64_tr_b16 a[118:119],v200 offset:17664
v_mul_f32 v150,v150,v134
v_mul_f32 v151,v151,v135
v_cvt_pk_bf16_f32 v88,v144,v145
v_cvt_pk_bf16_f32 v89,v146,v147
v_cvt_pk_bf16_f32 v90,v148,v149
s_waitcnt lgkmcnt(8)
v_mfma_f32_32x32x16_bf16 v[112:127],a[132:135],a[52:55],v[112:127]
ds_read_b64_tr_b16 a[120:121],v200 offset:18432
ds_read_b64_tr_b16 a[122:123],v200 offset:18688
v_cvt_pk_bf16_f32 v91,v150,v151
v_mul_f32 v144,v136,v136
v_mul_f32 v145,v137,v137
v_mul_f32 v146,v138,v138
v_mul_f32 v147,v139,v139
s_waitcnt lgkmcnt(8)
v_mfma_f32_32x32x16_bf16 v[112:127],a[136:139],a[56:59],v[112:127]
ds_read_b64_tr_b16 a[124:125],v200 offset:19456
ds_read_b64_tr_b16 a[126:127],v200 offset:19712
s_add_u32 s30,s101,71680
s_add_u32 m0,s60,62464
s_nop 0
buffer_load_dwordx4 v205,s[4:7],s30 offen lds
v_mul_f32 v148,v140,v140
v_mul_f32 v149,v141,v141
v_mul_f32 v150,v142,v142
v_mul_f32 v151,v143,v143
v_fma_f32 v144,v144,s58,v210
s_waitcnt lgkmcnt(8)
v_mfma_f32_32x32x16_bf16 v[112:127],a[140:143],a[60:63],v[112:127]
ds_read_b64_tr_b16 a[128:129],v200 offset:20480
ds_read_b64_tr_b16 a[130:131],v200 offset:20736
v_fma_f32 v145,v145,s58,v210
v_fma_f32 v146,v146,s58,v210
v_fma_f32 v147,v147,s58,v210
v_fma_f32 v148,v148,s58,v210
v_fma_f32 v149,v149,s58,v210
s_waitcnt lgkmcnt(8)
v_mfma_f32_32x32x16_bf16 v[112:127],a[112:115],a[64:67],v[112:127]
ds_read_b64_tr_b16 a[132:133],v200 offset:21504
ds_read_b64_tr_b16 a[134:135],v200 offset:21760
v_fma_f32 v150,v150,s58,v210
v_fma_f32 v151,v151,s58,v210
v_mul_f32 v144,v144,v136
v_mul_f32 v145,v145,v137
v_mul_f32 v146,v146,v138
s_waitcnt lgkmcnt(8)
v_mfma_f32_32x32x16_bf16 v[112:127],a[116:119],a[68:71],v[112:127]
ds_read_b64_tr_b16 a[136:137],v200 offset:22528
ds_read_b64_tr_b16 a[138:139],v200 offset:22784
v_mul_f32 v147,v147,v139
v_mul_f32 v148,v148,v140
v_mul_f32 v149,v149,v141
v_mul_f32 v150,v150,v142
v_mul_f32 v151,v151,v143
s_waitcnt lgkmcnt(8)
v_mfma_f32_32x32x16_bf16 v[112:127],a[120:123],a[72:75],v[112:127]
ds_read_b64_tr_b16 a[140:141],v200 offset:23552
ds_read_b64_tr_b16 a[142:143],v200 offset:23808
s_add_u32 s30,s101,86016
s_add_u32 m0,s60,63488
s_nop 0
buffer_load_dwordx4 v205,s[4:7],s30 offen lds
v_exp_f32 v144,v144
v_exp_f32 v145,v145
v_exp_f32 v146,v146
v_exp_f32 v147,v147
v_exp_f32 v148,v148
s_waitcnt lgkmcnt(8)
v_mfma_f32_32x32x16_bf16 v[112:127],a[124:127],a[76:79],v[112:127]
ds_read_b64_tr_b16 a[112:113],v200 offset:24576
ds_read_b64_tr_b16 a[114:115],v200 offset:24832
v_exp_f32 v149,v149
v_exp_f32 v150,v150
v_exp_f32 v151,v151
v_add_f32 v144,1.0,v144
v_add_f32 v145,1.0,v145
s_waitcnt lgkmcnt(8)
v_mfma_f32_32x32x16_bf16 v[112:127],a[128:131],a[80:83],v[112:127]
ds_read_b64_tr_b16 a[116:117],v200 offset:25600
ds_read_b64_tr_b16 a[118:119],v200 offset:25856
v_add_f32 v146,1.0,v146
v_add_f32 v147,1.0,v147
v_add_f32 v148,1.0,v148
v_add_f32 v149,1.0,v149
v_add_f32 v150,1.0,v150
s_waitcnt lgkmcnt(8)
v_mfma_f32_32x32x16_bf16 v[112:127],a[132:135],a[84:87],v[112:127]
ds_read_b64_tr_b16 a[120:121],v200 offset:26624
ds_read_b64_tr_b16 a[122:123],v200 offset:26880
v_add_f32 v151,1.0,v151
v_rcp_f32 v144,v144
v_rcp_f32 v145,v145
v_rcp_f32 v146,v146
v_rcp_f32 v147,v147
s_waitcnt vmcnt(7)
s_barrier
s_waitcnt lgkmcnt(8)
v_mfma_f32_32x32x16_bf16 v[112:127],a[136:139],a[88:91],v[112:127]
ds_read_b64_tr_b16 a[124:125],v200 offset:27648
ds_read_b64_tr_b16 a[126:127],v200 offset:27904
s_add_u32 s30,s101,64
s_add_u32 m0,s60,86016
s_nop 0
buffer_load_dwordx4 v205,s[4:7],s30 offen lds
v_rcp_f32 v148,v148
v_rcp_f32 v149,v149
v_rcp_f32 v150,v150
v_rcp_f32 v151,v151
v_mul_f32 v144,v144,v136
s_waitcnt lgkmcnt(8)
v_mfma_f32_32x32x16_bf16 v[112:127],a[140:143],a[92:95],v[112:127]
ds_read_b64_tr_b16 a[128:129],v200 offset:28672
ds_read_b64_tr_b16 a[130:131],v200 offset:28928
v_mul_f32 v145,v145,v137
v_mul_f32 v146,v146,v138
v_mul_f32 v147,v147,v139
v_mul_f32 v148,v148,v140
v_mul_f32 v149,v149,v141
s_waitcnt lgkmcnt(8)
v_mfma_f32_32x32x16_bf16 v[112:127],a[112:115],a[96:99],v[112:127]
ds_read_b64_tr_b16 a[132:133],v200 offset:29696
ds_read_b64_tr_b16 a[134:135],v200 offset:29952
v_mul_f32 v150,v150,v142
v_mul_f32 v151,v151,v143
v_cvt_pk_bf16_f32 v92,v144,v145
v_cvt_pk_bf16_f32 v93,v146,v147
v_cvt_pk_bf16_f32 v94,v148,v149
s_waitcnt lgkmcnt(8)
v_mfma_f32_32x32x16_bf16 v[112:127],a[116:119],a[100:103],v[112:127]
ds_read_b64_tr_b16 a[136:137],v200 offset:30720
ds_read_b64_tr_b16 a[138:139],v200 offset:30976
v_cvt_pk_bf16_f32 v95,v150,v151
ds_read_b128 v[128:131],v220 offset:1664
ds_read_b128 v[132:135],v220 offset:1696
ds_read_b128 v[136:139],v220 offset:1728
ds_read_b128 v[140:143],v220 offset:1760
s_waitcnt lgkmcnt(12)
v_mfma_f32_32x32x16_bf16 v[112:127],a[120:123],a[104:107],v[112:127]
ds_read_b64_tr_b16 a[140:141],v200 offset:31744
ds_read_b64_tr_b16 a[142:143],v200 offset:32000
s_add_u32 s30,s101,14400
s_add_u32 m0,s60,87040
s_nop 0
buffer_load_dwordx4 v205,s[4:7],s30 offen lds
s_waitcnt lgkmcnt(12)
v_mfma_f32_32x32x16_bf16 v[112:127],a[124:127],a[108:111],v[112:127]
ds_read_b64_tr_b16 a[112:113],v200 offset:32768
ds_read_b64_tr_b16 a[114:115],v200 offset:33024
s_waitcnt lgkmcnt(4)
v_mfma_f32_32x32x16_bf16 v[128:143],a[128:131],a[0:3],v[128:143]
ds_read_b64_tr_b16 a[116:117],v200 offset:33792
ds_read_b64_tr_b16 a[118:119],v200 offset:34048
v_mfma_f32_32x32x16_bf16 v[128:143],a[132:135],a[4:7],v[128:143]
ds_read_b64_tr_b16 a[120:121],v200 offset:34816
ds_read_b64_tr_b16 a[122:123],v200 offset:35072
v_mfma_f32_32x32x16_bf16 v[128:143],a[136:139],a[8:11],v[128:143]
ds_read_b64_tr_b16 a[124:125],v200 offset:35840
ds_read_b64_tr_b16 a[126:127],v200 offset:36096
s_add_u32 s30,s101,28736
s_add_u32 m0,s60,88064
s_nop 0
buffer_load_dwordx4 v205,s[4:7],s30 offen lds
v_mul_f32 v144,v112,v112
v_mul_f32 v145,v113,v113
v_mul_f32 v146,v114,v114
v_mul_f32 v147,v115,v115
v_mul_f32 v148,v116,v116
v_mul_f32 v149,v117,v117
s_waitcnt lgkmcnt(8)
v_mfma_f32_32x32x16_bf16 v[128:143],a[140:143],a[12:15],v[128:143]
ds_read_b64_tr_b16 a[128:129],v200 offset:36864
ds_read_b64_tr_b16 a[130:131],v200 offset:37120
v_mul_f32 v150,v118,v118
v_mul_f32 v151,v119,v119
v_fma_f32 v144,v144,s58,v210
v_fma_f32 v145,v145,s58,v210
v_fma_f32 v146,v146,s58,v210
v_fma_f32 v147,v147,s58,v210
s_waitcnt lgkmcnt(8)
v_mfma_f32_32x32x16_bf16 v[128:143],a[112:115],a[16:19],v[128:143]
ds_read_b64_tr_b16 a[132:133],v200 offset:37888
ds_read_b64_tr_b16 a[134:135],v200 offset:38144
v_fma_f32 v148,v148,s58,v210
v_fma_f32 v149,v149,s58,v210
v_fma_f32 v150,v150,s58,v210
v_fma_f32 v151,v151,s58,v210
v_mul_f32 v144,v144,v112
v_mul_f32 v145,v145,v113
s_waitcnt lgkmcnt(8)
v_mfma_f32_32x32x16_bf16 v[128:143],a[116:119],a[20:23],v[128:143]
ds_read_b64_tr_b16 a[136:137],v200 offset:38912
ds_read_b64_tr_b16 a[138:139],v200 offset:39168
v_mul_f32 v146,v146,v114
v_mul_f32 v147,v147,v115
v_mul_f32 v148,v148,v116
v_mul_f32 v149,v149,v117
v_mul_f32 v150,v150,v118
v_mul_f32 v151,v151,v119
s_waitcnt lgkmcnt(8)
v_mfma_f32_32x32x16_bf16 v[128:143],a[120:123],a[24:27],v[128:143]
ds_read_b64_tr_b16 a[140:141],v200 offset:39936
ds_read_b64_tr_b16 a[142:143],v200 offset:40192
s_add_u32 s30,s101,43072
s_add_u32 m0,s60,89088
s_nop 0
buffer_load_dwordx4 v205,s[4:7],s30 offen lds
v_exp_f32 v144,v144
v_exp_f32 v145,v145
v_exp_f32 v146,v146
v_exp_f32 v147,v147
v_exp_f32 v148,v148
s_waitcnt lgkmcnt(8)
v_mfma_f32_32x32x16_bf16 v[128:143],a[124:127],a[28:31],v[128:143]
ds_read_b64_tr_b16 a[112:113],v200 offset:40960
ds_read_b64_tr_b16 a[114:115],v200 offset:41216
v_exp_f32 v149,v149
v_exp_f32 v150,v150
v_exp_f32 v151,v151
v_add_f32 v144,1.0,v144
v_add_f32 v145,1.0,v145
s_waitcnt lgkmcnt(8)
v_mfma_f32_32x32x16_bf16 v[128:143],a[128:131],a[32:35],v[128:143]
ds_read_b64_tr_b16 a[116:117],v200 offset:41984
ds_read_b64_tr_b16 a[118:119],v200 offset:42240
v_add_f32 v146,1.0,v146
v_add_f32 v147,1.0,v147
v_add_f32 v148,1.0,v148
v_add_f32 v149,1.0,v149
v_add_f32 v150,1.0,v150
s_waitcnt lgkmcnt(8)
v_mfma_f32_32x32x16_bf16 v[128:143],a[132:135],a[36:39],v[128:143]
ds_read_b64_tr_b16 a[120:121],v200 offset:43008
ds_read_b64_tr_b16 a[122:123],v200 offset:43264
v_add_f32 v151,1.0,v151
v_rcp_f32 v144,v144
v_rcp_f32 v145,v145
v_rcp_f32 v146,v146
v_rcp_f32 v147,v147
s_waitcnt lgkmcnt(8)
v_mfma_f32_32x32x16_bf16 v[128:143],a[136:139],a[40:43],v[128:143]
ds_read_b64_tr_b16 a[124:125],v200 offset:44032
ds_read_b64_tr_b16 a[126:127],v200 offset:44288
s_add_u32 s30,s101,57408
s_add_u32 m0,s60,90112
s_nop 0
buffer_load_dwordx4 v205,s[4:7],s30 offen lds
v_rcp_f32 v148,v148
v_rcp_f32 v149,v149
v_rcp_f32 v150,v150
v_rcp_f32 v151,v151
v_mul_f32 v144,v144,v112
s_waitcnt lgkmcnt(8)
v_mfma_f32_32x32x16_bf16 v[128:143],a[140:143],a[44:47],v[128:143]
ds_read_b64_tr_b16 a[128:129],v200 offset:45056
ds_read_b64_tr_b16 a[130:131],v200 offset:45312
v_mul_f32 v145,v145,v113
v_mul_f32 v146,v146,v114
v_mul_f32 v147,v147,v115
v_mul_f32 v148,v148,v116
v_mul_f32 v149,v149,v117
s_waitcnt lgkmcnt(8)
v_mfma_f32_32x32x16_bf16 v[128:143],a[112:115],a[48:51],v[128:143]
ds_read_b64_tr_b16 a[132:133],v200 offset:46080
ds_read_b64_tr_b16 a[134:135],v200 offset:46336
v_mul_f32 v150,v150,v118
v_mul_f32 v151,v151,v119
v_cvt_pk_bf16_f32 v96,v144,v145
v_cvt_pk_bf16_f32 v97,v146,v147
v_cvt_pk_bf16_f32 v98,v148,v149
s_waitcnt lgkmcnt(8)
v_mfma_f32_32x32x16_bf16 v[128:143],a[116:119],a[52:55],v[128:143]
ds_read_b64_tr_b16 a[136:137],v200 offset:47104
ds_read_b64_tr_b16 a[138:139],v200 offset:47360
v_cvt_pk_bf16_f32 v99,v150,v151
v_mul_f32 v144,v120,v120
v_mul_f32 v145,v121,v121
v_mul_f32 v146,v122,v122
v_mul_f32 v147,v123,v123
s_waitcnt lgkmcnt(8)
v_mfma_f32_32x32x16_bf16 v[128:143],a[120:123],a[56:59],v[128:143]
ds_read_b64_tr_b16 a[140:141],v200 offset:48128
ds_read_b64_tr_b16 a[142:143],v200 offset:48384
s_add_u32 s30,s101,71744
s_add_u32 m0,s60,91136
s_nop 0
buffer_load_dwordx4 v205,s[4:7],s30 offen lds
v_mul_f32 v148,v124,v124
v_mul_f32 v149,v125,v125
v_mul_f32 v150,v126,v126
v_mul_f32 v151,v127,v127
v_fma_f32 v144,v144,s58,v210
s_waitcnt lgkmcnt(8)
v_mfma_f32_32x32x16_bf16 v[128:143],a[124:127],a[60:63],v[128:143]
ds_read_b64_tr_b16 a[112:113],v200 offset:49152
ds_read_b64_tr_b16 a[114:115],v200 offset:49408
v_fma_f32 v145,v145,s58,v210
v_fma_f32 v146,v146,s58,v210
v_fma_f32 v147,v147,s58,v210
v_fma_f32 v148,v148,s58,v210
v_fma_f32 v149,v149,s58,v210
s_waitcnt lgkmcnt(8)
v_mfma_f32_32x32x16_bf16 v[128:143],a[128:131],a[64:67],v[128:143]
ds_read_b64_tr_b16 a[116:117],v200 offset:50176
ds_read_b64_tr_b16 a[118:119],v200 offset:50432
v_fma_f32 v150,v150,s58,v210
v_fma_f32 v151,v151,s58,v210
v_mul_f32 v144,v144,v120
v_mul_f32 v145,v145,v121
v_mul_f32 v146,v146,v122
s_waitcnt lgkmcnt(8)
v_mfma_f32_32x32x16_bf16 v[128:143],a[132:135],a[68:71],v[128:143]
ds_read_b64_tr_b16 a[120:121],v200 offset:51200
ds_read_b64_tr_b16 a[122:123],v200 offset:51456
v_mul_f32 v147,v147,v123
v_mul_f32 v148,v148,v124
v_mul_f32 v149,v149,v125
v_mul_f32 v150,v150,v126
v_mul_f32 v151,v151,v127
s_waitcnt lgkmcnt(8)
v_mfma_f32_32x32x16_bf16 v[128:143],a[136:139],a[72:75],v[128:143]
ds_read_b64_tr_b16 a[124:125],v200 offset:52224
ds_read_b64_tr_b16 a[126:127],v200 offset:52480
s_add_u32 s30,s101,86080
s_add_u32 m0,s60,92160
s_nop 0
buffer_load_dwordx4 v205,s[4:7],s30 offen lds
v_exp_f32 v144,v144
v_exp_f32 v145,v145
v_exp_f32 v146,v146
v_exp_f32 v147,v147
v_exp_f32 v148,v148
s_waitcnt lgkmcnt(8)
v_mfma_f32_32x32x16_bf16 v[128:143],a[140:143],a[76:79],v[128:143]
ds_read_b64_tr_b16 a[128:129],v200 offset:53248
ds_read_b64_tr_b16 a[130:131],v200 offset:53504
v_exp_f32 v149,v149
v_exp_f32 v150,v150
v_exp_f32 v151,v151
v_add_f32 v144,1.0,v144
v_add_f32 v145,1.0,v145
s_waitcnt lgkmcnt(8)
v_mfma_f32_32x32x16_bf16 v[128:143],a[112:115],a[80:83],v[128:143]
ds_read_b64_tr_b16 a[132:133],v200 offset:54272
ds_read_b64_tr_b16 a[134:135],v200 offset:54528
v_add_f32 v146,1.0,v146
v_add_f32 v147,1.0,v147
v_add_f32 v148,1.0,v148
v_add_f32 v149,1.0,v149
v_add_f32 v150,1.0,v150
s_waitcnt lgkmcnt(8)
v_mfma_f32_32x32x16_bf16 v[128:143],a[116:119],a[84:87],v[128:143]
ds_read_b64_tr_b16 a[136:137],v200 offset:55296
ds_read_b64_tr_b16 a[138:139],v200 offset:55552
v_add_f32 v151,1.0,v151
v_rcp_f32 v144,v144
v_rcp_f32 v145,v145
v_rcp_f32 v146,v146
v_rcp_f32 v147,v147
s_waitcnt vmcnt(7)
s_barrier
s_waitcnt lgkmcnt(8)
v_mfma_f32_32x32x16_bf16 v[128:143],a[120:123],a[88:91],v[128:143]
ds_read_b64_tr_b16 a[140:141],v200 offset:56320
ds_read_b64_tr_b16 a[142:143],v200 offset:56576
s_add_u32 s30,s101,128
s_add_u32 m0,s60,0
s_nop 0
buffer_load_dwordx4 v205,s[4:7],s30 offen lds
v_rcp_f32 v148,v148
v_rcp_f32 v149,v149
v_rcp_f32 v150,v150
v_rcp_f32 v151,v151
v_mul_f32 v144,v144,v120
s_waitcnt lgkmcnt(8)
v_mfma_f32_32x32x16_bf16 v[128:143],a[124:127],a[92:95],v[128:143]
ds_read_b64_tr_b16 a[112:113],v203 offset:0
ds_read_b64_tr_b16 a[114:115],v203 offset:512
v_mul_f32 v145,v145,v121
v_mul_f32 v146,v146,v122
v_mul_f32 v147,v147,v123
v_mul_f32 v148,v148,v124
v_mul_f32 v149,v149,v125
s_waitcnt lgkmcnt(8)
v_mfma_f32_32x32x16_bf16 v[128:143],a[128:131],a[96:99],v[128:143]
ds_read_b64_tr_b16 a[116:117],v203 offset:1024
ds_read_b64_tr_b16 a[118:119],v203 offset:1536
v_mul_f32 v150,v150,v126
v_mul_f32 v151,v151,v127
v_cvt_pk_bf16_f32 v100,v144,v145
v_cvt_pk_bf16_f32 v101,v146,v147
v_cvt_pk_bf16_f32 v102,v148,v149
s_waitcnt lgkmcnt(8)
v_mfma_f32_32x32x16_bf16 v[128:143],a[132:135],a[100:103],v[128:143]
ds_read_b64_tr_b16 a[120:121],v203 offset:2048
ds_read_b64_tr_b16 a[122:123],v203 offset:2560
v_cvt_pk_bf16_f32 v103,v150,v151
ds_read_b128 v[112:115],v220 offset:2048
ds_read_b128 v[116:119],v220 offset:2080
ds_read_b128 v[120:123],v220 offset:2112
ds_read_b128 v[124:127],v220 offset:2144
s_waitcnt lgkmcnt(12)
v_mfma_f32_32x32x16_bf16 v[128:143],a[136:139],a[104:107],v[128:143]
ds_read_b64_tr_b16 a[124:125],v203 offset:3072
ds_read_b64_tr_b16 a[126:127],v203 offset:3584
s_add_u32 s30,s101,14464
s_add_u32 m0,s60,1024
s_nop 0
buffer_load_dwordx4 v205,s[4:7],s30 offen lds
s_waitcnt lgkmcnt(12)
v_mfma_f32_32x32x16_bf16 v[128:143],a[140:143],a[108:111],v[128:143]
ds_read_b64_tr_b16 a[128:129],v203 offset:4096
ds_read_b64_tr_b16 a[130:131],v203 offset:4608
s_waitcnt lgkmcnt(4)
v_mfma_f32_32x32x16_bf16 v[112:127],a[112:115],v[0:3],v[112:127]
ds_read_b64_tr_b16 a[132:133],v203 offset:5120
ds_read_b64_tr_b16 a[134:135],v203 offset:5632
v_mfma_f32_32x32x16_bf16 v[112:127],a[116:119],v[4:7],v[112:127]
ds_read_b64_tr_b16 a[136:137],v203 offset:6144
ds_read_b64_tr_b16 a[138:139],v203 offset:6656
v_mfma_f32_32x32x16_bf16 v[112:127],a[120:123],v[8:11],v[112:127]
ds_read_b64_tr_b16 a[140:141],v203 offset:7168
ds_read_b64_tr_b16 a[142:143],v203 offset:7680
s_add_u32 s30,s101,28800
s_add_u32 m0,s60,2048
s_nop 0
buffer_load_dwordx4 v205,s[4:7],s30 offen lds
v_mul_f32 v144,v128,v128
v_mul_f32 v145,v129,v129
v_mul_f32 v146,v130,v130
v_mul_f32 v147,v131,v131
v_mul_f32 v148,v132,v132
v_mul_f32 v149,v133,v133
s_waitcnt lgkmcnt(8)
v_mfma_f32_32x32x16_bf16 v[112:127],a[124:127],v[12:15],v[112:127]
ds_read_b64_tr_b16 a[112:113],v203 offset:8192
ds_read_b64_tr_b16 a[114:115],v203 offset:8704
v_mul_f32 v150,v134,v134
v_mul_f32 v151,v135,v135
v_fma_f32 v144,v144,s58,v210
v_fma_f32 v145,v145,s58,v210
v_fma_f32 v146,v146,s58,v210
v_fma_f32 v147,v147,s58,v210
s_waitcnt lgkmcnt(8)
v_mfma_f32_32x32x16_bf16 v[112:127],a[128:131],v[16:19],v[112:127]
ds_read_b64_tr_b16 a[116:117],v203 offset:9216
ds_read_b64_tr_b16 a[118:119],v203 offset:9728
v_fma_f32 v148,v148,s58,v210
v_fma_f32 v149,v149,s58,v210
v_fma_f32 v150,v150,s58,v210
v_fma_f32 v151,v151,s58,v210
v_mul_f32 v144,v144,v128
v_mul_f32 v145,v145,v129
s_waitcnt lgkmcnt(8)
v_mfma_f32_32x32x16_bf16 v[112:127],a[132:135],v[20:23],v[112:127]
ds_read_b64_tr_b16 a[120:121],v203 offset:10240
ds_read_b64_tr_b16 a[122:123],v203 offset:10752
v_mul_f32 v146,v146,v130
v_mul_f32 v147,v147,v131
v_mul_f32 v148,v148,v132
v_mul_f32 v149,v149,v133
v_mul_f32 v150,v150,v134
v_mul_f32 v151,v151,v135
s_waitcnt lgkmcnt(8)
v_mfma_f32_32x32x16_bf16 v[112:127],a[136:139],v[24:27],v[112:127]
ds_read_b64_tr_b16 a[124:125],v203 offset:11264
ds_read_b64_tr_b16 a[126:127],v203 offset:11776
s_add_u32 s30,s101,43136
s_add_u32 m0,s60,3072
s_nop 0
buffer_load_dwordx4 v205,s[4:7],s30 offen lds
v_exp_f32 v144,v144
v_exp_f32 v145,v145
v_exp_f32 v146,v146
v_exp_f32 v147,v147
v_exp_f32 v148,v148
s_waitcnt lgkmcnt(8)
v_mfma_f32_32x32x16_bf16 v[112:127],a[140:143],v[28:31],v[112:127]
ds_read_b64_tr_b16 a[128:129],v203 offset:12288
ds_read_b64_tr_b16 a[130:131],v203 offset:12800
v_exp_f32 v149,v149
v_exp_f32 v150,v150
v_exp_f32 v151,v151
v_add_f32 v144,1.0,v144
v_add_f32 v145,1.0,v145
s_waitcnt lgkmcnt(8)
v_mfma_f32_32x32x16_bf16 v[112:127],a[112:115],v[32:35],v[112:127]
ds_read_b64_tr_b16 a[132:133],v203 offset:13312
ds_read_b64_tr_b16 a[134:135],v203 offset:13824
v_add_f32 v146,1.0,v146
v_add_f32 v147,1.0,v147
v_add_f32 v148,1.0,v148
v_add_f32 v149,1.0,v149
v_add_f32 v150,1.0,v150
s_waitcnt lgkmcnt(8)
v_mfma_f32_32x32x16_bf16 v[112:127],a[116:119],v[36:39],v[112:127]
ds_read_b64_tr_b16 a[136:137],v203 offset:14336
ds_read_b64_tr_b16 a[138:139],v203 offset:14848
v_add_f32 v151,1.0,v151
v_rcp_f32 v144,v144
v_rcp_f32 v145,v145
v_rcp_f32 v146,v146
v_rcp_f32 v147,v147
s_waitcnt lgkmcnt(8)
v_mfma_f32_32x32x16_bf16 v[112:127],a[120:123],v[40:43],v[112:127]
ds_read_b64_tr_b16 a[140:141],v203 offset:15360
ds_read_b64_tr_b16 a[142:143],v203 offset:15872
s_add_u32 s30,s101,57472
s_add_u32 m0,s60,4096
s_nop 0
buffer_load_dwordx4 v205,s[4:7],s30 offen lds
v_rcp_f32 v148,v148
v_rcp_f32 v149,v149
v_rcp_f32 v150,v150
v_rcp_f32 v151,v151
v_mul_f32 v144,v144,v128
s_waitcnt lgkmcnt(8)
v_mfma_f32_32x32x16_bf16 v[112:127],a[124:127],v[44:47],v[112:127]
ds_read_b64_tr_b16 a[112:113],v203 offset:16384
ds_read_b64_tr_b16 a[114:115],v203 offset:16896
v_mul_f32 v145,v145,v129
v_mul_f32 v146,v146,v130
v_mul_f32 v147,v147,v131
v_mul_f32 v148,v148,v132
v_mul_f32 v149,v149,v133
s_waitcnt lgkmcnt(8)
v_mfma_f32_32x32x16_bf16 v[112:127],a[128:131],v[48:51],v[112:127]
ds_read_b64_tr_b16 a[116:117],v203 offset:17408
ds_read_b64_tr_b16 a[118:119],v203 offset:17920
v_mul_f32 v150,v150,v134
v_mul_f32 v151,v151,v135
v_cvt_pk_bf16_f32 v104,v144,v145
v_cvt_pk_bf16_f32 v105,v146,v147
v_cvt_pk_bf16_f32 v106,v148,v149
s_waitcnt lgkmcnt(8)
v_mfma_f32_32x32x16_bf16 v[112:127],a[132:135],v[52:55],v[112:127]
ds_read_b64_tr_b16 a[120:121],v203 offset:18432
ds_read_b64_tr_b16 a[122:123],v203 offset:18944
v_cvt_pk_bf16_f32 v107,v150,v151
v_mul_f32 v144,v136,v136
v_mul_f32 v145,v137,v137
v_mul_f32 v146,v138,v138
v_mul_f32 v147,v139,v139
s_waitcnt lgkmcnt(8)
v_mfma_f32_32x32x16_bf16 v[112:127],a[136:139],v[56:59],v[112:127]
ds_read_b64_tr_b16 a[124:125],v203 offset:19456
ds_read_b64_tr_b16 a[126:127],v203 offset:19968
s_add_u32 s30,s101,71808
s_add_u32 m0,s60,5120
s_nop 0
buffer_load_dwordx4 v205,s[4:7],s30 offen lds
v_mul_f32 v148,v140,v140
v_mul_f32 v149,v141,v141
v_mul_f32 v150,v142,v142
v_mul_f32 v151,v143,v143
v_fma_f32 v144,v144,s58,v210
s_waitcnt lgkmcnt(8)
v_mfma_f32_32x32x16_bf16 v[112:127],a[140:143],v[60:63],v[112:127]
ds_read_b64_tr_b16 a[128:129],v203 offset:20480
ds_read_b64_tr_b16 a[130:131],v203 offset:20992
v_fma_f32 v145,v145,s58,v210
v_fma_f32 v146,v146,s58,v210
v_fma_f32 v147,v147,s58,v210
v_fma_f32 v148,v148,s58,v210
v_fma_f32 v149,v149,s58,v210
s_waitcnt lgkmcnt(8)
v_mfma_f32_32x32x16_bf16 v[112:127],a[112:115],v[64:67],v[112:127]
ds_read_b64_tr_b16 a[132:133],v203 offset:21504
ds_read_b64_tr_b16 a[134:135],v203 offset:22016
v_fma_f32 v150,v150,s58,v210
v_fma_f32 v151,v151,s58,v210
v_mul_f32 v144,v144,v136
v_mul_f32 v145,v145,v137
v_mul_f32 v146,v146,v138
s_waitcnt lgkmcnt(8)
v_mfma_f32_32x32x16_bf16 v[112:127],a[116:119],v[68:71],v[112:127]
ds_read_b64_tr_b16 a[136:137],v203 offset:22528
ds_read_b64_tr_b16 a[138:139],v203 offset:23040
v_mul_f32 v147,v147,v139
v_mul_f32 v148,v148,v140
v_mul_f32 v149,v149,v141
v_mul_f32 v150,v150,v142
v_mul_f32 v151,v151,v143
s_waitcnt lgkmcnt(8)
v_mfma_f32_32x32x16_bf16 v[112:127],a[120:123],v[72:75],v[112:127]
ds_read_b64_tr_b16 a[140:141],v203 offset:23552
ds_read_b64_tr_b16 a[142:143],v203 offset:24064
s_add_u32 s30,s101,86144
s_add_u32 m0,s60,6144
s_nop 0
buffer_load_dwordx4 v205,s[4:7],s30 offen lds
v_exp_f32 v144,v144
v_exp_f32 v145,v145
v_exp_f32 v146,v146
v_exp_f32 v147,v147
v_exp_f32 v148,v148
s_waitcnt lgkmcnt(8)
v_mfma_f32_32x32x16_bf16 v[112:127],a[124:127],v[76:79],v[112:127]
ds_read_b64_tr_b16 a[112:113],v203 offset:24576
ds_read_b64_tr_b16 a[114:115],v203 offset:25088
v_exp_f32 v149,v149
v_exp_f32 v150,v150
v_exp_f32 v151,v151
v_add_f32 v144,1.0,v144
v_add_f32 v145,1.0,v145
s_waitcnt lgkmcnt(8)
v_mfma_f32_32x32x16_bf16 v[112:127],a[128:131],v[80:83],v[112:127]
ds_read_b64_tr_b16 a[116:117],v203 offset:25600
ds_read_b64_tr_b16 a[118:119],v203 offset:26112
v_add_f32 v146,1.0,v146
v_add_f32 v147,1.0,v147
v_add_f32 v148,1.0,v148
v_add_f32 v149,1.0,v149
v_add_f32 v150,1.0,v150
s_waitcnt lgkmcnt(8)
v_mfma_f32_32x32x16_bf16 v[112:127],a[132:135],v[84:87],v[112:127]
ds_read_b64_tr_b16 a[120:121],v203 offset:26624
ds_read_b64_tr_b16 a[122:123],v203 offset:27136
v_add_f32 v151,1.0,v151
v_rcp_f32 v144,v144
v_rcp_f32 v145,v145
v_rcp_f32 v146,v146
v_rcp_f32 v147,v147
s_waitcnt vmcnt(7)
s_barrier
s_waitcnt lgkmcnt(8)
v_mfma_f32_32x32x16_bf16 v[112:127],a[136:139],v[88:91],v[112:127]
ds_read_b64_tr_b16 a[124:125],v203 offset:27648
ds_read_b64_tr_b16 a[126:127],v203 offset:28160
s_add_u32 s30,s101,192
s_add_u32 m0,s60,28672
s_nop 0
buffer_load_dwordx4 v205,s[4:7],s30 offen lds
v_rcp_f32 v148,v148
v_rcp_f32 v149,v149
v_rcp_f32 v150,v150
v_rcp_f32 v151,v151
v_mul_f32 v144,v144,v136
s_waitcnt lgkmcnt(8)
v_mfma_f32_32x32x16_bf16 v[112:127],a[140:143],v[92:95],v[112:127]
ds_read_b64_tr_b16 a[128:129],v203 offset:28672
ds_read_b64_tr_b16 a[130:131],v203 offset:29184
v_mul_f32 v145,v145,v137
v_mul_f32 v146,v146,v138
v_mul_f32 v147,v147,v139
v_mul_f32 v148,v148,v140
v_mul_f32 v149,v149,v141
s_waitcnt lgkmcnt(8)
v_mfma_f32_32x32x16_bf16 v[112:127],a[112:115],v[96:99],v[112:127]
ds_read_b64_tr_b16 a[132:133],v203 offset:29696
ds_read_b64_tr_b16 a[134:135],v203 offset:30208
v_mul_f32 v150,v150,v142
v_mul_f32 v151,v151,v143
v_cvt_pk_bf16_f32 v108,v144,v145
v_cvt_pk_bf16_f32 v109,v146,v147
v_cvt_pk_bf16_f32 v110,v148,v149
s_waitcnt lgkmcnt(8)
v_mfma_f32_32x32x16_bf16 v[112:127],a[116:119],v[100:103],v[112:127]
ds_read_b64_tr_b16 a[136:137],v203 offset:30720
ds_read_b64_tr_b16 a[138:139],v203 offset:31232
v_cvt_pk_bf16_f32 v111,v150,v151
ds_read_b128 v[128:131],v220 offset:2176
ds_read_b128 v[132:135],v220 offset:2208
ds_read_b128 v[136:139],v220 offset:2240
ds_read_b128 v[140:143],v220 offset:2272
s_waitcnt lgkmcnt(12)
v_mfma_f32_32x32x16_bf16 v[112:127],a[120:123],v[104:107],v[112:127]
ds_read_b64_tr_b16 a[140:141],v203 offset:31744
ds_read_b64_tr_b16 a[142:143],v203 offset:32256
s_add_u32 s30,s101,14528
s_add_u32 m0,s60,29696
s_nop 0
buffer_load_dwordx4 v205,s[4:7],s30 offen lds
s_waitcnt lgkmcnt(12)
v_mfma_f32_32x32x16_bf16 v[112:127],a[124:127],v[108:111],v[112:127]
ds_read_b64_tr_b16 a[112:113],v203 offset:32768
ds_read_b64_tr_b16 a[114:115],v203 offset:33280
s_waitcnt lgkmcnt(4)
v_mfma_f32_32x32x16_bf16 v[128:143],a[128:131],v[0:3],v[128:143]
ds_read_b64_tr_b16 a[116:117],v203 offset:33792
ds_read_b64_tr_b16 a[118:119],v203 offset:34304
v_mfma_f32_32x32x16_bf16 v[128:143],a[132:135],v[4:7],v[128:143]
ds_read_b64_tr_b16 a[120:121],v203 offset:34816
ds_read_b64_tr_b16 a[122:123],v203 offset:35328
v_mfma_f32_32x32x16_bf16 v[128:143],a[136:139],v[8:11],v[128:143]
ds_read_b64_tr_b16 a[124:125],v203 offset:35840
ds_read_b64_tr_b16 a[126:127],v203 offset:36352
s_add_u32 s30,s101,28864
s_add_u32 m0,s60,30720
s_nop 0
buffer_load_dwordx4 v205,s[4:7],s30 offen lds
s_add_u32 s31,s59,0
s_waitcnt lgkmcnt(8)
v_mfma_f32_32x32x16_bf16 v[128:143],a[140:143],v[12:15],v[128:143]
ds_read_b64_tr_b16 a[128:129],v203 offset:36864
ds_read_b64_tr_b16 a[130:131],v203 offset:37376
buffer_store_dwordx4 v[112:115],v211,s[8:11],s31 offen sc1
s_waitcnt lgkmcnt(8)
v_mfma_f32_32x32x16_bf16 v[128:143],a[112:115],v[16:19],v[128:143]
ds_read_b64_tr_b16 a[132:133],v203 offset:37888
ds_read_b64_tr_b16 a[134:135],v203 offset:38400
buffer_store_dwordx4 v[116:119],v211,s[8:11],s31 offen offset:1024 sc1
s_waitcnt lgkmcnt(8)
v_mfma_f32_32x32x16_bf16 v[128:143],a[116:119],v[20:23],v[128:143]
ds_read_b64_tr_b16 a[136:137],v203 offset:38912
ds_read_b64_tr_b16 a[138:139],v203 offset:39424
buffer_store_dwordx4 v[120:123],v211,s[8:11],s31 offen offset:2048 sc1
s_waitcnt lgkmcnt(8)
v_mfma_f32_32x32x16_bf16 v[128:143],a[120:123],v[24:27],v[128:143]
ds_read_b64_tr_b16 a[140:141],v203 offset:39936
ds_read_b64_tr_b16 a[142:143],v203 offset:40448
s_add_u32 s30,s101,43200
s_add_u32 m0,s60,31744
s_nop 0
buffer_load_dwordx4 v205,s[4:7],s30 offen lds
buffer_store_dwordx4 v[124:127],v211,s[8:11],s31 offen offset:3072 sc1
s_waitcnt lgkmcnt(8)
v_mfma_f32_32x32x16_bf16 v[128:143],a[124:127],v[28:31],v[128:143]
ds_read_b64_tr_b16 a[112:113],v203 offset:40960
ds_read_b64_tr_b16 a[114:115],v203 offset:41472
s_nop 1
s_waitcnt lgkmcnt(8)
v_mfma_f32_32x32x16_bf16 v[128:143],a[128:131],v[32:35],v[128:143]
ds_read_b64_tr_b16 a[116:117],v203 offset:41984
ds_read_b64_tr_b16 a[118:119],v203 offset:42496
ds_read_b128 v[112:115],v220 offset:2304
s_waitcnt lgkmcnt(9)
v_mfma_f32_32x32x16_bf16 v[128:143],a[132:135],v[36:39],v[128:143]
ds_read_b64_tr_b16 a[120:121],v203 offset:43008
ds_read_b64_tr_b16 a[122:123],v203 offset:43520
ds_read_b128 v[116:119],v220 offset:2336
s_waitcnt lgkmcnt(10)
v_mfma_f32_32x32x16_bf16 v[128:143],a[136:139],v[40:43],v[128:143]
ds_read_b64_tr_b16 a[124:125],v203 offset:44032
ds_read_b64_tr_b16 a[126:127],v203 offset:44544
s_add_u32 s30,s101,57536
s_add_u32 m0,s60,32768
s_nop 0
buffer_load_dwordx4 v205,s[4:7],s30 offen lds
ds_read_b128 v[120:123],v220 offset:2368
s_waitcnt lgkmcnt(11)
v_mfma_f32_32x32x16_bf16 v[128:143],a[140:143],v[44:47],v[128:143]
ds_read_b64_tr_b16 a[128:129],v203 offset:45056
ds_read_b64_tr_b16 a[130:131],v203 offset:45568
ds_read_b128 v[124:127],v220 offset:2400
s_waitcnt lgkmcnt(12)
v_mfma_f32_32x32x16_bf16 v[128:143],a[112:115],v[48:51],v[128:143]
ds_read_b64_tr_b16 a[132:133],v203 offset:46080
ds_read_b64_tr_b16 a[134:135],v203 offset:46592
s_waitcnt lgkmcnt(12)
v_mfma_f32_32x32x16_bf16 v[128:143],a[116:119],v[52:55],v[128:143]
ds_read_b64_tr_b16 a[136:137],v203 offset:47104
ds_read_b64_tr_b16 a[138:139],v203 offset:47616
s_waitcnt lgkmcnt(11)
v_mfma_f32_32x32x16_bf16 v[128:143],a[120:123],v[56:59],v[128:143]
ds_read_b64_tr_b16 a[140:141],v203 offset:48128
ds_read_b64_tr_b16 a[142:143],v203 offset:48640
s_add_u32 s30,s101,71872
s_add_u32 m0,s60,33792
s_nop 0
buffer_load_dwordx4 v205,s[4:7],s30 offen lds
s_waitcnt lgkmcnt(10)
v_mfma_f32_32x32x16_bf16 v[128:143],a[124:127],v[60:63],v[128:143]
ds_read_b64_tr_b16 a[112:113],v203 offset:49152
ds_read_b64_tr_b16 a[114:115],v203 offset:49664
s_waitcnt lgkmcnt(9)
v_mfma_f32_32x32x16_bf16 v[128:143],a[128:131],v[64:67],v[128:143]
ds_read_b64_tr_b16 a[116:117],v203 offset:50176
ds_read_b64_tr_b16 a[118:119],v203 offset:50688
s_waitcnt lgkmcnt(8)
v_mfma_f32_32x32x16_bf16 v[128:143],a[132:135],v[68:71],v[128:143]
ds_read_b64_tr_b16 a[120:121],v203 offset:51200
ds_read_b64_tr_b16 a[122:123],v203 offset:51712
s_waitcnt lgkmcnt(8)
v_mfma_f32_32x32x16_bf16 v[128:143],a[136:139],v[72:75],v[128:143]
ds_read_b64_tr_b16 a[124:125],v203 offset:52224
ds_read_b64_tr_b16 a[126:127],v203 offset:52736
s_add_u32 s30,s101,86208
s_add_u32 m0,s60,34816
s_nop 0
buffer_load_dwordx4 v205,s[4:7],s30 offen lds
s_waitcnt lgkmcnt(8)
v_mfma_f32_32x32x16_bf16 v[128:143],a[140:143],v[76:79],v[128:143]
ds_read_b64_tr_b16 a[128:129],v203 offset:53248
ds_read_b64_tr_b16 a[130:131],v203 offset:53760
s_waitcnt lgkmcnt(8)
v_mfma_f32_32x32x16_bf16 v[128:143],a[112:115],v[80:83],v[128:143]
ds_read_b64_tr_b16 a[132:133],v203 offset:54272
ds_read_b64_tr_b16 a[134:135],v203 offset:54784
s_waitcnt lgkmcnt(8)
v_mfma_f32_32x32x16_bf16 v[128:143],a[116:119],v[84:87],v[128:143]
ds_read_b64_tr_b16 a[136:137],v203 offset:55296
ds_read_b64_tr_b16 a[138:139],v203 offset:55808
s_waitcnt vmcnt(11)
s_barrier
s_waitcnt lgkmcnt(8)
v_mfma_f32_32x32x16_bf16 v[128:143],a[120:123],v[88:91],v[128:143]
ds_read_b64_tr_b16 a[140:141],v203 offset:56320
ds_read_b64_tr_b16 a[142:143],v203 offset:56832
s_add_u32 s30,s101,256
s_add_u32 m0,s60,57344
s_nop 0
buffer_load_dwordx4 v205,s[4:7],s30 offen lds
s_waitcnt lgkmcnt(8)
v_mfma_f32_32x32x16_bf16 v[128:143],a[124:127],v[92:95],v[128:143]
ds_read_b64_tr_b16 a[112:113],v202 offset:0
ds_read_b64_tr_b16 a[114:115],v202 offset:512
s_waitcnt lgkmcnt(8)
v_mfma_f32_32x32x16_bf16 v[128:143],a[128:131],v[96:99],v[128:143]
ds_read_b64_tr_b16 a[116:117],v202 offset:1024
ds_read_b64_tr_b16 a[118:119],v202 offset:1536
s_waitcnt lgkmcnt(8)
v_mfma_f32_32x32x16_bf16 v[128:143],a[132:135],v[100:103],v[128:143]
ds_read_b64_tr_b16 a[120:121],v202 offset:2048
ds_read_b64_tr_b16 a[122:123],v202 offset:2560
s_waitcnt lgkmcnt(8)
v_mfma_f32_32x32x16_bf16 v[128:143],a[136:139],v[104:107],v[128:143]
ds_read_b64_tr_b16 a[124:125],v202 offset:3072
ds_read_b64_tr_b16 a[126:127],v202 offset:3584
s_add_u32 s30,s101,14592
s_add_u32 m0,s60,58368
s_nop 0
buffer_load_dwordx4 v205,s[4:7],s30 offen lds
s_waitcnt lgkmcnt(8)
v_mfma_f32_32x32x16_bf16 v[128:143],a[140:143],v[108:111],v[128:143]
ds_read_b64_tr_b16 a[128:129],v202 offset:4096
ds_read_b64_tr_b16 a[130:131],v202 offset:4608
s_waitcnt lgkmcnt(8)
v_mfma_f32_32x32x16_bf16 v[112:127],a[112:115],v[0:3],v[112:127]
ds_read_b64_tr_b16 a[132:133],v202 offset:5120
ds_read_b64_tr_b16 a[134:135],v202 offset:5632
s_waitcnt lgkmcnt(8)
v_mfma_f32_32x32x16_bf16 v[112:127],a[116:119],v[4:7],v[112:127]
ds_read_b64_tr_b16 a[136:137],v202 offset:6144
ds_read_b64_tr_b16 a[138:139],v202 offset:6656
s_waitcnt lgkmcnt(8)
v_mfma_f32_32x32x16_bf16 v[112:127],a[120:123],v[8:11],v[112:127]
ds_read_b64_tr_b16 a[140:141],v202 offset:7168
ds_read_b64_tr_b16 a[142:143],v202 offset:7680
s_add_u32 s30,s101,28928
s_add_u32 m0,s60,59392
s_nop 0
buffer_load_dwordx4 v205,s[4:7],s30 offen lds
s_add_u32 s31,s59,4096
s_waitcnt lgkmcnt(8)
v_mfma_f32_32x32x16_bf16 v[112:127],a[124:127],v[12:15],v[112:127]
ds_read_b64_tr_b16 a[112:113],v202 offset:8192
ds_read_b64_tr_b16 a[114:115],v202 offset:8704
buffer_store_dwordx4 v[128:131],v211,s[8:11],s31 offen sc1
s_waitcnt lgkmcnt(8)
v_mfma_f32_32x32x16_bf16 v[112:127],a[128:131],v[16:19],v[112:127]
ds_read_b64_tr_b16 a[116:117],v202 offset:9216
ds_read_b64_tr_b16 a[118:119],v202 offset:9728
buffer_store_dwordx4 v[132:135],v211,s[8:11],s31 offen offset:1024 sc1
s_waitcnt lgkmcnt(8)
v_mfma_f32_32x32x16_bf16 v[112:127],a[132:135],v[20:23],v[112:127]
ds_read_b64_tr_b16 a[120:121],v202 offset:10240
ds_read_b64_tr_b16 a[122:123],v202 offset:10752
buffer_store_dwordx4 v[136:139],v211,s[8:11],s31 offen offset:2048 sc1
s_waitcnt lgkmcnt(8)
v_mfma_f32_32x32x16_bf16 v[112:127],a[136:139],v[24:27],v[112:127]
ds_read_b64_tr_b16 a[124:125],v202 offset:11264
ds_read_b64_tr_b16 a[126:127],v202 offset:11776
s_add_u32 s30,s101,43264
s_add_u32 m0,s60,60416
s_nop 0
buffer_load_dwordx4 v205,s[4:7],s30 offen lds
buffer_store_dwordx4 v[140:143],v211,s[8:11],s31 offen offset:3072 sc1
s_waitcnt lgkmcnt(8)
v_mfma_f32_32x32x16_bf16 v[112:127],a[140:143],v[28:31],v[112:127]
ds_read_b64_tr_b16 a[128:129],v202 offset:12288
ds_read_b64_tr_b16 a[130:131],v202 offset:12800
s_nop 1
s_waitcnt lgkmcnt(8)
v_mfma_f32_32x32x16_bf16 v[112:127],a[112:115],v[32:35],v[112:127]
ds_read_b64_tr_b16 a[132:133],v202 offset:13312
ds_read_b64_tr_b16 a[134:135],v202 offset:13824
ds_read_b128 v[128:131],v220 offset:2432
s_waitcnt lgkmcnt(9)
v_mfma_f32_32x32x16_bf16 v[112:127],a[116:119],v[36:39],v[112:127]
ds_read_b64_tr_b16 a[136:137],v202 offset:14336
ds_read_b64_tr_b16 a[138:139],v202 offset:14848
ds_read_b128 v[132:135],v220 offset:2464
s_waitcnt lgkmcnt(10)
v_mfma_f32_32x32x16_bf16 v[112:127],a[120:123],v[40:43],v[112:127]
ds_read_b64_tr_b16 a[140:141],v202 offset:15360
ds_read_b64_tr_b16 a[142:143],v202 offset:15872
s_add_u32 s30,s101,57600
s_add_u32 m0,s60,61440
s_nop 0
buffer_load_dwordx4 v205,s[4:7],s30 offen lds
ds_read_b128 v[136:139],v220 offset:2496
s_waitcnt lgkmcnt(11)
v_mfma_f32_32x32x16_bf16 v[112:127],a[124:127],v[44:47],v[112:127]
ds_read_b64_tr_b16 a[112:113],v202 offset:16384
ds_read_b64_tr_b16 a[114:115],v202 offset:16896
ds_read_b128 v[140:143],v220 offset:2528
s_waitcnt lgkmcnt(12)
v_mfma_f32_32x32x16_bf16 v[112:127],a[128:131],v[48:51],v[112:127]
ds_read_b64_tr_b16 a[116:117],v202 offset:17408
ds_read_b64_tr_b16 a[118:119],v202 offset:17920
s_waitcnt lgkmcnt(12)
v_mfma_f32_32x32x16_bf16 v[112:127],a[132:135],v[52:55],v[112:127]
ds_read_b64_tr_b16 a[120:121],v202 offset:18432
ds_read_b64_tr_b16 a[122:123],v202 offset:18944
s_waitcnt lgkmcnt(11)
v_mfma_f32_32x32x16_bf16 v[112:127],a[136:139],v[56:59],v[112:127]
ds_read_b64_tr_b16 a[124:125],v202 offset:19456
ds_read_b64_tr_b16 a[126:127],v202 offset:19968
s_add_u32 s30,s101,71936
s_add_u32 m0,s60,62464
s_nop 0
buffer_load_dwordx4 v205,s[4:7],s30 offen lds
s_waitcnt lgkmcnt(10)
v_mfma_f32_32x32x16_bf16 v[112:127],a[140:143],v[60:63],v[112:127]
ds_read_b64_tr_b16 a[128:129],v202 offset:20480
ds_read_b64_tr_b16 a[130:131],v202 offset:20992
s_waitcnt lgkmcnt(9)
v_mfma_f32_32x32x16_bf16 v[112:127],a[112:115],v[64:67],v[112:127]
ds_read_b64_tr_b16 a[132:133],v202 offset:21504
ds_read_b64_tr_b16 a[134:135],v202 offset:22016
s_waitcnt lgkmcnt(8)
v_mfma_f32_32x32x16_bf16 v[112:127],a[116:119],v[68:71],v[112:127]
ds_read_b64_tr_b16 a[136:137],v202 offset:22528
ds_read_b64_tr_b16 a[138:139],v202 offset:23040
s_waitcnt lgkmcnt(8)
v_mfma_f32_32x32x16_bf16 v[112:127],a[120:123],v[72:75],v[112:127]
ds_read_b64_tr_b16 a[140:141],v202 offset:23552
ds_read_b64_tr_b16 a[142:143],v202 offset:24064
s_add_u32 s30,s101,86272
s_add_u32 m0,s60,63488
s_nop 0
buffer_load_dwordx4 v205,s[4:7],s30 offen lds
s_waitcnt lgkmcnt(8)
v_mfma_f32_32x32x16_bf16 v[112:127],a[124:127],v[76:79],v[112:127]
ds_read_b64_tr_b16 a[112:113],v202 offset:24576
ds_read_b64_tr_b16 a[114:115],v202 offset:25088
s_waitcnt lgkmcnt(8)
v_mfma_f32_32x32x16_bf16 v[112:127],a[128:131],v[80:83],v[112:127]
ds_read_b64_tr_b16 a[116:117],v202 offset:25600
ds_read_b64_tr_b16 a[118:119],v202 offset:26112
s_waitcnt lgkmcnt(8)
v_mfma_f32_32x32x16_bf16 v[112:127],a[132:135],v[84:87],v[112:127]
ds_read_b64_tr_b16 a[120:121],v202 offset:26624
ds_read_b64_tr_b16 a[122:123],v202 offset:27136
s_waitcnt vmcnt(11)
s_barrier
s_waitcnt lgkmcnt(8)
v_mfma_f32_32x32x16_bf16 v[112:127],a[136:139],v[88:91],v[112:127]
ds_read_b64_tr_b16 a[124:125],v202 offset:27648
ds_read_b64_tr_b16 a[126:127],v202 offset:28160
s_add_u32 s30,s101,320
s_add_u32 m0,s60,86016
s_nop 0
buffer_load_dwordx4 v205,s[4:7],s30 offen lds
s_waitcnt lgkmcnt(8)
v_mfma_f32_32x32x16_bf16 v[112:127],a[140:143],v[92:95],v[112:127]
ds_read_b64_tr_b16 a[128:129],v202 offset:28672
ds_read_b64_tr_b16 a[130:131],v202 offset:29184
s_waitcnt lgkmcnt(8)
v_mfma_f32_32x32x16_bf16 v[112:127],a[112:115],v[96:99],v[112:127]
ds_read_b64_tr_b16 a[132:133],v202 offset:29696
ds_read_b64_tr_b16 a[134:135],v202 offset:30208
s_waitcnt lgkmcnt(8)
v_mfma_f32_32x32x16_bf16 v[112:127],a[116:119],v[100:103],v[112:127]
ds_read_b64_tr_b16 a[136:137],v202 offset:30720
ds_read_b64_tr_b16 a[138:139],v202 offset:31232
s_waitcnt lgkmcnt(8)
v_mfma_f32_32x32x16_bf16 v[112:127],a[120:123],v[104:107],v[112:127]
ds_read_b64_tr_b16 a[140:141],v202 offset:31744
ds_read_b64_tr_b16 a[142:143],v202 offset:32256
s_add_u32 s30,s101,14656
s_add_u32 m0,s60,87040
s_nop 0
buffer_load_dwordx4 v205,s[4:7],s30 offen lds
s_waitcnt lgkmcnt(8)
v_mfma_f32_32x32x16_bf16 v[112:127],a[124:127],v[108:111],v[112:127]
ds_read_b64_tr_b16 a[112:113],v202 offset:32768
ds_read_b64_tr_b16 a[114:115],v202 offset:33280
s_waitcnt lgkmcnt(8)
v_mfma_f32_32x32x16_bf16 v[128:143],a[128:131],v[0:3],v[128:143]
ds_read_b64_tr_b16 a[116:117],v202 offset:33792
ds_read_b64_tr_b16 a[118:119],v202 offset:34304
s_waitcnt lgkmcnt(8)
v_mfma_f32_32x32x16_bf16 v[128:143],a[132:135],v[4:7],v[128:143]
ds_read_b64_tr_b16 a[120:121],v202 offset:34816
ds_read_b64_tr_b16 a[122:123],v202 offset:35328
s_waitcnt lgkmcnt(8)
v_mfma_f32_32x32x16_bf16 v[128:143],a[136:139],v[8:11],v[128:143]
ds_read_b64_tr_b16 a[124:125],v202 offset:35840
ds_read_b64_tr_b16 a[126:127],v202 offset:36352
s_add_u32 s30,s101,28992
s_add_u32 m0,s60,88064
s_nop 0
buffer_load_dwordx4 v205,s[4:7],s30 offen lds
s_add_u32 s31,s59,8192
s_waitcnt lgkmcnt(8)
v_mfma_f32_32x32x16_bf16 v[128:143],a[140:143],v[12:15],v[128:143]
ds_read_b64_tr_b16 a[128:129],v202 offset:36864
ds_read_b64_tr_b16 a[130:131],v202 offset:37376
buffer_store_dwordx4 v[112:115],v211,s[8:11],s31 offen sc1
s_waitcnt lgkmcnt(8)
v_mfma_f32_32x32x16_bf16 v[128:143],a[112:115],v[16:19],v[128:143]
ds_read_b64_tr_b16 a[132:133],v202 offset:37888
ds_read_b64_tr_b16 a[134:135],v202 offset:38400
buffer_store_dwordx4 v[116:119],v211,s[8:11],s31 offen offset:1024 sc1
s_waitcnt lgkmcnt(8)
v_mfma_f32_32x32x16_bf16 v[128:143],a[116:119],v[20:23],v[128:143]
ds_read_b64_tr_b16 a[136:137],v202 offset:38912
ds_read_b64_tr_b16 a[138:139],v202 offset:39424
buffer_store_dwordx4 v[120:123],v211,s[8:11],s31 offen offset:2048 sc1
s_waitcnt lgkmcnt(8)
v_mfma_f32_32x32x16_bf16 v[128:143],a[120:123],v[24:27],v[128:143]
ds_read_b64_tr_b16 a[140:141],v202 offset:39936
ds_read_b64_tr_b16 a[142:143],v202 offset:40448
s_add_u32 s30,s101,43328
s_add_u32 m0,s60,89088
s_nop 0
buffer_load_dwordx4 v205,s[4:7],s30 offen lds
buffer_store_dwordx4 v[124:127],v211,s[8:11],s31 offen offset:3072 sc1
s_waitcnt lgkmcnt(8)
v_mfma_f32_32x32x16_bf16 v[128:143],a[124:127],v[28:31],v[128:143]
ds_read_b64_tr_b16 a[112:113],v202 offset:40960
ds_read_b64_tr_b16 a[114:115],v202 offset:41472
s_nop 1
s_waitcnt lgkmcnt(8)
v_mfma_f32_32x32x16_bf16 v[128:143],a[128:131],v[32:35],v[128:143]
ds_read_b64_tr_b16 a[116:117],v202 offset:41984
ds_read_b64_tr_b16 a[118:119],v202 offset:42496
ds_read_b128 v[112:115],v220 offset:2560
s_waitcnt lgkmcnt(9)
v_mfma_f32_32x32x16_bf16 v[128:143],a[132:135],v[36:39],v[128:143]
ds_read_b64_tr_b16 a[120:121],v202 offset:43008
ds_read_b64_tr_b16 a[122:123],v202 offset:43520
ds_read_b128 v[116:119],v220 offset:2592
s_waitcnt lgkmcnt(10)
v_mfma_f32_32x32x16_bf16 v[128:143],a[136:139],v[40:43],v[128:143]
ds_read_b64_tr_b16 a[124:125],v202 offset:44032
ds_read_b64_tr_b16 a[126:127],v202 offset:44544
s_add_u32 s30,s101,57664
s_add_u32 m0,s60,90112
s_nop 0
buffer_load_dwordx4 v205,s[4:7],s30 offen lds
ds_read_b128 v[120:123],v220 offset:2624
s_waitcnt lgkmcnt(11)
v_mfma_f32_32x32x16_bf16 v[128:143],a[140:143],v[44:47],v[128:143]
ds_read_b64_tr_b16 a[128:129],v202 offset:45056
ds_read_b64_tr_b16 a[130:131],v202 offset:45568
ds_read_b128 v[124:127],v220 offset:2656
s_waitcnt lgkmcnt(12)
v_mfma_f32_32x32x16_bf16 v[128:143],a[112:115],v[48:51],v[128:143]
ds_read_b64_tr_b16 a[132:133],v202 offset:46080
ds_read_b64_tr_b16 a[134:135],v202 offset:46592
s_waitcnt lgkmcnt(12)
v_mfma_f32_32x32x16_bf16 v[128:143],a[116:119],v[52:55],v[128:143]
ds_read_b64_tr_b16 a[136:137],v202 offset:47104
ds_read_b64_tr_b16 a[138:139],v202 offset:47616
s_waitcnt lgkmcnt(11)
v_mfma_f32_32x32x16_bf16 v[128:143],a[120:123],v[56:59],v[128:143]
ds_read_b64_tr_b16 a[140:141],v202 offset:48128
ds_read_b64_tr_b16 a[142:143],v202 offset:48640
s_add_u32 s30,s101,72000
s_add_u32 m0,s60,91136
s_nop 0
buffer_load_dwordx4 v205,s[4:7],s30 offen lds
s_waitcnt lgkmcnt(10)
v_mfma_f32_32x32x16_bf16 v[128:143],a[124:127],v[60:63],v[128:143]
ds_read_b64_tr_b16 a[112:113],v202 offset:49152
ds_read_b64_tr_b16 a[114:115],v202 offset:49664
s_waitcnt lgkmcnt(9)
v_mfma_f32_32x32x16_bf16 v[128:143],a[128:131],v[64:67],v[128:143]
ds_read_b64_tr_b16 a[116:117],v202 offset:50176
ds_read_b64_tr_b16 a[118:119],v202 offset:50688
s_waitcnt lgkmcnt(8)
v_mfma_f32_32x32x16_bf16 v[128:143],a[132:135],v[68:71],v[128:143]
ds_read_b64_tr_b16 a[120:121],v202 offset:51200
ds_read_b64_tr_b16 a[122:123],v202 offset:51712
s_waitcnt lgkmcnt(8)
v_mfma_f32_32x32x16_bf16 v[128:143],a[136:139],v[72:75],v[128:143]
ds_read_b64_tr_b16 a[124:125],v202 offset:52224
ds_read_b64_tr_b16 a[126:127],v202 offset:52736
s_add_u32 s30,s101,86336
s_add_u32 m0,s60,92160
s_nop 0
buffer_load_dwordx4 v205,s[4:7],s30 offen lds
s_waitcnt lgkmcnt(8)
v_mfma_f32_32x32x16_bf16 v[128:143],a[140:143],v[76:79],v[128:143]
ds_read_b64_tr_b16 a[128:129],v202 offset:53248
ds_read_b64_tr_b16 a[130:131],v202 offset:53760
s_waitcnt lgkmcnt(8)
v_mfma_f32_32x32x16_bf16 v[128:143],a[112:115],v[80:83],v[128:143]
ds_read_b64_tr_b16 a[132:133],v202 offset:54272
ds_read_b64_tr_b16 a[134:135],v202 offset:54784
s_waitcnt lgkmcnt(8)
v_mfma_f32_32x32x16_bf16 v[128:143],a[116:119],v[84:87],v[128:143]
ds_read_b64_tr_b16 a[136:137],v202 offset:55296
ds_read_b64_tr_b16 a[138:139],v202 offset:55808
s_waitcnt vmcnt(11)
s_barrier
s_waitcnt lgkmcnt(8)
v_mfma_f32_32x32x16_bf16 v[128:143],a[120:123],v[88:91],v[128:143]
ds_read_b64_tr_b16 a[140:141],v202 offset:56320
ds_read_b64_tr_b16 a[142:143],v202 offset:56832
s_add_u32 s30,s101,384
s_add_u32 m0,s60,0
s_nop 0
buffer_load_dwordx4 v205,s[4:7],s30 offen lds
s_waitcnt lgkmcnt(8)
v_mfma_f32_32x32x16_bf16 v[128:143],a[124:127],v[92:95],v[128:143]
ds_read_b64_tr_b16 a[112:113],v203 offset:0
ds_read_b64_tr_b16 a[114:115],v203 offset:512
s_waitcnt lgkmcnt(8)
v_mfma_f32_32x32x16_bf16 v[128:143],a[128:131],v[96:99],v[128:143]
ds_read_b64_tr_b16 a[116:117],v203 offset:1024
ds_read_b64_tr_b16 a[118:119],v203 offset:1536
s_waitcnt lgkmcnt(8)
v_mfma_f32_32x32x16_bf16 v[128:143],a[132:135],v[100:103],v[128:143]
ds_read_b64_tr_b16 a[120:121],v203 offset:2048
ds_read_b64_tr_b16 a[122:123],v203 offset:2560
s_waitcnt lgkmcnt(8)
v_mfma_f32_32x32x16_bf16 v[128:143],a[136:139],v[104:107],v[128:143]
ds_read_b64_tr_b16 a[124:125],v203 offset:3072
ds_read_b64_tr_b16 a[126:127],v203 offset:3584
s_add_u32 s30,s101,14720
s_add_u32 m0,s60,1024
s_nop 0
buffer_load_dwordx4 v205,s[4:7],s30 offen lds
s_waitcnt lgkmcnt(8)
v_mfma_f32_32x32x16_bf16 v[128:143],a[140:143],v[108:111],v[128:143]
ds_read_b64_tr_b16 a[128:129],v203 offset:4096
ds_read_b64_tr_b16 a[130:131],v203 offset:4608
s_waitcnt lgkmcnt(8)
v_mfma_f32_32x32x16_bf16 v[112:127],a[112:115],v[0:3],v[112:127]
ds_read_b64_tr_b16 a[132:133],v203 offset:5120
ds_read_b64_tr_b16 a[134:135],v203 offset:5632
s_waitcnt lgkmcnt(8)
v_mfma_f32_32x32x16_bf16 v[112:127],a[116:119],v[4:7],v[112:127]
ds_read_b64_tr_b16 a[136:137],v203 offset:6144
ds_read_b64_tr_b16 a[138:139],v203 offset:6656
s_waitcnt lgkmcnt(8)
v_mfma_f32_32x32x16_bf16 v[112:127],a[120:123],v[8:11],v[112:127]
ds_read_b64_tr_b16 a[140:141],v203 offset:7168
ds_read_b64_tr_b16 a[142:143],v203 offset:7680
s_add_u32 s30,s101,29056
s_add_u32 m0,s60,2048
s_nop 0
buffer_load_dwordx4 v205,s[4:7],s30 offen lds
s_add_u32 s31,s59,12288
s_waitcnt lgkmcnt(8)
v_mfma_f32_32x32x16_bf16 v[112:127],a[124:127],v[12:15],v[112:127]
ds_read_b64_tr_b16 a[112:113],v203 offset:8192
ds_read_b64_tr_b16 a[114:115],v203 offset:8704
buffer_store_dwordx4 v[128:131],v211,s[8:11],s31 offen sc1
s_waitcnt lgkmcnt(8)
v_mfma_f32_32x32x16_bf16 v[112:127],a[128:131],v[16:19],v[112:127]
ds_read_b64_tr_b16 a[116:117],v203 offset:9216
ds_read_b64_tr_b16 a[118:119],v203 offset:9728
buffer_store_dwordx4 v[132:135],v211,s[8:11],s31 offen offset:1024 sc1
s_waitcnt lgkmcnt(8)
v_mfma_f32_32x32x16_bf16 v[112:127],a[132:135],v[20:23],v[112:127]
ds_read_b64_tr_b16 a[120:121],v203 offset:10240
ds_read_b64_tr_b16 a[122:123],v203 offset:10752
buffer_store_dwordx4 v[136:139],v211,s[8:11],s31 offen offset:2048 sc1
s_waitcnt lgkmcnt(8)
v_mfma_f32_32x32x16_bf16 v[112:127],a[136:139],v[24:27],v[112:127]
ds_read_b64_tr_b16 a[124:125],v203 offset:11264
ds_read_b64_tr_b16 a[126:127],v203 offset:11776
s_add_u32 s30,s101,43392
s_add_u32 m0,s60,3072
s_nop 0
buffer_load_dwordx4 v205,s[4:7],s30 offen lds
buffer_store_dwordx4 v[140:143],v211,s[8:11],s31 offen offset:3072 sc1
s_waitcnt lgkmcnt(8)
v_mfma_f32_32x32x16_bf16 v[112:127],a[140:143],v[28:31],v[112:127]
ds_read_b64_tr_b16 a[128:129],v203 offset:12288
ds_read_b64_tr_b16 a[130:131],v203 offset:12800
s_nop 1
s_waitcnt lgkmcnt(8)
v_mfma_f32_32x32x16_bf16 v[112:127],a[112:115],v[32:35],v[112:127]
ds_read_b64_tr_b16 a[132:133],v203 offset:13312
ds_read_b64_tr_b16 a[134:135],v203 offset:13824
ds_read_b128 v[128:131],v220 offset:2688
s_waitcnt lgkmcnt(9)
v_mfma_f32_32x32x16_bf16 v[112:127],a[116:119],v[36:39],v[112:127]
ds_read_b64_tr_b16 a[136:137],v203 offset:14336
ds_read_b64_tr_b16 a[138:139],v203 offset:14848
ds_read_b128 v[132:135],v220 offset:2720
s_waitcnt lgkmcnt(10)
v_mfma_f32_32x32x16_bf16 v[112:127],a[120:123],v[40:43],v[112:127]
ds_read_b64_tr_b16 a[140:141],v203 offset:15360
ds_read_b64_tr_b16 a[142:143],v203 offset:15872
s_add_u32 s30,s101,57728
s_add_u32 m0,s60,4096
s_nop 0
buffer_load_dwordx4 v205,s[4:7],s30 offen lds
ds_read_b128 v[136:139],v220 offset:2752
s_waitcnt lgkmcnt(11)
v_mfma_f32_32x32x16_bf16 v[112:127],a[124:127],v[44:47],v[112:127]
ds_read_b64_tr_b16 a[112:113],v203 offset:16384
ds_read_b64_tr_b16 a[114:115],v203 offset:16896
ds_read_b128 v[140:143],v220 offset:2784
s_waitcnt lgkmcnt(12)
v_mfma_f32_32x32x16_bf16 v[112:127],a[128:131],v[48:51],v[112:127]
ds_read_b64_tr_b16 a[116:117],v203 offset:17408
ds_read_b64_tr_b16 a[118:119],v203 offset:17920
s_waitcnt lgkmcnt(12)
v_mfma_f32_32x32x16_bf16 v[112:127],a[132:135],v[52:55],v[112:127]
ds_read_b64_tr_b16 a[120:121],v203 offset:18432
ds_read_b64_tr_b16 a[122:123],v203 offset:18944
s_waitcnt lgkmcnt(11)
v_mfma_f32_32x32x16_bf16 v[112:127],a[136:139],v[56:59],v[112:127]
ds_read_b64_tr_b16 a[124:125],v203 offset:19456
ds_read_b64_tr_b16 a[126:127],v203 offset:19968
s_add_u32 s30,s101,72064
s_add_u32 m0,s60,5120
s_nop 0
buffer_load_dwordx4 v205,s[4:7],s30 offen lds
s_waitcnt lgkmcnt(10)
v_mfma_f32_32x32x16_bf16 v[112:127],a[140:143],v[60:63],v[112:127]
ds_read_b64_tr_b16 a[128:129],v203 offset:20480
ds_read_b64_tr_b16 a[130:131],v203 offset:20992
s_waitcnt lgkmcnt(9)
v_mfma_f32_32x32x16_bf16 v[112:127],a[112:115],v[64:67],v[112:127]
ds_read_b64_tr_b16 a[132:133],v203 offset:21504
ds_read_b64_tr_b16 a[134:135],v203 offset:22016
s_waitcnt lgkmcnt(8)
v_mfma_f32_32x32x16_bf16 v[112:127],a[116:119],v[68:71],v[112:127]
ds_read_b64_tr_b16 a[136:137],v203 offset:22528
ds_read_b64_tr_b16 a[138:139],v203 offset:23040
s_waitcnt lgkmcnt(8)
v_mfma_f32_32x32x16_bf16 v[112:127],a[120:123],v[72:75],v[112:127]
ds_read_b64_tr_b16 a[140:141],v203 offset:23552
ds_read_b64_tr_b16 a[142:143],v203 offset:24064
s_add_u32 s30,s101,86400
s_add_u32 m0,s60,6144
s_nop 0
buffer_load_dwordx4 v205,s[4:7],s30 offen lds
s_waitcnt lgkmcnt(8)
v_mfma_f32_32x32x16_bf16 v[112:127],a[124:127],v[76:79],v[112:127]
ds_read_b64_tr_b16 a[112:113],v203 offset:24576
ds_read_b64_tr_b16 a[114:115],v203 offset:25088
s_waitcnt lgkmcnt(8)
v_mfma_f32_32x32x16_bf16 v[112:127],a[128:131],v[80:83],v[112:127]
ds_read_b64_tr_b16 a[116:117],v203 offset:25600
ds_read_b64_tr_b16 a[118:119],v203 offset:26112
s_waitcnt lgkmcnt(8)
v_mfma_f32_32x32x16_bf16 v[112:127],a[132:135],v[84:87],v[112:127]
ds_read_b64_tr_b16 a[120:121],v203 offset:26624
ds_read_b64_tr_b16 a[122:123],v203 offset:27136
s_waitcnt vmcnt(11)
s_barrier
s_waitcnt lgkmcnt(8)
v_mfma_f32_32x32x16_bf16 v[112:127],a[136:139],v[88:91],v[112:127]
ds_read_b64_tr_b16 a[124:125],v203 offset:27648
ds_read_b64_tr_b16 a[126:127],v203 offset:28160
s_add_u32 s30,s101,448
s_add_u32 m0,s60,28672
s_nop 0
buffer_load_dwordx4 v205,s[4:7],s30 offen lds
s_waitcnt lgkmcnt(8)
v_mfma_f32_32x32x16_bf16 v[112:127],a[140:143],v[92:95],v[112:127]
ds_read_b64_tr_b16 a[128:129],v203 offset:28672
ds_read_b64_tr_b16 a[130:131],v203 offset:29184
s_waitcnt lgkmcnt(8)
v_mfma_f32_32x32x16_bf16 v[112:127],a[112:115],v[96:99],v[112:127]
ds_read_b64_tr_b16 a[132:133],v203 offset:29696
ds_read_b64_tr_b16 a[134:135],v203 offset:30208
s_waitcnt lgkmcnt(8)
v_mfma_f32_32x32x16_bf16 v[112:127],a[116:119],v[100:103],v[112:127]
ds_read_b64_tr_b16 a[136:137],v203 offset:30720
ds_read_b64_tr_b16 a[138:139],v203 offset:31232
s_waitcnt lgkmcnt(8)
v_mfma_f32_32x32x16_bf16 v[112:127],a[120:123],v[104:107],v[112:127]
ds_read_b64_tr_b16 a[140:141],v203 offset:31744
ds_read_b64_tr_b16 a[142:143],v203 offset:32256
s_add_u32 s30,s101,14784
s_add_u32 m0,s60,29696
s_nop 0
buffer_load_dwordx4 v205,s[4:7],s30 offen lds
s_waitcnt lgkmcnt(8)
v_mfma_f32_32x32x16_bf16 v[112:127],a[124:127],v[108:111],v[112:127]
ds_read_b64_tr_b16 a[112:113],v203 offset:32768
ds_read_b64_tr_b16 a[114:115],v203 offset:33280
s_waitcnt lgkmcnt(8)
v_mfma_f32_32x32x16_bf16 v[128:143],a[128:131],v[0:3],v[128:143]
ds_read_b64_tr_b16 a[116:117],v203 offset:33792
ds_read_b64_tr_b16 a[118:119],v203 offset:34304
s_waitcnt lgkmcnt(8)
v_mfma_f32_32x32x16_bf16 v[128:143],a[132:135],v[4:7],v[128:143]
ds_read_b64_tr_b16 a[120:121],v203 offset:34816
ds_read_b64_tr_b16 a[122:123],v203 offset:35328
s_waitcnt lgkmcnt(8)
v_mfma_f32_32x32x16_bf16 v[128:143],a[136:139],v[8:11],v[128:143]
ds_read_b64_tr_b16 a[124:125],v203 offset:35840
ds_read_b64_tr_b16 a[126:127],v203 offset:36352
s_add_u32 s30,s101,29120
s_add_u32 m0,s60,30720
s_nop 0
buffer_load_dwordx4 v205,s[4:7],s30 offen lds
s_add_u32 s31,s59,16384
s_waitcnt lgkmcnt(8)
v_mfma_f32_32x32x16_bf16 v[128:143],a[140:143],v[12:15],v[128:143]
ds_read_b64_tr_b16 a[128:129],v203 offset:36864
ds_read_b64_tr_b16 a[130:131],v203 offset:37376
buffer_store_dwordx4 v[112:115],v211,s[8:11],s31 offen sc1
s_waitcnt lgkmcnt(8)
v_mfma_f32_32x32x16_bf16 v[128:143],a[112:115],v[16:19],v[128:143]
ds_read_b64_tr_b16 a[132:133],v203 offset:37888
ds_read_b64_tr_b16 a[134:135],v203 offset:38400
buffer_store_dwordx4 v[116:119],v211,s[8:11],s31 offen offset:1024 sc1
s_waitcnt lgkmcnt(8)
v_mfma_f32_32x32x16_bf16 v[128:143],a[116:119],v[20:23],v[128:143]
ds_read_b64_tr_b16 a[136:137],v203 offset:38912
ds_read_b64_tr_b16 a[138:139],v203 offset:39424
buffer_store_dwordx4 v[120:123],v211,s[8:11],s31 offen offset:2048 sc1
s_waitcnt lgkmcnt(8)
v_mfma_f32_32x32x16_bf16 v[128:143],a[120:123],v[24:27],v[128:143]
ds_read_b64_tr_b16 a[140:141],v203 offset:39936
ds_read_b64_tr_b16 a[142:143],v203 offset:40448
s_add_u32 s30,s101,43456
s_add_u32 m0,s60,31744
s_nop 0
buffer_load_dwordx4 v205,s[4:7],s30 offen lds
buffer_store_dwordx4 v[124:127],v211,s[8:11],s31 offen offset:3072 sc1
s_waitcnt lgkmcnt(8)
v_mfma_f32_32x32x16_bf16 v[128:143],a[124:127],v[28:31],v[128:143]
ds_read_b64_tr_b16 a[112:113],v203 offset:40960
ds_read_b64_tr_b16 a[114:115],v203 offset:41472
s_nop 1
s_waitcnt lgkmcnt(8)
v_mfma_f32_32x32x16_bf16 v[128:143],a[128:131],v[32:35],v[128:143]
ds_read_b64_tr_b16 a[116:117],v203 offset:41984
ds_read_b64_tr_b16 a[118:119],v203 offset:42496
ds_read_b128 v[112:115],v220 offset:2816
s_waitcnt lgkmcnt(9)
v_mfma_f32_32x32x16_bf16 v[128:143],a[132:135],v[36:39],v[128:143]
ds_read_b64_tr_b16 a[120:121],v203 offset:43008
ds_read_b64_tr_b16 a[122:123],v203 offset:43520
ds_read_b128 v[116:119],v220 offset:2848
s_waitcnt lgkmcnt(10)
v_mfma_f32_32x32x16_bf16 v[128:143],a[136:139],v[40:43],v[128:143]
ds_read_b64_tr_b16 a[124:125],v203 offset:44032
ds_read_b64_tr_b16 a[126:127],v203 offset:44544
s_add_u32 s30,s101,57792
s_add_u32 m0,s60,32768
s_nop 0
buffer_load_dwordx4 v205,s[4:7],s30 offen lds
ds_read_b128 v[120:123],v220 offset:2880
s_waitcnt lgkmcnt(11)
v_mfma_f32_32x32x16_bf16 v[128:143],a[140:143],v[44:47],v[128:143]
ds_read_b64_tr_b16 a[128:129],v203 offset:45056
ds_read_b64_tr_b16 a[130:131],v203 offset:45568
ds_read_b128 v[124:127],v220 offset:2912
s_waitcnt lgkmcnt(12)
v_mfma_f32_32x32x16_bf16 v[128:143],a[112:115],v[48:51],v[128:143]
ds_read_b64_tr_b16 a[132:133],v203 offset:46080
ds_read_b64_tr_b16 a[134:135],v203 offset:46592
s_waitcnt lgkmcnt(12)
v_mfma_f32_32x32x16_bf16 v[128:143],a[116:119],v[52:55],v[128:143]
ds_read_b64_tr_b16 a[136:137],v203 offset:47104
ds_read_b64_tr_b16 a[138:139],v203 offset:47616
s_waitcnt lgkmcnt(11)
v_mfma_f32_32x32x16_bf16 v[128:143],a[120:123],v[56:59],v[128:143]
ds_read_b64_tr_b16 a[140:141],v203 offset:48128
ds_read_b64_tr_b16 a[142:143],v203 offset:48640
s_add_u32 s30,s101,72128
s_add_u32 m0,s60,33792
s_nop 0
buffer_load_dwordx4 v205,s[4:7],s30 offen lds
s_waitcnt lgkmcnt(10)
v_mfma_f32_32x32x16_bf16 v[128:143],a[124:127],v[60:63],v[128:143]
ds_read_b64_tr_b16 a[112:113],v203 offset:49152
ds_read_b64_tr_b16 a[114:115],v203 offset:49664
s_waitcnt lgkmcnt(9)
v_mfma_f32_32x32x16_bf16 v[128:143],a[128:131],v[64:67],v[128:143]
ds_read_b64_tr_b16 a[116:117],v203 offset:50176
ds_read_b64_tr_b16 a[118:119],v203 offset:50688
s_waitcnt lgkmcnt(8)
v_mfma_f32_32x32x16_bf16 v[128:143],a[132:135],v[68:71],v[128:143]
ds_read_b64_tr_b16 a[120:121],v203 offset:51200
ds_read_b64_tr_b16 a[122:123],v203 offset:51712
s_waitcnt lgkmcnt(8)
v_mfma_f32_32x32x16_bf16 v[128:143],a[136:139],v[72:75],v[128:143]
ds_read_b64_tr_b16 a[124:125],v203 offset:52224
ds_read_b64_tr_b16 a[126:127],v203 offset:52736
s_add_u32 s30,s101,86464
s_add_u32 m0,s60,34816
s_nop 0
buffer_load_dwordx4 v205,s[4:7],s30 offen lds
s_waitcnt lgkmcnt(8)
v_mfma_f32_32x32x16_bf16 v[128:143],a[140:143],v[76:79],v[128:143]
ds_read_b64_tr_b16 a[128:129],v203 offset:53248
ds_read_b64_tr_b16 a[130:131],v203 offset:53760
s_waitcnt lgkmcnt(8)
v_mfma_f32_32x32x16_bf16 v[128:143],a[112:115],v[80:83],v[128:143]
ds_read_b64_tr_b16 a[132:133],v203 offset:54272
ds_read_b64_tr_b16 a[134:135],v203 offset:54784
s_waitcnt lgkmcnt(8)
v_mfma_f32_32x32x16_bf16 v[128:143],a[116:119],v[84:87],v[128:143]
ds_read_b64_tr_b16 a[136:137],v203 offset:55296
ds_read_b64_tr_b16 a[138:139],v203 offset:55808
s_waitcnt vmcnt(11)
s_barrier
s_waitcnt lgkmcnt(8)
v_mfma_f32_32x32x16_bf16 v[128:143],a[120:123],v[88:91],v[128:143]
ds_read_b64_tr_b16 a[140:141],v203 offset:56320
ds_read_b64_tr_b16 a[142:143],v203 offset:56832
s_add_u32 s30,s101,512
s_add_u32 m0,s60,57344
s_nop 0
buffer_load_dwordx4 v205,s[4:7],s30 offen lds
s_waitcnt lgkmcnt(8)
v_mfma_f32_32x32x16_bf16 v[128:143],a[124:127],v[92:95],v[128:143]
ds_read_b64_tr_b16 a[112:113],v202 offset:0
ds_read_b64_tr_b16 a[114:115],v202 offset:512
s_waitcnt lgkmcnt(8)
v_mfma_f32_32x32x16_bf16 v[128:143],a[128:131],v[96:99],v[128:143]
ds_read_b64_tr_b16 a[116:117],v202 offset:1024
ds_read_b64_tr_b16 a[118:119],v202 offset:1536
s_waitcnt lgkmcnt(8)
v_mfma_f32_32x32x16_bf16 v[128:143],a[132:135],v[100:103],v[128:143]
ds_read_b64_tr_b16 a[120:121],v202 offset:2048
ds_read_b64_tr_b16 a[122:123],v202 offset:2560
s_waitcnt lgkmcnt(8)
v_mfma_f32_32x32x16_bf16 v[128:143],a[136:139],v[104:107],v[128:143]
ds_read_b64_tr_b16 a[124:125],v202 offset:3072
ds_read_b64_tr_b16 a[126:127],v202 offset:3584
s_add_u32 s30,s101,14848
s_add_u32 m0,s60,58368
s_nop 0
buffer_load_dwordx4 v205,s[4:7],s30 offen lds
s_waitcnt lgkmcnt(8)
v_mfma_f32_32x32x16_bf16 v[128:143],a[140:143],v[108:111],v[128:143]
ds_read_b64_tr_b16 a[128:129],v202 offset:4096
ds_read_b64_tr_b16 a[130:131],v202 offset:4608
s_waitcnt lgkmcnt(8)
v_mfma_f32_32x32x16_bf16 v[112:127],a[112:115],v[0:3],v[112:127]
ds_read_b64_tr_b16 a[132:133],v202 offset:5120
ds_read_b64_tr_b16 a[134:135],v202 offset:5632
s_waitcnt lgkmcnt(8)
v_mfma_f32_32x32x16_bf16 v[112:127],a[116:119],v[4:7],v[112:127]
ds_read_b64_tr_b16 a[136:137],v202 offset:6144
ds_read_b64_tr_b16 a[138:139],v202 offset:6656
s_waitcnt lgkmcnt(8)
v_mfma_f32_32x32x16_bf16 v[112:127],a[120:123],v[8:11],v[112:127]
ds_read_b64_tr_b16 a[140:141],v202 offset:7168
ds_read_b64_tr_b16 a[142:143],v202 offset:7680
s_add_u32 s30,s101,29184
s_add_u32 m0,s60,59392
s_nop 0
buffer_load_dwordx4 v205,s[4:7],s30 offen lds
s_add_u32 s31,s59,20480
s_waitcnt lgkmcnt(8)
v_mfma_f32_32x32x16_bf16 v[112:127],a[124:127],v[12:15],v[112:127]
ds_read_b64_tr_b16 a[112:113],v202 offset:8192
ds_read_b64_tr_b16 a[114:115],v202 offset:8704
buffer_store_dwordx4 v[128:131],v211,s[8:11],s31 offen sc1
s_waitcnt lgkmcnt(8)
v_mfma_f32_32x32x16_bf16 v[112:127],a[128:131],v[16:19],v[112:127]
ds_read_b64_tr_b16 a[116:117],v202 offset:9216
ds_read_b64_tr_b16 a[118:119],v202 offset:9728
buffer_store_dwordx4 v[132:135],v211,s[8:11],s31 offen offset:1024 sc1
s_waitcnt lgkmcnt(8)
v_mfma_f32_32x32x16_bf16 v[112:127],a[132:135],v[20:23],v[112:127]
ds_read_b64_tr_b16 a[120:121],v202 offset:10240
ds_read_b64_tr_b16 a[122:123],v202 offset:10752
buffer_store_dwordx4 v[136:139],v211,s[8:11],s31 offen offset:2048 sc1
s_waitcnt lgkmcnt(8)
v_mfma_f32_32x32x16_bf16 v[112:127],a[136:139],v[24:27],v[112:127]
ds_read_b64_tr_b16 a[124:125],v202 offset:11264
ds_read_b64_tr_b16 a[126:127],v202 offset:11776
s_add_u32 s30,s101,43520
s_add_u32 m0,s60,60416
s_nop 0
buffer_load_dwordx4 v205,s[4:7],s30 offen lds
buffer_store_dwordx4 v[140:143],v211,s[8:11],s31 offen offset:3072 sc1
s_waitcnt lgkmcnt(8)
v_mfma_f32_32x32x16_bf16 v[112:127],a[140:143],v[28:31],v[112:127]
ds_read_b64_tr_b16 a[128:129],v202 offset:12288
ds_read_b64_tr_b16 a[130:131],v202 offset:12800
s_nop 1
s_waitcnt lgkmcnt(8)
v_mfma_f32_32x32x16_bf16 v[112:127],a[112:115],v[32:35],v[112:127]
ds_read_b64_tr_b16 a[132:133],v202 offset:13312
ds_read_b64_tr_b16 a[134:135],v202 offset:13824
ds_read_b128 v[128:131],v220 offset:2944
s_waitcnt lgkmcnt(9)
v_mfma_f32_32x32x16_bf16 v[112:127],a[116:119],v[36:39],v[112:127]
ds_read_b64_tr_b16 a[136:137],v202 offset:14336
ds_read_b64_tr_b16 a[138:139],v202 offset:14848
ds_read_b128 v[132:135],v220 offset:2976
s_waitcnt lgkmcnt(10)
v_mfma_f32_32x32x16_bf16 v[112:127],a[120:123],v[40:43],v[112:127]
ds_read_b64_tr_b16 a[140:141],v202 offset:15360
ds_read_b64_tr_b16 a[142:143],v202 offset:15872
s_add_u32 s30,s101,57856
s_add_u32 m0,s60,61440
s_nop 0
buffer_load_dwordx4 v205,s[4:7],s30 offen lds
ds_read_b128 v[136:139],v220 offset:3008
s_waitcnt lgkmcnt(11)
v_mfma_f32_32x32x16_bf16 v[112:127],a[124:127],v[44:47],v[112:127]
ds_read_b64_tr_b16 a[112:113],v202 offset:16384
ds_read_b64_tr_b16 a[114:115],v202 offset:16896
ds_read_b128 v[140:143],v220 offset:3040
s_waitcnt lgkmcnt(12)
v_mfma_f32_32x32x16_bf16 v[112:127],a[128:131],v[48:51],v[112:127]
ds_read_b64_tr_b16 a[116:117],v202 offset:17408
ds_read_b64_tr_b16 a[118:119],v202 offset:17920
s_waitcnt lgkmcnt(12)
v_mfma_f32_32x32x16_bf16 v[112:127],a[132:135],v[52:55],v[112:127]
ds_read_b64_tr_b16 a[120:121],v202 offset:18432
ds_read_b64_tr_b16 a[122:123],v202 offset:18944
s_waitcnt lgkmcnt(11)
v_mfma_f32_32x32x16_bf16 v[112:127],a[136:139],v[56:59],v[112:127]
ds_read_b64_tr_b16 a[124:125],v202 offset:19456
ds_read_b64_tr_b16 a[126:127],v202 offset:19968
s_add_u32 s30,s101,72192
s_add_u32 m0,s60,62464
s_nop 0
buffer_load_dwordx4 v205,s[4:7],s30 offen lds
s_waitcnt lgkmcnt(10)
v_mfma_f32_32x32x16_bf16 v[112:127],a[140:143],v[60:63],v[112:127]
ds_read_b64_tr_b16 a[128:129],v202 offset:20480
ds_read_b64_tr_b16 a[130:131],v202 offset:20992
s_waitcnt lgkmcnt(9)
v_mfma_f32_32x32x16_bf16 v[112:127],a[112:115],v[64:67],v[112:127]
ds_read_b64_tr_b16 a[132:133],v202 offset:21504
ds_read_b64_tr_b16 a[134:135],v202 offset:22016
s_waitcnt lgkmcnt(8)
v_mfma_f32_32x32x16_bf16 v[112:127],a[116:119],v[68:71],v[112:127]
ds_read_b64_tr_b16 a[136:137],v202 offset:22528
ds_read_b64_tr_b16 a[138:139],v202 offset:23040
s_waitcnt lgkmcnt(8)
v_mfma_f32_32x32x16_bf16 v[112:127],a[120:123],v[72:75],v[112:127]
ds_read_b64_tr_b16 a[140:141],v202 offset:23552
ds_read_b64_tr_b16 a[142:143],v202 offset:24064
s_add_u32 s30,s101,86528
s_add_u32 m0,s60,63488
s_nop 0
buffer_load_dwordx4 v205,s[4:7],s30 offen lds
s_waitcnt lgkmcnt(8)
v_mfma_f32_32x32x16_bf16 v[112:127],a[124:127],v[76:79],v[112:127]
ds_read_b64_tr_b16 a[112:113],v202 offset:24576
ds_read_b64_tr_b16 a[114:115],v202 offset:25088
s_waitcnt lgkmcnt(8)
v_mfma_f32_32x32x16_bf16 v[112:127],a[128:131],v[80:83],v[112:127]
ds_read_b64_tr_b16 a[116:117],v202 offset:25600
ds_read_b64_tr_b16 a[118:119],v202 offset:26112
s_waitcnt lgkmcnt(8)
v_mfma_f32_32x32x16_bf16 v[112:127],a[132:135],v[84:87],v[112:127]
ds_read_b64_tr_b16 a[120:121],v202 offset:26624
ds_read_b64_tr_b16 a[122:123],v202 offset:27136
s_waitcnt vmcnt(11)
s_barrier
s_waitcnt lgkmcnt(8)
v_mfma_f32_32x32x16_bf16 v[112:127],a[136:139],v[88:91],v[112:127]
ds_read_b64_tr_b16 a[124:125],v202 offset:27648
ds_read_b64_tr_b16 a[126:127],v202 offset:28160
s_add_u32 s30,s101,576
s_add_u32 m0,s60,86016
s_nop 0
buffer_load_dwordx4 v205,s[4:7],s30 offen lds
s_waitcnt lgkmcnt(8)
v_mfma_f32_32x32x16_bf16 v[112:127],a[140:143],v[92:95],v[112:127]
ds_read_b64_tr_b16 a[128:129],v202 offset:28672
ds_read_b64_tr_b16 a[130:131],v202 offset:29184
s_waitcnt lgkmcnt(8)
v_mfma_f32_32x32x16_bf16 v[112:127],a[112:115],v[96:99],v[112:127]
ds_read_b64_tr_b16 a[132:133],v202 offset:29696
ds_read_b64_tr_b16 a[134:135],v202 offset:30208
s_waitcnt lgkmcnt(8)
v_mfma_f32_32x32x16_bf16 v[112:127],a[116:119],v[100:103],v[112:127]
ds_read_b64_tr_b16 a[136:137],v202 offset:30720
ds_read_b64_tr_b16 a[138:139],v202 offset:31232
s_waitcnt lgkmcnt(8)
v_mfma_f32_32x32x16_bf16 v[112:127],a[120:123],v[104:107],v[112:127]
ds_read_b64_tr_b16 a[140:141],v202 offset:31744
ds_read_b64_tr_b16 a[142:143],v202 offset:32256
s_add_u32 s30,s101,14912
s_add_u32 m0,s60,87040
s_nop 0
buffer_load_dwordx4 v205,s[4:7],s30 offen lds
s_waitcnt lgkmcnt(8)
v_mfma_f32_32x32x16_bf16 v[112:127],a[124:127],v[108:111],v[112:127]
ds_read_b64_tr_b16 a[112:113],v202 offset:32768
ds_read_b64_tr_b16 a[114:115],v202 offset:33280
s_waitcnt lgkmcnt(8)
v_mfma_f32_32x32x16_bf16 v[128:143],a[128:131],v[0:3],v[128:143]
ds_read_b64_tr_b16 a[116:117],v202 offset:33792
ds_read_b64_tr_b16 a[118:119],v202 offset:34304
s_waitcnt lgkmcnt(8)
v_mfma_f32_32x32x16_bf16 v[128:143],a[132:135],v[4:7],v[128:143]
ds_read_b64_tr_b16 a[120:121],v202 offset:34816
ds_read_b64_tr_b16 a[122:123],v202 offset:35328
s_waitcnt lgkmcnt(8)
v_mfma_f32_32x32x16_bf16 v[128:143],a[136:139],v[8:11],v[128:143]
ds_read_b64_tr_b16 a[124:125],v202 offset:35840
ds_read_b64_tr_b16 a[126:127],v202 offset:36352
s_add_u32 s30,s101,29248
s_add_u32 m0,s60,88064
s_nop 0
buffer_load_dwordx4 v205,s[4:7],s30 offen lds
s_add_u32 s31,s59,24576
s_waitcnt lgkmcnt(8)
v_mfma_f32_32x32x16_bf16 v[128:143],a[140:143],v[12:15],v[128:143]
ds_read_b64_tr_b16 a[128:129],v202 offset:36864
ds_read_b64_tr_b16 a[130:131],v202 offset:37376
buffer_store_dwordx4 v[112:115],v211,s[8:11],s31 offen sc1
s_waitcnt lgkmcnt(8)
v_mfma_f32_32x32x16_bf16 v[128:143],a[112:115],v[16:19],v[128:143]
ds_read_b64_tr_b16 a[132:133],v202 offset:37888
ds_read_b64_tr_b16 a[134:135],v202 offset:38400
buffer_store_dwordx4 v[116:119],v211,s[8:11],s31 offen offset:1024 sc1
s_waitcnt lgkmcnt(8)
v_mfma_f32_32x32x16_bf16 v[128:143],a[116:119],v[20:23],v[128:143]
ds_read_b64_tr_b16 a[136:137],v202 offset:38912
ds_read_b64_tr_b16 a[138:139],v202 offset:39424
buffer_store_dwordx4 v[120:123],v211,s[8:11],s31 offen offset:2048 sc1
s_waitcnt lgkmcnt(8)
v_mfma_f32_32x32x16_bf16 v[128:143],a[120:123],v[24:27],v[128:143]
ds_read_b64_tr_b16 a[140:141],v202 offset:39936
ds_read_b64_tr_b16 a[142:143],v202 offset:40448
s_add_u32 s30,s101,43584
s_add_u32 m0,s60,89088
s_nop 0
buffer_load_dwordx4 v205,s[4:7],s30 offen lds
buffer_store_dwordx4 v[124:127],v211,s[8:11],s31 offen offset:3072 sc1
s_waitcnt lgkmcnt(8)
v_mfma_f32_32x32x16_bf16 v[128:143],a[124:127],v[28:31],v[128:143]
ds_read_b64_tr_b16 a[112:113],v202 offset:40960
ds_read_b64_tr_b16 a[114:115],v202 offset:41472
s_nop 1
s_waitcnt lgkmcnt(8)
v_mfma_f32_32x32x16_bf16 v[128:143],a[128:131],v[32:35],v[128:143]
ds_read_b64_tr_b16 a[116:117],v202 offset:41984
ds_read_b64_tr_b16 a[118:119],v202 offset:42496
ds_read_b128 v[112:115],v220 offset:3072
s_waitcnt lgkmcnt(9)
v_mfma_f32_32x32x16_bf16 v[128:143],a[132:135],v[36:39],v[128:143]
ds_read_b64_tr_b16 a[120:121],v202 offset:43008
ds_read_b64_tr_b16 a[122:123],v202 offset:43520
ds_read_b128 v[116:119],v220 offset:3104
s_waitcnt lgkmcnt(10)
v_mfma_f32_32x32x16_bf16 v[128:143],a[136:139],v[40:43],v[128:143]
ds_read_b64_tr_b16 a[124:125],v202 offset:44032
ds_read_b64_tr_b16 a[126:127],v202 offset:44544
s_add_u32 s30,s101,57920
s_add_u32 m0,s60,90112
s_nop 0
buffer_load_dwordx4 v205,s[4:7],s30 offen lds
ds_read_b128 v[120:123],v220 offset:3136
s_waitcnt lgkmcnt(11)
v_mfma_f32_32x32x16_bf16 v[128:143],a[140:143],v[44:47],v[128:143]
ds_read_b64_tr_b16 a[128:129],v202 offset:45056
ds_read_b64_tr_b16 a[130:131],v202 offset:45568
ds_read_b128 v[124:127],v220 offset:3168
s_waitcnt lgkmcnt(12)
v_mfma_f32_32x32x16_bf16 v[128:143],a[112:115],v[48:51],v[128:143]
ds_read_b64_tr_b16 a[132:133],v202 offset:46080
ds_read_b64_tr_b16 a[134:135],v202 offset:46592
s_waitcnt lgkmcnt(12)
v_mfma_f32_32x32x16_bf16 v[128:143],a[116:119],v[52:55],v[128:143]
ds_read_b64_tr_b16 a[136:137],v202 offset:47104
ds_read_b64_tr_b16 a[138:139],v202 offset:47616
s_waitcnt lgkmcnt(11)
v_mfma_f32_32x32x16_bf16 v[128:143],a[120:123],v[56:59],v[128:143]
ds_read_b64_tr_b16 a[140:141],v202 offset:48128
ds_read_b64_tr_b16 a[142:143],v202 offset:48640
s_add_u32 s30,s101,72256
s_add_u32 m0,s60,91136
s_nop 0
buffer_load_dwordx4 v205,s[4:7],s30 offen lds
s_waitcnt lgkmcnt(10)
v_mfma_f32_32x32x16_bf16 v[128:143],a[124:127],v[60:63],v[128:143]
ds_read_b64_tr_b16 a[112:113],v202 offset:49152
ds_read_b64_tr_b16 a[114:115],v202 offset:49664
s_waitcnt lgkmcnt(9)
v_mfma_f32_32x32x16_bf16 v[128:143],a[128:131],v[64:67],v[128:143]
ds_read_b64_tr_b16 a[116:117],v202 offset:50176
ds_read_b64_tr_b16 a[118:119],v202 offset:50688
s_waitcnt lgkmcnt(8)
v_mfma_f32_32x32x16_bf16 v[128:143],a[132:135],v[68:71],v[128:143]
ds_read_b64_tr_b16 a[120:121],v202 offset:51200
ds_read_b64_tr_b16 a[122:123],v202 offset:51712
s_waitcnt lgkmcnt(8)
v_mfma_f32_32x32x16_bf16 v[128:143],a[136:139],v[72:75],v[128:143]
ds_read_b64_tr_b16 a[124:125],v202 offset:52224
ds_read_b64_tr_b16 a[126:127],v202 offset:52736
s_add_u32 s30,s101,86592
s_add_u32 m0,s60,92160
s_nop 0
buffer_load_dwordx4 v205,s[4:7],s30 offen lds
s_waitcnt lgkmcnt(8)
v_mfma_f32_32x32x16_bf16 v[128:143],a[140:143],v[76:79],v[128:143]
ds_read_b64_tr_b16 a[128:129],v202 offset:53248
ds_read_b64_tr_b16 a[130:131],v202 offset:53760
s_waitcnt lgkmcnt(8)
v_mfma_f32_32x32x16_bf16 v[128:143],a[112:115],v[80:83],v[128:143]
ds_read_b64_tr_b16 a[132:133],v202 offset:54272
ds_read_b64_tr_b16 a[134:135],v202 offset:54784
s_waitcnt lgkmcnt(8)
v_mfma_f32_32x32x16_bf16 v[128:143],a[116:119],v[84:87],v[128:143]
ds_read_b64_tr_b16 a[136:137],v202 offset:55296
ds_read_b64_tr_b16 a[138:139],v202 offset:55808
s_waitcnt vmcnt(11)
s_barrier
s_waitcnt lgkmcnt(8)
v_mfma_f32_32x32x16_bf16 v[128:143],a[120:123],v[88:91],v[128:143]
ds_read_b64_tr_b16 a[140:141],v202 offset:56320
ds_read_b64_tr_b16 a[142:143],v202 offset:56832
s_add_u32 s30,s101,640
s_add_u32 m0,s60,0
s_nop 0
buffer_load_dwordx4 v205,s[4:7],s30 offen lds
s_waitcnt lgkmcnt(8)
v_mfma_f32_32x32x16_bf16 v[128:143],a[124:127],v[92:95],v[128:143]
ds_read_b64_tr_b16 a[112:113],v203 offset:0
ds_read_b64_tr_b16 a[114:115],v203 offset:512
s_waitcnt lgkmcnt(8)
v_mfma_f32_32x32x16_bf16 v[128:143],a[128:131],v[96:99],v[128:143]
ds_read_b64_tr_b16 a[116:117],v203 offset:1024
ds_read_b64_tr_b16 a[118:119],v203 offset:1536
s_waitcnt lgkmcnt(8)
v_mfma_f32_32x32x16_bf16 v[128:143],a[132:135],v[100:103],v[128:143]
ds_read_b64_tr_b16 a[120:121],v203 offset:2048
ds_read_b64_tr_b16 a[122:123],v203 offset:2560
s_waitcnt lgkmcnt(8)
v_mfma_f32_32x32x16_bf16 v[128:143],a[136:139],v[104:107],v[128:143]
ds_read_b64_tr_b16 a[124:125],v203 offset:3072
ds_read_b64_tr_b16 a[126:127],v203 offset:3584
s_add_u32 s30,s101,14976
s_add_u32 m0,s60,1024
s_nop 0
buffer_load_dwordx4 v205,s[4:7],s30 offen lds
s_waitcnt lgkmcnt(8)
v_mfma_f32_32x32x16_bf16 v[128:143],a[140:143],v[108:111],v[128:143]
ds_read_b64_tr_b16 a[128:129],v203 offset:4096
ds_read_b64_tr_b16 a[130:131],v203 offset:4608
s_waitcnt lgkmcnt(8)
v_mfma_f32_32x32x16_bf16 v[112:127],a[112:115],v[0:3],v[112:127]
ds_read_b64_tr_b16 a[132:133],v203 offset:5120
ds_read_b64_tr_b16 a[134:135],v203 offset:5632
s_waitcnt lgkmcnt(8)
v_mfma_f32_32x32x16_bf16 v[112:127],a[116:119],v[4:7],v[112:127]
ds_read_b64_tr_b16 a[136:137],v203 offset:6144
ds_read_b64_tr_b16 a[138:139],v203 offset:6656
s_waitcnt lgkmcnt(8)
v_mfma_f32_32x32x16_bf16 v[112:127],a[120:123],v[8:11],v[112:127]
ds_read_b64_tr_b16 a[140:141],v203 offset:7168
ds_read_b64_tr_b16 a[142:143],v203 offset:7680
s_add_u32 s30,s101,29312
s_add_u32 m0,s60,2048
s_nop 0
buffer_load_dwordx4 v205,s[4:7],s30 offen lds
s_add_u32 s31,s59,28672
s_waitcnt lgkmcnt(8)
v_mfma_f32_32x32x16_bf16 v[112:127],a[124:127],v[12:15],v[112:127]
ds_read_b64_tr_b16 a[112:113],v203 offset:8192
ds_read_b64_tr_b16 a[114:115],v203 offset:8704
buffer_store_dwordx4 v[128:131],v211,s[8:11],s31 offen sc1
s_waitcnt lgkmcnt(8)
v_mfma_f32_32x32x16_bf16 v[112:127],a[128:131],v[16:19],v[112:127]
ds_read_b64_tr_b16 a[116:117],v203 offset:9216
ds_read_b64_tr_b16 a[118:119],v203 offset:9728
buffer_store_dwordx4 v[132:135],v211,s[8:11],s31 offen offset:1024 sc1
s_waitcnt lgkmcnt(8)
v_mfma_f32_32x32x16_bf16 v[112:127],a[132:135],v[20:23],v[112:127]
ds_read_b64_tr_b16 a[120:121],v203 offset:10240
ds_read_b64_tr_b16 a[122:123],v203 offset:10752
buffer_store_dwordx4 v[136:139],v211,s[8:11],s31 offen offset:2048 sc1
s_waitcnt lgkmcnt(8)
v_mfma_f32_32x32x16_bf16 v[112:127],a[136:139],v[24:27],v[112:127]
ds_read_b64_tr_b16 a[124:125],v203 offset:11264
ds_read_b64_tr_b16 a[126:127],v203 offset:11776
s_add_u32 s30,s101,43648
s_add_u32 m0,s60,3072
s_nop 0
buffer_load_dwordx4 v205,s[4:7],s30 offen lds
buffer_store_dwordx4 v[140:143],v211,s[8:11],s31 offen offset:3072 sc1
s_waitcnt lgkmcnt(8)
v_mfma_f32_32x32x16_bf16 v[112:127],a[140:143],v[28:31],v[112:127]
ds_read_b64_tr_b16 a[128:129],v203 offset:12288
ds_read_b64_tr_b16 a[130:131],v203 offset:12800
s_nop 1
s_waitcnt lgkmcnt(8)
v_mfma_f32_32x32x16_bf16 v[112:127],a[112:115],v[32:35],v[112:127]
ds_read_b64_tr_b16 a[132:133],v203 offset:13312
ds_read_b64_tr_b16 a[134:135],v203 offset:13824
ds_read_b128 v[128:131],v220 offset:3200
s_waitcnt lgkmcnt(9)
v_mfma_f32_32x32x16_bf16 v[112:127],a[116:119],v[36:39],v[112:127]
ds_read_b64_tr_b16 a[136:137],v203 offset:14336
ds_read_b64_tr_b16 a[138:139],v203 offset:14848
ds_read_b128 v[132:135],v220 offset:3232
s_waitcnt lgkmcnt(10)
v_mfma_f32_32x32x16_bf16 v[112:127],a[120:123],v[40:43],v[112:127]
ds_read_b64_tr_b16 a[140:141],v203 offset:15360
ds_read_b64_tr_b16 a[142:143],v203 offset:15872
s_add_u32 s30,s101,57984
s_add_u32 m0,s60,4096
s_nop 0
buffer_load_dwordx4 v205,s[4:7],s30 offen lds
ds_read_b128 v[136:139],v220 offset:3264
s_waitcnt lgkmcnt(11)
v_mfma_f32_32x32x16_bf16 v[112:127],a[124:127],v[44:47],v[112:127]
ds_read_b64_tr_b16 a[112:113],v203 offset:16384
ds_read_b64_tr_b16 a[114:115],v203 offset:16896
ds_read_b128 v[140:143],v220 offset:3296
s_waitcnt lgkmcnt(12)
v_mfma_f32_32x32x16_bf16 v[112:127],a[128:131],v[48:51],v[112:127]
ds_read_b64_tr_b16 a[116:117],v203 offset:17408
ds_read_b64_tr_b16 a[118:119],v203 offset:17920
s_waitcnt lgkmcnt(12)
v_mfma_f32_32x32x16_bf16 v[112:127],a[132:135],v[52:55],v[112:127]
ds_read_b64_tr_b16 a[120:121],v203 offset:18432
ds_read_b64_tr_b16 a[122:123],v203 offset:18944
s_waitcnt lgkmcnt(11)
v_mfma_f32_32x32x16_bf16 v[112:127],a[136:139],v[56:59],v[112:127]
ds_read_b64_tr_b16 a[124:125],v203 offset:19456
ds_read_b64_tr_b16 a[126:127],v203 offset:19968
s_add_u32 s30,s101,72320
s_add_u32 m0,s60,5120
s_nop 0
buffer_load_dwordx4 v205,s[4:7],s30 offen lds
s_waitcnt lgkmcnt(10)
v_mfma_f32_32x32x16_bf16 v[112:127],a[140:143],v[60:63],v[112:127]
ds_read_b64_tr_b16 a[128:129],v203 offset:20480
ds_read_b64_tr_b16 a[130:131],v203 offset:20992
s_waitcnt lgkmcnt(9)
v_mfma_f32_32x32x16_bf16 v[112:127],a[112:115],v[64:67],v[112:127]
ds_read_b64_tr_b16 a[132:133],v203 offset:21504
ds_read_b64_tr_b16 a[134:135],v203 offset:22016
s_waitcnt lgkmcnt(8)
v_mfma_f32_32x32x16_bf16 v[112:127],a[116:119],v[68:71],v[112:127]
ds_read_b64_tr_b16 a[136:137],v203 offset:22528
ds_read_b64_tr_b16 a[138:139],v203 offset:23040
s_waitcnt lgkmcnt(8)
v_mfma_f32_32x32x16_bf16 v[112:127],a[120:123],v[72:75],v[112:127]
ds_read_b64_tr_b16 a[140:141],v203 offset:23552
ds_read_b64_tr_b16 a[142:143],v203 offset:24064
s_add_u32 s30,s101,86656
s_add_u32 m0,s60,6144
s_nop 0
buffer_load_dwordx4 v205,s[4:7],s30 offen lds
s_waitcnt lgkmcnt(8)
v_mfma_f32_32x32x16_bf16 v[112:127],a[124:127],v[76:79],v[112:127]
ds_read_b64_tr_b16 a[112:113],v203 offset:24576
ds_read_b64_tr_b16 a[114:115],v203 offset:25088
s_waitcnt lgkmcnt(8)
v_mfma_f32_32x32x16_bf16 v[112:127],a[128:131],v[80:83],v[112:127]
ds_read_b64_tr_b16 a[116:117],v203 offset:25600
ds_read_b64_tr_b16 a[118:119],v203 offset:26112
s_waitcnt lgkmcnt(8)
v_mfma_f32_32x32x16_bf16 v[112:127],a[132:135],v[84:87],v[112:127]
ds_read_b64_tr_b16 a[120:121],v203 offset:26624
ds_read_b64_tr_b16 a[122:123],v203 offset:27136
s_waitcnt vmcnt(11)
s_barrier
s_waitcnt lgkmcnt(8)
v_mfma_f32_32x32x16_bf16 v[112:127],a[136:139],v[88:91],v[112:127]
ds_read_b64_tr_b16 a[124:125],v203 offset:27648
ds_read_b64_tr_b16 a[126:127],v203 offset:28160
s_add_u32 s30,s101,704
s_add_u32 m0,s60,28672
s_nop 0
buffer_load_dwordx4 v205,s[4:7],s30 offen lds
s_waitcnt lgkmcnt(8)
v_mfma_f32_32x32x16_bf16 v[112:127],a[140:143],v[92:95],v[112:127]
ds_read_b64_tr_b16 a[128:129],v203 offset:28672
ds_read_b64_tr_b16 a[130:131],v203 offset:29184
s_waitcnt lgkmcnt(8)
v_mfma_f32_32x32x16_bf16 v[112:127],a[112:115],v[96:99],v[112:127]
ds_read_b64_tr_b16 a[132:133],v203 offset:29696
ds_read_b64_tr_b16 a[134:135],v203 offset:30208
s_waitcnt lgkmcnt(8)
v_mfma_f32_32x32x16_bf16 v[112:127],a[116:119],v[100:103],v[112:127]
ds_read_b64_tr_b16 a[136:137],v203 offset:30720
ds_read_b64_tr_b16 a[138:139],v203 offset:31232
s_waitcnt lgkmcnt(8)
v_mfma_f32_32x32x16_bf16 v[112:127],a[120:123],v[104:107],v[112:127]
ds_read_b64_tr_b16 a[140:141],v203 offset:31744
ds_read_b64_tr_b16 a[142:143],v203 offset:32256
s_add_u32 s30,s101,15040
s_add_u32 m0,s60,29696
s_nop 0
buffer_load_dwordx4 v205,s[4:7],s30 offen lds
s_waitcnt lgkmcnt(8)
v_mfma_f32_32x32x16_bf16 v[112:127],a[124:127],v[108:111],v[112:127]
ds_read_b64_tr_b16 a[112:113],v203 offset:32768
ds_read_b64_tr_b16 a[114:115],v203 offset:33280
s_waitcnt lgkmcnt(8)
v_mfma_f32_32x32x16_bf16 v[128:143],a[128:131],v[0:3],v[128:143]
ds_read_b64_tr_b16 a[116:117],v203 offset:33792
ds_read_b64_tr_b16 a[118:119],v203 offset:34304
s_waitcnt lgkmcnt(8)
v_mfma_f32_32x32x16_bf16 v[128:143],a[132:135],v[4:7],v[128:143]
ds_read_b64_tr_b16 a[120:121],v203 offset:34816
ds_read_b64_tr_b16 a[122:123],v203 offset:35328
s_waitcnt lgkmcnt(8)
v_mfma_f32_32x32x16_bf16 v[128:143],a[136:139],v[8:11],v[128:143]
ds_read_b64_tr_b16 a[124:125],v203 offset:35840
ds_read_b64_tr_b16 a[126:127],v203 offset:36352
s_add_u32 s30,s101,29376
s_add_u32 m0,s60,30720
s_nop 0
buffer_load_dwordx4 v205,s[4:7],s30 offen lds
s_add_u32 s31,s59,32768
s_waitcnt lgkmcnt(8)
v_mfma_f32_32x32x16_bf16 v[128:143],a[140:143],v[12:15],v[128:143]
ds_read_b64_tr_b16 a[128:129],v203 offset:36864
ds_read_b64_tr_b16 a[130:131],v203 offset:37376
buffer_store_dwordx4 v[112:115],v211,s[8:11],s31 offen sc1
s_waitcnt lgkmcnt(8)
v_mfma_f32_32x32x16_bf16 v[128:143],a[112:115],v[16:19],v[128:143]
ds_read_b64_tr_b16 a[132:133],v203 offset:37888
ds_read_b64_tr_b16 a[134:135],v203 offset:38400
buffer_store_dwordx4 v[116:119],v211,s[8:11],s31 offen offset:1024 sc1
s_waitcnt lgkmcnt(8)
v_mfma_f32_32x32x16_bf16 v[128:143],a[116:119],v[20:23],v[128:143]
ds_read_b64_tr_b16 a[136:137],v203 offset:38912
ds_read_b64_tr_b16 a[138:139],v203 offset:39424
buffer_store_dwordx4 v[120:123],v211,s[8:11],s31 offen offset:2048 sc1
s_waitcnt lgkmcnt(8)
v_mfma_f32_32x32x16_bf16 v[128:143],a[120:123],v[24:27],v[128:143]
ds_read_b64_tr_b16 a[140:141],v203 offset:39936
ds_read_b64_tr_b16 a[142:143],v203 offset:40448
s_add_u32 s30,s101,43712
s_add_u32 m0,s60,31744
s_nop 0
buffer_load_dwordx4 v205,s[4:7],s30 offen lds
buffer_store_dwordx4 v[124:127],v211,s[8:11],s31 offen offset:3072 sc1
s_waitcnt lgkmcnt(8)
v_mfma_f32_32x32x16_bf16 v[128:143],a[124:127],v[28:31],v[128:143]
ds_read_b64_tr_b16 a[112:113],v203 offset:40960
ds_read_b64_tr_b16 a[114:115],v203 offset:41472
s_nop 1
s_waitcnt lgkmcnt(8)
v_mfma_f32_32x32x16_bf16 v[128:143],a[128:131],v[32:35],v[128:143]
ds_read_b64_tr_b16 a[116:117],v203 offset:41984
ds_read_b64_tr_b16 a[118:119],v203 offset:42496
ds_read_b128 v[112:115],v220 offset:3328
s_waitcnt lgkmcnt(9)
v_mfma_f32_32x32x16_bf16 v[128:143],a[132:135],v[36:39],v[128:143]
ds_read_b64_tr_b16 a[120:121],v203 offset:43008
ds_read_b64_tr_b16 a[122:123],v203 offset:43520
ds_read_b128 v[116:119],v220 offset:3360
s_waitcnt lgkmcnt(10)
v_mfma_f32_32x32x16_bf16 v[128:143],a[136:139],v[40:43],v[128:143]
ds_read_b64_tr_b16 a[124:125],v203 offset:44032
ds_read_b64_tr_b16 a[126:127],v203 offset:44544
s_add_u32 s30,s101,58048
s_add_u32 m0,s60,32768
s_nop 0
buffer_load_dwordx4 v205,s[4:7],s30 offen lds
ds_read_b128 v[120:123],v220 offset:3392
s_waitcnt lgkmcnt(11)
v_mfma_f32_32x32x16_bf16 v[128:143],a[140:143],v[44:47],v[128:143]
ds_read_b64_tr_b16 a[128:129],v203 offset:45056
ds_read_b64_tr_b16 a[130:131],v203 offset:45568
ds_read_b128 v[124:127],v220 offset:3424
s_waitcnt lgkmcnt(12)
v_mfma_f32_32x32x16_bf16 v[128:143],a[112:115],v[48:51],v[128:143]
ds_read_b64_tr_b16 a[132:133],v203 offset:46080
ds_read_b64_tr_b16 a[134:135],v203 offset:46592
s_waitcnt lgkmcnt(12)
v_mfma_f32_32x32x16_bf16 v[128:143],a[116:119],v[52:55],v[128:143]
ds_read_b64_tr_b16 a[136:137],v203 offset:47104
ds_read_b64_tr_b16 a[138:139],v203 offset:47616
s_waitcnt lgkmcnt(11)
v_mfma_f32_32x32x16_bf16 v[128:143],a[120:123],v[56:59],v[128:143]
ds_read_b64_tr_b16 a[140:141],v203 offset:48128
ds_read_b64_tr_b16 a[142:143],v203 offset:48640
s_add_u32 s30,s101,72384
s_add_u32 m0,s60,33792
s_nop 0
buffer_load_dwordx4 v205,s[4:7],s30 offen lds
s_waitcnt lgkmcnt(10)
v_mfma_f32_32x32x16_bf16 v[128:143],a[124:127],v[60:63],v[128:143]
ds_read_b64_tr_b16 a[112:113],v203 offset:49152
ds_read_b64_tr_b16 a[114:115],v203 offset:49664
s_waitcnt lgkmcnt(9)
v_mfma_f32_32x32x16_bf16 v[128:143],a[128:131],v[64:67],v[128:143]
ds_read_b64_tr_b16 a[116:117],v203 offset:50176
ds_read_b64_tr_b16 a[118:119],v203 offset:50688
s_waitcnt lgkmcnt(8)
v_mfma_f32_32x32x16_bf16 v[128:143],a[132:135],v[68:71],v[128:143]
ds_read_b64_tr_b16 a[120:121],v203 offset:51200
ds_read_b64_tr_b16 a[122:123],v203 offset:51712
s_waitcnt lgkmcnt(8)
v_mfma_f32_32x32x16_bf16 v[128:143],a[136:139],v[72:75],v[128:143]
ds_read_b64_tr_b16 a[124:125],v203 offset:52224
ds_read_b64_tr_b16 a[126:127],v203 offset:52736
s_add_u32 s30,s101,86720
s_add_u32 m0,s60,34816
s_nop 0
buffer_load_dwordx4 v205,s[4:7],s30 offen lds
s_waitcnt lgkmcnt(8)
v_mfma_f32_32x32x16_bf16 v[128:143],a[140:143],v[76:79],v[128:143]
ds_read_b64_tr_b16 a[128:129],v203 offset:53248
ds_read_b64_tr_b16 a[130:131],v203 offset:53760
s_waitcnt lgkmcnt(8)
v_mfma_f32_32x32x16_bf16 v[128:143],a[112:115],v[80:83],v[128:143]
ds_read_b64_tr_b16 a[132:133],v203 offset:54272
ds_read_b64_tr_b16 a[134:135],v203 offset:54784
s_waitcnt lgkmcnt(8)
v_mfma_f32_32x32x16_bf16 v[128:143],a[116:119],v[84:87],v[128:143]
ds_read_b64_tr_b16 a[136:137],v203 offset:55296
ds_read_b64_tr_b16 a[138:139],v203 offset:55808
s_waitcnt vmcnt(11)
s_barrier
s_waitcnt lgkmcnt(8)
v_mfma_f32_32x32x16_bf16 v[128:143],a[120:123],v[88:91],v[128:143]
ds_read_b64_tr_b16 a[140:141],v203 offset:56320
ds_read_b64_tr_b16 a[142:143],v203 offset:56832
s_add_u32 s30,s101,768
s_add_u32 m0,s60,57344
s_nop 0
buffer_load_dwordx4 v205,s[4:7],s30 offen lds
s_waitcnt lgkmcnt(8)
v_mfma_f32_32x32x16_bf16 v[128:143],a[124:127],v[92:95],v[128:143]
ds_read_b64_tr_b16 a[112:113],v202 offset:0
ds_read_b64_tr_b16 a[114:115],v202 offset:512
s_waitcnt lgkmcnt(8)
v_mfma_f32_32x32x16_bf16 v[128:143],a[128:131],v[96:99],v[128:143]
ds_read_b64_tr_b16 a[116:117],v202 offset:1024
ds_read_b64_tr_b16 a[118:119],v202 offset:1536
s_waitcnt lgkmcnt(8)
v_mfma_f32_32x32x16_bf16 v[128:143],a[132:135],v[100:103],v[128:143]
ds_read_b64_tr_b16 a[120:121],v202 offset:2048
ds_read_b64_tr_b16 a[122:123],v202 offset:2560
s_waitcnt lgkmcnt(8)
v_mfma_f32_32x32x16_bf16 v[128:143],a[136:139],v[104:107],v[128:143]
ds_read_b64_tr_b16 a[124:125],v202 offset:3072
ds_read_b64_tr_b16 a[126:127],v202 offset:3584
s_add_u32 s30,s101,15104
s_add_u32 m0,s60,58368
s_nop 0
buffer_load_dwordx4 v205,s[4:7],s30 offen lds
s_waitcnt lgkmcnt(8)
v_mfma_f32_32x32x16_bf16 v[128:143],a[140:143],v[108:111],v[128:143]
ds_read_b64_tr_b16 a[128:129],v202 offset:4096
ds_read_b64_tr_b16 a[130:131],v202 offset:4608
s_waitcnt lgkmcnt(8)
v_mfma_f32_32x32x16_bf16 v[112:127],a[112:115],v[0:3],v[112:127]
ds_read_b64_tr_b16 a[132:133],v202 offset:5120
ds_read_b64_tr_b16 a[134:135],v202 offset:5632
s_waitcnt lgkmcnt(8)
v_mfma_f32_32x32x16_bf16 v[112:127],a[116:119],v[4:7],v[112:127]
ds_read_b64_tr_b16 a[136:137],v202 offset:6144
ds_read_b64_tr_b16 a[138:139],v202 offset:6656
s_waitcnt lgkmcnt(8)
v_mfma_f32_32x32x16_bf16 v[112:127],a[120:123],v[8:11],v[112:127]
ds_read_b64_tr_b16 a[140:141],v202 offset:7168
ds_read_b64_tr_b16 a[142:143],v202 offset:7680
s_add_u32 s30,s101,29440
s_add_u32 m0,s60,59392
s_nop 0
buffer_load_dwordx4 v205,s[4:7],s30 offen lds
s_add_u32 s31,s59,36864
s_waitcnt lgkmcnt(8)
v_mfma_f32_32x32x16_bf16 v[112:127],a[124:127],v[12:15],v[112:127]
ds_read_b64_tr_b16 a[112:113],v202 offset:8192
ds_read_b64_tr_b16 a[114:115],v202 offset:8704
buffer_store_dwordx4 v[128:131],v211,s[8:11],s31 offen sc1
s_waitcnt lgkmcnt(8)
v_mfma_f32_32x32x16_bf16 v[112:127],a[128:131],v[16:19],v[112:127]
ds_read_b64_tr_b16 a[116:117],v202 offset:9216
ds_read_b64_tr_b16 a[118:119],v202 offset:9728
buffer_store_dwordx4 v[132:135],v211,s[8:11],s31 offen offset:1024 sc1
s_waitcnt lgkmcnt(8)
v_mfma_f32_32x32x16_bf16 v[112:127],a[132:135],v[20:23],v[112:127]
ds_read_b64_tr_b16 a[120:121],v202 offset:10240
ds_read_b64_tr_b16 a[122:123],v202 offset:10752
buffer_store_dwordx4 v[136:139],v211,s[8:11],s31 offen offset:2048 sc1
s_waitcnt lgkmcnt(8)
v_mfma_f32_32x32x16_bf16 v[112:127],a[136:139],v[24:27],v[112:127]
ds_read_b64_tr_b16 a[124:125],v202 offset:11264
ds_read_b64_tr_b16 a[126:127],v202 offset:11776
s_add_u32 s30,s101,43776
s_add_u32 m0,s60,60416
s_nop 0
buffer_load_dwordx4 v205,s[4:7],s30 offen lds
buffer_store_dwordx4 v[140:143],v211,s[8:11],s31 offen offset:3072 sc1
s_waitcnt lgkmcnt(8)
v_mfma_f32_32x32x16_bf16 v[112:127],a[140:143],v[28:31],v[112:127]
ds_read_b64_tr_b16 a[128:129],v202 offset:12288
ds_read_b64_tr_b16 a[130:131],v202 offset:12800
s_nop 1
s_waitcnt lgkmcnt(8)
v_mfma_f32_32x32x16_bf16 v[112:127],a[112:115],v[32:35],v[112:127]
ds_read_b64_tr_b16 a[132:133],v202 offset:13312
ds_read_b64_tr_b16 a[134:135],v202 offset:13824
ds_read_b128 v[128:131],v220 offset:3456
s_waitcnt lgkmcnt(9)
v_mfma_f32_32x32x16_bf16 v[112:127],a[116:119],v[36:39],v[112:127]
ds_read_b64_tr_b16 a[136:137],v202 offset:14336
ds_read_b64_tr_b16 a[138:139],v202 offset:14848
ds_read_b128 v[132:135],v220 offset:3488
s_waitcnt lgkmcnt(10)
v_mfma_f32_32x32x16_bf16 v[112:127],a[120:123],v[40:43],v[112:127]
ds_read_b64_tr_b16 a[140:141],v202 offset:15360
ds_read_b64_tr_b16 a[142:143],v202 offset:15872
s_add_u32 s30,s101,58112
s_add_u32 m0,s60,61440
s_nop 0
buffer_load_dwordx4 v205,s[4:7],s30 offen lds
ds_read_b128 v[136:139],v220 offset:3520
s_waitcnt lgkmcnt(11)
v_mfma_f32_32x32x16_bf16 v[112:127],a[124:127],v[44:47],v[112:127]
ds_read_b64_tr_b16 a[112:113],v202 offset:16384
ds_read_b64_tr_b16 a[114:115],v202 offset:16896
ds_read_b128 v[140:143],v220 offset:3552
s_waitcnt lgkmcnt(12)
v_mfma_f32_32x32x16_bf16 v[112:127],a[128:131],v[48:51],v[112:127]
ds_read_b64_tr_b16 a[116:117],v202 offset:17408
ds_read_b64_tr_b16 a[118:119],v202 offset:17920
s_waitcnt lgkmcnt(12)
v_mfma_f32_32x32x16_bf16 v[112:127],a[132:135],v[52:55],v[112:127]
ds_read_b64_tr_b16 a[120:121],v202 offset:18432
ds_read_b64_tr_b16 a[122:123],v202 offset:18944
s_waitcnt lgkmcnt(11)
v_mfma_f32_32x32x16_bf16 v[112:127],a[136:139],v[56:59],v[112:127]
ds_read_b64_tr_b16 a[124:125],v202 offset:19456
ds_read_b64_tr_b16 a[126:127],v202 offset:19968
s_add_u32 s30,s101,72448
s_add_u32 m0,s60,62464
s_nop 0
buffer_load_dwordx4 v205,s[4:7],s30 offen lds
s_waitcnt lgkmcnt(10)
v_mfma_f32_32x32x16_bf16 v[112:127],a[140:143],v[60:63],v[112:127]
ds_read_b64_tr_b16 a[128:129],v202 offset:20480
ds_read_b64_tr_b16 a[130:131],v202 offset:20992
s_waitcnt lgkmcnt(9)
v_mfma_f32_32x32x16_bf16 v[112:127],a[112:115],v[64:67],v[112:127]
ds_read_b64_tr_b16 a[132:133],v202 offset:21504
ds_read_b64_tr_b16 a[134:135],v202 offset:22016
s_waitcnt lgkmcnt(8)
v_mfma_f32_32x32x16_bf16 v[112:127],a[116:119],v[68:71],v[112:127]
ds_read_b64_tr_b16 a[136:137],v202 offset:22528
ds_read_b64_tr_b16 a[138:139],v202 offset:23040
s_waitcnt lgkmcnt(8)
v_mfma_f32_32x32x16_bf16 v[112:127],a[120:123],v[72:75],v[112:127]
ds_read_b64_tr_b16 a[140:141],v202 offset:23552
ds_read_b64_tr_b16 a[142:143],v202 offset:24064
s_add_u32 s30,s101,86784
s_add_u32 m0,s60,63488
s_nop 0
buffer_load_dwordx4 v205,s[4:7],s30 offen lds
s_waitcnt lgkmcnt(8)
v_mfma_f32_32x32x16_bf16 v[112:127],a[124:127],v[76:79],v[112:127]
ds_read_b64_tr_b16 a[112:113],v202 offset:24576
ds_read_b64_tr_b16 a[114:115],v202 offset:25088
s_waitcnt lgkmcnt(8)
v_mfma_f32_32x32x16_bf16 v[112:127],a[128:131],v[80:83],v[112:127]
ds_read_b64_tr_b16 a[116:117],v202 offset:25600
ds_read_b64_tr_b16 a[118:119],v202 offset:26112
s_waitcnt lgkmcnt(8)
v_mfma_f32_32x32x16_bf16 v[112:127],a[132:135],v[84:87],v[112:127]
ds_read_b64_tr_b16 a[120:121],v202 offset:26624
ds_read_b64_tr_b16 a[122:123],v202 offset:27136
s_waitcnt vmcnt(11)
s_barrier
s_waitcnt lgkmcnt(8)
v_mfma_f32_32x32x16_bf16 v[112:127],a[136:139],v[88:91],v[112:127]
ds_read_b64_tr_b16 a[124:125],v202 offset:27648
ds_read_b64_tr_b16 a[126:127],v202 offset:28160
s_add_u32 s30,s101,832
s_add_u32 m0,s60,86016
s_nop 0
buffer_load_dwordx4 v205,s[4:7],s30 offen lds
s_waitcnt lgkmcnt(8)
v_mfma_f32_32x32x16_bf16 v[112:127],a[140:143],v[92:95],v[112:127]
ds_read_b64_tr_b16 a[128:129],v202 offset:28672
ds_read_b64_tr_b16 a[130:131],v202 offset:29184
s_waitcnt lgkmcnt(8)
v_mfma_f32_32x32x16_bf16 v[112:127],a[112:115],v[96:99],v[112:127]
ds_read_b64_tr_b16 a[132:133],v202 offset:29696
ds_read_b64_tr_b16 a[134:135],v202 offset:30208
s_waitcnt lgkmcnt(8)
v_mfma_f32_32x32x16_bf16 v[112:127],a[116:119],v[100:103],v[112:127]
ds_read_b64_tr_b16 a[136:137],v202 offset:30720
ds_read_b64_tr_b16 a[138:139],v202 offset:31232
s_waitcnt lgkmcnt(8)
v_mfma_f32_32x32x16_bf16 v[112:127],a[120:123],v[104:107],v[112:127]
ds_read_b64_tr_b16 a[140:141],v202 offset:31744
ds_read_b64_tr_b16 a[142:143],v202 offset:32256
s_add_u32 s30,s101,15168
s_add_u32 m0,s60,87040
s_nop 0
buffer_load_dwordx4 v205,s[4:7],s30 offen lds
s_waitcnt lgkmcnt(8)
v_mfma_f32_32x32x16_bf16 v[112:127],a[124:127],v[108:111],v[112:127]
ds_read_b64_tr_b16 a[112:113],v202 offset:32768
ds_read_b64_tr_b16 a[114:115],v202 offset:33280
s_waitcnt lgkmcnt(8)
v_mfma_f32_32x32x16_bf16 v[128:143],a[128:131],v[0:3],v[128:143]
ds_read_b64_tr_b16 a[116:117],v202 offset:33792
ds_read_b64_tr_b16 a[118:119],v202 offset:34304
s_waitcnt lgkmcnt(8)
v_mfma_f32_32x32x16_bf16 v[128:143],a[132:135],v[4:7],v[128:143]
ds_read_b64_tr_b16 a[120:121],v202 offset:34816
ds_read_b64_tr_b16 a[122:123],v202 offset:35328
s_waitcnt lgkmcnt(8)
v_mfma_f32_32x32x16_bf16 v[128:143],a[136:139],v[8:11],v[128:143]
ds_read_b64_tr_b16 a[124:125],v202 offset:35840
ds_read_b64_tr_b16 a[126:127],v202 offset:36352
s_add_u32 s30,s101,29504
s_add_u32 m0,s60,88064
s_nop 0
buffer_load_dwordx4 v205,s[4:7],s30 offen lds
s_add_u32 s31,s59,40960
s_waitcnt lgkmcnt(8)
v_mfma_f32_32x32x16_bf16 v[128:143],a[140:143],v[12:15],v[128:143]
ds_read_b64_tr_b16 a[128:129],v202 offset:36864
ds_read_b64_tr_b16 a[130:131],v202 offset:37376
buffer_store_dwordx4 v[112:115],v211,s[8:11],s31 offen sc1
s_waitcnt lgkmcnt(8)
v_mfma_f32_32x32x16_bf16 v[128:143],a[112:115],v[16:19],v[128:143]
ds_read_b64_tr_b16 a[132:133],v202 offset:37888
ds_read_b64_tr_b16 a[134:135],v202 offset:38400
buffer_store_dwordx4 v[116:119],v211,s[8:11],s31 offen offset:1024 sc1
s_waitcnt lgkmcnt(8)
v_mfma_f32_32x32x16_bf16 v[128:143],a[116:119],v[20:23],v[128:143]
ds_read_b64_tr_b16 a[136:137],v202 offset:38912
ds_read_b64_tr_b16 a[138:139],v202 offset:39424
buffer_store_dwordx4 v[120:123],v211,s[8:11],s31 offen offset:2048 sc1
s_waitcnt lgkmcnt(8)
v_mfma_f32_32x32x16_bf16 v[128:143],a[120:123],v[24:27],v[128:143]
ds_read_b64_tr_b16 a[140:141],v202 offset:39936
ds_read_b64_tr_b16 a[142:143],v202 offset:40448
s_add_u32 s30,s101,43840
s_add_u32 m0,s60,89088
s_nop 0
buffer_load_dwordx4 v205,s[4:7],s30 offen lds
buffer_store_dwordx4 v[124:127],v211,s[8:11],s31 offen offset:3072 sc1
s_waitcnt lgkmcnt(8)
v_mfma_f32_32x32x16_bf16 v[128:143],a[124:127],v[28:31],v[128:143]
ds_read_b64_tr_b16 a[112:113],v202 offset:40960
ds_read_b64_tr_b16 a[114:115],v202 offset:41472
s_nop 1
s_waitcnt lgkmcnt(8)
v_mfma_f32_32x32x16_bf16 v[128:143],a[128:131],v[32:35],v[128:143]
ds_read_b64_tr_b16 a[116:117],v202 offset:41984
ds_read_b64_tr_b16 a[118:119],v202 offset:42496
ds_read_b128 v[112:115],v220 offset:3584
s_waitcnt lgkmcnt(9)
v_mfma_f32_32x32x16_bf16 v[128:143],a[132:135],v[36:39],v[128:143]
ds_read_b64_tr_b16 a[120:121],v202 offset:43008
ds_read_b64_tr_b16 a[122:123],v202 offset:43520
ds_read_b128 v[116:119],v220 offset:3616
s_waitcnt lgkmcnt(10)
v_mfma_f32_32x32x16_bf16 v[128:143],a[136:139],v[40:43],v[128:143]
ds_read_b64_tr_b16 a[124:125],v202 offset:44032
ds_read_b64_tr_b16 a[126:127],v202 offset:44544
s_add_u32 s30,s101,58176
s_add_u32 m0,s60,90112
s_nop 0
buffer_load_dwordx4 v205,s[4:7],s30 offen lds
ds_read_b128 v[120:123],v220 offset:3648
s_waitcnt lgkmcnt(11)
v_mfma_f32_32x32x16_bf16 v[128:143],a[140:143],v[44:47],v[128:143]
ds_read_b64_tr_b16 a[128:129],v202 offset:45056
ds_read_b64_tr_b16 a[130:131],v202 offset:45568
ds_read_b128 v[124:127],v220 offset:3680
s_waitcnt lgkmcnt(12)
v_mfma_f32_32x32x16_bf16 v[128:143],a[112:115],v[48:51],v[128:143]
ds_read_b64_tr_b16 a[132:133],v202 offset:46080
ds_read_b64_tr_b16 a[134:135],v202 offset:46592
s_waitcnt lgkmcnt(12)
v_mfma_f32_32x32x16_bf16 v[128:143],a[116:119],v[52:55],v[128:143]
ds_read_b64_tr_b16 a[136:137],v202 offset:47104
ds_read_b64_tr_b16 a[138:139],v202 offset:47616
s_waitcnt lgkmcnt(11)
v_mfma_f32_32x32x16_bf16 v[128:143],a[120:123],v[56:59],v[128:143]
ds_read_b64_tr_b16 a[140:141],v202 offset:48128
ds_read_b64_tr_b16 a[142:143],v202 offset:48640
s_add_u32 s30,s101,72512
s_add_u32 m0,s60,91136
s_nop 0
buffer_load_dwordx4 v205,s[4:7],s30 offen lds
s_waitcnt lgkmcnt(10)
v_mfma_f32_32x32x16_bf16 v[128:143],a[124:127],v[60:63],v[128:143]
ds_read_b64_tr_b16 a[112:113],v202 offset:49152
ds_read_b64_tr_b16 a[114:115],v202 offset:49664
s_waitcnt lgkmcnt(9)
v_mfma_f32_32x32x16_bf16 v[128:143],a[128:131],v[64:67],v[128:143]
ds_read_b64_tr_b16 a[116:117],v202 offset:50176
ds_read_b64_tr_b16 a[118:119],v202 offset:50688
s_waitcnt lgkmcnt(8)
v_mfma_f32_32x32x16_bf16 v[128:143],a[132:135],v[68:71],v[128:143]
ds_read_b64_tr_b16 a[120:121],v202 offset:51200
ds_read_b64_tr_b16 a[122:123],v202 offset:51712
s_waitcnt lgkmcnt(8)
v_mfma_f32_32x32x16_bf16 v[128:143],a[136:139],v[72:75],v[128:143]
ds_read_b64_tr_b16 a[124:125],v202 offset:52224
ds_read_b64_tr_b16 a[126:127],v202 offset:52736
s_add_u32 s30,s101,86848
s_add_u32 m0,s60,92160
s_nop 0
buffer_load_dwordx4 v205,s[4:7],s30 offen lds
s_waitcnt lgkmcnt(8)
v_mfma_f32_32x32x16_bf16 v[128:143],a[140:143],v[76:79],v[128:143]
ds_read_b64_tr_b16 a[128:129],v202 offset:53248
ds_read_b64_tr_b16 a[130:131],v202 offset:53760
s_waitcnt lgkmcnt(8)
v_mfma_f32_32x32x16_bf16 v[128:143],a[112:115],v[80:83],v[128:143]
ds_read_b64_tr_b16 a[132:133],v202 offset:54272
ds_read_b64_tr_b16 a[134:135],v202 offset:54784
s_waitcnt lgkmcnt(8)
v_mfma_f32_32x32x16_bf16 v[128:143],a[116:119],v[84:87],v[128:143]
ds_read_b64_tr_b16 a[136:137],v202 offset:55296
ds_read_b64_tr_b16 a[138:139],v202 offset:55808
s_waitcnt vmcnt(11)
s_barrier
s_waitcnt lgkmcnt(8)
v_mfma_f32_32x32x16_bf16 v[128:143],a[120:123],v[88:91],v[128:143]
ds_read_b64_tr_b16 a[140:141],v202 offset:56320
ds_read_b64_tr_b16 a[142:143],v202 offset:56832
s_waitcnt lgkmcnt(8)
v_mfma_f32_32x32x16_bf16 v[128:143],a[124:127],v[92:95],v[128:143]
ds_read_b64_tr_b16 a[112:113],v203 offset:0
ds_read_b64_tr_b16 a[114:115],v203 offset:512
s_waitcnt lgkmcnt(8)
v_mfma_f32_32x32x16_bf16 v[128:143],a[128:131],v[96:99],v[128:143]
ds_read_b64_tr_b16 a[116:117],v203 offset:1024
ds_read_b64_tr_b16 a[118:119],v203 offset:1536
s_waitcnt lgkmcnt(8)
v_mfma_f32_32x32x16_bf16 v[128:143],a[132:135],v[100:103],v[128:143]
ds_read_b64_tr_b16 a[120:121],v203 offset:2048
ds_read_b64_tr_b16 a[122:123],v203 offset:2560
s_waitcnt lgkmcnt(8)
v_mfma_f32_32x32x16_bf16 v[128:143],a[136:139],v[104:107],v[128:143]
ds_read_b64_tr_b16 a[124:125],v203 offset:3072
ds_read_b64_tr_b16 a[126:127],v203 offset:3584
s_waitcnt lgkmcnt(8)
v_mfma_f32_32x32x16_bf16 v[128:143],a[140:143],v[108:111],v[128:143]
ds_read_b64_tr_b16 a[128:129],v203 offset:4096
ds_read_b64_tr_b16 a[130:131],v203 offset:4608
s_waitcnt lgkmcnt(8)
v_mfma_f32_32x32x16_bf16 v[112:127],a[112:115],v[0:3],v[112:127]
ds_read_b64_tr_b16 a[132:133],v203 offset:5120
ds_read_b64_tr_b16 a[134:135],v203 offset:5632
s_waitcnt lgkmcnt(8)
v_mfma_f32_32x32x16_bf16 v[112:127],a[116:119],v[4:7],v[112:127]
ds_read_b64_tr_b16 a[136:137],v203 offset:6144
ds_read_b64_tr_b16 a[138:139],v203 offset:6656
s_waitcnt lgkmcnt(8)
v_mfma_f32_32x32x16_bf16 v[112:127],a[120:123],v[8:11],v[112:127]
ds_read_b64_tr_b16 a[140:141],v203 offset:7168
ds_read_b64_tr_b16 a[142:143],v203 offset:7680
s_add_u32 s31,s59,45056
s_waitcnt lgkmcnt(8)
v_mfma_f32_32x32x16_bf16 v[112:127],a[124:127],v[12:15],v[112:127]
ds_read_b64_tr_b16 a[112:113],v203 offset:8192
ds_read_b64_tr_b16 a[114:115],v203 offset:8704
buffer_store_dwordx4 v[128:131],v211,s[8:11],s31 offen sc1
s_waitcnt lgkmcnt(8)
v_mfma_f32_32x32x16_bf16 v[112:127],a[128:131],v[16:19],v[112:127]
ds_read_b64_tr_b16 a[116:117],v203 offset:9216
ds_read_b64_tr_b16 a[118:119],v203 offset:9728
buffer_store_dwordx4 v[132:135],v211,s[8:11],s31 offen offset:1024 sc1
s_waitcnt lgkmcnt(8)
v_mfma_f32_32x32x16_bf16 v[112:127],a[132:135],v[20:23],v[112:127]
ds_read_b64_tr_b16 a[120:121],v203 offset:10240
ds_read_b64_tr_b16 a[122:123],v203 offset:10752
buffer_store_dwordx4 v[136:139],v211,s[8:11],s31 offen offset:2048 sc1
s_waitcnt lgkmcnt(8)
v_mfma_f32_32x32x16_bf16 v[112:127],a[136:139],v[24:27],v[112:127]
ds_read_b64_tr_b16 a[124:125],v203 offset:11264
ds_read_b64_tr_b16 a[126:127],v203 offset:11776
buffer_store_dwordx4 v[140:143],v211,s[8:11],s31 offen offset:3072 sc1
s_waitcnt lgkmcnt(8)
v_mfma_f32_32x32x16_bf16 v[112:127],a[140:143],v[28:31],v[112:127]
ds_read_b64_tr_b16 a[128:129],v203 offset:12288
ds_read_b64_tr_b16 a[130:131],v203 offset:12800
s_nop 1
s_waitcnt lgkmcnt(8)
v_mfma_f32_32x32x16_bf16 v[112:127],a[112:115],v[32:35],v[112:127]
ds_read_b64_tr_b16 a[132:133],v203 offset:13312
ds_read_b64_tr_b16 a[134:135],v203 offset:13824
ds_read_b128 v[128:131],v220 offset:3712
s_waitcnt lgkmcnt(9)
v_mfma_f32_32x32x16_bf16 v[112:127],a[116:119],v[36:39],v[112:127]
ds_read_b64_tr_b16 a[136:137],v203 offset:14336
ds_read_b64_tr_b16 a[138:139],v203 offset:14848
ds_read_b128 v[132:135],v220 offset:3744
s_waitcnt lgkmcnt(10)
v_mfma_f32_32x32x16_bf16 v[112:127],a[120:123],v[40:43],v[112:127]
ds_read_b64_tr_b16 a[140:141],v203 offset:15360
ds_read_b64_tr_b16 a[142:143],v203 offset:15872
ds_read_b128 v[136:139],v220 offset:3776
s_waitcnt lgkmcnt(11)
v_mfma_f32_32x32x16_bf16 v[112:127],a[124:127],v[44:47],v[112:127]
ds_read_b64_tr_b16 a[112:113],v203 offset:16384
ds_read_b64_tr_b16 a[114:115],v203 offset:16896
ds_read_b128 v[140:143],v220 offset:3808
s_waitcnt lgkmcnt(12)
v_mfma_f32_32x32x16_bf16 v[112:127],a[128:131],v[48:51],v[112:127]
ds_read_b64_tr_b16 a[116:117],v203 offset:17408
ds_read_b64_tr_b16 a[118:119],v203 offset:17920
s_waitcnt lgkmcnt(12)
v_mfma_f32_32x32x16_bf16 v[112:127],a[132:135],v[52:55],v[112:127]
ds_read_b64_tr_b16 a[120:121],v203 offset:18432
ds_read_b64_tr_b16 a[122:123],v203 offset:18944
s_waitcnt lgkmcnt(11)
v_mfma_f32_32x32x16_bf16 v[112:127],a[136:139],v[56:59],v[112:127]
ds_read_b64_tr_b16 a[124:125],v203 offset:19456
ds_read_b64_tr_b16 a[126:127],v203 offset:19968
s_waitcnt lgkmcnt(10)
v_mfma_f32_32x32x16_bf16 v[112:127],a[140:143],v[60:63],v[112:127]
ds_read_b64_tr_b16 a[128:129],v203 offset:20480
ds_read_b64_tr_b16 a[130:131],v203 offset:20992
s_waitcnt lgkmcnt(9)
v_mfma_f32_32x32x16_bf16 v[112:127],a[112:115],v[64:67],v[112:127]
ds_read_b64_tr_b16 a[132:133],v203 offset:21504
ds_read_b64_tr_b16 a[134:135],v203 offset:22016
s_waitcnt lgkmcnt(8)
v_mfma_f32_32x32x16_bf16 v[112:127],a[116:119],v[68:71],v[112:127]
ds_read_b64_tr_b16 a[136:137],v203 offset:22528
ds_read_b64_tr_b16 a[138:139],v203 offset:23040
s_waitcnt lgkmcnt(8)
v_mfma_f32_32x32x16_bf16 v[112:127],a[120:123],v[72:75],v[112:127]
ds_read_b64_tr_b16 a[140:141],v203 offset:23552
ds_read_b64_tr_b16 a[142:143],v203 offset:24064
s_waitcnt lgkmcnt(8)
v_mfma_f32_32x32x16_bf16 v[112:127],a[124:127],v[76:79],v[112:127]
ds_read_b64_tr_b16 a[112:113],v203 offset:24576
ds_read_b64_tr_b16 a[114:115],v203 offset:25088
s_waitcnt lgkmcnt(8)
v_mfma_f32_32x32x16_bf16 v[112:127],a[128:131],v[80:83],v[112:127]
ds_read_b64_tr_b16 a[116:117],v203 offset:25600
ds_read_b64_tr_b16 a[118:119],v203 offset:26112
s_waitcnt lgkmcnt(8)
v_mfma_f32_32x32x16_bf16 v[112:127],a[132:135],v[84:87],v[112:127]
ds_read_b64_tr_b16 a[120:121],v203 offset:26624
ds_read_b64_tr_b16 a[122:123],v203 offset:27136
s_waitcnt vmcnt(4)
s_barrier
s_waitcnt lgkmcnt(8)
v_mfma_f32_32x32x16_bf16 v[112:127],a[136:139],v[88:91],v[112:127]
ds_read_b64_tr_b16 a[124:125],v203 offset:27648
ds_read_b64_tr_b16 a[126:127],v203 offset:28160
s_waitcnt lgkmcnt(8)
v_mfma_f32_32x32x16_bf16 v[112:127],a[140:143],v[92:95],v[112:127]
ds_read_b64_tr_b16 a[128:129],v203 offset:28672
ds_read_b64_tr_b16 a[130:131],v203 offset:29184
s_waitcnt lgkmcnt(8)
v_mfma_f32_32x32x16_bf16 v[112:127],a[112:115],v[96:99],v[112:127]
ds_read_b64_tr_b16 a[132:133],v203 offset:29696
ds_read_b64_tr_b16 a[134:135],v203 offset:30208
s_waitcnt lgkmcnt(8)
v_mfma_f32_32x32x16_bf16 v[112:127],a[116:119],v[100:103],v[112:127]
ds_read_b64_tr_b16 a[136:137],v203 offset:30720
ds_read_b64_tr_b16 a[138:139],v203 offset:31232
s_waitcnt lgkmcnt(8)
v_mfma_f32_32x32x16_bf16 v[112:127],a[120:123],v[104:107],v[112:127]
ds_read_b64_tr_b16 a[140:141],v203 offset:31744
ds_read_b64_tr_b16 a[142:143],v203 offset:32256
s_waitcnt lgkmcnt(8)
v_mfma_f32_32x32x16_bf16 v[112:127],a[124:127],v[108:111],v[112:127]
ds_read_b64_tr_b16 a[112:113],v203 offset:32768
ds_read_b64_tr_b16 a[114:115],v203 offset:33280
s_waitcnt lgkmcnt(8)
v_mfma_f32_32x32x16_bf16 v[128:143],a[128:131],v[0:3],v[128:143]
ds_read_b64_tr_b16 a[116:117],v203 offset:33792
ds_read_b64_tr_b16 a[118:119],v203 offset:34304
s_waitcnt lgkmcnt(8)
v_mfma_f32_32x32x16_bf16 v[128:143],a[132:135],v[4:7],v[128:143]
ds_read_b64_tr_b16 a[120:121],v203 offset:34816
ds_read_b64_tr_b16 a[122:123],v203 offset:35328
s_waitcnt lgkmcnt(8)
v_mfma_f32_32x32x16_bf16 v[128:143],a[136:139],v[8:11],v[128:143]
ds_read_b64_tr_b16 a[124:125],v203 offset:35840
ds_read_b64_tr_b16 a[126:127],v203 offset:36352
s_add_u32 s31,s59,49152
s_waitcnt lgkmcnt(8)
v_mfma_f32_32x32x16_bf16 v[128:143],a[140:143],v[12:15],v[128:143]
ds_read_b64_tr_b16 a[128:129],v203 offset:36864
ds_read_b64_tr_b16 a[130:131],v203 offset:37376
buffer_store_dwordx4 v[112:115],v211,s[8:11],s31 offen sc1
s_waitcnt lgkmcnt(8)
v_mfma_f32_32x32x16_bf16 v[128:143],a[112:115],v[16:19],v[128:143]
ds_read_b64_tr_b16 a[132:133],v203 offset:37888
ds_read_b64_tr_b16 a[134:135],v203 offset:38400
buffer_store_dwordx4 v[116:119],v211,s[8:11],s31 offen offset:1024 sc1
s_waitcnt lgkmcnt(8)
v_mfma_f32_32x32x16_bf16 v[128:143],a[116:119],v[20:23],v[128:143]
ds_read_b64_tr_b16 a[136:137],v203 offset:38912
ds_read_b64_tr_b16 a[138:139],v203 offset:39424
buffer_store_dwordx4 v[120:123],v211,s[8:11],s31 offen offset:2048 sc1
s_waitcnt lgkmcnt(8)
v_mfma_f32_32x32x16_bf16 v[128:143],a[120:123],v[24:27],v[128:143]
ds_read_b64_tr_b16 a[140:141],v203 offset:39936
ds_read_b64_tr_b16 a[142:143],v203 offset:40448
buffer_store_dwordx4 v[124:127],v211,s[8:11],s31 offen offset:3072 sc1
s_waitcnt lgkmcnt(8)
v_mfma_f32_32x32x16_bf16 v[128:143],a[124:127],v[28:31],v[128:143]
ds_read_b64_tr_b16 a[112:113],v203 offset:40960
ds_read_b64_tr_b16 a[114:115],v203 offset:41472
s_nop 1
s_waitcnt lgkmcnt(8)
v_mfma_f32_32x32x16_bf16 v[128:143],a[128:131],v[32:35],v[128:143]
ds_read_b64_tr_b16 a[116:117],v203 offset:41984
ds_read_b64_tr_b16 a[118:119],v203 offset:42496
s_waitcnt lgkmcnt(8)
v_mfma_f32_32x32x16_bf16 v[128:143],a[132:135],v[36:39],v[128:143]
ds_read_b64_tr_b16 a[120:121],v203 offset:43008
ds_read_b64_tr_b16 a[122:123],v203 offset:43520
s_waitcnt lgkmcnt(8)
v_mfma_f32_32x32x16_bf16 v[128:143],a[136:139],v[40:43],v[128:143]
ds_read_b64_tr_b16 a[124:125],v203 offset:44032
ds_read_b64_tr_b16 a[126:127],v203 offset:44544
s_waitcnt lgkmcnt(8)
v_mfma_f32_32x32x16_bf16 v[128:143],a[140:143],v[44:47],v[128:143]
ds_read_b64_tr_b16 a[128:129],v203 offset:45056
ds_read_b64_tr_b16 a[130:131],v203 offset:45568
s_waitcnt lgkmcnt(8)
v_mfma_f32_32x32x16_bf16 v[128:143],a[112:115],v[48:51],v[128:143]
ds_read_b64_tr_b16 a[132:133],v203 offset:46080
ds_read_b64_tr_b16 a[134:135],v203 offset:46592
s_waitcnt lgkmcnt(8)
v_mfma_f32_32x32x16_bf16 v[128:143],a[116:119],v[52:55],v[128:143]
ds_read_b64_tr_b16 a[136:137],v203 offset:47104
ds_read_b64_tr_b16 a[138:139],v203 offset:47616
s_waitcnt lgkmcnt(8)
v_mfma_f32_32x32x16_bf16 v[128:143],a[120:123],v[56:59],v[128:143]
ds_read_b64_tr_b16 a[140:141],v203 offset:48128
ds_read_b64_tr_b16 a[142:143],v203 offset:48640
s_waitcnt lgkmcnt(8)
v_mfma_f32_32x32x16_bf16 v[128:143],a[124:127],v[60:63],v[128:143]
ds_read_b64_tr_b16 a[112:113],v203 offset:49152
ds_read_b64_tr_b16 a[114:115],v203 offset:49664
s_waitcnt lgkmcnt(8)
v_mfma_f32_32x32x16_bf16 v[128:143],a[128:131],v[64:67],v[128:143]
ds_read_b64_tr_b16 a[116:117],v203 offset:50176
ds_read_b64_tr_b16 a[118:119],v203 offset:50688
s_waitcnt lgkmcnt(8)
v_mfma_f32_32x32x16_bf16 v[128:143],a[132:135],v[68:71],v[128:143]
ds_read_b64_tr_b16 a[120:121],v203 offset:51200
ds_read_b64_tr_b16 a[122:123],v203 offset:51712
s_waitcnt lgkmcnt(8)
v_mfma_f32_32x32x16_bf16 v[128:143],a[136:139],v[72:75],v[128:143]
ds_read_b64_tr_b16 a[124:125],v203 offset:52224
ds_read_b64_tr_b16 a[126:127],v203 offset:52736
s_waitcnt lgkmcnt(8)
v_mfma_f32_32x32x16_bf16 v[128:143],a[140:143],v[76:79],v[128:143]
ds_read_b64_tr_b16 a[128:129],v203 offset:53248
ds_read_b64_tr_b16 a[130:131],v203 offset:53760
s_waitcnt lgkmcnt(8)
v_mfma_f32_32x32x16_bf16 v[128:143],a[112:115],v[80:83],v[128:143]
ds_read_b64_tr_b16 a[132:133],v203 offset:54272
ds_read_b64_tr_b16 a[134:135],v203 offset:54784
s_waitcnt lgkmcnt(8)
v_mfma_f32_32x32x16_bf16 v[128:143],a[116:119],v[84:87],v[128:143]
ds_read_b64_tr_b16 a[136:137],v203 offset:55296
ds_read_b64_tr_b16 a[138:139],v203 offset:55808
s_waitcnt lgkmcnt(8)
v_mfma_f32_32x32x16_bf16 v[128:143],a[120:123],v[88:91],v[128:143]
ds_read_b64_tr_b16 a[140:141],v203 offset:56320
ds_read_b64_tr_b16 a[142:143],v203 offset:56832
s_waitcnt lgkmcnt(8)
v_mfma_f32_32x32x16_bf16 v[128:143],a[124:127],v[92:95],v[128:143]
s_waitcnt lgkmcnt(6)
v_mfma_f32_32x32x16_bf16 v[128:143],a[128:131],v[96:99],v[128:143]
s_waitcnt lgkmcnt(4)
v_mfma_f32_32x32x16_bf16 v[128:143],a[132:135],v[100:103],v[128:143]
s_waitcnt lgkmcnt(2)
v_mfma_f32_32x32x16_bf16 v[128:143],a[136:139],v[104:107],v[128:143]
s_waitcnt lgkmcnt(0)
v_mfma_f32_32x32x16_bf16 v[128:143],a[140:143],v[108:111],v[128:143]
s_add_u32 s31,s59,53248
s_nop 10
buffer_store_dwordx4 v[128:131],v211,s[8:11],s31 offen sc1
buffer_store_dwordx4 v[132:135],v211,s[8:11],s31 offen offset:1024 sc1
buffer_store_dwordx4 v[136:139],v211,s[8:11],s31 offen offset:2048 sc1
buffer_store_dwordx4 v[140:143],v211,s[8:11],s31 offen offset:3072 sc1
s_nop 1
s_lshl_b32 s30,s97,7
s_lshl_b32 s31,s98,2
s_add_u32 s30,s30,s31
s_add_u32 s30,s30,50599936
s_waitcnt vmcnt(0)
s_barrier
s_cmp_lg_u32 s24,0
s_cbranch_scc1 sf_241
v_mov_b32 v248,1
s_mov_b64 exec,1
buffer_store_dword v248,v199,s[8:11],s30 offen sc1
s_mov_b64 exec,-1
sf_241:
s_branch L_next
L_codeend:
.section .rodata,"a"
.p2align 6
.amdhsa_kernel gated_mix__memory_aug_recurrent_mem_tr__mixer_channel_mlp__prompt_kernel
  .amdhsa_next_free_vgpr 512
  .amdhsa_next_free_sgpr 102
  .amdhsa_accum_offset 256
  .amdhsa_group_segment_fixed_size 0
  .amdhsa_kernarg_size 128
  .amdhsa_user_sgpr_count 2
  .amdhsa_user_sgpr_kernarg_segment_ptr 1
  .amdhsa_system_sgpr_workgroup_id_x 1
.end_amdhsa_kernel
.p2align 2
.type L_table,@object
L_table:
.long 32768,32880,32992,12288,12289,12290,12304,16384,16400,16416,16432,16448,16464,16480,12305,12306
.long 12320,12321,12322,12336,12337,16385,16401,16417,16433,16449,16465,16481,12338,12352,12353,12354
.long 36864,36870,36876,16386,16402,16418,16434,16450,16466,16482,32784,32896,33008,16,32,4096
.long 17,16387,16403,16419,16435,16451,16467,16483,33,4097,18,34,8192,8193,8194,16388
.long 16404,16420,16436,16452,16468,16484,36865,36871,36877,32800,32912,4098,19,16389,16405,16421
.long 16437,16453,16469,16485,35,4099,20,36,4100,21,8195,16390,16406,16422,16438,16454
.long 16470,16486,36866,36872,32816,32928,37,4101,22,16391,16407,16423,16439,16455,16471,16487
.long 38,4102,23,39,4103,8208,8209,16392,16408,16424,16440,16456,16472,16488,8210,8211
.long 36867,36873,32832,32944,24,16393,16409,16425,16441,16457,16473,16489,40,4104,25,41
.long 4105,26,42,16394,16410,16426,16442,16458,16474,16490,8224,8225,8226,8227,8240,8241
.long 36868,16395,16411,16427,16443,16459,16475,16491,36874,32848,32960,4106,27,43,4107,16396
.long 16412,16428,16444,16460,16476,16492,28,44,4108,29,8242,8243,8256,16397,16413,16429
.long 16445,16461,16477,16493,36869,36875,32864,32976,45,4109,30,16398,16414,16430,16446,16462
.long 16478,16494,46,4110,31,47,4111,8257,8258,16399,16415,16431,16447,16463,16479,16495
.long 8259,8272,8273,8274,8275,8288,8289,8290,8291,8304,8305,8306,8307,48,49,50
.long 51,52,53,54,55,56,57,58,59,60,61,62,63,4112,4113,4114
.long 4115,4116,4117,4118,4119,4120,4121,4122,4123,4124,4125,4126,4127,4128,4129,4130
.long 4131,4132,4133,4134,4135,4136,4137,4138,4139,4140,4141,4142,4143,64,65,66
.long 67,68,69,70,71,72,73,74,75,76,77,78,79,8320,8321,8322
.long 8323,12291,12292,12293,12294,12307,12308,12309,12310,12323,12324,12325,12326,12339,12340,12341
.long 12342,80,81,82,83,84,85,86,87,88,89,90,91,92,93,94
.long 95,8336,8337,8338,8339,12355,12356,12357,12358,12371,12372,12373,12374,12387,12388,12389
.long 12390,12403,12404,12405,12406,96,97,98,99,100,101,102,103,104,105,106
.long 107,108,109,110,111,8352,8353,8354,8355,12419,12420,12421,12422,12435,12436,12437
.long 12438,12451,12452,12453,12454,12467,12468,12469,12470,112,113,114,115,116,117,118
.long 119,120,121,122,123,124,125,126,127,8368,8369,8370,8371,4144,4145,4146
.long 4147,4148,4149,4150,4151,4152,4153,4154,4155,4156,4157,4158,4159,12483,12484,12485
.long 12486,12499,12500,12501,12502,12515,12516,12517,12518,12531,12532,12533,12534,128,129,130
.long 131,132,133,134,135,136,137,138,139,140,141,142,143,8384,8385,8386
.long 8387,4160,4161,4162,4163,4164,4165,4166,4167,4168,4169,4170,4171,4172,4173,4174
.long 4175,12547,12548,12549,12550,12563,12564,12565,12566,12579,12580,12581,12582,12595,12596,12597
.long 12598,144,145,146,147,148,149,150,151,152,153,154,155,156,157,158
.long 159,8400,8401,8402,8403,4176,4177,4178,4179,4180,4181,4182,4183,4184,4185,4186
.long 4187,4188,4189,4190,4191,12611,12612,12613,12614,12627,12628,12629,12630,12643,12644,12645
.long 12646,12659,12660,12661,12662,160,161,162,163,164,165,166,167,168,169,170
.long 171,172,173,174,175,8416,8417,8418,8419,4192,4193,4194,4195,4196,4197,4198
.long 4199,4200,4201,4202,4203,4204,4205,4206,4207,12675,12676,12677,12678,12691,12692,12693
.long 12694,12707,12708,12709,12710,12723,12724,12725,12726,176,177,178,179,180,181,182
.long 183,184,185,186,187,188,189,190,191,8432,8433,8434,8435,4208,4209,4210
.long 4211,4212,4213,4214,4215,4216,4217,4218,4219,4220,4221,4222,4223,12739,12740,12741
.long 12742,12755,12756,12757,12758,12771,12772,12773,12774,12787,12788,12789,12790,192,193,194
.long 195,196,197,198,199,200,201,202,203,204,205,206,207,4224,4225,4226
.long 4227,4228,4229,4230,4231,4232,4233,4234,4235,4236,4237,4238,4239,12803,12804,12805
.long 12806,12819,12820,12821,12822,12835,12836,12837,12838,12851,12852,12853,12854,208,209,210
.long 211,212,213,214,215,216,217,218,219,220,221,222,223,4240,4241,4242
.long 4243,4244,4245,4246,4247,4248,4249,4250,4251,4252,4253,4254,4255,12867,12868,12869
.long 12870,12883,12884,12885,12886,12899,12900,12901,12902,12915,12916,12917,12918,224,225,226
.long 227,228,229,230,231,232,233,234,235,236,237,238,239,4256,4257,4258
.long 4259,4260,4261,4262,4263,4264,4265,4266,4267,4268,4269,4270,4271,12931,12932,12933
.long 12934,12947,12948,12949,12950,12963,12964,12965,12966,12979,12980,12981,12982,240,241,242
.long 243,244,245,246,247,248,249,250,251,252,253,254,255,4272,4273,4274
.long 4275,4276,4277,4278,4279,4280,4281,4282,4283,4284,4285,4286,4287,12995,12996,12997
.long 12998,13011,13012,13013,13014,13027,13028,13029,13030,13043,13044,13045,13046,4288,4289,4290
.long 4291,4292,4293,4294,4295,4296,4297,4298,4299,4300,4301,4302,4303,13059,13060,13061
.long 13062,13075,13076,13077,13078,13091,13092,13093,13094,13107,13108,13109,13110,4304,4305,4306
.long 4307,4308,4309,4310,4311,4312,4313,4314,4315,4316,4317,4318,4319,13123,13124,13125
.long 13126,13139,13140,13141,13142,13155,13156,13157,13158,13171,13172,13173,13174,4320,4321,4322
.long 4323,4324,4325,4326,4327,4328,4329,4330,4331,4332,4333,4334,4335,13187,13188,13189
.long 13190,13203,13204,13205,13206,13219,13220,13221,13222,13235,13236,13237,13238,5360,5361,5362
.long 5363,5364,5365,5366,5367,5368,5369,5370,5371,5372,5373,5374,5375,14275,14276,14277
.long 14278,14291,14292,14293,14294,14307,14308,14309,14310,14323,14324,14325,14326,12368,12369,12370
.long 12384,12385,12386,12400,12401,12402,12416,12417,12418,12432,12433,12434,12448,12449,12450,12464
.long 12465,12466,12480,12481,12482,12496,12497,12498,12512,12513,12514,12528,12529,12530,12544,12545
.long 12546,12560,12561,12562,12576,12577,12578,12592,12593,12594,12608,12609,12610,12624,12625,12626
.long 12640,12641,12642,12656,12657,12658,12672,12673,12674,12688,12689,12690,12704,12705,12706,12720
.long 12721,12722,12736,12737,12738,12752,12753,12754,12768,12769,12770,12784,12785,12786,12800,12801
.long 12802,12816,12817,12818,12832,12833,12834,12848,12849,12850,12864,12865,12866,12880,12881,12882
.long 12896,12897,12898,12912,12913,12914,12928,12929,12930,12944,12945,12946,12960,12961,12962,12976
.long 12977,12978,12992,12993,12994,13008,13009,13010,13024,13025,13026,13040,13041,13042,13056,13057
.long 13058,13072,13073,13074,13088,13089,13090,13104,13105,13106,13120,13121,13122,13136,13137,13138
.long 13152,13153,13154,13168,13169,13170,13184,13185,13186,13200,13201,13202,13216,13217,13218,13232
.long 13233,13234,13248,13249,13250,13264,13265,13266,14304,14305,14306,14320,14321,14322
.size L_table, 4600
```
